```python
import torch

def _softmax(x, axis=-1):
    return torch.softmax(x, dim=axis)
def _gelu(x):
    return torch.nn.functional.gelu(x, approximate="tanh")
def _silu(x):
    return torch.nn.functional.silu(x)
def _sigmoid(x):
    return torch.sigmoid(x)
def _layernorm(x, axis=-1, eps=1e-5):
    m = x.mean(dim=axis, keepdim=True)
    v = x.var(dim=axis, keepdim=True, unbiased=False)
    return (x - m) / torch.sqrt(v + eps)
def _scatter_add(tgt, idx, src, axis=0):
    return tgt.clone().index_add_(axis, idx, src)
def _segment_sum(src, seg, n):
    out = torch.zeros((n,) + src.shape[1:], dtype=src.dtype)
    return out.index_add_(0, seg, src)
def _pad(x, pw):
    flat = tuple(v for pair in reversed(pw) for v in pair)
    return torch.nn.functional.pad(x, flat)

kernel_name = 'standalone__mha_block_cached__near_ridge'

def setup_inputs():

    _w = (lambda a: (lambda t: t.to(torch.bfloat16) if t.is_floating_point() else t)(torch.as_tensor(a)))
    B, Sq, D = 8, 240, 640
    H, Sk, Dh = 32, 1024, 128
    return {
        "x": _w((lambda *s: torch.randn(*s, dtype=torch.bfloat16) * 0.8)(B, Sq, D)),
        "k_cache": _w((lambda *s: torch.randn(*s, dtype=torch.bfloat16) * 0.8)(B, H, Sk, Dh)),
        "v_cache": _w((lambda *s: torch.randn(*s, dtype=torch.bfloat16) * 0.05)(B, H, Sk, Dh)),
        "wq": _w((lambda *s: torch.randn(*s, dtype=torch.bfloat16) * 0.8)(D, H * Dh) * (D ** -0.5)),
        "wo": _w((lambda *s: torch.randn(*s, dtype=torch.bfloat16) * 0.05)(H * Dh, D) * ((H * Dh) ** -0.5)),
    }

def reference(x, k_cache, v_cache, wq, wo):
    B, Sq, D = x.shape
    H, Dh = 32, 128
    q = (lambda x, *d: x.permute(*d))((x @ wq).reshape(B, Sq, H, Dh), 0, 2, 1, 3)
    scores = torch.einsum("bhqd,bhkd->bhqk", q, k_cache) * (Dh ** -0.5)
    p = _softmax(scores, axis=-1)
    o = torch.einsum("bhqk,bhkd->bhqd", p, v_cache)
    return (lambda x, *d: x.permute(*d))(o, 0, 2, 1, 3).reshape(B, Sq, H * Dh) @ wo
```

```asm
; @launch grid=(256,1,1) block=(256,1,1) lds=163840
.amdgcn_target "amdgcn-amd-amdhsa--gfx950"
.text
.globl standalone__mha_block_cached__near_ridge_kernel
.p2align 8
.type standalone__mha_block_cached__near_ridge_kernel,@function
standalone__mha_block_cached__near_ridge_kernel:
  s_cmp_ge_u32 s2, 256
  s_cbranch_scc1 L_end
  s_mov_b32 s35, 0
  s_load_dwordx4 s[4:7], s[0:1], 0
  s_load_dwordx4 s[44:47], s[0:1], 16
  v_lshrrev_b32 v2, 6, v0
  v_and_b32 v1, 63, v0
  v_readfirstlane_b32 s3, v2
  s_and_b32 s50, s2, 7
  s_lshr_b32 s51, s2, 3
  s_and_b32 s52, s51, 3
  s_lshr_b32 s53, s51, 2
  s_bfe_u32 s28, s2, 0x10000
  s_lshl2_add_u32 s28, s28, s52
  s_lshr_b32 s54, s50, 1
  s_lshl3_add_u32 s29, s54, s53
  s_add_u32 s52, s52, s53
  s_and_b32 s52, s52, 1
  s_mul_i32 s32, s52, 5
  s_add_u32 s54, s54, s50
  s_and_b32 s54, s54, 1
  s_lshl1_add_u32 s32, s54, s32
  s_lshl_b32 s30, s32, 7
  s_lshl_b32 s31, s32, 19
  s_lshl_b32 s40, s3, 12
  s_lshl1_add_u32 s36, s40, 131072
  s_add_u32 s39, s40, 81920
  v_lshrrev_b32 v3, 4, v1
  v_lshrrev_b32 v4, 3, v1
  v_and_b32 v5, 7, v1
  v_and_b32 v2, 15, v1
  s_mul_i32 s52, s3, 81920
  v_mul_u32_u24 v8, 1280, v4
  v_xor_b32 v9, v3, v5
  v_lshlrev_b32 v9, 4, v9
  v_add3_u32 v192, v9, s52, v8
  v_xor_b32 v17, 64, v192
  v_add_u32 v193, 9216, v17
  v_add_u32 v194, 18432, v192
  v_add_u32 v195, 27648, v17
  v_add_u32 v196, 40960, v192
  v_add_u32 v197, 50176, v17
  v_add_u32 v198, 59392, v192
  v_add_u32 v199, 68608, v17
  s_lshl_b32 s52, s3, 17
  v_lshlrev_b32 v8, 13, v3
  v_and_b32 v9, 1, v3
  v_lshrrev_b32 v10, 1, v3
  v_lshl_or_b32 v9, v10, 2, v9
  v_xor_b32 v9, v9, v2
  v_lshlrev_b32 v9, 4, v9
  v_add3_u32 v200, v9, s52, v8
  v_xor_b32 v17, 128, v200
  v_add_u32 v201, 31744, v200
  v_add_u32 v202, 63488, v17
  v_add_u32 v203, 95232, v17
  s_mul_i32 s52, s28, 307200
  s_lshl_b32 s53, s29, 8
  s_mov_b32 s10, 307200
  s_mov_b32 s11, 0x20000
  s_mov_b32 s14, 5234944
  s_mov_b32 s15, 0x20000
  s_waitcnt lgkmcnt(0)
  s_add_u32 s8, s4, s52
  s_addc_u32 s9, s5, 0
  s_add_u32 s12, s46, s53
  s_addc_u32 s13, s47, 0
  s_mov_b32 m0, s36
  s_nop 0
  buffer_load_dwordx4 v192, s[8:11], s30 offen lds
  buffer_load_dwordx4 v193, s[8:11], s30 offen offset:1024 lds
  buffer_load_dwordx4 v194, s[8:11], s30 offen offset:2048 lds
  buffer_load_dwordx4 v195, s[8:11], s30 offen offset:3072 lds
  s_add_u32 m0, s36, 4096
  s_nop 0
  buffer_load_dwordx4 v196, s[8:11], s30 offen lds
  buffer_load_dwordx4 v197, s[8:11], s30 offen offset:1024 lds
  buffer_load_dwordx4 v198, s[8:11], s30 offen offset:2048 lds
  buffer_load_dwordx4 v199, s[8:11], s30 offen offset:3072 lds
  s_add_u32 m0, s39, 32768
  s_nop 0
  buffer_load_dwordx4 v200, s[12:15], s31 offen lds
  buffer_load_dwordx4 v201, s[12:15], s31 offen offset:1024 lds
  buffer_load_dwordx4 v202, s[12:15], s31 offen offset:2048 lds
  buffer_load_dwordx4 v203, s[12:15], s31 offen offset:3072 lds
  s_add_u32 s32, s32, 1
  s_cmp_eq_u32 s32, 10
  s_cselect_b32 s32, 0, s32
  s_lshl_b32 s30, s32, 7
  s_lshl_b32 s31, s32, 19
  s_load_dwordx2 s[48:49], s[0:1], 56
  s_load_dwordx4 s[56:59], s[0:1], 32
  s_load_dwordx2 s[46:47], s[0:1], 48
  s_getpc_b64 s[54:55]
L_cbase:
  s_lshl2_add_u32 s52, s51, s3
  s_mul_i32 s52, s52, 5
  v_min_u32 v18, 4, v1
  v_add_u32 v18, s52, v18
  v_lshlrev_b32 v18, 7, v18
  v_min_u32 v18, L_exact-L_cbase, v18
  v_mov_b32 v19, s55
  v_add_co_u32 v18, vcc, s54, v18
  s_nop 1
  v_addc_co_u32 v19, vcc, 0, v19, vcc
  global_load_dword v20, v[18:19], off
  s_mov_b32 s33, s40
  s_and_b32 s52, s3, 1
  s_lshl_b32 s52, s52, 13
  s_cmp_ge_u32 s3, 2
  s_mov_b32 s53, 65536
  s_cselect_b32 s37, 16384, s53
  s_mov_b32 s53, 32768
  s_cselect_b32 s38, 49152, s53
  s_add_u32 s37, s37, s52
  s_add_u32 s38, s38, s52
  v_bfe_u32 v6, v1, 2, 2
  v_and_b32 v7, 3, v1
  v_lshrrev_b32 v9, 1, v2
  v_or_b32 v8, 0, v3
  v_xor_b32 v8, v8, v9
  v_lshlrev_b32 v8, 4, v8
  v_lshl_add_u32 v8, v2, 7, v8
  v_add_u32 v204, s36, v8
  v_add_u32 v206, s37, v8
  v_add_u32 v208, s38, v8
  v_or_b32 v8, 4, v3
  v_xor_b32 v8, v8, v9
  v_lshlrev_b32 v8, 4, v8
  v_lshl_add_u32 v8, v2, 7, v8
  v_add_u32 v205, s36, v8
  v_add_u32 v207, s37, v8
  v_add_u32 v209, s38, v8
  v_lshrrev_b32 v11, 1, v7
  v_and_b32 v12, 1, v7
  v_lshlrev_b32 v12, 3, v12
  v_and_b32 v9, 1, v6
  v_lshrrev_b32 v10, 1, v6
  v_lshl_or_b32 v9, v10, 2, v9
  v_and_b32 v10, 1, v3
  v_lshl_or_b32 v9, v10, 3, v9
  v_lshl_or_b32 v9, v11, 1, v9
  v_lshl_add_u32 v13, v3, 3, v6
  v_lshl_add_u32 v13, v13, 8, v12
  v_add_u32 v13, 81920, v13
  v_xor_b32 v8, 0, v9
  v_lshl_add_u32 v210, v8, 4, v13
  v_xor_b32 v8, 1, v9
  v_lshl_add_u32 v211, v8, 4, v13
  v_xor_b32 v8, 4, v9
  v_lshl_add_u32 v212, v8, 4, v13
  v_xor_b32 v8, 5, v9
  v_lshl_add_u32 v213, v8, 4, v13
  v_xor_b32 v8, 8, v9
  v_lshl_add_u32 v214, v8, 4, v13
  v_xor_b32 v8, 9, v9
  v_lshl_add_u32 v215, v8, 4, v13
  v_xor_b32 v8, 12, v9
  v_lshl_add_u32 v216, v8, 4, v13
  v_xor_b32 v8, 13, v9
  v_lshl_add_u32 v217, v8, 4, v13
  s_mov_b32 m0, s37
  s_nop 0
  buffer_load_dwordx4 v192, s[8:11], s30 offen lds
  buffer_load_dwordx4 v193, s[8:11], s30 offen offset:1024 lds
  buffer_load_dwordx4 v194, s[8:11], s30 offen offset:2048 lds
  buffer_load_dwordx4 v195, s[8:11], s30 offen offset:3072 lds
  s_add_u32 m0, s37, 4096
  s_nop 0
  buffer_load_dwordx4 v196, s[8:11], s30 offen lds
  buffer_load_dwordx4 v197, s[8:11], s30 offen offset:1024 lds
  buffer_load_dwordx4 v198, s[8:11], s30 offen offset:2048 lds
  buffer_load_dwordx4 v199, s[8:11], s30 offen offset:3072 lds
  s_add_u32 m0, s39, 0
  s_nop 0
  buffer_load_dwordx4 v200, s[12:15], s31 offen lds
  buffer_load_dwordx4 v201, s[12:15], s31 offen offset:1024 lds
  buffer_load_dwordx4 v202, s[12:15], s31 offen offset:2048 lds
  buffer_load_dwordx4 v203, s[12:15], s31 offen offset:3072 lds
  s_add_u32 s32, s32, 1
  s_cmp_eq_u32 s32, 10
  s_cselect_b32 s32, 0, s32
  s_lshl_b32 s30, s32, 7
  s_lshl_b32 s31, s32, 19
  s_waitcnt vmcnt(13) lgkmcnt(0)
  s_barrier
  ds_read_b128 a[224:227], v204
  ds_read_b128 a[240:243], v205
  ds_read_b64_tr_b16 a[160:161], v210 offset:32768
  ds_read_b64_tr_b16 a[162:163], v210 offset:33792
  ds_read_b64_tr_b16 a[192:193], v210 offset:40960
  ds_read_b64_tr_b16 a[194:195], v210 offset:41984
  ds_read_b64_tr_b16 a[164:165], v211 offset:32768
  ds_read_b64_tr_b16 a[166:167], v211 offset:33792
  ds_read_b64_tr_b16 a[196:197], v211 offset:40960
  ds_read_b64_tr_b16 a[198:199], v211 offset:41984
  ds_read_b64_tr_b16 a[168:169], v212 offset:32768
  ds_read_b64_tr_b16 a[170:171], v212 offset:33792
  ds_read_b64_tr_b16 a[200:201], v212 offset:40960
  ds_read_b64_tr_b16 a[202:203], v212 offset:41984
  s_waitcnt lgkmcnt(8)
  s_cmp_eq_u32 s3, 3
  s_cbranch_scc1 L_w3
L_sec0:
  v_mfma_f32_16x16x32_bf16 v[32:35], a[160:163], a[224:227], 0
  ds_read_b64_tr_b16 a[172:173], v213 offset:32768
  ds_read_b64_tr_b16 a[174:175], v213 offset:33792
  v_mfma_f32_16x16x32_bf16 v[32:35], a[192:195], a[240:243], v[32:35]
  s_waitcnt lgkmcnt(6)
  ds_read_b64_tr_b16 a[204:205], v213 offset:40960
  ds_read_b64_tr_b16 a[206:207], v213 offset:41984
  v_mfma_f32_16x16x32_bf16 v[36:39], a[164:167], a[224:227], 0
  ds_read_b64_tr_b16 a[176:177], v214 offset:32768
  ds_read_b64_tr_b16 a[178:179], v214 offset:33792
  v_mfma_f32_16x16x32_bf16 v[36:39], a[196:199], a[240:243], v[36:39]
  s_waitcnt lgkmcnt(6)
  ds_read_b64_tr_b16 a[208:209], v214 offset:40960
  ds_read_b64_tr_b16 a[210:211], v214 offset:41984
  v_mfma_f32_16x16x32_bf16 v[40:43], a[168:171], a[224:227], 0
  ds_read_b64_tr_b16 a[180:181], v215 offset:32768
  ds_read_b64_tr_b16 a[182:183], v215 offset:33792
  v_mfma_f32_16x16x32_bf16 v[40:43], a[200:203], a[240:243], v[40:43]
  s_waitcnt lgkmcnt(6)
  ds_read_b64_tr_b16 a[212:213], v215 offset:40960
  ds_read_b64_tr_b16 a[214:215], v215 offset:41984
  v_mfma_f32_16x16x32_bf16 v[44:47], a[172:175], a[224:227], 0
  ds_read_b64_tr_b16 a[184:185], v216 offset:32768
  ds_read_b64_tr_b16 a[186:187], v216 offset:33792
  v_mfma_f32_16x16x32_bf16 v[44:47], a[204:207], a[240:243], v[44:47]
  s_mov_b32 m0, s38
  s_waitcnt lgkmcnt(6)
  ds_read_b64_tr_b16 a[216:217], v216 offset:40960
  ds_read_b64_tr_b16 a[218:219], v216 offset:41984
  v_mfma_f32_16x16x32_bf16 v[48:51], a[176:179], a[224:227], 0
  ds_read_b64_tr_b16 a[188:189], v217 offset:32768
  ds_read_b64_tr_b16 a[190:191], v217 offset:33792
  buffer_load_dwordx4 v192, s[8:11], s30 offen lds
  v_mfma_f32_16x16x32_bf16 v[48:51], a[208:211], a[240:243], v[48:51]
  s_waitcnt lgkmcnt(6)
  ds_read_b64_tr_b16 a[220:221], v217 offset:40960
  ds_read_b64_tr_b16 a[222:223], v217 offset:41984
  v_mfma_f32_16x16x32_bf16 v[52:55], a[180:183], a[224:227], 0
  ds_read_b128 a[228:231], v204 offset:2048
  ds_read_b128 a[244:247], v205 offset:2048
  v_mfma_f32_16x16x32_bf16 v[52:55], a[212:215], a[240:243], v[52:55]
  s_waitcnt lgkmcnt(6)
  ds_read_b128 a[232:235], v204 offset:4096
  ds_read_b128 a[248:251], v205 offset:4096
  v_mfma_f32_16x16x32_bf16 v[56:59], a[184:187], a[224:227], 0
  ds_read_b128 a[236:239], v204 offset:6144
  ds_read_b128 a[252:255], v205 offset:6144
  buffer_load_dwordx4 v193, s[8:11], s30 offen offset:1024 lds
  v_mfma_f32_16x16x32_bf16 v[56:59], a[216:219], a[240:243], v[56:59]
  s_waitcnt lgkmcnt(6)
  v_mfma_f32_16x16x32_bf16 v[60:63], a[188:191], a[224:227], 0
  v_mfma_f32_16x16x32_bf16 v[60:63], a[220:223], a[240:243], v[60:63]
  s_waitcnt lgkmcnt(0)
  v_mfma_f32_16x16x32_bf16 v[64:67], a[160:163], a[228:231], 0
  buffer_load_dwordx4 v194, s[8:11], s30 offen offset:2048 lds
  v_mfma_f32_16x16x32_bf16 v[64:67], a[192:195], a[244:247], v[64:67]
  v_mfma_f32_16x16x32_bf16 v[68:71], a[164:167], a[228:231], 0
  v_mfma_f32_16x16x32_bf16 v[68:71], a[196:199], a[244:247], v[68:71]
  v_mfma_f32_16x16x32_bf16 v[72:75], a[168:171], a[228:231], 0
  buffer_load_dwordx4 v195, s[8:11], s30 offen offset:3072 lds
  v_mfma_f32_16x16x32_bf16 v[72:75], a[200:203], a[244:247], v[72:75]
  v_mfma_f32_16x16x32_bf16 v[76:79], a[172:175], a[228:231], 0
  s_waitcnt lgkmcnt(0)
  s_barrier
  v_mfma_f32_16x16x32_bf16 v[76:79], a[204:207], a[244:247], v[76:79]
  s_add_u32 m0, s38, 4096
  v_mfma_f32_16x16x32_bf16 v[80:83], a[176:179], a[228:231], 0
  buffer_load_dwordx4 v196, s[8:11], s30 offen lds
  v_mfma_f32_16x16x32_bf16 v[80:83], a[208:211], a[244:247], v[80:83]
  v_mfma_f32_16x16x32_bf16 v[84:87], a[180:183], a[228:231], 0
  v_mfma_f32_16x16x32_bf16 v[84:87], a[212:215], a[244:247], v[84:87]
  v_mfma_f32_16x16x32_bf16 v[88:91], a[184:187], a[228:231], 0
  buffer_load_dwordx4 v197, s[8:11], s30 offen offset:1024 lds
  v_mfma_f32_16x16x32_bf16 v[88:91], a[216:219], a[244:247], v[88:91]
  v_mfma_f32_16x16x32_bf16 v[92:95], a[188:191], a[228:231], 0
  v_mfma_f32_16x16x32_bf16 v[92:95], a[220:223], a[244:247], v[92:95]
  v_mfma_f32_16x16x32_bf16 v[96:99], a[160:163], a[232:235], 0
  v_mfma_f32_16x16x32_bf16 v[96:99], a[192:195], a[248:251], v[96:99]
  buffer_load_dwordx4 v198, s[8:11], s30 offen offset:2048 lds
  v_mfma_f32_16x16x32_bf16 v[100:103], a[164:167], a[232:235], 0
  v_mfma_f32_16x16x32_bf16 v[100:103], a[196:199], a[248:251], v[100:103]
  v_mfma_f32_16x16x32_bf16 v[104:107], a[168:171], a[232:235], 0
  v_mfma_f32_16x16x32_bf16 v[104:107], a[200:203], a[248:251], v[104:107]
  buffer_load_dwordx4 v199, s[8:11], s30 offen offset:3072 lds
  v_mfma_f32_16x16x32_bf16 v[108:111], a[172:175], a[232:235], 0
  v_mfma_f32_16x16x32_bf16 v[108:111], a[204:207], a[248:251], v[108:111]
  v_mfma_f32_16x16x32_bf16 v[112:115], a[176:179], a[232:235], 0
  s_add_u32 m0, s39, 16384
  s_waitcnt vmcnt(8)
  s_barrier
  v_mfma_f32_16x16x32_bf16 v[112:115], a[208:211], a[248:251], v[112:115]
  ds_read_b128 a[64:67], v206
  ds_read_b128 a[80:83], v207
  buffer_load_dwordx4 v200, s[12:15], s31 offen lds
  v_mfma_f32_16x16x32_bf16 v[116:119], a[180:183], a[232:235], 0
  ds_read_b64_tr_b16 a[0:1], v210 offset:0
  ds_read_b64_tr_b16 a[2:3], v210 offset:1024
  v_mfma_f32_16x16x32_bf16 v[116:119], a[212:215], a[248:251], v[116:119]
  ds_read_b64_tr_b16 a[32:33], v210 offset:8192
  ds_read_b64_tr_b16 a[34:35], v210 offset:9216
  v_mfma_f32_16x16x32_bf16 v[120:123], a[184:187], a[232:235], 0
  ds_read_b64_tr_b16 a[4:5], v211 offset:0
  ds_read_b64_tr_b16 a[6:7], v211 offset:1024
  v_mfma_f32_16x16x32_bf16 v[120:123], a[216:219], a[248:251], v[120:123]
  ds_read_b64_tr_b16 a[36:37], v211 offset:8192
  ds_read_b64_tr_b16 a[38:39], v211 offset:9216
  buffer_load_dwordx4 v201, s[12:15], s31 offen offset:1024 lds
  v_mfma_f32_16x16x32_bf16 v[124:127], a[188:191], a[232:235], 0
  ds_read_b64_tr_b16 a[8:9], v212 offset:0
  ds_read_b64_tr_b16 a[10:11], v212 offset:1024
  v_mfma_f32_16x16x32_bf16 v[124:127], a[220:223], a[248:251], v[124:127]
  ds_read_b64_tr_b16 a[40:41], v212 offset:8192
  ds_read_b64_tr_b16 a[42:43], v212 offset:9216
  v_mfma_f32_16x16x32_bf16 v[128:131], a[160:163], a[236:239], 0
  ds_read_b64_tr_b16 a[12:13], v213 offset:0
  ds_read_b64_tr_b16 a[14:15], v213 offset:1024
  v_mfma_f32_16x16x32_bf16 v[128:131], a[192:195], a[252:255], v[128:131]
  ds_read_b64_tr_b16 a[44:45], v213 offset:8192
  ds_read_b64_tr_b16 a[46:47], v213 offset:9216
  buffer_load_dwordx4 v202, s[12:15], s31 offen offset:2048 lds
  v_mfma_f32_16x16x32_bf16 v[132:135], a[164:167], a[236:239], 0
  ds_read_b64_tr_b16 a[16:17], v214 offset:0
  ds_read_b64_tr_b16 a[18:19], v214 offset:1024
  v_mfma_f32_16x16x32_bf16 v[132:135], a[196:199], a[252:255], v[132:135]
  ds_read_b64_tr_b16 a[48:49], v214 offset:8192
  ds_read_b64_tr_b16 a[50:51], v214 offset:9216
  v_mfma_f32_16x16x32_bf16 v[136:139], a[168:171], a[236:239], 0
  ds_read_b64_tr_b16 a[20:21], v215 offset:0
  ds_read_b64_tr_b16 a[22:23], v215 offset:1024
  v_mfma_f32_16x16x32_bf16 v[136:139], a[200:203], a[252:255], v[136:139]
  ds_read_b64_tr_b16 a[52:53], v215 offset:8192
  ds_read_b64_tr_b16 a[54:55], v215 offset:9216
  buffer_load_dwordx4 v203, s[12:15], s31 offen offset:3072 lds
  v_mfma_f32_16x16x32_bf16 v[140:143], a[172:175], a[236:239], 0
  s_add_u32 s32, s32, 1
  ds_read_b64_tr_b16 a[24:25], v216 offset:0
  ds_read_b64_tr_b16 a[26:27], v216 offset:1024
  v_mfma_f32_16x16x32_bf16 v[140:143], a[204:207], a[252:255], v[140:143]
  s_cmp_eq_u32 s32, 10
  s_cselect_b32 s32, 0, s32
  ds_read_b64_tr_b16 a[56:57], v216 offset:8192
  ds_read_b64_tr_b16 a[58:59], v216 offset:9216
  v_mfma_f32_16x16x32_bf16 v[144:147], a[176:179], a[236:239], 0
  s_lshl_b32 s30, s32, 7
  ds_read_b64_tr_b16 a[28:29], v217 offset:0
  ds_read_b64_tr_b16 a[30:31], v217 offset:1024
  v_mfma_f32_16x16x32_bf16 v[144:147], a[208:211], a[252:255], v[144:147]
  s_lshl_b32 s31, s32, 19
  s_mov_b32 m0, s36
  ds_read_b64_tr_b16 a[60:61], v217 offset:8192
  ds_read_b64_tr_b16 a[62:63], v217 offset:9216
  v_mfma_f32_16x16x32_bf16 v[148:151], a[180:183], a[236:239], 0
  ds_read_b128 a[68:71], v206 offset:2048
  ds_read_b128 a[84:87], v207 offset:2048
  buffer_load_dwordx4 v192, s[8:11], s30 offen lds
  v_mfma_f32_16x16x32_bf16 v[148:151], a[212:215], a[252:255], v[148:151]
  ds_read_b128 a[72:75], v206 offset:4096
  ds_read_b128 a[88:91], v207 offset:4096
  v_mfma_f32_16x16x32_bf16 v[152:155], a[184:187], a[236:239], 0
  ds_read_b128 a[76:79], v206 offset:6144
  ds_read_b128 a[92:95], v207 offset:6144
  v_mfma_f32_16x16x32_bf16 v[152:155], a[216:219], a[252:255], v[152:155]
  v_mfma_f32_16x16x32_bf16 v[156:159], a[188:191], a[236:239], 0
  buffer_load_dwordx4 v193, s[8:11], s30 offen offset:1024 lds
  v_mfma_f32_16x16x32_bf16 v[156:159], a[220:223], a[252:255], v[156:159]
  s_waitcnt lgkmcnt(0)
  s_barrier
  v_mfma_f32_16x16x32_bf16 v[32:35], a[0:3], a[64:67], v[32:35]
  v_mfma_f32_16x16x32_bf16 v[32:35], a[32:35], a[80:83], v[32:35]
  v_mfma_f32_16x16x32_bf16 v[36:39], a[4:7], a[64:67], v[36:39]
  buffer_load_dwordx4 v194, s[8:11], s30 offen offset:2048 lds
  s_lshl_b32 s52, s28, 5
  v_mfma_f32_16x16x32_bf16 v[36:39], a[36:39], a[80:83], v[36:39]
  s_add_u32 s52, s52, s29
  v_mfma_f32_16x16x32_bf16 v[40:43], a[8:11], a[64:67], v[40:43]
  s_lshl_b32 s52, s52, 7
  v_mfma_f32_16x16x32_bf16 v[40:43], a[40:43], a[80:83], v[40:43]
  s_add_u32 s52, s52, 25165824
  v_mfma_f32_16x16x32_bf16 v[44:47], a[12:15], a[64:67], v[44:47]
  buffer_load_dwordx4 v195, s[8:11], s30 offen offset:3072 lds
  v_mov_b32 v18, s52
  v_mfma_f32_16x16x32_bf16 v[44:47], a[44:47], a[80:83], v[44:47]
  v_mov_b32 v19, 0
  s_mov_b64 exec, 1
  global_store_dword v18, v19, s[48:49] sc1
  s_mov_b64 exec, -1
  v_mfma_f32_16x16x32_bf16 v[48:51], a[16:19], a[64:67], v[48:51]
  v_and_b32 v0, 31, v1
  v_lshlrev_b32 v0, 3, v0
  v_mfma_f32_16x16x32_bf16 v[48:51], a[48:51], a[80:83], v[48:51]
  s_add_u32 m0, s36, 4096
  s_lshl_b32 s52, s28, 5
  v_mfma_f32_16x16x32_bf16 v[52:55], a[20:23], a[64:67], v[52:55]
  buffer_load_dwordx4 v196, s[8:11], s30 offen lds
  s_add_u32 s52, s52, s29
  v_mfma_f32_16x16x32_bf16 v[52:55], a[52:55], a[80:83], v[52:55]
  s_lshl_b32 s52, s52, 18
  v_mfma_f32_16x16x32_bf16 v[56:59], a[24:27], a[64:67], v[56:59]
  s_add_u32 s16, s6, s52
  s_addc_u32 s17, s7, 0
  v_mfma_f32_16x16x32_bf16 v[56:59], a[56:59], a[80:83], v[56:59]
  s_mov_b32 s18, 262144
  v_mfma_f32_16x16x32_bf16 v[60:63], a[28:31], a[64:67], v[60:63]
  buffer_load_dwordx4 v197, s[8:11], s30 offen offset:1024 lds
  s_mov_b32 s19, 0x20000
  v_mfma_f32_16x16x32_bf16 v[60:63], a[60:63], a[80:83], v[60:63]
  s_add_u32 s20, s44, s52
  s_addc_u32 s21, s45, 0
  v_mfma_f32_16x16x32_bf16 v[64:67], a[0:3], a[68:71], v[64:67]
  s_mov_b32 s22, 262144
  v_mfma_f32_16x16x32_bf16 v[64:67], a[32:35], a[84:87], v[64:67]
  s_mov_b32 s23, 0x20000
  v_mfma_f32_16x16x32_bf16 v[68:71], a[4:7], a[68:71], v[68:71]
  buffer_load_dwordx4 v198, s[8:11], s30 offen offset:2048 lds
  s_mul_i32 s52, s28, 1966080
  v_mfma_f32_16x16x32_bf16 v[68:71], a[36:39], a[84:87], v[68:71]
  s_add_u32 s24, s48, s52
  s_addc_u32 s25, s49, 0
  v_mfma_f32_16x16x32_bf16 v[72:75], a[8:11], a[68:71], v[72:75]
  s_mov_b32 s26, 1966080
  v_mfma_f32_16x16x32_bf16 v[72:75], a[40:43], a[84:87], v[72:75]
  s_mov_b32 s27, 0x20000
  v_mfma_f32_16x16x32_bf16 v[76:79], a[12:15], a[68:71], v[76:79]
  buffer_load_dwordx4 v199, s[8:11], s30 offen offset:3072 lds
  v_lshlrev_b32 v10, 8, v3
  v_mfma_f32_16x16x32_bf16 v[76:79], a[44:47], a[84:87], v[76:79]
  v_add_u32 v9, 0, v3
  v_xor_b32 v9, v9, v2
  v_mfma_f32_16x16x32_bf16 v[80:83], a[16:19], a[68:71], v[80:83]
  v_lshl_add_u32 v236, v9, 4, v10
  v_add_u32 v9, 4, v3
  v_mfma_f32_16x16x32_bf16 v[80:83], a[48:51], a[84:87], v[80:83]
  s_add_u32 m0, s39, 32768
  v_xor_b32 v9, v9, v2
  v_lshl_add_u32 v237, v9, 4, v10
  v_mfma_f32_16x16x32_bf16 v[84:87], a[20:23], a[68:71], v[84:87]
  buffer_load_dwordx4 v200, s[12:15], s31 offen lds
  v_add_u32 v9, 8, v3
  v_mfma_f32_16x16x32_bf16 v[84:87], a[52:55], a[84:87], v[84:87]
  v_xor_b32 v9, v9, v2
  v_lshl_add_u32 v238, v9, 4, v10
  v_mfma_f32_16x16x32_bf16 v[88:91], a[24:27], a[68:71], v[88:91]
  v_add_u32 v9, 12, v3
  v_xor_b32 v9, v9, v2
  v_mfma_f32_16x16x32_bf16 v[88:91], a[56:59], a[84:87], v[88:91]
  v_lshl_add_u32 v239, v9, 4, v10
  v_add_u32 v9, 0, v3
  v_mfma_f32_16x16x32_bf16 v[92:95], a[28:31], a[68:71], v[92:95]
  buffer_load_dwordx4 v201, s[12:15], s31 offen offset:1024 lds
  v_lshlrev_b32 v9, 1, v9
  v_mfma_f32_16x16x32_bf16 v[92:95], a[60:63], a[84:87], v[92:95]
  v_xor_b32 v9, v9, v2
  v_lshl_add_u32 v240, v9, 4, v10
  v_mfma_f32_16x16x32_bf16 v[96:99], a[0:3], a[72:75], v[96:99]
  v_add_u32 v9, 4, v3
  v_lshlrev_b32 v9, 1, v9
  v_mfma_f32_16x16x32_bf16 v[96:99], a[32:35], a[88:91], v[96:99]
  v_xor_b32 v9, v9, v2
  v_lshl_add_u32 v241, v9, 4, v10
  v_mfma_f32_16x16x32_bf16 v[100:103], a[4:7], a[72:75], v[100:103]
  buffer_load_dwordx4 v202, s[12:15], s31 offen offset:2048 lds
  v_and_b32 v10, 1, v3
  v_mfma_f32_16x16x32_bf16 v[100:103], a[36:39], a[88:91], v[100:103]
  v_lshl_or_b32 v9, v10, 2, v6
  v_lshl_or_b32 v9, v9, 1, v11
  v_mfma_f32_16x16x32_bf16 v[104:107], a[8:11], a[72:75], v[104:107]
  v_lshl_add_u32 v14, v3, 2, v6
  v_lshl_add_u32 v14, v14, 8, v12
  v_mfma_f32_16x16x32_bf16 v[104:107], a[40:43], a[88:91], v[104:107]
  v_add_u32 v14, 65536, v14
  v_xor_b32 v8, 0, v9
  v_mfma_f32_16x16x32_bf16 v[108:111], a[12:15], a[72:75], v[108:111]
  buffer_load_dwordx4 v203, s[12:15], s31 offen offset:3072 lds
  v_lshl_add_u32 v228, v8, 4, v14
  v_mfma_f32_16x16x32_bf16 v[108:111], a[44:47], a[88:91], v[108:111]
  s_add_u32 s32, s32, 1
  v_xor_b32 v8, 2, v9
  v_lshl_add_u32 v229, v8, 4, v14
  v_mfma_f32_16x16x32_bf16 v[112:115], a[16:19], a[72:75], v[112:115]
  s_cmp_eq_u32 s32, 10
  s_cselect_b32 s32, 0, s32
  s_waitcnt vmcnt(13)
  s_barrier
  v_mfma_f32_16x16x32_bf16 v[112:115], a[48:51], a[88:91], v[112:115]
  s_lshl_b32 s30, s32, 7
  ds_read_b128 v[160:163], v208
  ds_read_b128 v[176:179], v209
  v_mfma_f32_16x16x32_bf16 v[116:119], a[20:23], a[72:75], v[116:119]
  s_mov_b32 m0, s37
  s_lshl_b32 s31, s32, 19
  ds_read_b64_tr_b16 a[96:97], v210 offset:16384
  ds_read_b64_tr_b16 a[98:99], v210 offset:17408
  v_mfma_f32_16x16x32_bf16 v[116:119], a[52:55], a[88:91], v[116:119]
  ds_read_b64_tr_b16 a[128:129], v210 offset:24576
  ds_read_b64_tr_b16 a[130:131], v210 offset:25600
  buffer_load_dwordx4 v192, s[8:11], s30 offen lds
  v_mfma_f32_16x16x32_bf16 v[120:123], a[24:27], a[72:75], v[120:123]
  ds_read_b64_tr_b16 a[100:101], v211 offset:16384
  ds_read_b64_tr_b16 a[102:103], v211 offset:17408
  v_mfma_f32_16x16x32_bf16 v[120:123], a[56:59], a[88:91], v[120:123]
  ds_read_b64_tr_b16 a[132:133], v211 offset:24576
  ds_read_b64_tr_b16 a[134:135], v211 offset:25600
  v_mfma_f32_16x16x32_bf16 v[124:127], a[28:31], a[72:75], v[124:127]
  ds_read_b64_tr_b16 a[104:105], v212 offset:16384
  ds_read_b64_tr_b16 a[106:107], v212 offset:17408
  v_mfma_f32_16x16x32_bf16 v[124:127], a[60:63], a[88:91], v[124:127]
  ds_read_b64_tr_b16 a[136:137], v212 offset:24576
  ds_read_b64_tr_b16 a[138:139], v212 offset:25600
  buffer_load_dwordx4 v193, s[8:11], s30 offen offset:1024 lds
  v_mfma_f32_16x16x32_bf16 v[128:131], a[0:3], a[76:79], v[128:131]
  ds_read_b64_tr_b16 a[108:109], v213 offset:16384
  ds_read_b64_tr_b16 a[110:111], v213 offset:17408
  v_mfma_f32_16x16x32_bf16 v[128:131], a[32:35], a[92:95], v[128:131]
  ds_read_b64_tr_b16 a[140:141], v213 offset:24576
  ds_read_b64_tr_b16 a[142:143], v213 offset:25600
  v_mfma_f32_16x16x32_bf16 v[132:135], a[4:7], a[76:79], v[132:135]
  ds_read_b64_tr_b16 a[112:113], v214 offset:16384
  ds_read_b64_tr_b16 a[114:115], v214 offset:17408
  v_mfma_f32_16x16x32_bf16 v[132:135], a[36:39], a[92:95], v[132:135]
  ds_read_b64_tr_b16 a[144:145], v214 offset:24576
  ds_read_b64_tr_b16 a[146:147], v214 offset:25600
  buffer_load_dwordx4 v194, s[8:11], s30 offen offset:2048 lds
  v_mfma_f32_16x16x32_bf16 v[136:139], a[8:11], a[76:79], v[136:139]
  ds_read_b64_tr_b16 a[116:117], v215 offset:16384
  ds_read_b64_tr_b16 a[118:119], v215 offset:17408
  v_mfma_f32_16x16x32_bf16 v[136:139], a[40:43], a[92:95], v[136:139]
  ds_read_b64_tr_b16 a[148:149], v215 offset:24576
  ds_read_b64_tr_b16 a[150:151], v215 offset:25600
  v_mfma_f32_16x16x32_bf16 v[140:143], a[12:15], a[76:79], v[140:143]
  ds_read_b64_tr_b16 a[120:121], v216 offset:16384
  ds_read_b64_tr_b16 a[122:123], v216 offset:17408
  v_mfma_f32_16x16x32_bf16 v[140:143], a[44:47], a[92:95], v[140:143]
  ds_read_b64_tr_b16 a[152:153], v216 offset:24576
  ds_read_b64_tr_b16 a[154:155], v216 offset:25600
  buffer_load_dwordx4 v195, s[8:11], s30 offen offset:3072 lds
  v_mfma_f32_16x16x32_bf16 v[144:147], a[16:19], a[76:79], v[144:147]
  ds_read_b64_tr_b16 a[124:125], v217 offset:16384
  ds_read_b64_tr_b16 a[126:127], v217 offset:17408
  v_mfma_f32_16x16x32_bf16 v[144:147], a[48:51], a[92:95], v[144:147]
  ds_read_b64_tr_b16 a[156:157], v217 offset:24576
  ds_read_b64_tr_b16 a[158:159], v217 offset:25600
  v_mfma_f32_16x16x32_bf16 v[148:151], a[20:23], a[76:79], v[148:151]
  s_add_u32 m0, s37, 4096
  ds_read_b128 v[164:167], v208 offset:2048
  ds_read_b128 v[180:183], v209 offset:2048
  v_mfma_f32_16x16x32_bf16 v[148:151], a[52:55], a[92:95], v[148:151]
  ds_read_b128 v[168:171], v208 offset:4096
  ds_read_b128 v[184:187], v209 offset:4096
  buffer_load_dwordx4 v196, s[8:11], s30 offen lds
  v_mfma_f32_16x16x32_bf16 v[152:155], a[24:27], a[76:79], v[152:155]
  ds_read_b128 v[172:175], v208 offset:6144
  ds_read_b128 v[188:191], v209 offset:6144
  v_mfma_f32_16x16x32_bf16 v[152:155], a[56:59], a[92:95], v[152:155]
  v_xor_b32 v8, 4, v9
  v_lshl_add_u32 v230, v8, 4, v14
  v_mfma_f32_16x16x32_bf16 v[156:159], a[28:31], a[76:79], v[156:159]
  v_xor_b32 v8, 6, v9
  v_lshl_add_u32 v231, v8, 4, v14
  v_mfma_f32_16x16x32_bf16 v[156:159], a[60:63], a[92:95], v[156:159]
  buffer_load_dwordx4 v197, s[8:11], s30 offen offset:1024 lds
  s_waitcnt lgkmcnt(0)
  s_barrier
  v_mfma_f32_16x16x32_bf16 v[32:35], a[96:99], v[160:163], v[32:35]
  v_xor_b32 v8, 8, v9
  v_lshl_add_u32 v232, v8, 4, v14
  v_mfma_f32_16x16x32_bf16 v[32:35], a[128:131], v[176:179], v[32:35]
  v_xor_b32 v8, 10, v9
  v_lshl_add_u32 v233, v8, 4, v14
  v_mfma_f32_16x16x32_bf16 v[36:39], a[100:103], v[160:163], v[36:39]
  v_xor_b32 v8, 12, v9
  v_lshl_add_u32 v234, v8, 4, v14
  v_mfma_f32_16x16x32_bf16 v[36:39], a[132:135], v[176:179], v[36:39]
  buffer_load_dwordx4 v198, s[8:11], s30 offen offset:2048 lds
  v_xor_b32 v8, 14, v9
  v_mfma_f32_16x16x32_bf16 v[40:43], a[104:107], v[160:163], v[40:43]
  v_lshl_add_u32 v235, v8, 4, v14
  v_or_b32 v8, 0, v3
  v_mfma_f32_16x16x32_bf16 v[40:43], a[136:139], v[176:179], v[40:43]
  v_xor_b32 v8, v8, v2
  v_lshlrev_b32 v8, 4, v8
  v_mfma_f32_16x16x32_bf16 v[44:47], a[108:111], v[160:163], v[44:47]
  v_lshl_add_u32 v224, v2, 8, v8
  v_or_b32 v8, 4, v3
  v_mfma_f32_16x16x32_bf16 v[44:47], a[140:143], v[176:179], v[44:47]
  buffer_load_dwordx4 v199, s[8:11], s30 offen offset:3072 lds
  v_xor_b32 v8, v8, v2
  v_mfma_f32_16x16x32_bf16 v[48:51], a[112:115], v[160:163], v[48:51]
  v_lshlrev_b32 v8, 4, v8
  v_lshl_add_u32 v225, v2, 8, v8
  v_mfma_f32_16x16x32_bf16 v[48:51], a[144:147], v[176:179], v[48:51]
  v_or_b32 v8, 8, v3
  v_xor_b32 v8, v8, v2
  v_mfma_f32_16x16x32_bf16 v[52:55], a[116:119], v[160:163], v[52:55]
  s_add_u32 m0, s39, 0
  v_lshlrev_b32 v8, 4, v8
  v_lshl_add_u32 v226, v2, 8, v8
  v_mfma_f32_16x16x32_bf16 v[52:55], a[148:151], v[176:179], v[52:55]
  buffer_load_dwordx4 v200, s[12:15], s31 offen lds
  v_or_b32 v8, 12, v3
  v_mfma_f32_16x16x32_bf16 v[56:59], a[120:123], v[160:163], v[56:59]
  v_xor_b32 v8, v8, v2
  v_lshlrev_b32 v8, 4, v8
  v_mfma_f32_16x16x32_bf16 v[56:59], a[152:155], v[176:179], v[56:59]
  v_lshl_add_u32 v227, v2, 8, v8
  v_mov_b32 v242, 0xff800000
  v_mfma_f32_16x16x32_bf16 v[60:63], a[124:127], v[160:163], v[60:63]
  v_mov_b32 v243, 0xff800000
  v_mov_b32 v244, 0xff800000
  v_mfma_f32_16x16x32_bf16 v[60:63], a[156:159], v[176:179], v[60:63]
  buffer_load_dwordx4 v201, s[12:15], s31 offen offset:1024 lds
  v_mov_b32 v245, 0xff800000
  v_mfma_f32_16x16x32_bf16 v[64:67], a[96:99], v[164:167], v[64:67]
  v_lshlrev_b32 v15, 4, v1
  v_lshlrev_b32 v9, 1, v3
  v_mfma_f32_16x16x32_bf16 v[64:67], a[128:131], v[180:183], v[64:67]
  v_xor_b32 v9, v9, v5
  v_lshlrev_b32 v9, 4, v9
  v_mfma_f32_16x16x32_bf16 v[68:71], a[100:103], v[164:167], v[68:71]
  v_mul_u32_u24 v8, 1280, v4
  v_add_u32 v8, v8, v9
  v_mfma_f32_16x16x32_bf16 v[68:71], a[132:135], v[180:183], v[68:71]
  buffer_load_dwordx4 v202, s[12:15], s31 offen offset:2048 lds
  v_add_u32 v246, 0, v8
  v_mfma_f32_16x16x32_bf16 v[72:75], a[104:107], v[164:167], v[72:75]
  v_add_u32 v247, 9216, v8
  v_add_u32 v248, 18432, v8
  v_mfma_f32_16x16x32_bf16 v[72:75], a[136:139], v[180:183], v[72:75]
  v_add_u32 v249, 27648, v8
  v_lshl_add_u32 v14, v3, 2, v6
  v_mfma_f32_16x16x32_bf16 v[76:79], a[108:111], v[164:167], v[76:79]
  s_waitcnt vmcnt(11)
  s_barrier
  v_mfma_f32_16x16x32_bf16 v[76:79], a[140:143], v[180:183], v[76:79]
  ds_read_b128 a[224:227], v204
  ds_read_b128 a[240:243], v205
  buffer_load_dwordx4 v203, s[12:15], s31 offen offset:3072 lds
  v_mfma_f32_16x16x32_bf16 v[80:83], a[112:115], v[164:167], v[80:83]
  s_add_u32 s32, s32, 1
  ds_read_b64_tr_b16 a[160:161], v210 offset:32768
  v_bfe_u32 v13, v14, 1, 2
  v_mfma_f32_16x16x32_bf16 v[80:83], a[144:147], v[180:183], v[80:83]
  s_cmp_eq_u32 s32, 10
  s_cselect_b32 s32, 0, s32
  ds_read_b64_tr_b16 a[162:163], v210 offset:33792
  v_lshl_or_b32 v13, v13, 1, v11
  v_mfma_f32_16x16x32_bf16 v[84:87], a[116:119], v[164:167], v[84:87]
  s_lshl_b32 s30, s32, 7
  ds_read_b64_tr_b16 a[192:193], v210 offset:40960
  ds_read_b64_tr_b16 a[194:195], v210 offset:41984
  v_mfma_f32_16x16x32_bf16 v[84:87], a[148:151], v[180:183], v[84:87]
  s_mov_b32 m0, s38
  s_lshl_b32 s31, s32, 19
  ds_read_b64_tr_b16 a[164:165], v211 offset:32768
  v_lshl_add_u32 v14, v14, 7, v12
  v_mfma_f32_16x16x32_bf16 v[88:91], a[120:123], v[164:167], v[88:91]
  ds_read_b64_tr_b16 a[166:167], v211 offset:33792
  buffer_load_dwordx4 v192, s[8:11], s30 offen lds
  v_mfma_f32_16x16x32_bf16 v[88:91], a[152:155], v[180:183], v[88:91]
  ds_read_b64_tr_b16 a[196:197], v211 offset:40960
  ds_read_b64_tr_b16 a[198:199], v211 offset:41984
  v_mfma_f32_16x16x32_bf16 v[92:95], a[124:127], v[164:167], v[92:95]
  ds_read_b64_tr_b16 a[168:169], v212 offset:32768
  v_add_u32 v14, s40, v14
  v_mfma_f32_16x16x32_bf16 v[92:95], a[156:159], v[180:183], v[92:95]
  ds_read_b64_tr_b16 a[170:171], v212 offset:33792
  s_add_u32 s53, s3, 0
  v_mfma_f32_16x16x32_bf16 v[96:99], a[96:99], v[168:171], v[96:99]
  ds_read_b64_tr_b16 a[200:201], v212 offset:40960
  ds_read_b64_tr_b16 a[202:203], v212 offset:41984
  buffer_load_dwordx4 v193, s[8:11], s30 offen offset:1024 lds
  v_mfma_f32_16x16x32_bf16 v[96:99], a[128:131], v[184:187], v[96:99]
  ds_read_b64_tr_b16 a[172:173], v213 offset:32768
  s_and_b32 s53, s53, 3
  v_mfma_f32_16x16x32_bf16 v[100:103], a[100:103], v[168:171], v[100:103]
  ds_read_b64_tr_b16 a[174:175], v213 offset:33792
  s_lshl_b32 s53, s53, 1
  v_mfma_f32_16x16x32_bf16 v[100:103], a[132:135], v[184:187], v[100:103]
  ds_read_b64_tr_b16 a[204:205], v213 offset:40960
  ds_read_b64_tr_b16 a[206:207], v213 offset:41984
  v_mfma_f32_16x16x32_bf16 v[104:107], a[104:107], v[168:171], v[104:107]
  ds_read_b64_tr_b16 a[176:177], v214 offset:32768
  buffer_load_dwordx4 v194, s[8:11], s30 offen offset:2048 lds
  v_mfma_f32_16x16x32_bf16 v[104:107], a[136:139], v[184:187], v[104:107]
  ds_read_b64_tr_b16 a[178:179], v214 offset:33792
  v_xor_b32 v16, s53, v13
  v_mfma_f32_16x16x32_bf16 v[108:111], a[108:111], v[168:171], v[108:111]
  ds_read_b64_tr_b16 a[208:209], v214 offset:40960
  ds_read_b64_tr_b16 a[210:211], v214 offset:41984
  v_mfma_f32_16x16x32_bf16 v[108:111], a[140:143], v[184:187], v[108:111]
  ds_read_b64_tr_b16 a[180:181], v215 offset:32768
  v_lshl_add_u32 v28, v16, 4, v14
  v_mfma_f32_16x16x32_bf16 v[112:115], a[112:115], v[168:171], v[112:115]
  ds_read_b64_tr_b16 a[182:183], v215 offset:33792
  buffer_load_dwordx4 v195, s[8:11], s30 offen offset:3072 lds
  v_mfma_f32_16x16x32_bf16 v[112:115], a[144:147], v[184:187], v[112:115]
  ds_read_b64_tr_b16 a[212:213], v215 offset:40960
  ds_read_b64_tr_b16 a[214:215], v215 offset:41984
  v_mfma_f32_16x16x32_bf16 v[116:119], a[116:119], v[168:171], v[116:119]
  ds_read_b64_tr_b16 a[184:185], v216 offset:32768
  v_add_u32 v250, 65536, v28
  v_mfma_f32_16x16x32_bf16 v[116:119], a[148:151], v[184:187], v[116:119]
  s_add_u32 m0, s38, 4096
  ds_read_b64_tr_b16 a[186:187], v216 offset:33792
  v_add_u32 v7, 131072, v28
  v_mfma_f32_16x16x32_bf16 v[120:123], a[120:123], v[168:171], v[120:123]
  ds_read_b64_tr_b16 a[216:217], v216 offset:40960
  ds_read_b64_tr_b16 a[218:219], v216 offset:41984
  buffer_load_dwordx4 v196, s[8:11], s30 offen lds
  v_mfma_f32_16x16x32_bf16 v[120:123], a[152:155], v[184:187], v[120:123]
  ds_read_b64_tr_b16 a[188:189], v217 offset:32768
  s_add_u32 s53, s3, 1
  v_mfma_f32_16x16x32_bf16 v[124:127], a[124:127], v[168:171], v[124:127]
  ds_read_b64_tr_b16 a[190:191], v217 offset:33792
  s_and_b32 s53, s53, 3
  v_mfma_f32_16x16x32_bf16 v[124:127], a[156:159], v[184:187], v[124:127]
  ds_read_b64_tr_b16 a[220:221], v217 offset:40960
  ds_read_b64_tr_b16 a[222:223], v217 offset:41984
  v_mfma_f32_16x16x32_bf16 v[128:131], a[96:99], v[172:175], v[128:131]
  ds_read_b128 a[228:231], v204 offset:2048
  buffer_load_dwordx4 v197, s[8:11], s30 offen offset:1024 lds
  v_mfma_f32_16x16x32_bf16 v[128:131], a[128:131], v[188:191], v[128:131]
  ds_read_b128 a[244:247], v205 offset:2048
  s_lshl_b32 s53, s53, 1
  v_mfma_f32_16x16x32_bf16 v[132:135], a[100:103], v[172:175], v[132:135]
  ds_read_b128 a[232:235], v204 offset:4096
  ds_read_b128 a[248:251], v205 offset:4096
  v_mfma_f32_16x16x32_bf16 v[132:135], a[132:135], v[188:191], v[132:135]
  ds_read_b128 a[236:239], v204 offset:6144
  v_xor_b32 v16, s53, v13
  v_mfma_f32_16x16x32_bf16 v[136:139], a[104:107], v[172:175], v[136:139]
  ds_read_b128 a[252:255], v205 offset:6144
  buffer_load_dwordx4 v198, s[8:11], s30 offen offset:2048 lds
  v_mfma_f32_16x16x32_bf16 v[136:139], a[136:139], v[188:191], v[136:139]
  v_lshl_add_u32 v29, v16, 4, v14
  v_add_u32 v251, 65536, v29
  v_mfma_f32_16x16x32_bf16 v[140:143], a[108:111], v[172:175], v[140:143]
  v_add_u32 v8, 131072, v29
  s_add_u32 s53, s3, 2
  v_mfma_f32_16x16x32_bf16 v[140:143], a[140:143], v[188:191], v[140:143]
  s_and_b32 s53, s53, 3
  v_mfma_f32_16x16x32_bf16 v[144:147], a[112:115], v[172:175], v[144:147]
  buffer_load_dwordx4 v199, s[8:11], s30 offen offset:3072 lds
  s_lshl_b32 s53, s53, 1
  v_mfma_f32_16x16x32_bf16 v[144:147], a[144:147], v[188:191], v[144:147]
  v_xor_b32 v16, s53, v13
  v_lshl_add_u32 v30, v16, 4, v14
  v_mfma_f32_16x16x32_bf16 v[148:151], a[116:119], v[172:175], v[148:151]
  v_add_u32 v252, 65536, v30
  v_add_u32 v9, 131072, v30
  v_mfma_f32_16x16x32_bf16 v[148:151], a[148:151], v[188:191], v[148:151]
  s_add_u32 m0, s39, 16384
  s_add_u32 s53, s3, 3
  v_mfma_f32_16x16x32_bf16 v[152:155], a[120:123], v[172:175], v[152:155]
  buffer_load_dwordx4 v200, s[12:15], s31 offen lds
  s_and_b32 s53, s53, 3
  v_mfma_f32_16x16x32_bf16 v[152:155], a[152:155], v[188:191], v[152:155]
  s_lshl_b32 s53, s53, 1
  v_mfma_f32_16x16x32_bf16 v[156:159], a[124:127], v[172:175], v[156:159]
  s_waitcnt vmcnt(9) lgkmcnt(0)
  s_barrier
  v_mfma_f32_16x16x32_bf16 v[156:159], a[156:159], v[188:191], v[156:159]
  ds_read_b128 a[64:67], v206
  ds_read_b128 a[80:83], v207
  v_mfma_f32_16x16x32_bf16 v[32:35], a[160:163], a[224:227], v[32:35]
  ds_read_b64_tr_b16 a[0:1], v210 offset:0
  buffer_load_dwordx4 v201, s[12:15], s31 offen offset:1024 lds
  v_mfma_f32_16x16x32_bf16 v[32:35], a[192:195], a[240:243], v[32:35]
  ds_read_b64_tr_b16 a[2:3], v210 offset:1024
  v_xor_b32 v16, s53, v13
  v_mfma_f32_16x16x32_bf16 v[36:39], a[164:167], a[224:227], v[36:39]
  ds_read_b64_tr_b16 a[32:33], v210 offset:8192
  ds_read_b64_tr_b16 a[34:35], v210 offset:9216
  v_mfma_f32_16x16x32_bf16 v[36:39], a[196:199], a[240:243], v[36:39]
  ds_read_b64_tr_b16 a[4:5], v211 offset:0
  v_lshl_add_u32 v31, v16, 4, v14
  v_mfma_f32_16x16x32_bf16 v[40:43], a[168:171], a[224:227], v[40:43]
  ds_read_b64_tr_b16 a[6:7], v211 offset:1024
  buffer_load_dwordx4 v202, s[12:15], s31 offen offset:2048 lds
  v_mfma_f32_16x16x32_bf16 v[40:43], a[200:203], a[240:243], v[40:43]
  ds_read_b64_tr_b16 a[36:37], v211 offset:8192
  ds_read_b64_tr_b16 a[38:39], v211 offset:9216
  v_mfma_f32_16x16x32_bf16 v[44:47], a[172:175], a[224:227], v[44:47]
  ds_read_b64_tr_b16 a[8:9], v212 offset:0
  v_add_u32 v253, 65536, v31
  v_mfma_f32_16x16x32_bf16 v[44:47], a[204:207], a[240:243], v[44:47]
  ds_read_b64_tr_b16 a[10:11], v212 offset:1024
  v_add_u32 v10, 131072, v31
  v_mfma_f32_16x16x32_bf16 v[48:51], a[176:179], a[224:227], v[48:51]
  ds_read_b64_tr_b16 a[40:41], v212 offset:8192
  ds_read_b64_tr_b16 a[42:43], v212 offset:9216
  buffer_load_dwordx4 v203, s[12:15], s31 offen offset:3072 lds
  v_mfma_f32_16x16x32_bf16 v[48:51], a[208:211], a[240:243], v[48:51]
  s_add_u32 s32, s32, 1
  ds_read_b64_tr_b16 a[12:13], v213 offset:0
  v_add_u32 v4, 0, v15
  v_mfma_f32_16x16x32_bf16 v[52:55], a[180:183], a[224:227], v[52:55]
  s_cmp_eq_u32 s32, 10
  s_cselect_b32 s32, 0, s32
  ds_read_b64_tr_b16 a[14:15], v213 offset:1024
  v_add_u32 v5, 131072, v15
  v_mfma_f32_16x16x32_bf16 v[52:55], a[212:215], a[240:243], v[52:55]
  s_lshl_b32 s30, s32, 7
  ds_read_b64_tr_b16 a[44:45], v213 offset:8192
  ds_read_b64_tr_b16 a[46:47], v213 offset:9216
  v_mfma_f32_16x16x32_bf16 v[56:59], a[184:187], a[224:227], v[56:59]
  s_mov_b32 m0, s36
  s_lshl_b32 s31, s32, 19
  ds_read_b64_tr_b16 a[16:17], v214 offset:0
  v_add_u32 v13, 262144, v15
  v_mfma_f32_16x16x32_bf16 v[56:59], a[216:219], a[240:243], v[56:59]
  ds_read_b64_tr_b16 a[18:19], v214 offset:1024
  buffer_load_dwordx4 v192, s[8:11], s30 offen lds
  v_mfma_f32_16x16x32_bf16 v[60:63], a[188:191], a[224:227], v[60:63]
  ds_read_b64_tr_b16 a[48:49], v214 offset:8192
  ds_read_b64_tr_b16 a[50:51], v214 offset:9216
  v_mfma_f32_16x16x32_bf16 v[60:63], a[220:223], a[240:243], v[60:63]
  ds_read_b64_tr_b16 a[20:21], v215 offset:0
  v_add_u32 v14, 393216, v15
  v_mfma_f32_16x16x32_bf16 v[64:67], a[160:163], a[228:231], v[64:67]
  ds_read_b64_tr_b16 a[22:23], v215 offset:1024
  v_add_u32 v254, 524288, v15
  v_mfma_f32_16x16x32_bf16 v[64:67], a[192:195], a[244:247], v[64:67]
  ds_read_b64_tr_b16 a[52:53], v215 offset:8192
  ds_read_b64_tr_b16 a[54:55], v215 offset:9216
  buffer_load_dwordx4 v193, s[8:11], s30 offen offset:1024 lds
  v_mfma_f32_16x16x32_bf16 v[68:71], a[164:167], a[228:231], v[68:71]
  ds_read_b64_tr_b16 a[24:25], v216 offset:0
  s_min_u32 s51, s51, 29
  v_mfma_f32_16x16x32_bf16 v[68:71], a[196:199], a[244:247], v[68:71]
  ds_read_b64_tr_b16 a[26:27], v216 offset:1024
  s_cmp_ge_u32 s51, 15
  s_cselect_b32 s52, 1, 0
  s_cselect_b32 s53, 15, 0
  v_mfma_f32_16x16x32_bf16 v[72:75], a[168:171], a[228:231], v[72:75]
  ds_read_b64_tr_b16 a[56:57], v216 offset:8192
  ds_read_b64_tr_b16 a[58:59], v216 offset:9216
  v_mfma_f32_16x16x32_bf16 v[72:75], a[200:203], a[244:247], v[72:75]
  ds_read_b64_tr_b16 a[28:29], v217 offset:0
  buffer_load_dwordx4 v194, s[8:11], s30 offen offset:2048 lds
  v_mfma_f32_16x16x32_bf16 v[76:79], a[172:175], a[228:231], v[76:79]
  ds_read_b64_tr_b16 a[30:31], v217 offset:1024
  s_sub_u32 s53, s51, s53
  v_mfma_f32_16x16x32_bf16 v[76:79], a[204:207], a[244:247], v[76:79]
  ds_read_b64_tr_b16 a[60:61], v217 offset:8192
  ds_read_b64_tr_b16 a[62:63], v217 offset:9216
  v_mfma_f32_16x16x32_bf16 v[80:83], a[176:179], a[228:231], v[80:83]
  ds_read_b128 a[68:71], v206 offset:2048
  s_and_b32 s43, s50, 6
  v_mfma_f32_16x16x32_bf16 v[80:83], a[208:211], a[244:247], v[80:83]
  ds_read_b128 a[84:87], v207 offset:2048
  buffer_load_dwordx4 v195, s[8:11], s30 offen offset:3072 lds
  v_mfma_f32_16x16x32_bf16 v[84:87], a[180:183], a[228:231], v[84:87]
  ds_read_b128 a[72:75], v206 offset:4096
  ds_read_b128 a[88:91], v207 offset:4096
  v_mfma_f32_16x16x32_bf16 v[84:87], a[212:215], a[244:247], v[84:87]
  ds_read_b128 a[76:79], v206 offset:6144
  s_add_u32 s43, s43, s52
  v_mfma_f32_16x16x32_bf16 v[88:91], a[184:187], a[228:231], v[88:91]
  s_add_u32 m0, s36, 4096
  ds_read_b128 a[92:95], v207 offset:6144
  s_mul_i32 s54, s53, 52
  v_mfma_f32_16x16x32_bf16 v[88:91], a[216:219], a[244:247], v[88:91]
  buffer_load_dwordx4 v196, s[8:11], s30 offen lds
  s_lshr_b32 s54, s54, 8
  v_mfma_f32_16x16x32_bf16 v[92:95], a[188:191], a[228:231], v[92:95]
  s_mul_i32 s41, s54, 5
  v_mfma_f32_16x16x32_bf16 v[92:95], a[220:223], a[244:247], v[92:95]
  s_sub_u32 s53, s53, s41
  v_mfma_f32_16x16x32_bf16 v[96:99], a[160:163], a[232:235], v[96:99]
  s_and_b32 s55, s50, 1
  v_mfma_f32_16x16x32_bf16 v[96:99], a[192:195], a[248:251], v[96:99]
  buffer_load_dwordx4 v197, s[8:11], s30 offen offset:1024 lds
  s_mul_i32 s55, s55, 5
  v_mfma_f32_16x16x32_bf16 v[100:103], a[164:167], a[232:235], v[100:103]
  s_add_u32 s55, s55, s53
  v_mfma_f32_16x16x32_bf16 v[100:103], a[196:199], a[248:251], v[100:103]
  s_mul_i32 s52, s52, 3
  v_mfma_f32_16x16x32_bf16 v[104:107], a[168:171], a[232:235], v[104:107]
  s_add_u32 s41, s54, s52
  v_mfma_f32_16x16x32_bf16 v[104:107], a[200:203], a[248:251], v[104:107]
  buffer_load_dwordx4 v198, s[8:11], s30 offen offset:2048 lds
  s_mul_i32 s41, s41, 43
  v_mfma_f32_16x16x32_bf16 v[108:111], a[172:175], a[232:235], v[108:111]
  s_lshr_b32 s41, s41, 3
  v_mfma_f32_16x16x32_bf16 v[108:111], a[204:207], a[248:251], v[108:111]
  s_and_b32 s41, s41, 31
  v_mfma_f32_16x16x32_bf16 v[112:115], a[176:179], a[232:235], v[112:115]
  s_mov_b32 s44, 1040356334
  v_mfma_f32_16x16x32_bf16 v[112:115], a[208:211], a[248:251], v[112:115]
  buffer_load_dwordx4 v199, s[8:11], s30 offen offset:3072 lds
  s_mov_b32 s45, 1040356334
  v_mfma_f32_16x16x32_bf16 v[116:119], a[180:183], a[232:235], v[116:119]
  v_mfma_f32_16x16x32_bf16 v[116:119], a[212:215], a[248:251], v[116:119]
  v_mfma_f32_16x16x32_bf16 v[120:123], a[184:187], a[232:235], v[120:123]
  s_add_u32 m0, s39, 32768
  v_mfma_f32_16x16x32_bf16 v[120:123], a[216:219], a[248:251], v[120:123]
  buffer_load_dwordx4 v200, s[12:15], s31 offen lds
  v_mfma_f32_16x16x32_bf16 v[124:127], a[188:191], a[232:235], v[124:127]
  v_mfma_f32_16x16x32_bf16 v[124:127], a[220:223], a[248:251], v[124:127]
  v_mfma_f32_16x16x32_bf16 v[128:131], a[160:163], a[236:239], v[128:131]
  v_mfma_f32_16x16x32_bf16 v[128:131], a[192:195], a[252:255], v[128:131]
  buffer_load_dwordx4 v201, s[12:15], s31 offen offset:1024 lds
  v_mfma_f32_16x16x32_bf16 v[132:135], a[164:167], a[236:239], v[132:135]
  v_mfma_f32_16x16x32_bf16 v[132:135], a[196:199], a[252:255], v[132:135]
  s_waitcnt vmcnt(10) lgkmcnt(0)
  s_barrier
  v_mfma_f32_16x16x32_bf16 v[136:139], a[168:171], a[236:239], v[136:139]
  ds_read_b128 v[160:163], v208
  ds_read_b128 v[176:179], v209
  v_mfma_f32_16x16x32_bf16 v[136:139], a[200:203], a[252:255], v[136:139]
  ds_read_b64_tr_b16 a[96:97], v210 offset:16384
  buffer_load_dwordx4 v202, s[12:15], s31 offen offset:2048 lds
  v_mfma_f32_16x16x32_bf16 v[140:143], a[172:175], a[236:239], v[140:143]
  ds_read_b64_tr_b16 a[98:99], v210 offset:17408
  v_mfma_f32_16x16x32_bf16 v[140:143], a[204:207], a[252:255], v[140:143]
  ds_read_b64_tr_b16 a[128:129], v210 offset:24576
  ds_read_b64_tr_b16 a[130:131], v210 offset:25600
  v_mfma_f32_16x16x32_bf16 v[144:147], a[176:179], a[236:239], v[144:147]
  ds_read_b64_tr_b16 a[100:101], v211 offset:16384
  v_mfma_f32_16x16x32_bf16 v[144:147], a[208:211], a[252:255], v[144:147]
  ds_read_b64_tr_b16 a[102:103], v211 offset:17408
  buffer_load_dwordx4 v203, s[12:15], s31 offen offset:3072 lds
  v_mfma_f32_16x16x32_bf16 v[148:151], a[180:183], a[236:239], v[148:151]
  s_add_u32 s32, s32, 1
  ds_read_b64_tr_b16 a[132:133], v211 offset:24576
  ds_read_b64_tr_b16 a[134:135], v211 offset:25600
  v_mfma_f32_16x16x32_bf16 v[148:151], a[212:215], a[252:255], v[148:151]
  s_cmp_eq_u32 s32, 10
  s_cselect_b32 s32, 0, s32
  ds_read_b64_tr_b16 a[104:105], v212 offset:16384
  v_mfma_f32_16x16x32_bf16 v[152:155], a[184:187], a[236:239], v[152:155]
  s_lshl_b32 s30, s32, 7
  ds_read_b64_tr_b16 a[106:107], v212 offset:17408
  v_mfma_f32_16x16x32_bf16 v[152:155], a[216:219], a[252:255], v[152:155]
  s_mov_b32 m0, s37
  s_lshl_b32 s31, s32, 19
  ds_read_b64_tr_b16 a[136:137], v212 offset:24576
  ds_read_b64_tr_b16 a[138:139], v212 offset:25600
  v_mfma_f32_16x16x32_bf16 v[156:159], a[188:191], a[236:239], v[156:159]
  ds_read_b64_tr_b16 a[108:109], v213 offset:16384
  buffer_load_dwordx4 v192, s[8:11], s30 offen lds
  v_mfma_f32_16x16x32_bf16 v[156:159], a[220:223], a[252:255], v[156:159]
  ds_read_b64_tr_b16 a[110:111], v213 offset:17408
  v_mfma_f32_16x16x32_bf16 v[32:35], a[0:3], a[64:67], v[32:35]
  ds_read_b64_tr_b16 a[140:141], v213 offset:24576
  ds_read_b64_tr_b16 a[142:143], v213 offset:25600
  v_mfma_f32_16x16x32_bf16 v[32:35], a[32:35], a[80:83], v[32:35]
  ds_read_b64_tr_b16 a[112:113], v214 offset:16384
  v_mfma_f32_16x16x32_bf16 v[36:39], a[4:7], a[64:67], v[36:39]
  ds_read_b64_tr_b16 a[114:115], v214 offset:17408
  buffer_load_dwordx4 v193, s[8:11], s30 offen offset:1024 lds
  v_mfma_f32_16x16x32_bf16 v[36:39], a[36:39], a[80:83], v[36:39]
  ds_read_b64_tr_b16 a[144:145], v214 offset:24576
  ds_read_b64_tr_b16 a[146:147], v214 offset:25600
  v_mfma_f32_16x16x32_bf16 v[40:43], a[8:11], a[64:67], v[40:43]
  ds_read_b64_tr_b16 a[116:117], v215 offset:16384
  v_mfma_f32_16x16x32_bf16 v[40:43], a[40:43], a[80:83], v[40:43]
  ds_read_b64_tr_b16 a[118:119], v215 offset:17408
  v_mfma_f32_16x16x32_bf16 v[44:47], a[12:15], a[64:67], v[44:47]
  ds_read_b64_tr_b16 a[148:149], v215 offset:24576
  ds_read_b64_tr_b16 a[150:151], v215 offset:25600
  buffer_load_dwordx4 v194, s[8:11], s30 offen offset:2048 lds
  v_mfma_f32_16x16x32_bf16 v[44:47], a[44:47], a[80:83], v[44:47]
  ds_read_b64_tr_b16 a[120:121], v216 offset:16384
  v_mfma_f32_16x16x32_bf16 v[48:51], a[16:19], a[64:67], v[48:51]
  ds_read_b64_tr_b16 a[122:123], v216 offset:17408
  v_mfma_f32_16x16x32_bf16 v[48:51], a[48:51], a[80:83], v[48:51]
  ds_read_b64_tr_b16 a[152:153], v216 offset:24576
  ds_read_b64_tr_b16 a[154:155], v216 offset:25600
  v_mfma_f32_16x16x32_bf16 v[52:55], a[20:23], a[64:67], v[52:55]
  ds_read_b64_tr_b16 a[124:125], v217 offset:16384
  buffer_load_dwordx4 v195, s[8:11], s30 offen offset:3072 lds
  v_mfma_f32_16x16x32_bf16 v[52:55], a[52:55], a[80:83], v[52:55]
  ds_read_b64_tr_b16 a[126:127], v217 offset:17408
  v_mfma_f32_16x16x32_bf16 v[56:59], a[24:27], a[64:67], v[56:59]
  ds_read_b64_tr_b16 a[156:157], v217 offset:24576
  ds_read_b64_tr_b16 a[158:159], v217 offset:25600
  v_mfma_f32_16x16x32_bf16 v[56:59], a[56:59], a[80:83], v[56:59]
  s_add_u32 m0, s37, 4096
  ds_read_b128 v[164:167], v208 offset:2048
  v_mfma_f32_16x16x32_bf16 v[60:63], a[28:31], a[64:67], v[60:63]
  ds_read_b128 v[180:183], v209 offset:2048
  buffer_load_dwordx4 v196, s[8:11], s30 offen lds
  v_mfma_f32_16x16x32_bf16 v[60:63], a[60:63], a[80:83], v[60:63]
  ds_read_b128 v[168:171], v208 offset:4096
  ds_read_b128 v[184:187], v209 offset:4096
  v_mfma_f32_16x16x32_bf16 v[64:67], a[0:3], a[68:71], v[64:67]
  ds_read_b128 v[172:175], v208 offset:6144
  v_mfma_f32_16x16x32_bf16 v[64:67], a[32:35], a[84:87], v[64:67]
  ds_read_b128 v[188:191], v209 offset:6144
  v_mfma_f32_16x16x32_bf16 v[68:71], a[4:7], a[68:71], v[68:71]
  buffer_load_dwordx4 v197, s[8:11], s30 offen offset:1024 lds
  v_mfma_f32_16x16x32_bf16 v[68:71], a[36:39], a[84:87], v[68:71]
  v_mfma_f32_16x16x32_bf16 v[72:75], a[8:11], a[68:71], v[72:75]
  v_mfma_f32_16x16x32_bf16 v[72:75], a[40:43], a[84:87], v[72:75]
  v_mfma_f32_16x16x32_bf16 v[76:79], a[12:15], a[68:71], v[76:79]
  buffer_load_dwordx4 v198, s[8:11], s30 offen offset:2048 lds
  v_mfma_f32_16x16x32_bf16 v[76:79], a[44:47], a[84:87], v[76:79]
  v_mfma_f32_16x16x32_bf16 v[80:83], a[16:19], a[68:71], v[80:83]
  v_mfma_f32_16x16x32_bf16 v[80:83], a[48:51], a[84:87], v[80:83]
  v_mfma_f32_16x16x32_bf16 v[84:87], a[20:23], a[68:71], v[84:87]
  buffer_load_dwordx4 v199, s[8:11], s30 offen offset:3072 lds
  v_mfma_f32_16x16x32_bf16 v[84:87], a[52:55], a[84:87], v[84:87]
  v_mfma_f32_16x16x32_bf16 v[88:91], a[24:27], a[68:71], v[88:91]
  v_mfma_f32_16x16x32_bf16 v[88:91], a[56:59], a[84:87], v[88:91]
  s_add_u32 m0, s39, 0
  v_mfma_f32_16x16x32_bf16 v[92:95], a[28:31], a[68:71], v[92:95]
  buffer_load_dwordx4 v200, s[12:15], s31 offen lds
  v_mfma_f32_16x16x32_bf16 v[92:95], a[60:63], a[84:87], v[92:95]
  v_mfma_f32_16x16x32_bf16 v[96:99], a[0:3], a[72:75], v[96:99]
  v_mfma_f32_16x16x32_bf16 v[96:99], a[32:35], a[88:91], v[96:99]
  v_mfma_f32_16x16x32_bf16 v[100:103], a[4:7], a[72:75], v[100:103]
  buffer_load_dwordx4 v201, s[12:15], s31 offen offset:1024 lds
  v_mfma_f32_16x16x32_bf16 v[100:103], a[36:39], a[88:91], v[100:103]
  v_mfma_f32_16x16x32_bf16 v[104:107], a[8:11], a[72:75], v[104:107]
  s_waitcnt vmcnt(10) lgkmcnt(0)
  s_barrier
  v_mfma_f32_16x16x32_bf16 v[104:107], a[40:43], a[88:91], v[104:107]
  ds_read_b128 a[224:227], v204
  ds_read_b128 a[240:243], v205
  v_mfma_f32_16x16x32_bf16 v[108:111], a[12:15], a[72:75], v[108:111]
  ds_read_b64_tr_b16 a[160:161], v210 offset:32768
  buffer_load_dwordx4 v202, s[12:15], s31 offen offset:2048 lds
  v_mfma_f32_16x16x32_bf16 v[108:111], a[44:47], a[88:91], v[108:111]
  ds_read_b64_tr_b16 a[162:163], v210 offset:33792
  v_mfma_f32_16x16x32_bf16 v[112:115], a[16:19], a[72:75], v[112:115]
  ds_read_b64_tr_b16 a[192:193], v210 offset:40960
  ds_read_b64_tr_b16 a[194:195], v210 offset:41984
  v_mfma_f32_16x16x32_bf16 v[112:115], a[48:51], a[88:91], v[112:115]
  ds_read_b64_tr_b16 a[164:165], v211 offset:32768
  v_mfma_f32_16x16x32_bf16 v[116:119], a[20:23], a[72:75], v[116:119]
  ds_read_b64_tr_b16 a[166:167], v211 offset:33792
  buffer_load_dwordx4 v203, s[12:15], s31 offen offset:3072 lds
  v_mfma_f32_16x16x32_bf16 v[116:119], a[52:55], a[88:91], v[116:119]
  s_add_u32 s32, s32, 1
  ds_read_b64_tr_b16 a[196:197], v211 offset:40960
  ds_read_b64_tr_b16 a[198:199], v211 offset:41984
  v_mfma_f32_16x16x32_bf16 v[120:123], a[24:27], a[72:75], v[120:123]
  s_cmp_eq_u32 s32, 10
  s_cselect_b32 s32, 0, s32
  ds_read_b64_tr_b16 a[168:169], v212 offset:32768
  v_mfma_f32_16x16x32_bf16 v[120:123], a[56:59], a[88:91], v[120:123]
  s_lshl_b32 s30, s32, 7
  ds_read_b64_tr_b16 a[170:171], v212 offset:33792
  v_mfma_f32_16x16x32_bf16 v[124:127], a[28:31], a[72:75], v[124:127]
  s_mov_b32 m0, s38
  s_lshl_b32 s31, s32, 19
  ds_read_b64_tr_b16 a[200:201], v212 offset:40960
  ds_read_b64_tr_b16 a[202:203], v212 offset:41984
  v_mfma_f32_16x16x32_bf16 v[124:127], a[60:63], a[88:91], v[124:127]
  ds_read_b64_tr_b16 a[172:173], v213 offset:32768
  buffer_load_dwordx4 v192, s[8:11], s30 offen lds
  v_mfma_f32_16x16x32_bf16 v[128:131], a[0:3], a[76:79], v[128:131]
  ds_read_b64_tr_b16 a[174:175], v213 offset:33792
  v_mfma_f32_16x16x32_bf16 v[128:131], a[32:35], a[92:95], v[128:131]
  ds_read_b64_tr_b16 a[204:205], v213 offset:40960
  ds_read_b64_tr_b16 a[206:207], v213 offset:41984
  v_mfma_f32_16x16x32_bf16 v[132:135], a[4:7], a[76:79], v[132:135]
  ds_read_b64_tr_b16 a[176:177], v214 offset:32768
  v_mfma_f32_16x16x32_bf16 v[132:135], a[36:39], a[92:95], v[132:135]
  ds_read_b64_tr_b16 a[178:179], v214 offset:33792
  buffer_load_dwordx4 v193, s[8:11], s30 offen offset:1024 lds
  v_mfma_f32_16x16x32_bf16 v[136:139], a[8:11], a[76:79], v[136:139]
  ds_read_b64_tr_b16 a[208:209], v214 offset:40960
  ds_read_b64_tr_b16 a[210:211], v214 offset:41984
  v_mfma_f32_16x16x32_bf16 v[136:139], a[40:43], a[92:95], v[136:139]
  ds_read_b64_tr_b16 a[180:181], v215 offset:32768
  v_mfma_f32_16x16x32_bf16 v[140:143], a[12:15], a[76:79], v[140:143]
  ds_read_b64_tr_b16 a[182:183], v215 offset:33792
  v_mfma_f32_16x16x32_bf16 v[140:143], a[44:47], a[92:95], v[140:143]
  ds_read_b64_tr_b16 a[212:213], v215 offset:40960
  ds_read_b64_tr_b16 a[214:215], v215 offset:41984
  buffer_load_dwordx4 v194, s[8:11], s30 offen offset:2048 lds
  v_mfma_f32_16x16x32_bf16 v[144:147], a[16:19], a[76:79], v[144:147]
  ds_read_b64_tr_b16 a[184:185], v216 offset:32768
  v_mfma_f32_16x16x32_bf16 v[144:147], a[48:51], a[92:95], v[144:147]
  ds_read_b64_tr_b16 a[186:187], v216 offset:33792
  v_mfma_f32_16x16x32_bf16 v[148:151], a[20:23], a[76:79], v[148:151]
  ds_read_b64_tr_b16 a[216:217], v216 offset:40960
  ds_read_b64_tr_b16 a[218:219], v216 offset:41984
  v_mfma_f32_16x16x32_bf16 v[148:151], a[52:55], a[92:95], v[148:151]
  ds_read_b64_tr_b16 a[188:189], v217 offset:32768
  buffer_load_dwordx4 v195, s[8:11], s30 offen offset:3072 lds
  v_mfma_f32_16x16x32_bf16 v[152:155], a[24:27], a[76:79], v[152:155]
  ds_read_b64_tr_b16 a[190:191], v217 offset:33792
  v_mfma_f32_16x16x32_bf16 v[152:155], a[56:59], a[92:95], v[152:155]
  ds_read_b64_tr_b16 a[220:221], v217 offset:40960
  ds_read_b64_tr_b16 a[222:223], v217 offset:41984
  v_mfma_f32_16x16x32_bf16 v[156:159], a[28:31], a[76:79], v[156:159]
  s_add_u32 m0, s38, 4096
  ds_read_b128 a[228:231], v204 offset:2048
  v_mfma_f32_16x16x32_bf16 v[156:159], a[60:63], a[92:95], v[156:159]
  ds_read_b128 a[244:247], v205 offset:2048
  buffer_load_dwordx4 v196, s[8:11], s30 offen lds
  v_mfma_f32_16x16x32_bf16 v[32:35], a[96:99], v[160:163], v[32:35]
  ds_read_b128 a[232:235], v204 offset:4096
  ds_read_b128 a[248:251], v205 offset:4096
  v_mfma_f32_16x16x32_bf16 v[32:35], a[128:131], v[176:179], v[32:35]
  ds_read_b128 a[236:239], v204 offset:6144
  v_mfma_f32_16x16x32_bf16 v[36:39], a[100:103], v[160:163], v[36:39]
  ds_read_b128 a[252:255], v205 offset:6144
  v_mfma_f32_16x16x32_bf16 v[36:39], a[132:135], v[176:179], v[36:39]
  buffer_load_dwordx4 v197, s[8:11], s30 offen offset:1024 lds
  v_mfma_f32_16x16x32_bf16 v[40:43], a[104:107], v[160:163], v[40:43]
  v_mfma_f32_16x16x32_bf16 v[40:43], a[136:139], v[176:179], v[40:43]
  v_mfma_f32_16x16x32_bf16 v[44:47], a[108:111], v[160:163], v[44:47]
  v_mfma_f32_16x16x32_bf16 v[44:47], a[140:143], v[176:179], v[44:47]
  buffer_load_dwordx4 v198, s[8:11], s30 offen offset:2048 lds
  v_mfma_f32_16x16x32_bf16 v[48:51], a[112:115], v[160:163], v[48:51]
  v_mfma_f32_16x16x32_bf16 v[48:51], a[144:147], v[176:179], v[48:51]
  v_mfma_f32_16x16x32_bf16 v[52:55], a[116:119], v[160:163], v[52:55]
  v_mfma_f32_16x16x32_bf16 v[52:55], a[148:151], v[176:179], v[52:55]
  buffer_load_dwordx4 v199, s[8:11], s30 offen offset:3072 lds
  v_mfma_f32_16x16x32_bf16 v[56:59], a[120:123], v[160:163], v[56:59]
  v_mfma_f32_16x16x32_bf16 v[56:59], a[152:155], v[176:179], v[56:59]
  v_mfma_f32_16x16x32_bf16 v[60:63], a[124:127], v[160:163], v[60:63]
  s_add_u32 m0, s39, 16384
  v_mfma_f32_16x16x32_bf16 v[60:63], a[156:159], v[176:179], v[60:63]
  buffer_load_dwordx4 v200, s[12:15], s31 offen lds
  v_mfma_f32_16x16x32_bf16 v[64:67], a[96:99], v[164:167], v[64:67]
  v_mfma_f32_16x16x32_bf16 v[64:67], a[128:131], v[180:183], v[64:67]
  v_mfma_f32_16x16x32_bf16 v[68:71], a[100:103], v[164:167], v[68:71]
  v_mfma_f32_16x16x32_bf16 v[68:71], a[132:135], v[180:183], v[68:71]
  buffer_load_dwordx4 v201, s[12:15], s31 offen offset:1024 lds
  v_mfma_f32_16x16x32_bf16 v[72:75], a[104:107], v[164:167], v[72:75]
  v_mfma_f32_16x16x32_bf16 v[72:75], a[136:139], v[180:183], v[72:75]
  s_waitcnt vmcnt(10) lgkmcnt(0)
  s_barrier
  v_mfma_f32_16x16x32_bf16 v[76:79], a[108:111], v[164:167], v[76:79]
  ds_read_b128 a[64:67], v206
  ds_read_b128 a[80:83], v207
  v_mfma_f32_16x16x32_bf16 v[76:79], a[140:143], v[180:183], v[76:79]
  ds_read_b64_tr_b16 a[0:1], v210 offset:0
  buffer_load_dwordx4 v202, s[12:15], s31 offen offset:2048 lds
  v_mfma_f32_16x16x32_bf16 v[80:83], a[112:115], v[164:167], v[80:83]
  ds_read_b64_tr_b16 a[2:3], v210 offset:1024
  v_mfma_f32_16x16x32_bf16 v[80:83], a[144:147], v[180:183], v[80:83]
  ds_read_b64_tr_b16 a[32:33], v210 offset:8192
  ds_read_b64_tr_b16 a[34:35], v210 offset:9216
  v_mfma_f32_16x16x32_bf16 v[84:87], a[116:119], v[164:167], v[84:87]
  ds_read_b64_tr_b16 a[4:5], v211 offset:0
  v_mfma_f32_16x16x32_bf16 v[84:87], a[148:151], v[180:183], v[84:87]
  ds_read_b64_tr_b16 a[6:7], v211 offset:1024
  buffer_load_dwordx4 v203, s[12:15], s31 offen offset:3072 lds
  v_mfma_f32_16x16x32_bf16 v[88:91], a[120:123], v[164:167], v[88:91]
  s_add_u32 s32, s32, 1
  ds_read_b64_tr_b16 a[36:37], v211 offset:8192
  ds_read_b64_tr_b16 a[38:39], v211 offset:9216
  v_mfma_f32_16x16x32_bf16 v[88:91], a[152:155], v[180:183], v[88:91]
  s_cmp_eq_u32 s32, 10
  s_cselect_b32 s32, 0, s32
  ds_read_b64_tr_b16 a[8:9], v212 offset:0
  v_mfma_f32_16x16x32_bf16 v[92:95], a[124:127], v[164:167], v[92:95]
  s_lshl_b32 s30, s32, 7
  ds_read_b64_tr_b16 a[10:11], v212 offset:1024
  v_mfma_f32_16x16x32_bf16 v[92:95], a[156:159], v[180:183], v[92:95]
  s_mov_b32 m0, s36
  s_lshl_b32 s31, s32, 19
  ds_read_b64_tr_b16 a[40:41], v212 offset:8192
  ds_read_b64_tr_b16 a[42:43], v212 offset:9216
  v_mfma_f32_16x16x32_bf16 v[96:99], a[96:99], v[168:171], v[96:99]
  ds_read_b64_tr_b16 a[12:13], v213 offset:0
  buffer_load_dwordx4 v192, s[8:11], s30 offen lds
  v_mfma_f32_16x16x32_bf16 v[96:99], a[128:131], v[184:187], v[96:99]
  ds_read_b64_tr_b16 a[14:15], v213 offset:1024
  v_mfma_f32_16x16x32_bf16 v[100:103], a[100:103], v[168:171], v[100:103]
  ds_read_b64_tr_b16 a[44:45], v213 offset:8192
  ds_read_b64_tr_b16 a[46:47], v213 offset:9216
  v_mfma_f32_16x16x32_bf16 v[100:103], a[132:135], v[184:187], v[100:103]
  ds_read_b64_tr_b16 a[16:17], v214 offset:0
  v_mfma_f32_16x16x32_bf16 v[104:107], a[104:107], v[168:171], v[104:107]
  ds_read_b64_tr_b16 a[18:19], v214 offset:1024
  buffer_load_dwordx4 v193, s[8:11], s30 offen offset:1024 lds
  v_mfma_f32_16x16x32_bf16 v[104:107], a[136:139], v[184:187], v[104:107]
  ds_read_b64_tr_b16 a[48:49], v214 offset:8192
  ds_read_b64_tr_b16 a[50:51], v214 offset:9216
  v_mfma_f32_16x16x32_bf16 v[108:111], a[108:111], v[168:171], v[108:111]
  ds_read_b64_tr_b16 a[20:21], v215 offset:0
  v_mfma_f32_16x16x32_bf16 v[108:111], a[140:143], v[184:187], v[108:111]
  ds_read_b64_tr_b16 a[22:23], v215 offset:1024
  v_mfma_f32_16x16x32_bf16 v[112:115], a[112:115], v[168:171], v[112:115]
  ds_read_b64_tr_b16 a[52:53], v215 offset:8192
  ds_read_b64_tr_b16 a[54:55], v215 offset:9216
  buffer_load_dwordx4 v194, s[8:11], s30 offen offset:2048 lds
  v_mfma_f32_16x16x32_bf16 v[112:115], a[144:147], v[184:187], v[112:115]
  ds_read_b64_tr_b16 a[24:25], v216 offset:0
  v_mfma_f32_16x16x32_bf16 v[116:119], a[116:119], v[168:171], v[116:119]
  ds_read_b64_tr_b16 a[26:27], v216 offset:1024
  v_mfma_f32_16x16x32_bf16 v[116:119], a[148:151], v[184:187], v[116:119]
  ds_read_b64_tr_b16 a[56:57], v216 offset:8192
  ds_read_b64_tr_b16 a[58:59], v216 offset:9216
  v_mfma_f32_16x16x32_bf16 v[120:123], a[120:123], v[168:171], v[120:123]
  ds_read_b64_tr_b16 a[28:29], v217 offset:0
  buffer_load_dwordx4 v195, s[8:11], s30 offen offset:3072 lds
  v_mfma_f32_16x16x32_bf16 v[120:123], a[152:155], v[184:187], v[120:123]
  ds_read_b64_tr_b16 a[30:31], v217 offset:1024
  v_mfma_f32_16x16x32_bf16 v[124:127], a[124:127], v[168:171], v[124:127]
  ds_read_b64_tr_b16 a[60:61], v217 offset:8192
  ds_read_b64_tr_b16 a[62:63], v217 offset:9216
  v_mfma_f32_16x16x32_bf16 v[124:127], a[156:159], v[184:187], v[124:127]
  s_add_u32 m0, s36, 4096
  ds_read_b128 a[68:71], v206 offset:2048
  v_mfma_f32_16x16x32_bf16 v[128:131], a[96:99], v[172:175], v[128:131]
  ds_read_b128 a[84:87], v207 offset:2048
  buffer_load_dwordx4 v196, s[8:11], s30 offen lds
  v_mfma_f32_16x16x32_bf16 v[128:131], a[128:131], v[188:191], v[128:131]
  ds_read_b128 a[72:75], v206 offset:4096
  ds_read_b128 a[88:91], v207 offset:4096
  v_mfma_f32_16x16x32_bf16 v[132:135], a[100:103], v[172:175], v[132:135]
  ds_read_b128 a[76:79], v206 offset:6144
  v_mfma_f32_16x16x32_bf16 v[132:135], a[132:135], v[188:191], v[132:135]
  ds_read_b128 a[92:95], v207 offset:6144
  v_mfma_f32_16x16x32_bf16 v[136:139], a[104:107], v[172:175], v[136:139]
  buffer_load_dwordx4 v197, s[8:11], s30 offen offset:1024 lds
  v_mfma_f32_16x16x32_bf16 v[136:139], a[136:139], v[188:191], v[136:139]
  v_mfma_f32_16x16x32_bf16 v[140:143], a[108:111], v[172:175], v[140:143]
  v_mfma_f32_16x16x32_bf16 v[140:143], a[140:143], v[188:191], v[140:143]
  v_mfma_f32_16x16x32_bf16 v[144:147], a[112:115], v[172:175], v[144:147]
  buffer_load_dwordx4 v198, s[8:11], s30 offen offset:2048 lds
  v_mfma_f32_16x16x32_bf16 v[144:147], a[144:147], v[188:191], v[144:147]
  v_mfma_f32_16x16x32_bf16 v[148:151], a[116:119], v[172:175], v[148:151]
  v_mfma_f32_16x16x32_bf16 v[148:151], a[148:151], v[188:191], v[148:151]
  v_mfma_f32_16x16x32_bf16 v[152:155], a[120:123], v[172:175], v[152:155]
  buffer_load_dwordx4 v199, s[8:11], s30 offen offset:3072 lds
  v_mfma_f32_16x16x32_bf16 v[152:155], a[152:155], v[188:191], v[152:155]
  v_mfma_f32_16x16x32_bf16 v[156:159], a[124:127], v[172:175], v[156:159]
  v_mfma_f32_16x16x32_bf16 v[156:159], a[156:159], v[188:191], v[156:159]
  s_add_u32 m0, s39, 32768
  v_mfma_f32_16x16x32_bf16 v[32:35], a[160:163], a[224:227], v[32:35]
  buffer_load_dwordx4 v200, s[12:15], s31 offen lds
  v_mfma_f32_16x16x32_bf16 v[32:35], a[192:195], a[240:243], v[32:35]
  v_mfma_f32_16x16x32_bf16 v[36:39], a[164:167], a[224:227], v[36:39]
  v_mfma_f32_16x16x32_bf16 v[36:39], a[196:199], a[240:243], v[36:39]
  v_mfma_f32_16x16x32_bf16 v[40:43], a[168:171], a[224:227], v[40:43]
  buffer_load_dwordx4 v201, s[12:15], s31 offen offset:1024 lds
  v_mfma_f32_16x16x32_bf16 v[40:43], a[200:203], a[240:243], v[40:43]
  v_mfma_f32_16x16x32_bf16 v[44:47], a[172:175], a[224:227], v[44:47]
  s_waitcnt vmcnt(10) lgkmcnt(0)
  s_barrier
  v_mfma_f32_16x16x32_bf16 v[44:47], a[204:207], a[240:243], v[44:47]
  ds_read_b128 v[160:163], v208
  ds_read_b128 v[176:179], v209
  v_mfma_f32_16x16x32_bf16 v[48:51], a[176:179], a[224:227], v[48:51]
  ds_read_b64_tr_b16 a[96:97], v210 offset:16384
  buffer_load_dwordx4 v202, s[12:15], s31 offen offset:2048 lds
  v_mfma_f32_16x16x32_bf16 v[48:51], a[208:211], a[240:243], v[48:51]
  ds_read_b64_tr_b16 a[98:99], v210 offset:17408
  v_mfma_f32_16x16x32_bf16 v[52:55], a[180:183], a[224:227], v[52:55]
  ds_read_b64_tr_b16 a[128:129], v210 offset:24576
  ds_read_b64_tr_b16 a[130:131], v210 offset:25600
  v_mfma_f32_16x16x32_bf16 v[52:55], a[212:215], a[240:243], v[52:55]
  ds_read_b64_tr_b16 a[100:101], v211 offset:16384
  v_mfma_f32_16x16x32_bf16 v[56:59], a[184:187], a[224:227], v[56:59]
  ds_read_b64_tr_b16 a[102:103], v211 offset:17408
  buffer_load_dwordx4 v203, s[12:15], s31 offen offset:3072 lds
  v_mfma_f32_16x16x32_bf16 v[56:59], a[216:219], a[240:243], v[56:59]
  s_add_u32 s32, s32, 1
  ds_read_b64_tr_b16 a[132:133], v211 offset:24576
  ds_read_b64_tr_b16 a[134:135], v211 offset:25600
  v_mfma_f32_16x16x32_bf16 v[60:63], a[188:191], a[224:227], v[60:63]
  s_cmp_eq_u32 s32, 10
  s_cselect_b32 s32, 0, s32
  ds_read_b64_tr_b16 a[104:105], v212 offset:16384
  v_mfma_f32_16x16x32_bf16 v[60:63], a[220:223], a[240:243], v[60:63]
  s_lshl_b32 s30, s32, 7
  ds_read_b64_tr_b16 a[106:107], v212 offset:17408
  v_mfma_f32_16x16x32_bf16 v[64:67], a[160:163], a[228:231], v[64:67]
  s_lshl_b32 s31, s32, 19
  ds_read_b64_tr_b16 a[136:137], v212 offset:24576
  ds_read_b64_tr_b16 a[138:139], v212 offset:25600
  v_mfma_f32_16x16x32_bf16 v[64:67], a[192:195], a[244:247], v[64:67]
  s_add_u32 m0, s40, 0
  ds_read_b64_tr_b16 a[108:109], v213 offset:16384
  v_mfma_f32_16x16x32_bf16 v[68:71], a[164:167], a[228:231], v[68:71]
  ds_read_b64_tr_b16 a[110:111], v213 offset:17408
  buffer_load_dwordx4 v236, s[16:19], s33 offen nt lds
  v_mfma_f32_16x16x32_bf16 v[68:71], a[196:199], a[244:247], v[68:71]
  ds_read_b64_tr_b16 a[140:141], v213 offset:24576
  ds_read_b64_tr_b16 a[142:143], v213 offset:25600
  v_mfma_f32_16x16x32_bf16 v[72:75], a[168:171], a[228:231], v[72:75]
  ds_read_b64_tr_b16 a[112:113], v214 offset:16384
  v_mfma_f32_16x16x32_bf16 v[72:75], a[200:203], a[244:247], v[72:75]
  ds_read_b64_tr_b16 a[114:115], v214 offset:17408
  v_mfma_f32_16x16x32_bf16 v[76:79], a[172:175], a[228:231], v[76:79]
  ds_read_b64_tr_b16 a[144:145], v214 offset:24576
  ds_read_b64_tr_b16 a[146:147], v214 offset:25600
  v_mfma_f32_16x16x32_bf16 v[76:79], a[204:207], a[244:247], v[76:79]
  ds_read_b64_tr_b16 a[116:117], v215 offset:16384
  v_mfma_f32_16x16x32_bf16 v[80:83], a[176:179], a[228:231], v[80:83]
  ds_read_b64_tr_b16 a[118:119], v215 offset:17408
  v_mfma_f32_16x16x32_bf16 v[80:83], a[208:211], a[244:247], v[80:83]
  ds_read_b64_tr_b16 a[148:149], v215 offset:24576
  ds_read_b64_tr_b16 a[150:151], v215 offset:25600
  v_mfma_f32_16x16x32_bf16 v[84:87], a[180:183], a[228:231], v[84:87]
  ds_read_b64_tr_b16 a[120:121], v216 offset:16384
  v_mfma_f32_16x16x32_bf16 v[84:87], a[212:215], a[244:247], v[84:87]
  ds_read_b64_tr_b16 a[122:123], v216 offset:17408
  v_mfma_f32_16x16x32_bf16 v[88:91], a[184:187], a[228:231], v[88:91]
  ds_read_b64_tr_b16 a[152:153], v216 offset:24576
  ds_read_b64_tr_b16 a[154:155], v216 offset:25600
  v_mfma_f32_16x16x32_bf16 v[88:91], a[216:219], a[244:247], v[88:91]
  ds_read_b64_tr_b16 a[124:125], v217 offset:16384
  v_mfma_f32_16x16x32_bf16 v[92:95], a[188:191], a[228:231], v[92:95]
  ds_read_b64_tr_b16 a[126:127], v217 offset:17408
  buffer_load_dwordx4 v237, s[16:19], s33 offen offset:1024 nt lds
  v_mfma_f32_16x16x32_bf16 v[92:95], a[220:223], a[244:247], v[92:95]
  ds_read_b64_tr_b16 a[156:157], v217 offset:24576
  ds_read_b64_tr_b16 a[158:159], v217 offset:25600
  v_mfma_f32_16x16x32_bf16 v[96:99], a[160:163], a[232:235], v[96:99]
  ds_read_b128 v[164:167], v208 offset:2048
  v_mfma_f32_16x16x32_bf16 v[96:99], a[192:195], a[248:251], v[96:99]
  ds_read_b128 v[180:183], v209 offset:2048
  v_mfma_f32_16x16x32_bf16 v[100:103], a[164:167], a[232:235], v[100:103]
  ds_read_b128 v[168:171], v208 offset:4096
  ds_read_b128 v[184:187], v209 offset:4096
  v_mfma_f32_16x16x32_bf16 v[100:103], a[196:199], a[248:251], v[100:103]
  ds_read_b128 v[172:175], v208 offset:6144
  v_mfma_f32_16x16x32_bf16 v[104:107], a[168:171], a[232:235], v[104:107]
  ds_read_b128 v[188:191], v209 offset:6144
  v_mfma_f32_16x16x32_bf16 v[104:107], a[200:203], a[248:251], v[104:107]
  v_mfma_f32_16x16x32_bf16 v[108:111], a[172:175], a[232:235], v[108:111]
  v_mfma_f32_16x16x32_bf16 v[108:111], a[204:207], a[248:251], v[108:111]
  v_mfma_f32_16x16x32_bf16 v[112:115], a[176:179], a[232:235], v[112:115]
  v_mfma_f32_16x16x32_bf16 v[112:115], a[208:211], a[248:251], v[112:115]
  v_mfma_f32_16x16x32_bf16 v[116:119], a[180:183], a[232:235], v[116:119]
  buffer_load_dwordx4 v238, s[16:19], s33 offen offset:2048 nt lds
  v_mfma_f32_16x16x32_bf16 v[116:119], a[212:215], a[248:251], v[116:119]
  v_mfma_f32_16x16x32_bf16 v[120:123], a[184:187], a[232:235], v[120:123]
  v_mfma_f32_16x16x32_bf16 v[120:123], a[216:219], a[248:251], v[120:123]
  v_mfma_f32_16x16x32_bf16 v[124:127], a[188:191], a[232:235], v[124:127]
  v_mfma_f32_16x16x32_bf16 v[124:127], a[220:223], a[248:251], v[124:127]
  v_mfma_f32_16x16x32_bf16 v[128:131], a[160:163], a[236:239], v[128:131]
  v_mfma_f32_16x16x32_bf16 v[128:131], a[192:195], a[252:255], v[128:131]
  v_mfma_f32_16x16x32_bf16 v[132:135], a[164:167], a[236:239], v[132:135]
  v_mfma_f32_16x16x32_bf16 v[132:135], a[196:199], a[252:255], v[132:135]
  v_mfma_f32_16x16x32_bf16 v[136:139], a[168:171], a[236:239], v[136:139]
  v_mfma_f32_16x16x32_bf16 v[136:139], a[200:203], a[252:255], v[136:139]
  v_mfma_f32_16x16x32_bf16 v[140:143], a[172:175], a[236:239], v[140:143]
  buffer_load_dwordx4 v239, s[16:19], s33 offen offset:3072 nt lds
  v_mfma_f32_16x16x32_bf16 v[140:143], a[204:207], a[252:255], v[140:143]
  v_mfma_f32_16x16x32_bf16 v[144:147], a[176:179], a[236:239], v[144:147]
  v_mfma_f32_16x16x32_bf16 v[144:147], a[208:211], a[252:255], v[144:147]
  v_mfma_f32_16x16x32_bf16 v[148:151], a[180:183], a[236:239], v[148:151]
  v_mfma_f32_16x16x32_bf16 v[148:151], a[212:215], a[252:255], v[148:151]
  v_mfma_f32_16x16x32_bf16 v[152:155], a[184:187], a[236:239], v[152:155]
  v_mfma_f32_16x16x32_bf16 v[152:155], a[216:219], a[252:255], v[152:155]
  v_mfma_f32_16x16x32_bf16 v[156:159], a[188:191], a[236:239], v[156:159]
  v_mfma_f32_16x16x32_bf16 v[156:159], a[220:223], a[252:255], v[156:159]
  v_mfma_f32_16x16x32_bf16 v[32:35], a[0:3], a[64:67], v[32:35]
  s_waitcnt vmcnt(4) lgkmcnt(0)
  s_barrier
  v_mfma_f32_16x16x32_bf16 v[32:35], a[32:35], a[80:83], v[32:35]
  s_add_u32 m0, s40, 65536
  ds_read_b128 a[224:227], v204
  ds_read_b128 a[240:243], v205
  v_mfma_f32_16x16x32_bf16 v[36:39], a[4:7], a[64:67], v[36:39]
  ds_read_b64_tr_b16 a[160:161], v210 offset:32768
  buffer_load_dwordx4 v240, s[20:23], s33 offen nt lds
  v_mfma_f32_16x16x32_bf16 v[36:39], a[36:39], a[80:83], v[36:39]
  ds_read_b64_tr_b16 a[162:163], v210 offset:33792
  v_mfma_f32_16x16x32_bf16 v[40:43], a[8:11], a[64:67], v[40:43]
  ds_read_b64_tr_b16 a[192:193], v210 offset:40960
  ds_read_b64_tr_b16 a[194:195], v210 offset:41984
  v_mfma_f32_16x16x32_bf16 v[40:43], a[40:43], a[80:83], v[40:43]
  ds_read_b64_tr_b16 a[164:165], v211 offset:32768
  v_mfma_f32_16x16x32_bf16 v[44:47], a[12:15], a[64:67], v[44:47]
  ds_read_b64_tr_b16 a[166:167], v211 offset:33792
  v_mfma_f32_16x16x32_bf16 v[44:47], a[44:47], a[80:83], v[44:47]
  ds_read_b64_tr_b16 a[196:197], v211 offset:40960
  ds_read_b64_tr_b16 a[198:199], v211 offset:41984
  v_mfma_f32_16x16x32_bf16 v[48:51], a[16:19], a[64:67], v[48:51]
  ds_read_b64_tr_b16 a[168:169], v212 offset:32768
  v_mfma_f32_16x16x32_bf16 v[48:51], a[48:51], a[80:83], v[48:51]
  ds_read_b64_tr_b16 a[170:171], v212 offset:33792
  v_mfma_f32_16x16x32_bf16 v[52:55], a[20:23], a[64:67], v[52:55]
  ds_read_b64_tr_b16 a[200:201], v212 offset:40960
  ds_read_b64_tr_b16 a[202:203], v212 offset:41984
  v_mfma_f32_16x16x32_bf16 v[52:55], a[52:55], a[80:83], v[52:55]
  ds_read_b64_tr_b16 a[172:173], v213 offset:32768
  v_mfma_f32_16x16x32_bf16 v[56:59], a[24:27], a[64:67], v[56:59]
  ds_read_b64_tr_b16 a[174:175], v213 offset:33792
  v_mfma_f32_16x16x32_bf16 v[56:59], a[56:59], a[80:83], v[56:59]
  ds_read_b64_tr_b16 a[204:205], v213 offset:40960
  ds_read_b64_tr_b16 a[206:207], v213 offset:41984
  v_mfma_f32_16x16x32_bf16 v[60:63], a[28:31], a[64:67], v[60:63]
  ds_read_b64_tr_b16 a[176:177], v214 offset:32768
  buffer_load_dwordx4 v241, s[20:23], s33 offen offset:1024 nt lds
  v_mfma_f32_16x16x32_bf16 v[60:63], a[60:63], a[80:83], v[60:63]
  ds_read_b64_tr_b16 a[178:179], v214 offset:33792
  v_mfma_f32_16x16x32_bf16 v[64:67], a[0:3], a[68:71], v[64:67]
  ds_read_b64_tr_b16 a[208:209], v214 offset:40960
  ds_read_b64_tr_b16 a[210:211], v214 offset:41984
  v_mfma_f32_16x16x32_bf16 v[64:67], a[32:35], a[84:87], v[64:67]
  ds_read_b64_tr_b16 a[180:181], v215 offset:32768
  v_mfma_f32_16x16x32_bf16 v[68:71], a[4:7], a[68:71], v[68:71]
  ds_read_b64_tr_b16 a[182:183], v215 offset:33792
  v_mfma_f32_16x16x32_bf16 v[68:71], a[36:39], a[84:87], v[68:71]
  ds_read_b64_tr_b16 a[212:213], v215 offset:40960
  ds_read_b64_tr_b16 a[214:215], v215 offset:41984
  v_mfma_f32_16x16x32_bf16 v[72:75], a[8:11], a[68:71], v[72:75]
  ds_read_b64_tr_b16 a[184:185], v216 offset:32768
  v_mfma_f32_16x16x32_bf16 v[72:75], a[40:43], a[84:87], v[72:75]
  ds_read_b64_tr_b16 a[186:187], v216 offset:33792
  v_mfma_f32_16x16x32_bf16 v[76:79], a[12:15], a[68:71], v[76:79]
  ds_read_b64_tr_b16 a[216:217], v216 offset:40960
  ds_read_b64_tr_b16 a[218:219], v216 offset:41984
  v_mfma_f32_16x16x32_bf16 v[76:79], a[44:47], a[84:87], v[76:79]
  ds_read_b64_tr_b16 a[188:189], v217 offset:32768
  v_mfma_f32_16x16x32_bf16 v[80:83], a[16:19], a[68:71], v[80:83]
  ds_read_b64_tr_b16 a[190:191], v217 offset:33792
  v_mfma_f32_16x16x32_bf16 v[80:83], a[48:51], a[84:87], v[80:83]
  ds_read_b64_tr_b16 a[220:221], v217 offset:40960
  ds_read_b64_tr_b16 a[222:223], v217 offset:41984
  v_mfma_f32_16x16x32_bf16 v[84:87], a[20:23], a[68:71], v[84:87]
  ds_read_b128 a[228:231], v204 offset:2048
  buffer_load_dwordx4 v240, s[20:23], s33 offen offset:2048 nt lds
  v_mfma_f32_16x16x32_bf16 v[84:87], a[52:55], a[84:87], v[84:87]
  ds_read_b128 a[244:247], v205 offset:2048
  v_mfma_f32_16x16x32_bf16 v[88:91], a[24:27], a[68:71], v[88:91]
  ds_read_b128 a[232:235], v204 offset:4096
  ds_read_b128 a[248:251], v205 offset:4096
  v_mfma_f32_16x16x32_bf16 v[88:91], a[56:59], a[84:87], v[88:91]
  ds_read_b128 a[236:239], v204 offset:6144
  v_mfma_f32_16x16x32_bf16 v[92:95], a[28:31], a[68:71], v[92:95]
  ds_read_b128 a[252:255], v205 offset:6144
  v_mfma_f32_16x16x32_bf16 v[92:95], a[60:63], a[84:87], v[92:95]
  v_mfma_f32_16x16x32_bf16 v[96:99], a[0:3], a[72:75], v[96:99]
  v_mfma_f32_16x16x32_bf16 v[96:99], a[32:35], a[88:91], v[96:99]
  v_mfma_f32_16x16x32_bf16 v[100:103], a[4:7], a[72:75], v[100:103]
  v_mfma_f32_16x16x32_bf16 v[100:103], a[36:39], a[88:91], v[100:103]
  v_mfma_f32_16x16x32_bf16 v[104:107], a[8:11], a[72:75], v[104:107]
  s_waitcnt lgkmcnt(0)
  s_barrier
  v_mfma_f32_16x16x32_bf16 v[104:107], a[40:43], a[88:91], v[104:107]
  v_mfma_f32_16x16x32_bf16 v[108:111], a[12:15], a[72:75], v[108:111]
  buffer_load_dwordx4 v241, s[20:23], s33 offen offset:3072 nt lds
  v_mfma_f32_16x16x32_bf16 v[108:111], a[44:47], a[88:91], v[108:111]
  v_mfma_f32_16x16x32_bf16 v[112:115], a[16:19], a[72:75], v[112:115]
  v_mfma_f32_16x16x32_bf16 v[112:115], a[48:51], a[88:91], v[112:115]
  v_mfma_f32_16x16x32_bf16 v[116:119], a[20:23], a[72:75], v[116:119]
  v_mfma_f32_16x16x32_bf16 v[116:119], a[52:55], a[88:91], v[116:119]
  v_mfma_f32_16x16x32_bf16 v[120:123], a[24:27], a[72:75], v[120:123]
  v_mfma_f32_16x16x32_bf16 v[120:123], a[56:59], a[88:91], v[120:123]
  v_mfma_f32_16x16x32_bf16 v[124:127], a[28:31], a[72:75], v[124:127]
  v_mfma_f32_16x16x32_bf16 v[124:127], a[60:63], a[88:91], v[124:127]
  v_mfma_f32_16x16x32_bf16 v[128:131], a[0:3], a[76:79], v[128:131]
  s_add_u32 s33, s33, 16384
  v_mfma_f32_16x16x32_bf16 v[128:131], a[32:35], a[92:95], v[128:131]
  s_add_u32 m0, s40, 16384
  v_mfma_f32_16x16x32_bf16 v[132:135], a[4:7], a[76:79], v[132:135]
  buffer_load_dwordx4 v236, s[16:19], s33 offen nt lds
  v_mfma_f32_16x16x32_bf16 v[132:135], a[36:39], a[92:95], v[132:135]
  v_mfma_f32_16x16x32_bf16 v[136:139], a[8:11], a[76:79], v[136:139]
  v_mfma_f32_16x16x32_bf16 v[136:139], a[40:43], a[92:95], v[136:139]
  v_mfma_f32_16x16x32_bf16 v[140:143], a[12:15], a[76:79], v[140:143]
  v_mfma_f32_16x16x32_bf16 v[140:143], a[44:47], a[92:95], v[140:143]
  v_mfma_f32_16x16x32_bf16 v[144:147], a[16:19], a[76:79], v[144:147]
  v_mfma_f32_16x16x32_bf16 v[144:147], a[48:51], a[92:95], v[144:147]
  v_mfma_f32_16x16x32_bf16 v[148:151], a[20:23], a[76:79], v[148:151]
  v_mfma_f32_16x16x32_bf16 v[148:151], a[52:55], a[92:95], v[148:151]
  v_mfma_f32_16x16x32_bf16 v[152:155], a[24:27], a[76:79], v[152:155]
  v_mfma_f32_16x16x32_bf16 v[152:155], a[56:59], a[92:95], v[152:155]
  v_mfma_f32_16x16x32_bf16 v[156:159], a[28:31], a[76:79], v[156:159]
  buffer_load_dwordx4 v237, s[16:19], s33 offen offset:1024 nt lds
  v_mfma_f32_16x16x32_bf16 v[156:159], a[60:63], a[92:95], v[156:159]
  v_mfma_f32_16x16x32_bf16 v[32:35], a[96:99], v[160:163], v[32:35]
  v_mfma_f32_16x16x32_bf16 v[32:35], a[128:131], v[176:179], v[32:35]
  v_mfma_f32_16x16x32_bf16 v[32:35], a[160:163], a[224:227], v[32:35]
  s_mul_i32 s52, s3, 1310720
  v_mfma_f32_16x16x32_bf16 v[32:35], a[192:195], a[240:243], v[32:35]
  v_mfma_f32_16x16x32_bf16 v[36:39], a[100:103], v[160:163], v[36:39]
  s_lshl_b32 s53, s55, 7
  v_mfma_f32_16x16x32_bf16 v[36:39], a[132:135], v[176:179], v[36:39]
  v_mfma_f32_16x16x32_bf16 v[36:39], a[164:167], a[224:227], v[36:39]
  s_add_u32 s52, s52, s53
  v_mfma_f32_16x16x32_bf16 v[36:39], a[196:199], a[240:243], v[36:39]
  v_mfma_f32_16x16x32_bf16 v[40:43], a[104:107], v[160:163], v[40:43]
  s_add_u32 s8, s56, s52
  s_addc_u32 s9, s57, 0
  v_mfma_f32_16x16x32_bf16 v[40:43], a[136:139], v[176:179], v[40:43]
  v_mfma_f32_16x16x32_bf16 v[40:43], a[168:171], a[224:227], v[40:43]
  s_mov_b32 s10, 1309568
  buffer_load_dwordx4 v238, s[16:19], s33 offen offset:2048 nt lds
  v_mfma_f32_16x16x32_bf16 v[40:43], a[200:203], a[240:243], v[40:43]
  v_mfma_f32_16x16x32_bf16 v[44:47], a[108:111], v[160:163], v[44:47]
  s_mov_b32 s11, 0x20000
  v_mfma_f32_16x16x32_bf16 v[44:47], a[140:143], v[176:179], v[44:47]
  v_mfma_f32_16x16x32_bf16 v[44:47], a[172:175], a[224:227], v[44:47]
  s_mul_i32 s52, s43, 15
  v_mfma_f32_16x16x32_bf16 v[44:47], a[204:207], a[240:243], v[44:47]
  v_mfma_f32_16x16x32_bf16 v[48:51], a[112:115], v[160:163], v[48:51]
  s_mul_i32 s53, s54, 5
  v_mfma_f32_16x16x32_bf16 v[48:51], a[144:147], v[176:179], v[48:51]
  v_mfma_f32_16x16x32_bf16 v[48:51], a[176:179], a[224:227], v[48:51]
  s_add_u32 s52, s52, s53
  v_mfma_f32_16x16x32_bf16 v[48:51], a[208:211], a[240:243], v[48:51]
  v_mfma_f32_16x16x32_bf16 v[52:55], a[116:119], v[160:163], v[52:55]
  s_lshl_b32 s52, s52, 17
  v_mfma_f32_16x16x32_bf16 v[52:55], a[148:151], v[176:179], v[52:55]
  v_mfma_f32_16x16x32_bf16 v[52:55], a[180:183], a[224:227], v[52:55]
  s_lshl_b32 s53, s3, 15
  buffer_load_dwordx4 v239, s[16:19], s33 offen offset:3072 nt lds
  v_mfma_f32_16x16x32_bf16 v[52:55], a[212:215], a[240:243], v[52:55]
  v_mfma_f32_16x16x32_bf16 v[56:59], a[120:123], v[160:163], v[56:59]
  s_add_u32 s52, s52, s53
  v_mfma_f32_16x16x32_bf16 v[56:59], a[152:155], v[176:179], v[56:59]
  v_mfma_f32_16x16x32_bf16 v[56:59], a[184:187], a[224:227], v[56:59]
  s_add_u32 s12, s48, s52
  s_addc_u32 s13, s49, 0
  v_mfma_f32_16x16x32_bf16 v[56:59], a[216:219], a[240:243], v[56:59]
  v_mfma_f32_16x16x32_bf16 v[60:63], a[124:127], v[160:163], v[60:63]
  s_mov_b32 s14, 557056
  v_mfma_f32_16x16x32_bf16 v[60:63], a[156:159], v[176:179], v[60:63]
  v_mfma_f32_16x16x32_bf16 v[60:63], a[188:191], a[224:227], v[60:63]
  s_mov_b32 s15, 0x20000
  v_mfma_f32_16x16x32_bf16 v[60:63], a[220:223], a[240:243], v[60:63]
  v_mfma_f32_16x16x32_bf16 v[64:67], a[96:99], v[164:167], v[64:67]
  v_mfma_f32_16x16x32_bf16 v[64:67], a[128:131], v[180:183], v[64:67]
  s_add_u32 m0, s40, 81920
  v_mfma_f32_16x16x32_bf16 v[64:67], a[160:163], a[228:231], v[64:67]
  buffer_load_dwordx4 v240, s[20:23], s33 offen nt lds
  v_mfma_f32_16x16x32_bf16 v[64:67], a[192:195], a[244:247], v[64:67]
  v_mfma_f32_16x16x32_bf16 v[68:71], a[100:103], v[164:167], v[68:71]
  v_mul_f32 v32, s44, v32
  v_mul_f32 v33, s44, v33
  v_mfma_f32_16x16x32_bf16 v[68:71], a[132:135], v[180:183], v[68:71]
  v_mul_f32 v34, s44, v34
  v_mul_f32 v35, s44, v35
  v_mfma_f32_16x16x32_bf16 v[68:71], a[164:167], a[228:231], v[68:71]
  v_mul_f32 v36, s44, v36
  v_mul_f32 v37, s44, v37
  v_mfma_f32_16x16x32_bf16 v[68:71], a[196:199], a[244:247], v[68:71]
  v_mul_f32 v38, s44, v38
  v_mul_f32 v39, s44, v39
  v_mfma_f32_16x16x32_bf16 v[72:75], a[104:107], v[164:167], v[72:75]
  v_cvt_pk_bf16_f32 v16, v32, v33
  v_cvt_pk_bf16_f32 v17, v34, v35
  v_mfma_f32_16x16x32_bf16 v[72:75], a[136:139], v[180:183], v[72:75]
  v_cvt_pk_bf16_f32 v18, v36, v37
  v_cvt_pk_bf16_f32 v19, v38, v39
  v_mfma_f32_16x16x32_bf16 v[72:75], a[168:171], a[228:231], v[72:75]
  v_permlane16_swap_b32 v16, v18
  v_permlane16_swap_b32 v17, v19
  v_mfma_f32_16x16x32_bf16 v[72:75], a[200:203], a[244:247], v[72:75]
  v_mul_f32 v40, s44, v40
  v_mul_f32 v41, s44, v41
  v_mfma_f32_16x16x32_bf16 v[76:79], a[108:111], v[164:167], v[76:79]
  v_mul_f32 v42, s44, v42
  v_mul_f32 v43, s44, v43
  v_mfma_f32_16x16x32_bf16 v[76:79], a[140:143], v[180:183], v[76:79]
  v_mul_f32 v44, s44, v44
  v_mul_f32 v45, s44, v45
  v_mfma_f32_16x16x32_bf16 v[76:79], a[172:175], a[228:231], v[76:79]
  buffer_load_dwordx4 v241, s[20:23], s33 offen offset:1024 nt lds
  v_mul_f32 v46, s44, v46
  v_mul_f32 v47, s44, v47
  v_mfma_f32_16x16x32_bf16 v[76:79], a[204:207], a[244:247], v[76:79]
  v_cvt_pk_bf16_f32 v20, v40, v41
  v_cvt_pk_bf16_f32 v21, v42, v43
  v_mfma_f32_16x16x32_bf16 v[80:83], a[112:115], v[164:167], v[80:83]
  v_cvt_pk_bf16_f32 v22, v44, v45
  v_cvt_pk_bf16_f32 v23, v46, v47
  v_mfma_f32_16x16x32_bf16 v[80:83], a[144:147], v[180:183], v[80:83]
  v_accvgpr_write_b32 a0, v16
  v_accvgpr_write_b32 a1, v17
  v_mfma_f32_16x16x32_bf16 v[80:83], a[176:179], a[228:231], v[80:83]
  v_accvgpr_write_b32 a2, v18
  v_accvgpr_write_b32 a3, v19
  v_mfma_f32_16x16x32_bf16 v[80:83], a[208:211], a[244:247], v[80:83]
  v_permlane16_swap_b32 v20, v22
  v_permlane16_swap_b32 v21, v23
  v_mfma_f32_16x16x32_bf16 v[84:87], a[116:119], v[164:167], v[84:87]
  v_mul_f32 v48, s44, v48
  v_mul_f32 v49, s44, v49
  v_mfma_f32_16x16x32_bf16 v[84:87], a[148:151], v[180:183], v[84:87]
  v_mul_f32 v50, s44, v50
  v_mul_f32 v51, s44, v51
  v_mfma_f32_16x16x32_bf16 v[84:87], a[180:183], a[228:231], v[84:87]
  v_mul_f32 v52, s44, v52
  v_mul_f32 v53, s44, v53
  v_mfma_f32_16x16x32_bf16 v[84:87], a[212:215], a[244:247], v[84:87]
  v_mul_f32 v54, s44, v54
  v_mul_f32 v55, s44, v55
  v_mfma_f32_16x16x32_bf16 v[88:91], a[120:123], v[164:167], v[88:91]
  v_cvt_pk_bf16_f32 v16, v48, v49
  v_cvt_pk_bf16_f32 v17, v50, v51
  v_mfma_f32_16x16x32_bf16 v[88:91], a[152:155], v[180:183], v[88:91]
  v_cvt_pk_bf16_f32 v18, v52, v53
  v_cvt_pk_bf16_f32 v19, v54, v55
  v_mfma_f32_16x16x32_bf16 v[88:91], a[184:187], a[228:231], v[88:91]
  buffer_load_dwordx4 v240, s[20:23], s33 offen offset:2048 nt lds
  v_accvgpr_write_b32 a4, v20
  v_accvgpr_write_b32 a5, v21
  v_mfma_f32_16x16x32_bf16 v[88:91], a[216:219], a[244:247], v[88:91]
  v_accvgpr_write_b32 a6, v22
  v_accvgpr_write_b32 a7, v23
  v_mfma_f32_16x16x32_bf16 v[92:95], a[124:127], v[164:167], v[92:95]
  v_permlane16_swap_b32 v16, v18
  v_permlane16_swap_b32 v17, v19
  v_mfma_f32_16x16x32_bf16 v[92:95], a[156:159], v[180:183], v[92:95]
  v_mul_f32 v56, s44, v56
  v_mul_f32 v57, s44, v57
  v_mfma_f32_16x16x32_bf16 v[92:95], a[188:191], a[228:231], v[92:95]
  v_mul_f32 v58, s44, v58
  v_mul_f32 v59, s44, v59
  v_mfma_f32_16x16x32_bf16 v[92:95], a[220:223], a[244:247], v[92:95]
  v_mul_f32 v60, s44, v60
  v_mul_f32 v61, s44, v61
  v_mfma_f32_16x16x32_bf16 v[96:99], a[96:99], v[168:171], v[96:99]
  v_mul_f32 v62, s44, v62
  v_mul_f32 v63, s44, v63
  v_mfma_f32_16x16x32_bf16 v[96:99], a[128:131], v[184:187], v[96:99]
  v_cvt_pk_bf16_f32 v20, v56, v57
  v_cvt_pk_bf16_f32 v21, v58, v59
  v_mfma_f32_16x16x32_bf16 v[96:99], a[160:163], a[232:235], v[96:99]
  v_cvt_pk_bf16_f32 v22, v60, v61
  v_cvt_pk_bf16_f32 v23, v62, v63
  v_mfma_f32_16x16x32_bf16 v[96:99], a[192:195], a[248:251], v[96:99]
  v_accvgpr_write_b32 a8, v16
  v_accvgpr_write_b32 a9, v17
  v_mfma_f32_16x16x32_bf16 v[100:103], a[100:103], v[168:171], v[100:103]
  v_accvgpr_write_b32 a10, v18
  v_accvgpr_write_b32 a11, v19
  v_mfma_f32_16x16x32_bf16 v[100:103], a[132:135], v[184:187], v[100:103]
  v_permlane16_swap_b32 v20, v22
  v_permlane16_swap_b32 v21, v23
  v_mfma_f32_16x16x32_bf16 v[100:103], a[164:167], a[232:235], v[100:103]
  buffer_load_dwordx4 v241, s[20:23], s33 offen offset:3072 nt lds
  v_accvgpr_write_b32 a12, v20
  v_accvgpr_write_b32 a13, v21
  v_mfma_f32_16x16x32_bf16 v[100:103], a[196:199], a[248:251], v[100:103]
  v_accvgpr_write_b32 a14, v22
  v_accvgpr_write_b32 a15, v23
  v_mfma_f32_16x16x32_bf16 v[104:107], a[104:107], v[168:171], v[104:107]
  v_mul_f32 v64, s44, v64
  v_mul_f32 v65, s44, v65
  v_mfma_f32_16x16x32_bf16 v[104:107], a[136:139], v[184:187], v[104:107]
  v_mul_f32 v66, s44, v66
  v_mul_f32 v67, s44, v67
  v_mfma_f32_16x16x32_bf16 v[104:107], a[168:171], a[232:235], v[104:107]
  v_mul_f32 v68, s44, v68
  v_mul_f32 v69, s44, v69
  v_mfma_f32_16x16x32_bf16 v[104:107], a[200:203], a[248:251], v[104:107]
  v_mul_f32 v70, s44, v70
  v_mul_f32 v71, s44, v71
  v_mfma_f32_16x16x32_bf16 v[108:111], a[108:111], v[168:171], v[108:111]
  v_cvt_pk_bf16_f32 v16, v64, v65
  v_cvt_pk_bf16_f32 v17, v66, v67
  v_mfma_f32_16x16x32_bf16 v[108:111], a[140:143], v[184:187], v[108:111]
  v_cvt_pk_bf16_f32 v18, v68, v69
  v_cvt_pk_bf16_f32 v19, v70, v71
  v_mfma_f32_16x16x32_bf16 v[108:111], a[172:175], a[232:235], v[108:111]
  v_permlane16_swap_b32 v16, v18
  v_permlane16_swap_b32 v17, v19
  v_mfma_f32_16x16x32_bf16 v[108:111], a[204:207], a[248:251], v[108:111]
  v_mul_f32 v72, s44, v72
  v_mul_f32 v73, s44, v73
  v_mfma_f32_16x16x32_bf16 v[112:115], a[112:115], v[168:171], v[112:115]
  s_add_u32 s33, s33, 16384
  v_mul_f32 v74, s44, v74
  v_mul_f32 v75, s44, v75
  v_mfma_f32_16x16x32_bf16 v[112:115], a[144:147], v[184:187], v[112:115]
  s_add_u32 m0, s40, 32768
  v_mul_f32 v76, s44, v76
  v_mul_f32 v77, s44, v77
  v_mfma_f32_16x16x32_bf16 v[112:115], a[176:179], a[232:235], v[112:115]
  buffer_load_dwordx4 v236, s[16:19], s33 offen nt lds
  v_mul_f32 v78, s44, v78
  v_mul_f32 v79, s44, v79
  v_mfma_f32_16x16x32_bf16 v[112:115], a[208:211], a[248:251], v[112:115]
  v_cvt_pk_bf16_f32 v20, v72, v73
  v_cvt_pk_bf16_f32 v21, v74, v75
  v_mfma_f32_16x16x32_bf16 v[116:119], a[116:119], v[168:171], v[116:119]
  v_cvt_pk_bf16_f32 v22, v76, v77
  v_cvt_pk_bf16_f32 v23, v78, v79
  v_mfma_f32_16x16x32_bf16 v[116:119], a[148:151], v[184:187], v[116:119]
  v_accvgpr_write_b32 a16, v16
  v_accvgpr_write_b32 a17, v17
  v_mfma_f32_16x16x32_bf16 v[116:119], a[180:183], a[232:235], v[116:119]
  v_accvgpr_write_b32 a18, v18
  v_accvgpr_write_b32 a19, v19
  v_mfma_f32_16x16x32_bf16 v[116:119], a[212:215], a[248:251], v[116:119]
  v_permlane16_swap_b32 v20, v22
  v_permlane16_swap_b32 v21, v23
  v_mfma_f32_16x16x32_bf16 v[120:123], a[120:123], v[168:171], v[120:123]
  v_mul_f32 v80, s44, v80
  v_mul_f32 v81, s44, v81
  v_mfma_f32_16x16x32_bf16 v[120:123], a[152:155], v[184:187], v[120:123]
  v_mul_f32 v82, s44, v82
  v_mul_f32 v83, s44, v83
  v_mfma_f32_16x16x32_bf16 v[120:123], a[184:187], a[232:235], v[120:123]
  v_mul_f32 v84, s44, v84
  v_mul_f32 v85, s44, v85
  v_mfma_f32_16x16x32_bf16 v[120:123], a[216:219], a[248:251], v[120:123]
  v_mul_f32 v86, s44, v86
  v_mul_f32 v87, s44, v87
  v_mfma_f32_16x16x32_bf16 v[124:127], a[124:127], v[168:171], v[124:127]
  v_cvt_pk_bf16_f32 v16, v80, v81
  v_cvt_pk_bf16_f32 v17, v82, v83
  v_mfma_f32_16x16x32_bf16 v[124:127], a[156:159], v[184:187], v[124:127]
  v_cvt_pk_bf16_f32 v18, v84, v85
  v_cvt_pk_bf16_f32 v19, v86, v87
  v_mfma_f32_16x16x32_bf16 v[124:127], a[188:191], a[232:235], v[124:127]
  buffer_load_dwordx4 v237, s[16:19], s33 offen offset:1024 nt lds
  v_accvgpr_write_b32 a20, v20
  v_accvgpr_write_b32 a21, v21
  v_mfma_f32_16x16x32_bf16 v[124:127], a[220:223], a[248:251], v[124:127]
  s_waitcnt vmcnt(10)
  s_barrier
  v_accvgpr_write_b32 a22, v22
  v_accvgpr_write_b32 a23, v23
  v_mfma_f32_16x16x32_bf16 v[128:131], a[96:99], v[172:175], v[128:131]
  ds_read_b128 a[64:67], v224 offset:0
  v_permlane16_swap_b32 v16, v18
  v_mfma_f32_16x16x32_bf16 v[128:131], a[128:131], v[188:191], v[128:131]
  v_permlane16_swap_b32 v17, v19
  v_mul_f32 v88, s44, v88
  v_mfma_f32_16x16x32_bf16 v[128:131], a[160:163], a[236:239], v[128:131]
  ds_read_b128 a[68:71], v225 offset:0
  v_mul_f32 v89, s44, v89
  v_mfma_f32_16x16x32_bf16 v[128:131], a[192:195], a[252:255], v[128:131]
  v_mul_f32 v90, s44, v90
  v_mul_f32 v91, s44, v91
  v_mfma_f32_16x16x32_bf16 v[132:135], a[100:103], v[172:175], v[132:135]
  ds_read_b128 a[72:75], v226 offset:0
  v_mul_f32 v92, s44, v92
  v_mfma_f32_16x16x32_bf16 v[132:135], a[132:135], v[188:191], v[132:135]
  v_mul_f32 v93, s44, v93
  v_mul_f32 v94, s44, v94
  v_mfma_f32_16x16x32_bf16 v[132:135], a[164:167], a[236:239], v[132:135]
  ds_read_b128 a[76:79], v227 offset:0
  v_mul_f32 v95, s44, v95
  v_mfma_f32_16x16x32_bf16 v[132:135], a[196:199], a[252:255], v[132:135]
  v_cvt_pk_bf16_f32 v20, v88, v89
  v_cvt_pk_bf16_f32 v21, v90, v91
  v_mfma_f32_16x16x32_bf16 v[136:139], a[104:107], v[172:175], v[136:139]
  ds_read_b128 a[80:83], v224 offset:4096
  v_cvt_pk_bf16_f32 v22, v92, v93
  v_mfma_f32_16x16x32_bf16 v[136:139], a[136:139], v[188:191], v[136:139]
  v_cvt_pk_bf16_f32 v23, v94, v95
  v_accvgpr_write_b32 a24, v16
  v_mfma_f32_16x16x32_bf16 v[136:139], a[168:171], a[236:239], v[136:139]
  ds_read_b128 a[84:87], v225 offset:4096
  buffer_load_dwordx4 v238, s[16:19], s33 offen offset:2048 nt lds
  v_accvgpr_write_b32 a25, v17
  v_mfma_f32_16x16x32_bf16 v[136:139], a[200:203], a[252:255], v[136:139]
  v_accvgpr_write_b32 a26, v18
  v_accvgpr_write_b32 a27, v19
  v_mfma_f32_16x16x32_bf16 v[140:143], a[108:111], v[172:175], v[140:143]
  ds_read_b128 a[88:91], v226 offset:4096
  v_permlane16_swap_b32 v20, v22
  v_mfma_f32_16x16x32_bf16 v[140:143], a[140:143], v[188:191], v[140:143]
  v_permlane16_swap_b32 v21, v23
  v_accvgpr_write_b32 a28, v20
  v_mfma_f32_16x16x32_bf16 v[140:143], a[172:175], a[236:239], v[140:143]
  ds_read_b128 a[92:95], v227 offset:4096
  v_accvgpr_write_b32 a29, v21
  v_mfma_f32_16x16x32_bf16 v[140:143], a[204:207], a[252:255], v[140:143]
  v_accvgpr_write_b32 a30, v22
  v_accvgpr_write_b32 a31, v23
  v_mfma_f32_16x16x32_bf16 v[144:147], a[112:115], v[172:175], v[144:147]
  v_mul_f32 v96, s44, v96
  v_mul_f32 v97, s44, v97
  v_mfma_f32_16x16x32_bf16 v[144:147], a[144:147], v[188:191], v[144:147]
  v_mul_f32 v98, s44, v98
  v_mul_f32 v99, s44, v99
  v_mfma_f32_16x16x32_bf16 v[144:147], a[176:179], a[236:239], v[144:147]
  v_mul_f32 v100, s44, v100
  v_mul_f32 v101, s44, v101
  v_mfma_f32_16x16x32_bf16 v[144:147], a[208:211], a[252:255], v[144:147]
  v_mul_f32 v102, s44, v102
  v_mul_f32 v103, s44, v103
  v_mfma_f32_16x16x32_bf16 v[148:151], a[116:119], v[172:175], v[148:151]
  v_cvt_pk_bf16_f32 v16, v96, v97
  v_cvt_pk_bf16_f32 v17, v98, v99
  v_mfma_f32_16x16x32_bf16 v[148:151], a[148:151], v[188:191], v[148:151]
  v_cvt_pk_bf16_f32 v18, v100, v101
  v_cvt_pk_bf16_f32 v19, v102, v103
  v_mfma_f32_16x16x32_bf16 v[148:151], a[180:183], a[236:239], v[148:151]
  buffer_load_dwordx4 v239, s[16:19], s33 offen offset:3072 nt lds
  v_permlane16_swap_b32 v16, v18
  v_permlane16_swap_b32 v17, v19
  v_mfma_f32_16x16x32_bf16 v[148:151], a[212:215], a[252:255], v[148:151]
  v_mul_f32 v104, s44, v104
  v_mul_f32 v105, s44, v105
  v_mfma_f32_16x16x32_bf16 v[152:155], a[120:123], v[172:175], v[152:155]
  v_mul_f32 v106, s44, v106
  v_mul_f32 v107, s44, v107
  v_mfma_f32_16x16x32_bf16 v[152:155], a[152:155], v[188:191], v[152:155]
  v_mul_f32 v108, s44, v108
  v_mul_f32 v109, s44, v109
  v_mfma_f32_16x16x32_bf16 v[152:155], a[184:187], a[236:239], v[152:155]
  v_mul_f32 v110, s44, v110
  v_mul_f32 v111, s44, v111
  v_mfma_f32_16x16x32_bf16 v[152:155], a[216:219], a[252:255], v[152:155]
  v_cvt_pk_bf16_f32 v20, v104, v105
  v_cvt_pk_bf16_f32 v21, v106, v107
  v_mfma_f32_16x16x32_bf16 v[156:159], a[124:127], v[172:175], v[156:159]
  v_cvt_pk_bf16_f32 v22, v108, v109
  v_cvt_pk_bf16_f32 v23, v110, v111
  v_mfma_f32_16x16x32_bf16 v[156:159], a[156:159], v[188:191], v[156:159]
  v_accvgpr_write_b32 a32, v16
  v_accvgpr_write_b32 a33, v17
  v_mfma_f32_16x16x32_bf16 v[156:159], a[188:191], a[236:239], v[156:159]
  s_waitcnt lgkmcnt(0)
  v_accvgpr_write_b32 a34, v18
  v_accvgpr_write_b32 a35, v19
  v_mfma_f32_16x16x32_bf16 v[156:159], a[220:223], a[252:255], v[156:159]
  v_permlane16_swap_b32 v20, v22
  v_permlane16_swap_b32 v21, v23
  v_mul_f32 v112, s44, v112
  v_mul_f32 v113, s44, v113
  v_mul_f32 v114, s44, v114
  v_mul_f32 v115, s44, v115
  v_mul_f32 v116, s44, v116
  v_mul_f32 v117, s44, v117
  v_mul_f32 v118, s44, v118
  v_mul_f32 v119, s44, v119
  v_cvt_pk_bf16_f32 v16, v112, v113
  v_cvt_pk_bf16_f32 v17, v114, v115
  v_cvt_pk_bf16_f32 v18, v116, v117
  v_cvt_pk_bf16_f32 v19, v118, v119
  v_accvgpr_write_b32 a36, v20
  v_accvgpr_write_b32 a37, v21
  v_accvgpr_write_b32 a38, v22
  v_accvgpr_write_b32 a39, v23
  v_permlane16_swap_b32 v16, v18
  v_permlane16_swap_b32 v17, v19
  v_mul_f32 v120, s44, v120
  v_mul_f32 v121, s44, v121
  v_mul_f32 v122, s44, v122
  v_mul_f32 v123, s44, v123
  v_mul_f32 v124, s44, v124
  v_mul_f32 v125, s44, v125
  v_mul_f32 v126, s44, v126
  v_mul_f32 v127, s44, v127
  v_cvt_pk_bf16_f32 v20, v120, v121
  v_cvt_pk_bf16_f32 v21, v122, v123
  v_cvt_pk_bf16_f32 v22, v124, v125
  v_cvt_pk_bf16_f32 v23, v126, v127
  v_accvgpr_write_b32 a40, v16
  v_accvgpr_write_b32 a41, v17
  v_accvgpr_write_b32 a42, v18
  v_accvgpr_write_b32 a43, v19
  v_permlane16_swap_b32 v20, v22
  v_permlane16_swap_b32 v21, v23
  v_accvgpr_write_b32 a44, v20
  v_accvgpr_write_b32 a45, v21
  v_accvgpr_write_b32 a46, v22
  v_accvgpr_write_b32 a47, v23
  v_mfma_f32_16x16x32_bf16 v[160:163], a[64:67], a[0:3], 0
  s_add_u32 m0, s40, 98304
  ds_read_b64_tr_b16 a[128:129], v228 offset:0
  v_mul_f32 v128, s44, v128
  v_mul_f32 v129, s44, v129
  v_mul_f32 v130, s44, v130
  v_mfma_f32_16x16x32_bf16 v[160:163], a[68:71], a[4:7], v[160:163]
  ds_read_b64_tr_b16 a[130:131], v228 offset:4096
  buffer_load_dwordx4 v240, s[20:23], s33 offen nt lds
  v_mul_f32 v131, s44, v131
  v_mul_f32 v132, s44, v132
  v_mul_f32 v133, s44, v133
  v_mfma_f32_16x16x32_bf16 v[160:163], a[72:75], a[8:11], v[160:163]
  ds_read_b64_tr_b16 a[132:133], v229 offset:0
  v_mul_f32 v134, s44, v134
  v_mul_f32 v135, s44, v135
  v_cvt_pk_bf16_f32 v16, v128, v129
  v_mfma_f32_16x16x32_bf16 v[160:163], a[76:79], a[12:15], v[160:163]
  ds_read_b64_tr_b16 a[134:135], v229 offset:4096
  v_cvt_pk_bf16_f32 v17, v130, v131
  v_cvt_pk_bf16_f32 v18, v132, v133
  v_cvt_pk_bf16_f32 v19, v134, v135
  v_mfma_f32_16x16x32_bf16 v[164:167], a[80:83], a[0:3], 0
  ds_read_b64_tr_b16 a[136:137], v230 offset:0
  v_permlane16_swap_b32 v16, v18
  v_permlane16_swap_b32 v17, v19
  v_mul_f32 v136, s44, v136
  v_mfma_f32_16x16x32_bf16 v[164:167], a[84:87], a[4:7], v[164:167]
  ds_read_b64_tr_b16 a[138:139], v230 offset:4096
  v_mul_f32 v137, s44, v137
  v_mul_f32 v138, s44, v138
  v_mul_f32 v139, s44, v139
  v_mfma_f32_16x16x32_bf16 v[164:167], a[88:91], a[8:11], v[164:167]
  ds_read_b64_tr_b16 a[140:141], v231 offset:0
  v_mul_f32 v140, s44, v140
  v_mul_f32 v141, s44, v141
  v_mul_f32 v142, s44, v142
  v_mfma_f32_16x16x32_bf16 v[164:167], a[92:95], a[12:15], v[164:167]
  ds_read_b64_tr_b16 a[142:143], v231 offset:4096
  v_mul_f32 v143, s44, v143
  v_cvt_pk_bf16_f32 v20, v136, v137
  v_cvt_pk_bf16_f32 v21, v138, v139
  v_mfma_f32_16x16x32_bf16 v[168:171], a[64:67], a[16:19], 0
  ds_read_b64_tr_b16 a[144:145], v232 offset:0
  v_cvt_pk_bf16_f32 v22, v140, v141
  v_cvt_pk_bf16_f32 v23, v142, v143
  v_accvgpr_write_b32 a48, v16
  v_mfma_f32_16x16x32_bf16 v[168:171], a[68:71], a[20:23], v[168:171]
  ds_read_b64_tr_b16 a[146:147], v232 offset:4096
  buffer_load_dwordx4 v241, s[20:23], s33 offen offset:1024 nt lds
  v_accvgpr_write_b32 a49, v17
  v_accvgpr_write_b32 a50, v18
  v_accvgpr_write_b32 a51, v19
  v_mfma_f32_16x16x32_bf16 v[168:171], a[72:75], a[24:27], v[168:171]
  ds_read_b64_tr_b16 a[148:149], v233 offset:0
  v_permlane16_swap_b32 v20, v22
  v_permlane16_swap_b32 v21, v23
  v_mul_f32 v144, s44, v144
  v_mfma_f32_16x16x32_bf16 v[168:171], a[76:79], a[28:31], v[168:171]
  ds_read_b64_tr_b16 a[150:151], v233 offset:4096
  v_mul_f32 v145, s44, v145
  v_mul_f32 v146, s44, v146
  v_mul_f32 v147, s44, v147
  v_mfma_f32_16x16x32_bf16 v[172:175], a[80:83], a[16:19], 0
  ds_read_b64_tr_b16 a[152:153], v234 offset:0
  v_mul_f32 v148, s44, v148
  v_mul_f32 v149, s44, v149
  v_mul_f32 v150, s44, v150
  v_mfma_f32_16x16x32_bf16 v[172:175], a[84:87], a[20:23], v[172:175]
  ds_read_b64_tr_b16 a[154:155], v234 offset:4096
  v_mul_f32 v151, s44, v151
  v_cvt_pk_bf16_f32 v16, v144, v145
  v_cvt_pk_bf16_f32 v17, v146, v147
  v_mfma_f32_16x16x32_bf16 v[172:175], a[88:91], a[24:27], v[172:175]
  ds_read_b64_tr_b16 a[156:157], v235 offset:0
  v_cvt_pk_bf16_f32 v18, v148, v149
  v_cvt_pk_bf16_f32 v19, v150, v151
  v_accvgpr_write_b32 a52, v20
  v_mfma_f32_16x16x32_bf16 v[172:175], a[92:95], a[28:31], v[172:175]
  ds_read_b64_tr_b16 a[158:159], v235 offset:4096
  v_accvgpr_write_b32 a53, v21
  v_accvgpr_write_b32 a54, v22
  v_accvgpr_write_b32 a55, v23
  v_mfma_f32_16x16x32_bf16 v[176:179], a[64:67], a[32:35], 0
  ds_read_b128 a[96:99], v224 offset:8192
  v_permlane16_swap_b32 v16, v18
  v_permlane16_swap_b32 v17, v19
  v_mul_f32 v152, s44, v152
  v_mfma_f32_16x16x32_bf16 v[176:179], a[68:71], a[36:39], v[176:179]
  ds_read_b128 a[100:103], v225 offset:8192
  buffer_load_dwordx4 v240, s[20:23], s33 offen offset:2048 nt lds
  v_mul_f32 v153, s44, v153
  v_mul_f32 v154, s44, v154
  v_mul_f32 v155, s44, v155
  v_mfma_f32_16x16x32_bf16 v[176:179], a[72:75], a[40:43], v[176:179]
  ds_read_b128 a[104:107], v226 offset:8192
  v_mul_f32 v156, s44, v156
  v_mul_f32 v157, s44, v157
  v_mul_f32 v158, s44, v158
  v_mfma_f32_16x16x32_bf16 v[176:179], a[76:79], a[44:47], v[176:179]
  ds_read_b128 a[108:111], v227 offset:8192
  v_mul_f32 v159, s44, v159
  v_cvt_pk_bf16_f32 v20, v152, v153
  v_cvt_pk_bf16_f32 v21, v154, v155
  v_mfma_f32_16x16x32_bf16 v[180:183], a[80:83], a[32:35], 0
  ds_read_b128 a[112:115], v224 offset:12288
  v_cvt_pk_bf16_f32 v22, v156, v157
  v_cvt_pk_bf16_f32 v23, v158, v159
  v_accvgpr_write_b32 a56, v16
  v_mfma_f32_16x16x32_bf16 v[180:183], a[84:87], a[36:39], v[180:183]
  ds_read_b128 a[116:119], v225 offset:12288
  v_accvgpr_write_b32 a57, v17
  v_accvgpr_write_b32 a58, v18
  v_accvgpr_write_b32 a59, v19
  v_mfma_f32_16x16x32_bf16 v[180:183], a[88:91], a[40:43], v[180:183]
  ds_read_b128 a[120:123], v226 offset:12288
  v_permlane16_swap_b32 v20, v22
  v_permlane16_swap_b32 v21, v23
  v_accvgpr_write_b32 a60, v20
  v_mfma_f32_16x16x32_bf16 v[180:183], a[92:95], a[44:47], v[180:183]
  ds_read_b128 a[124:127], v227 offset:12288
  v_accvgpr_write_b32 a61, v21
  v_accvgpr_write_b32 a62, v22
  v_accvgpr_write_b32 a63, v23
  v_max3_f32 v208, v160, v161, v162
  v_max3_f32 v212, v168, v169, v170
  v_mov_b32 v27, 0x3f803f80
  v_max3_f32 v209, v163, v164, v165
  v_max3_f32 v213, v171, v172, v173
  v_max3_f32 v208, v208, v166, v167
  v_max3_f32 v212, v212, v174, v175
  v_accvgpr_write_b32 a208, v27
  v_max3_f32 v208, v208, v209, v242
  v_max3_f32 v212, v212, v213, v243
  v_mov_b32 v209, v208
  v_mov_b32 v213, v212
  v_accvgpr_write_b32 a209, v27
  v_permlane32_swap_b32 v208, v209
  v_permlane32_swap_b32 v212, v213
  v_max_f32 v208, v208, v209
  v_max_f32 v212, v212, v213
  v_accvgpr_write_b32 a210, v27
  v_mov_b32 v209, v208
  v_mov_b32 v213, v212
  s_nop 0
  v_permlane16_swap_b32 v208, v209
  v_permlane16_swap_b32 v212, v213
  v_accvgpr_write_b32 a211, v27
  v_max_f32 v208, v208, v209
  v_max_f32 v212, v212, v213
  v_mfma_f32_16x16x32_bf16 v[184:187], a[64:67], a[48:51], 0
  buffer_load_dwordx4 v241, s[20:23], s33 offen offset:3072 nt lds
  v_sub_f32 v160, v160, v208
  v_max3_f32 v216, v176, v177, v178
  v_sub_f32 v161, v161, v208
  v_sub_f32 v162, v162, v208
  v_sub_f32 v163, v163, v208
  v_max3_f32 v217, v179, v180, v181
  v_mfma_f32_16x16x32_bf16 v[184:187], a[68:71], a[52:55], v[184:187]
  v_sub_f32 v164, v164, v208
  v_sub_f32 v165, v165, v208
  v_max3_f32 v216, v216, v182, v183
  v_sub_f32 v166, v166, v208
  v_sub_f32 v167, v167, v208
  v_max3_f32 v216, v216, v217, v244
  v_mfma_f32_16x16x32_bf16 v[184:187], a[72:75], a[56:59], v[184:187]
  v_exp_f32 v160, v160
  v_exp_f32 v161, v161
  v_exp_f32 v162, v162
  v_mfma_f32_16x16x32_bf16 v[184:187], a[76:79], a[60:63], v[184:187]
  v_mov_b32 v217, v216
  v_exp_f32 v163, v163
  v_exp_f32 v164, v164
  v_permlane32_swap_b32 v216, v217
  v_mfma_f32_16x16x32_bf16 v[188:191], a[80:83], a[48:51], 0
  s_add_u32 s33, s33, 16384
  v_exp_f32 v165, v165
  v_exp_f32 v166, v166
  v_exp_f32 v167, v167
  v_mfma_f32_16x16x32_bf16 v[188:191], a[84:87], a[52:55], v[188:191]
  s_add_u32 m0, s40, 49152
  v_max_f32 v216, v216, v217
  v_sub_f32 v209, 0, v208
  v_sub_f32 v210, 0, v208
  v_mov_b32 v217, v216
  v_sub_f32 v211, 0, v208
  v_sub_f32 v208, 0, v208
  v_mfma_f32_16x16x32_bf16 v[188:191], a[88:91], a[56:59], v[188:191]
  buffer_load_dwordx4 v236, s[16:19], s33 offen nt lds
  v_permlane16_swap_b32 v216, v217
  v_cvt_pk_bf16_f32 v192, v160, v161
  v_cvt_pk_bf16_f32 v193, v162, v163
  v_cvt_pk_bf16_f32 v194, v164, v165
  v_max_f32 v216, v216, v217
  v_cvt_pk_bf16_f32 v195, v166, v167
  v_mfma_f32_16x16x32_bf16 v[188:191], a[92:95], a[60:63], v[188:191]
  s_waitcnt lgkmcnt(0)
  v_mfma_f32_16x16x32_bf16 v[32:35], a[128:131], v[192:195], 0
  v_sub_f32 v168, v168, v212
  v_max3_f32 v220, v184, v185, v186
  v_sub_f32 v169, v169, v212
  v_sub_f32 v170, v170, v212
  v_sub_f32 v171, v171, v212
  v_mfma_f32_16x16x32_bf16 v[36:39], a[132:135], v[192:195], 0
  v_max3_f32 v221, v187, v188, v189
  v_sub_f32 v172, v172, v212
  v_sub_f32 v173, v173, v212
  v_max3_f32 v220, v220, v190, v191
  v_sub_f32 v174, v174, v212
  v_mfma_f32_16x16x32_bf16 v[40:43], a[136:139], v[192:195], 0
  v_sub_f32 v175, v175, v212
  v_max3_f32 v220, v220, v221, v245
  v_exp_f32 v168, v168
  v_mfma_f32_16x16x32_bf16 v[44:47], a[140:143], v[192:195], 0
  v_exp_f32 v169, v169
  v_exp_f32 v170, v170
  v_mov_b32 v221, v220
  v_mfma_f32_16x16x32_bf16 v[48:51], a[144:147], v[192:195], 0
  v_exp_f32 v171, v171
  v_exp_f32 v172, v172
  v_permlane32_swap_b32 v220, v221
  v_mfma_f32_16x16x32_bf16 v[52:55], a[148:151], v[192:195], 0
  buffer_load_dwordx4 v237, s[16:19], s33 offen offset:1024 nt lds
  v_exp_f32 v173, v173
  v_exp_f32 v174, v174
  v_mfma_f32_16x16x32_bf16 v[56:59], a[152:155], v[192:195], 0
  v_exp_f32 v175, v175
  v_max_f32 v220, v220, v221
  v_sub_f32 v213, 0, v212
  v_sub_f32 v214, 0, v212
  v_mfma_f32_16x16x32_bf16 v[60:63], a[156:159], v[192:195], 0
  v_mov_b32 v221, v220
  v_sub_f32 v215, 0, v212
  v_sub_f32 v212, 0, v212
  v_permlane16_swap_b32 v220, v221
  v_cvt_pk_bf16_f32 v196, v168, v169
  v_mfma_f32_16x16x32_bf16 a[192:195], a[208:211], v[192:195], 0
  v_cvt_pk_bf16_f32 v197, v170, v171
  v_cvt_pk_bf16_f32 v198, v172, v173
  v_max_f32 v220, v220, v221
  v_cvt_pk_bf16_f32 v199, v174, v175
  s_nop 1
  v_mfma_f32_16x16x32_bf16 v[64:67], a[128:131], v[196:199], 0
  v_sub_f32 v176, v176, v216
  v_sub_f32 v184, v184, v220
  v_sub_f32 v177, v177, v216
  v_sub_f32 v185, v185, v220
  v_sub_f32 v178, v178, v216
  v_sub_f32 v186, v186, v220
  v_sub_f32 v179, v179, v216
  v_mfma_f32_16x16x32_bf16 v[68:71], a[132:135], v[196:199], 0
  v_sub_f32 v180, v180, v216
  v_sub_f32 v187, v187, v220
  v_sub_f32 v181, v181, v216
  v_sub_f32 v188, v188, v220
  v_sub_f32 v182, v182, v216
  v_sub_f32 v189, v189, v220
  v_sub_f32 v183, v183, v216
  v_mfma_f32_16x16x32_bf16 v[72:75], a[136:139], v[196:199], 0
  v_exp_f32 v176, v176
  v_sub_f32 v190, v190, v220
  v_exp_f32 v177, v177
  v_sub_f32 v191, v191, v220
  v_mfma_f32_16x16x32_bf16 v[76:79], a[140:143], v[196:199], 0
  buffer_load_dwordx4 v238, s[16:19], s33 offen offset:2048 nt lds
  v_exp_f32 v178, v178
  v_exp_f32 v184, v184
  v_exp_f32 v179, v179
  v_mfma_f32_16x16x32_bf16 v[80:83], a[144:147], v[196:199], 0
  v_exp_f32 v180, v180
  v_exp_f32 v185, v185
  v_exp_f32 v181, v181
  v_mfma_f32_16x16x32_bf16 v[84:87], a[148:151], v[196:199], 0
  v_exp_f32 v186, v186
  v_exp_f32 v182, v182
  v_exp_f32 v187, v187
  v_mfma_f32_16x16x32_bf16 v[88:91], a[152:155], v[196:199], 0
  v_exp_f32 v183, v183
  v_sub_f32 v217, 0, v216
  v_sub_f32 v221, 0, v220
  v_sub_f32 v218, 0, v216
  v_sub_f32 v222, 0, v220
  v_sub_f32 v219, 0, v216
  v_mfma_f32_16x16x32_bf16 v[92:95], a[156:159], v[196:199], 0
  v_sub_f32 v223, 0, v220
  v_sub_f32 v216, 0, v216
  v_cvt_pk_bf16_f32 v200, v176, v177
  v_sub_f32 v220, 0, v220
  v_cvt_pk_bf16_f32 v201, v178, v179
  v_cvt_pk_bf16_f32 v204, v184, v185
  v_cvt_pk_bf16_f32 v202, v180, v181
  v_mfma_f32_16x16x32_bf16 a[196:199], a[208:211], v[196:199], 0
  v_cvt_pk_bf16_f32 v205, v186, v187
  v_cvt_pk_bf16_f32 v203, v182, v183
  v_mfma_f32_16x16x32_bf16 v[160:163], a[96:99], a[0:3], v[208:211]
  v_exp_f32 v188, v188
  v_mfma_f32_16x16x32_bf16 v[160:163], a[100:103], a[4:7], v[160:163]
  ds_read_b64_tr_b16 a[160:161], v228 offset:8192
  buffer_load_dwordx4 v239, s[16:19], s33 offen offset:3072 nt lds
  v_mfma_f32_16x16x32_bf16 v[160:163], a[104:107], a[8:11], v[160:163]
  v_exp_f32 v189, v189
  v_mfma_f32_16x16x32_bf16 v[160:163], a[108:111], a[12:15], v[160:163]
  v_cvt_pk_bf16_f32 v206, v188, v189
  ds_read_b64_tr_b16 a[162:163], v228 offset:12288
  v_mfma_f32_16x16x32_bf16 v[164:167], a[112:115], a[0:3], v[208:211]
  v_exp_f32 v190, v190
  v_mfma_f32_16x16x32_bf16 v[164:167], a[116:119], a[4:7], v[164:167]
  ds_read_b64_tr_b16 a[164:165], v229 offset:8192
  ds_read_b64_tr_b16 a[166:167], v229 offset:12288
  v_mfma_f32_16x16x32_bf16 v[164:167], a[120:123], a[8:11], v[164:167]
  v_exp_f32 v191, v191
  v_mfma_f32_16x16x32_bf16 v[164:167], a[124:127], a[12:15], v[164:167]
  v_cvt_pk_bf16_f32 v207, v190, v191
  ds_read_b64_tr_b16 a[168:169], v230 offset:8192
  v_mfma_f32_16x16x32_bf16 v[96:99], a[128:131], v[200:203], 0
  v_exp_f32 v160, v160
  v_mfma_f32_16x16x32_bf16 v[100:103], a[132:135], v[200:203], 0
  ds_read_b64_tr_b16 a[170:171], v230 offset:12288
  ds_read_b64_tr_b16 a[172:173], v231 offset:8192
  v_mfma_f32_16x16x32_bf16 v[104:107], a[136:139], v[200:203], 0
  v_exp_f32 v161, v161
  v_mfma_f32_16x16x32_bf16 v[108:111], a[140:143], v[200:203], 0
  ds_read_b64_tr_b16 a[174:175], v231 offset:12288
  v_cvt_pk_bf16_f32 v192, v160, v161
  v_mfma_f32_16x16x32_bf16 v[112:115], a[144:147], v[200:203], 0
  v_exp_f32 v162, v162
  v_mfma_f32_16x16x32_bf16 v[116:119], a[148:151], v[200:203], 0
  ds_read_b64_tr_b16 a[176:177], v232 offset:8192
  ds_read_b64_tr_b16 a[178:179], v232 offset:12288
  v_mfma_f32_16x16x32_bf16 v[120:123], a[152:155], v[200:203], 0
  v_exp_f32 v163, v163
  v_mfma_f32_16x16x32_bf16 v[124:127], a[156:159], v[200:203], 0
  v_cvt_pk_bf16_f32 v193, v162, v163
  ds_read_b64_tr_b16 a[180:181], v233 offset:8192
  v_mfma_f32_16x16x32_bf16 a[200:203], a[208:211], v[200:203], 0
  ds_read_b64_tr_b16 a[182:183], v233 offset:12288
  v_mfma_f32_16x16x32_bf16 v[168:171], a[96:99], a[16:19], v[212:215]
  v_exp_f32 v164, v164
  v_mfma_f32_16x16x32_bf16 v[168:171], a[100:103], a[20:23], v[168:171]
  ds_read_b64_tr_b16 a[184:185], v234 offset:8192
  v_mfma_f32_16x16x32_bf16 v[168:171], a[104:107], a[24:27], v[168:171]
  v_exp_f32 v165, v165
  v_mfma_f32_16x16x32_bf16 v[168:171], a[108:111], a[28:31], v[168:171]
  ds_read_b64_tr_b16 a[186:187], v234 offset:12288
  v_cvt_pk_bf16_f32 v194, v164, v165
  v_mfma_f32_16x16x32_bf16 v[172:175], a[112:115], a[16:19], v[212:215]
  v_exp_f32 v166, v166
  v_mfma_f32_16x16x32_bf16 v[172:175], a[116:119], a[20:23], v[172:175]
  ds_read_b64_tr_b16 a[188:189], v235 offset:8192
  ds_read_b64_tr_b16 a[190:191], v235 offset:12288
  v_mfma_f32_16x16x32_bf16 v[172:175], a[120:123], a[24:27], v[172:175]
  v_exp_f32 v167, v167
  v_mfma_f32_16x16x32_bf16 v[172:175], a[124:127], a[28:31], v[172:175]
  v_cvt_pk_bf16_f32 v195, v166, v167
  v_mfma_f32_16x16x32_bf16 v[128:131], a[128:131], v[204:207], 0
  v_exp_f32 v168, v168
  v_mfma_f32_16x16x32_bf16 v[132:135], a[132:135], v[204:207], 0
  v_mfma_f32_16x16x32_bf16 v[136:139], a[136:139], v[204:207], 0
  v_exp_f32 v169, v169
  v_mfma_f32_16x16x32_bf16 v[140:143], a[140:143], v[204:207], 0
  v_cvt_pk_bf16_f32 v196, v168, v169
  v_mfma_f32_16x16x32_bf16 v[144:147], a[144:147], v[204:207], 0
  v_exp_f32 v170, v170
  v_mfma_f32_16x16x32_bf16 v[148:151], a[148:151], v[204:207], 0
  v_mfma_f32_16x16x32_bf16 v[152:155], a[152:155], v[204:207], 0
  v_exp_f32 v171, v171
  v_mfma_f32_16x16x32_bf16 v[156:159], a[156:159], v[204:207], 0
  v_cvt_pk_bf16_f32 v197, v170, v171
  v_mfma_f32_16x16x32_bf16 a[204:207], a[208:211], v[204:207], 0
  s_waitcnt vmcnt(12) lgkmcnt(0)
  s_barrier
  v_mfma_f32_16x16x32_bf16 v[176:179], a[96:99], a[32:35], v[216:219]
  s_add_u32 m0, s40, 114688
  v_exp_f32 v172, v172
  v_mfma_f32_16x16x32_bf16 v[176:179], a[100:103], a[36:39], v[176:179]
  ds_read_b128 a[64:67], v224 offset:16384
  buffer_load_dwordx4 v240, s[20:23], s33 offen nt lds
  v_mfma_f32_16x16x32_bf16 v[176:179], a[104:107], a[40:43], v[176:179]
  v_exp_f32 v173, v173
  v_mfma_f32_16x16x32_bf16 v[176:179], a[108:111], a[44:47], v[176:179]
  v_cvt_pk_bf16_f32 v198, v172, v173
  ds_read_b128 a[68:71], v225 offset:16384
  v_mfma_f32_16x16x32_bf16 v[180:183], a[112:115], a[32:35], v[216:219]
  v_exp_f32 v174, v174
  v_mfma_f32_16x16x32_bf16 v[180:183], a[116:119], a[36:39], v[180:183]
  ds_read_b128 a[72:75], v226 offset:16384
  v_mfma_f32_16x16x32_bf16 v[180:183], a[120:123], a[40:43], v[180:183]
  v_exp_f32 v175, v175
  v_mfma_f32_16x16x32_bf16 v[180:183], a[124:127], a[44:47], v[180:183]
  ds_read_b128 a[76:79], v227 offset:16384
  v_cvt_pk_bf16_f32 v199, v174, v175
  v_mfma_f32_16x16x32_bf16 v[32:35], a[160:163], v[192:195], v[32:35]
  v_exp_f32 v176, v176
  v_mfma_f32_16x16x32_bf16 v[36:39], a[164:167], v[192:195], v[36:39]
  ds_read_b128 a[80:83], v224 offset:20480
  v_mfma_f32_16x16x32_bf16 v[40:43], a[168:171], v[192:195], v[40:43]
  v_exp_f32 v177, v177
  v_mfma_f32_16x16x32_bf16 v[44:47], a[172:175], v[192:195], v[44:47]
  v_cvt_pk_bf16_f32 v200, v176, v177
  ds_read_b128 a[84:87], v225 offset:20480
  v_mfma_f32_16x16x32_bf16 v[48:51], a[176:179], v[192:195], v[48:51]
  v_exp_f32 v178, v178
  v_mfma_f32_16x16x32_bf16 v[52:55], a[180:183], v[192:195], v[52:55]
  ds_read_b128 a[88:91], v226 offset:20480
  v_mfma_f32_16x16x32_bf16 v[56:59], a[184:187], v[192:195], v[56:59]
  v_exp_f32 v179, v179
  v_mfma_f32_16x16x32_bf16 v[60:63], a[188:191], v[192:195], v[60:63]
  ds_read_b128 a[92:95], v227 offset:20480
  v_cvt_pk_bf16_f32 v201, v178, v179
  v_mfma_f32_16x16x32_bf16 a[192:195], a[208:211], v[192:195], a[192:195]
  v_mfma_f32_16x16x32_bf16 v[184:187], a[96:99], a[48:51], v[220:223]
  v_exp_f32 v180, v180
  v_mfma_f32_16x16x32_bf16 v[184:187], a[100:103], a[52:55], v[184:187]
  buffer_load_dwordx4 v241, s[20:23], s33 offen offset:1024 nt lds
  v_mfma_f32_16x16x32_bf16 v[184:187], a[104:107], a[56:59], v[184:187]
  v_exp_f32 v181, v181
  v_mfma_f32_16x16x32_bf16 v[184:187], a[108:111], a[60:63], v[184:187]
  v_cvt_pk_bf16_f32 v202, v180, v181
  v_mfma_f32_16x16x32_bf16 v[188:191], a[112:115], a[48:51], v[220:223]
  v_exp_f32 v182, v182
  v_mfma_f32_16x16x32_bf16 v[188:191], a[116:119], a[52:55], v[188:191]
  v_mfma_f32_16x16x32_bf16 v[188:191], a[120:123], a[56:59], v[188:191]
  v_exp_f32 v183, v183
  v_mfma_f32_16x16x32_bf16 v[188:191], a[124:127], a[60:63], v[188:191]
  v_cvt_pk_bf16_f32 v203, v182, v183
  v_mfma_f32_16x16x32_bf16 v[64:67], a[160:163], v[196:199], v[64:67]
  v_exp_f32 v184, v184
  v_mfma_f32_16x16x32_bf16 v[68:71], a[164:167], v[196:199], v[68:71]
  v_mfma_f32_16x16x32_bf16 v[72:75], a[168:171], v[196:199], v[72:75]
  v_exp_f32 v185, v185
  v_mfma_f32_16x16x32_bf16 v[76:79], a[172:175], v[196:199], v[76:79]
  v_cvt_pk_bf16_f32 v204, v184, v185
  v_mfma_f32_16x16x32_bf16 v[80:83], a[176:179], v[196:199], v[80:83]
  v_exp_f32 v186, v186
  v_mfma_f32_16x16x32_bf16 v[84:87], a[180:183], v[196:199], v[84:87]
  v_mfma_f32_16x16x32_bf16 v[88:91], a[184:187], v[196:199], v[88:91]
  v_exp_f32 v187, v187
  v_mfma_f32_16x16x32_bf16 v[92:95], a[188:191], v[196:199], v[92:95]
  s_waitcnt lgkmcnt(0)
  v_cvt_pk_bf16_f32 v205, v186, v187
  v_mfma_f32_16x16x32_bf16 a[196:199], a[208:211], v[196:199], a[196:199]
  s_and_b32 s52, s2, 31
  s_lshl_b32 s52, s52, 3
  v_mov_b32 v16, s52
  v_mov_b32 v17, 1
  s_cmp_lg_u32 s3, 0
  s_cbranch_scc1 L_noarr
  s_mov_b64 exec, 1
  global_atomic_add v16, v17, s[46:47] sc1
  s_mov_b64 exec, -1
L_noarr:
  s_mov_b32 s34, 3
.p2align 6
L_loop:
  v_mfma_f32_16x16x32_bf16 v[160:163], a[64:67], a[0:3], v[208:211]
  v_exp_f32 v188, v188
  v_mfma_f32_16x16x32_bf16 v[160:163], a[68:71], a[4:7], v[160:163]
  ds_read_b64_tr_b16 a[128:129], v228 offset:16384
  buffer_load_dwordx4 v240, s[20:23], s33 offen offset:2048 nt lds
  v_mfma_f32_16x16x32_bf16 v[160:163], a[72:75], a[8:11], v[160:163]
  v_exp_f32 v189, v189
  v_mfma_f32_16x16x32_bf16 v[160:163], a[76:79], a[12:15], v[160:163]
  v_cvt_pk_bf16_f32 v206, v188, v189
  ds_read_b64_tr_b16 a[130:131], v228 offset:20480
  v_mfma_f32_16x16x32_bf16 v[164:167], a[80:83], a[0:3], v[208:211]
  v_exp_f32 v190, v190
  v_mfma_f32_16x16x32_bf16 v[164:167], a[84:87], a[4:7], v[164:167]
  ds_read_b64_tr_b16 a[132:133], v229 offset:16384
  ds_read_b64_tr_b16 a[134:135], v229 offset:20480
  v_mfma_f32_16x16x32_bf16 v[164:167], a[88:91], a[8:11], v[164:167]
  v_exp_f32 v191, v191
  v_mfma_f32_16x16x32_bf16 v[164:167], a[92:95], a[12:15], v[164:167]
  v_cvt_pk_bf16_f32 v207, v190, v191
  ds_read_b64_tr_b16 a[136:137], v230 offset:16384
  v_mfma_f32_16x16x32_bf16 v[96:99], a[160:163], v[200:203], v[96:99]
  v_exp_f32 v160, v160
  v_mfma_f32_16x16x32_bf16 v[100:103], a[164:167], v[200:203], v[100:103]
  ds_read_b64_tr_b16 a[138:139], v230 offset:20480
  ds_read_b64_tr_b16 a[140:141], v231 offset:16384
  v_mfma_f32_16x16x32_bf16 v[104:107], a[168:171], v[200:203], v[104:107]
  v_exp_f32 v161, v161
  v_mfma_f32_16x16x32_bf16 v[108:111], a[172:175], v[200:203], v[108:111]
  ds_read_b64_tr_b16 a[142:143], v231 offset:20480
  v_cvt_pk_bf16_f32 v192, v160, v161
  v_mfma_f32_16x16x32_bf16 v[112:115], a[176:179], v[200:203], v[112:115]
  v_exp_f32 v162, v162
  v_mfma_f32_16x16x32_bf16 v[116:119], a[180:183], v[200:203], v[116:119]
  ds_read_b64_tr_b16 a[144:145], v232 offset:16384
  ds_read_b64_tr_b16 a[146:147], v232 offset:20480
  v_mfma_f32_16x16x32_bf16 v[120:123], a[184:187], v[200:203], v[120:123]
  v_exp_f32 v163, v163
  v_mfma_f32_16x16x32_bf16 v[124:127], a[188:191], v[200:203], v[124:127]
  v_cvt_pk_bf16_f32 v193, v162, v163
  ds_read_b64_tr_b16 a[148:149], v233 offset:16384
  v_mfma_f32_16x16x32_bf16 a[200:203], a[208:211], v[200:203], a[200:203]
  ds_read_b64_tr_b16 a[150:151], v233 offset:20480
  v_mfma_f32_16x16x32_bf16 v[168:171], a[64:67], a[16:19], v[212:215]
  v_exp_f32 v164, v164
  v_mfma_f32_16x16x32_bf16 v[168:171], a[68:71], a[20:23], v[168:171]
  ds_read_b64_tr_b16 a[152:153], v234 offset:16384
  buffer_load_dwordx4 v241, s[20:23], s33 offen offset:3072 nt lds
  v_mfma_f32_16x16x32_bf16 v[168:171], a[72:75], a[24:27], v[168:171]
  s_add_u32 s33, s33, 16384
  v_exp_f32 v165, v165
  v_mfma_f32_16x16x32_bf16 v[168:171], a[76:79], a[28:31], v[168:171]
  ds_read_b64_tr_b16 a[154:155], v234 offset:20480
  v_cvt_pk_bf16_f32 v194, v164, v165
  v_mfma_f32_16x16x32_bf16 v[172:175], a[80:83], a[16:19], v[212:215]
  v_exp_f32 v166, v166
  v_mfma_f32_16x16x32_bf16 v[172:175], a[84:87], a[20:23], v[172:175]
  ds_read_b64_tr_b16 a[156:157], v235 offset:16384
  ds_read_b64_tr_b16 a[158:159], v235 offset:20480
  v_mfma_f32_16x16x32_bf16 v[172:175], a[88:91], a[24:27], v[172:175]
  v_exp_f32 v167, v167
  v_mfma_f32_16x16x32_bf16 v[172:175], a[92:95], a[28:31], v[172:175]
  v_cvt_pk_bf16_f32 v195, v166, v167
  v_mfma_f32_16x16x32_bf16 v[128:131], a[160:163], v[204:207], v[128:131]
  v_exp_f32 v168, v168
  v_mfma_f32_16x16x32_bf16 v[132:135], a[164:167], v[204:207], v[132:135]
  v_mfma_f32_16x16x32_bf16 v[136:139], a[168:171], v[204:207], v[136:139]
  v_exp_f32 v169, v169
  v_mfma_f32_16x16x32_bf16 v[140:143], a[172:175], v[204:207], v[140:143]
  v_cvt_pk_bf16_f32 v196, v168, v169
  v_mfma_f32_16x16x32_bf16 v[144:147], a[176:179], v[204:207], v[144:147]
  v_exp_f32 v170, v170
  v_mfma_f32_16x16x32_bf16 v[148:151], a[180:183], v[204:207], v[148:151]
  v_mfma_f32_16x16x32_bf16 v[152:155], a[184:187], v[204:207], v[152:155]
  v_exp_f32 v171, v171
  v_mfma_f32_16x16x32_bf16 v[156:159], a[188:191], v[204:207], v[156:159]
  v_cvt_pk_bf16_f32 v197, v170, v171
  v_mfma_f32_16x16x32_bf16 a[204:207], a[208:211], v[204:207], a[204:207]
  s_waitcnt lgkmcnt(0)
  v_mfma_f32_16x16x32_bf16 v[176:179], a[64:67], a[32:35], v[216:219]
  s_add_u32 m0, s40, 0
  v_exp_f32 v172, v172
  v_mfma_f32_16x16x32_bf16 v[176:179], a[68:71], a[36:39], v[176:179]
  ds_read_b128 a[96:99], v224 offset:24576
  buffer_load_dwordx4 v236, s[16:19], s33 offen nt lds
  v_mfma_f32_16x16x32_bf16 v[176:179], a[72:75], a[40:43], v[176:179]
  v_exp_f32 v173, v173
  v_mfma_f32_16x16x32_bf16 v[176:179], a[76:79], a[44:47], v[176:179]
  v_cvt_pk_bf16_f32 v198, v172, v173
  ds_read_b128 a[100:103], v225 offset:24576
  v_mfma_f32_16x16x32_bf16 v[180:183], a[80:83], a[32:35], v[216:219]
  v_exp_f32 v174, v174
  v_mfma_f32_16x16x32_bf16 v[180:183], a[84:87], a[36:39], v[180:183]
  ds_read_b128 a[104:107], v226 offset:24576
  v_mfma_f32_16x16x32_bf16 v[180:183], a[88:91], a[40:43], v[180:183]
  v_exp_f32 v175, v175
  v_mfma_f32_16x16x32_bf16 v[180:183], a[92:95], a[44:47], v[180:183]
  ds_read_b128 a[108:111], v227 offset:24576
  v_cvt_pk_bf16_f32 v199, v174, v175
  v_mfma_f32_16x16x32_bf16 v[32:35], a[128:131], v[192:195], v[32:35]
  v_exp_f32 v176, v176
  v_mfma_f32_16x16x32_bf16 v[36:39], a[132:135], v[192:195], v[36:39]
  ds_read_b128 a[112:115], v224 offset:28672
  v_mfma_f32_16x16x32_bf16 v[40:43], a[136:139], v[192:195], v[40:43]
  v_exp_f32 v177, v177
  v_mfma_f32_16x16x32_bf16 v[44:47], a[140:143], v[192:195], v[44:47]
  v_cvt_pk_bf16_f32 v200, v176, v177
  ds_read_b128 a[116:119], v225 offset:28672
  v_mfma_f32_16x16x32_bf16 v[48:51], a[144:147], v[192:195], v[48:51]
  v_exp_f32 v178, v178
  v_mfma_f32_16x16x32_bf16 v[52:55], a[148:151], v[192:195], v[52:55]
  ds_read_b128 a[120:123], v226 offset:28672
  v_mfma_f32_16x16x32_bf16 v[56:59], a[152:155], v[192:195], v[56:59]
  v_exp_f32 v179, v179
  v_mfma_f32_16x16x32_bf16 v[60:63], a[156:159], v[192:195], v[60:63]
  ds_read_b128 a[124:127], v227 offset:28672
  v_cvt_pk_bf16_f32 v201, v178, v179
  v_mfma_f32_16x16x32_bf16 a[192:195], a[208:211], v[192:195], a[192:195]
  v_mfma_f32_16x16x32_bf16 v[184:187], a[64:67], a[48:51], v[220:223]
  v_exp_f32 v180, v180
  v_mfma_f32_16x16x32_bf16 v[184:187], a[68:71], a[52:55], v[184:187]
  buffer_load_dwordx4 v237, s[16:19], s33 offen offset:1024 nt lds
  v_mfma_f32_16x16x32_bf16 v[184:187], a[72:75], a[56:59], v[184:187]
  v_exp_f32 v181, v181
  v_mfma_f32_16x16x32_bf16 v[184:187], a[76:79], a[60:63], v[184:187]
  v_cvt_pk_bf16_f32 v202, v180, v181
  v_mfma_f32_16x16x32_bf16 v[188:191], a[80:83], a[48:51], v[220:223]
  v_exp_f32 v182, v182
  v_mfma_f32_16x16x32_bf16 v[188:191], a[84:87], a[52:55], v[188:191]
  v_mfma_f32_16x16x32_bf16 v[188:191], a[88:91], a[56:59], v[188:191]
  v_exp_f32 v183, v183
  v_mfma_f32_16x16x32_bf16 v[188:191], a[92:95], a[60:63], v[188:191]
  v_cvt_pk_bf16_f32 v203, v182, v183
  v_mfma_f32_16x16x32_bf16 v[64:67], a[128:131], v[196:199], v[64:67]
  v_exp_f32 v184, v184
  v_mfma_f32_16x16x32_bf16 v[68:71], a[132:135], v[196:199], v[68:71]
  v_mfma_f32_16x16x32_bf16 v[72:75], a[136:139], v[196:199], v[72:75]
  v_exp_f32 v185, v185
  v_mfma_f32_16x16x32_bf16 v[76:79], a[140:143], v[196:199], v[76:79]
  v_cvt_pk_bf16_f32 v204, v184, v185
  v_mfma_f32_16x16x32_bf16 v[80:83], a[144:147], v[196:199], v[80:83]
  v_exp_f32 v186, v186
  v_mfma_f32_16x16x32_bf16 v[84:87], a[148:151], v[196:199], v[84:87]
  v_mfma_f32_16x16x32_bf16 v[88:91], a[152:155], v[196:199], v[88:91]
  v_exp_f32 v187, v187
  v_mfma_f32_16x16x32_bf16 v[92:95], a[156:159], v[196:199], v[92:95]
  s_waitcnt lgkmcnt(0)
  v_cvt_pk_bf16_f32 v205, v186, v187
  v_mfma_f32_16x16x32_bf16 a[196:199], a[208:211], v[196:199], a[196:199]
  v_mfma_f32_16x16x32_bf16 v[160:163], a[96:99], a[0:3], v[208:211]
  v_exp_f32 v188, v188
  v_mfma_f32_16x16x32_bf16 v[160:163], a[100:103], a[4:7], v[160:163]
  ds_read_b64_tr_b16 a[160:161], v228 offset:24576
  buffer_load_dwordx4 v238, s[16:19], s33 offen offset:2048 nt lds
  v_mfma_f32_16x16x32_bf16 v[160:163], a[104:107], a[8:11], v[160:163]
  v_exp_f32 v189, v189
  v_mfma_f32_16x16x32_bf16 v[160:163], a[108:111], a[12:15], v[160:163]
  v_cvt_pk_bf16_f32 v206, v188, v189
  ds_read_b64_tr_b16 a[162:163], v228 offset:28672
  v_mfma_f32_16x16x32_bf16 v[164:167], a[112:115], a[0:3], v[208:211]
  v_exp_f32 v190, v190
  v_mfma_f32_16x16x32_bf16 v[164:167], a[116:119], a[4:7], v[164:167]
  ds_read_b64_tr_b16 a[164:165], v229 offset:24576
  ds_read_b64_tr_b16 a[166:167], v229 offset:28672
  v_mfma_f32_16x16x32_bf16 v[164:167], a[120:123], a[8:11], v[164:167]
  v_exp_f32 v191, v191
  v_mfma_f32_16x16x32_bf16 v[164:167], a[124:127], a[12:15], v[164:167]
  v_cvt_pk_bf16_f32 v207, v190, v191
  ds_read_b64_tr_b16 a[168:169], v230 offset:24576
  v_mfma_f32_16x16x32_bf16 v[96:99], a[128:131], v[200:203], v[96:99]
  v_exp_f32 v160, v160
  v_mfma_f32_16x16x32_bf16 v[100:103], a[132:135], v[200:203], v[100:103]
  ds_read_b64_tr_b16 a[170:171], v230 offset:28672
  ds_read_b64_tr_b16 a[172:173], v231 offset:24576
  v_mfma_f32_16x16x32_bf16 v[104:107], a[136:139], v[200:203], v[104:107]
  v_exp_f32 v161, v161
  v_mfma_f32_16x16x32_bf16 v[108:111], a[140:143], v[200:203], v[108:111]
  ds_read_b64_tr_b16 a[174:175], v231 offset:28672
  v_cvt_pk_bf16_f32 v192, v160, v161
  v_mfma_f32_16x16x32_bf16 v[112:115], a[144:147], v[200:203], v[112:115]
  v_exp_f32 v162, v162
  v_mfma_f32_16x16x32_bf16 v[116:119], a[148:151], v[200:203], v[116:119]
  ds_read_b64_tr_b16 a[176:177], v232 offset:24576
  ds_read_b64_tr_b16 a[178:179], v232 offset:28672
  v_mfma_f32_16x16x32_bf16 v[120:123], a[152:155], v[200:203], v[120:123]
  v_exp_f32 v163, v163
  v_mfma_f32_16x16x32_bf16 v[124:127], a[156:159], v[200:203], v[124:127]
  v_cvt_pk_bf16_f32 v193, v162, v163
  ds_read_b64_tr_b16 a[180:181], v233 offset:24576
  v_mfma_f32_16x16x32_bf16 a[200:203], a[208:211], v[200:203], a[200:203]
  ds_read_b64_tr_b16 a[182:183], v233 offset:28672
  v_mfma_f32_16x16x32_bf16 v[168:171], a[96:99], a[16:19], v[212:215]
  v_exp_f32 v164, v164
  v_mfma_f32_16x16x32_bf16 v[168:171], a[100:103], a[20:23], v[168:171]
  ds_read_b64_tr_b16 a[184:185], v234 offset:24576
  buffer_load_dwordx4 v239, s[16:19], s33 offen offset:3072 nt lds
  v_mfma_f32_16x16x32_bf16 v[168:171], a[104:107], a[24:27], v[168:171]
  v_exp_f32 v165, v165
  v_mfma_f32_16x16x32_bf16 v[168:171], a[108:111], a[28:31], v[168:171]
  ds_read_b64_tr_b16 a[186:187], v234 offset:28672
  v_cvt_pk_bf16_f32 v194, v164, v165
  v_mfma_f32_16x16x32_bf16 v[172:175], a[112:115], a[16:19], v[212:215]
  v_exp_f32 v166, v166
  v_mfma_f32_16x16x32_bf16 v[172:175], a[116:119], a[20:23], v[172:175]
  ds_read_b64_tr_b16 a[188:189], v235 offset:24576
  ds_read_b64_tr_b16 a[190:191], v235 offset:28672
  v_mfma_f32_16x16x32_bf16 v[172:175], a[120:123], a[24:27], v[172:175]
  v_exp_f32 v167, v167
  v_mfma_f32_16x16x32_bf16 v[172:175], a[124:127], a[28:31], v[172:175]
  v_cvt_pk_bf16_f32 v195, v166, v167
  v_mfma_f32_16x16x32_bf16 v[128:131], a[128:131], v[204:207], v[128:131]
  v_exp_f32 v168, v168
  v_mfma_f32_16x16x32_bf16 v[132:135], a[132:135], v[204:207], v[132:135]
  v_mfma_f32_16x16x32_bf16 v[136:139], a[136:139], v[204:207], v[136:139]
  v_exp_f32 v169, v169
  v_mfma_f32_16x16x32_bf16 v[140:143], a[140:143], v[204:207], v[140:143]
  v_cvt_pk_bf16_f32 v196, v168, v169
  v_mfma_f32_16x16x32_bf16 v[144:147], a[144:147], v[204:207], v[144:147]
  v_exp_f32 v170, v170
  v_mfma_f32_16x16x32_bf16 v[148:151], a[148:151], v[204:207], v[148:151]
  v_mfma_f32_16x16x32_bf16 v[152:155], a[152:155], v[204:207], v[152:155]
  v_exp_f32 v171, v171
  v_mfma_f32_16x16x32_bf16 v[156:159], a[156:159], v[204:207], v[156:159]
  v_cvt_pk_bf16_f32 v197, v170, v171
  v_mfma_f32_16x16x32_bf16 a[204:207], a[208:211], v[204:207], a[204:207]
  s_waitcnt vmcnt(12) lgkmcnt(0)
  s_barrier
  v_mfma_f32_16x16x32_bf16 v[176:179], a[96:99], a[32:35], v[216:219]
  s_add_u32 m0, s40, 65536
  v_exp_f32 v172, v172
  v_mfma_f32_16x16x32_bf16 v[176:179], a[100:103], a[36:39], v[176:179]
  ds_read_b128 a[64:67], v224 offset:32768
  buffer_load_dwordx4 v240, s[20:23], s33 offen nt lds
  v_mfma_f32_16x16x32_bf16 v[176:179], a[104:107], a[40:43], v[176:179]
  v_exp_f32 v173, v173
  v_mfma_f32_16x16x32_bf16 v[176:179], a[108:111], a[44:47], v[176:179]
  v_cvt_pk_bf16_f32 v198, v172, v173
  ds_read_b128 a[68:71], v225 offset:32768
  v_mfma_f32_16x16x32_bf16 v[180:183], a[112:115], a[32:35], v[216:219]
  v_exp_f32 v174, v174
  v_mfma_f32_16x16x32_bf16 v[180:183], a[116:119], a[36:39], v[180:183]
  ds_read_b128 a[72:75], v226 offset:32768
  v_mfma_f32_16x16x32_bf16 v[180:183], a[120:123], a[40:43], v[180:183]
  v_exp_f32 v175, v175
  v_mfma_f32_16x16x32_bf16 v[180:183], a[124:127], a[44:47], v[180:183]
  ds_read_b128 a[76:79], v227 offset:32768
  v_cvt_pk_bf16_f32 v199, v174, v175
  v_mfma_f32_16x16x32_bf16 v[32:35], a[160:163], v[192:195], v[32:35]
  v_exp_f32 v176, v176
  v_mfma_f32_16x16x32_bf16 v[36:39], a[164:167], v[192:195], v[36:39]
  ds_read_b128 a[80:83], v224 offset:36864
  v_mfma_f32_16x16x32_bf16 v[40:43], a[168:171], v[192:195], v[40:43]
  v_exp_f32 v177, v177
  v_mfma_f32_16x16x32_bf16 v[44:47], a[172:175], v[192:195], v[44:47]
  v_cvt_pk_bf16_f32 v200, v176, v177
  ds_read_b128 a[84:87], v225 offset:36864
  v_mfma_f32_16x16x32_bf16 v[48:51], a[176:179], v[192:195], v[48:51]
  v_exp_f32 v178, v178
  v_mfma_f32_16x16x32_bf16 v[52:55], a[180:183], v[192:195], v[52:55]
  ds_read_b128 a[88:91], v226 offset:36864
  v_mfma_f32_16x16x32_bf16 v[56:59], a[184:187], v[192:195], v[56:59]
  v_exp_f32 v179, v179
  v_mfma_f32_16x16x32_bf16 v[60:63], a[188:191], v[192:195], v[60:63]
  ds_read_b128 a[92:95], v227 offset:36864
  v_cvt_pk_bf16_f32 v201, v178, v179
  v_mfma_f32_16x16x32_bf16 a[192:195], a[208:211], v[192:195], a[192:195]
  v_mfma_f32_16x16x32_bf16 v[184:187], a[96:99], a[48:51], v[220:223]
  v_exp_f32 v180, v180
  v_mfma_f32_16x16x32_bf16 v[184:187], a[100:103], a[52:55], v[184:187]
  buffer_load_dwordx4 v241, s[20:23], s33 offen offset:1024 nt lds
  v_mfma_f32_16x16x32_bf16 v[184:187], a[104:107], a[56:59], v[184:187]
  v_exp_f32 v181, v181
  v_mfma_f32_16x16x32_bf16 v[184:187], a[108:111], a[60:63], v[184:187]
  v_cvt_pk_bf16_f32 v202, v180, v181
  v_mfma_f32_16x16x32_bf16 v[188:191], a[112:115], a[48:51], v[220:223]
  v_exp_f32 v182, v182
  v_mfma_f32_16x16x32_bf16 v[188:191], a[116:119], a[52:55], v[188:191]
  v_mfma_f32_16x16x32_bf16 v[188:191], a[120:123], a[56:59], v[188:191]
  v_exp_f32 v183, v183
  v_mfma_f32_16x16x32_bf16 v[188:191], a[124:127], a[60:63], v[188:191]
  v_cvt_pk_bf16_f32 v203, v182, v183
  v_mfma_f32_16x16x32_bf16 v[64:67], a[160:163], v[196:199], v[64:67]
  v_exp_f32 v184, v184
  v_mfma_f32_16x16x32_bf16 v[68:71], a[164:167], v[196:199], v[68:71]
  v_mfma_f32_16x16x32_bf16 v[72:75], a[168:171], v[196:199], v[72:75]
  v_exp_f32 v185, v185
  v_mfma_f32_16x16x32_bf16 v[76:79], a[172:175], v[196:199], v[76:79]
  v_cvt_pk_bf16_f32 v204, v184, v185
  v_mfma_f32_16x16x32_bf16 v[80:83], a[176:179], v[196:199], v[80:83]
  v_exp_f32 v186, v186
  v_mfma_f32_16x16x32_bf16 v[84:87], a[180:183], v[196:199], v[84:87]
  v_mfma_f32_16x16x32_bf16 v[88:91], a[184:187], v[196:199], v[88:91]
  v_exp_f32 v187, v187
  v_mfma_f32_16x16x32_bf16 v[92:95], a[188:191], v[196:199], v[92:95]
  s_waitcnt lgkmcnt(0)
  v_cvt_pk_bf16_f32 v205, v186, v187
  v_mfma_f32_16x16x32_bf16 a[196:199], a[208:211], v[196:199], a[196:199]
  v_mfma_f32_16x16x32_bf16 v[160:163], a[64:67], a[0:3], v[208:211]
  v_exp_f32 v188, v188
  v_mfma_f32_16x16x32_bf16 v[160:163], a[68:71], a[4:7], v[160:163]
  ds_read_b64_tr_b16 a[128:129], v228 offset:32768
  buffer_load_dwordx4 v240, s[20:23], s33 offen offset:2048 nt lds
  v_mfma_f32_16x16x32_bf16 v[160:163], a[72:75], a[8:11], v[160:163]
  v_exp_f32 v189, v189
  v_mfma_f32_16x16x32_bf16 v[160:163], a[76:79], a[12:15], v[160:163]
  v_cvt_pk_bf16_f32 v206, v188, v189
  ds_read_b64_tr_b16 a[130:131], v228 offset:36864
  v_mfma_f32_16x16x32_bf16 v[164:167], a[80:83], a[0:3], v[208:211]
  v_exp_f32 v190, v190
  v_mfma_f32_16x16x32_bf16 v[164:167], a[84:87], a[4:7], v[164:167]
  ds_read_b64_tr_b16 a[132:133], v229 offset:32768
  ds_read_b64_tr_b16 a[134:135], v229 offset:36864
  v_mfma_f32_16x16x32_bf16 v[164:167], a[88:91], a[8:11], v[164:167]
  v_exp_f32 v191, v191
  v_mfma_f32_16x16x32_bf16 v[164:167], a[92:95], a[12:15], v[164:167]
  v_cvt_pk_bf16_f32 v207, v190, v191
  ds_read_b64_tr_b16 a[136:137], v230 offset:32768
  v_mfma_f32_16x16x32_bf16 v[96:99], a[160:163], v[200:203], v[96:99]
  v_exp_f32 v160, v160
  v_mfma_f32_16x16x32_bf16 v[100:103], a[164:167], v[200:203], v[100:103]
  ds_read_b64_tr_b16 a[138:139], v230 offset:36864
  ds_read_b64_tr_b16 a[140:141], v231 offset:32768
  v_mfma_f32_16x16x32_bf16 v[104:107], a[168:171], v[200:203], v[104:107]
  v_exp_f32 v161, v161
  v_mfma_f32_16x16x32_bf16 v[108:111], a[172:175], v[200:203], v[108:111]
  ds_read_b64_tr_b16 a[142:143], v231 offset:36864
  v_cvt_pk_bf16_f32 v192, v160, v161
  v_mfma_f32_16x16x32_bf16 v[112:115], a[176:179], v[200:203], v[112:115]
  v_exp_f32 v162, v162
  v_mfma_f32_16x16x32_bf16 v[116:119], a[180:183], v[200:203], v[116:119]
  ds_read_b64_tr_b16 a[144:145], v232 offset:32768
  ds_read_b64_tr_b16 a[146:147], v232 offset:36864
  v_mfma_f32_16x16x32_bf16 v[120:123], a[184:187], v[200:203], v[120:123]
  v_exp_f32 v163, v163
  v_mfma_f32_16x16x32_bf16 v[124:127], a[188:191], v[200:203], v[124:127]
  v_cvt_pk_bf16_f32 v193, v162, v163
  ds_read_b64_tr_b16 a[148:149], v233 offset:32768
  v_mfma_f32_16x16x32_bf16 a[200:203], a[208:211], v[200:203], a[200:203]
  ds_read_b64_tr_b16 a[150:151], v233 offset:36864
  v_mfma_f32_16x16x32_bf16 v[168:171], a[64:67], a[16:19], v[212:215]
  v_exp_f32 v164, v164
  v_mfma_f32_16x16x32_bf16 v[168:171], a[68:71], a[20:23], v[168:171]
  ds_read_b64_tr_b16 a[152:153], v234 offset:32768
  buffer_load_dwordx4 v241, s[20:23], s33 offen offset:3072 nt lds
  v_mfma_f32_16x16x32_bf16 v[168:171], a[72:75], a[24:27], v[168:171]
  s_add_u32 s33, s33, 16384
  v_exp_f32 v165, v165
  v_mfma_f32_16x16x32_bf16 v[168:171], a[76:79], a[28:31], v[168:171]
  ds_read_b64_tr_b16 a[154:155], v234 offset:36864
  v_cvt_pk_bf16_f32 v194, v164, v165
  v_mfma_f32_16x16x32_bf16 v[172:175], a[80:83], a[16:19], v[212:215]
  v_exp_f32 v166, v166
  v_mfma_f32_16x16x32_bf16 v[172:175], a[84:87], a[20:23], v[172:175]
  ds_read_b64_tr_b16 a[156:157], v235 offset:32768
  ds_read_b64_tr_b16 a[158:159], v235 offset:36864
  v_mfma_f32_16x16x32_bf16 v[172:175], a[88:91], a[24:27], v[172:175]
  v_exp_f32 v167, v167
  v_mfma_f32_16x16x32_bf16 v[172:175], a[92:95], a[28:31], v[172:175]
  v_cvt_pk_bf16_f32 v195, v166, v167
  v_mfma_f32_16x16x32_bf16 v[128:131], a[160:163], v[204:207], v[128:131]
  v_exp_f32 v168, v168
  v_mfma_f32_16x16x32_bf16 v[132:135], a[164:167], v[204:207], v[132:135]
  v_mfma_f32_16x16x32_bf16 v[136:139], a[168:171], v[204:207], v[136:139]
  v_exp_f32 v169, v169
  v_mfma_f32_16x16x32_bf16 v[140:143], a[172:175], v[204:207], v[140:143]
  v_cvt_pk_bf16_f32 v196, v168, v169
  v_mfma_f32_16x16x32_bf16 v[144:147], a[176:179], v[204:207], v[144:147]
  v_exp_f32 v170, v170
  v_mfma_f32_16x16x32_bf16 v[148:151], a[180:183], v[204:207], v[148:151]
  v_mfma_f32_16x16x32_bf16 v[152:155], a[184:187], v[204:207], v[152:155]
  v_exp_f32 v171, v171
  v_mfma_f32_16x16x32_bf16 v[156:159], a[188:191], v[204:207], v[156:159]
  v_cvt_pk_bf16_f32 v197, v170, v171
  v_mfma_f32_16x16x32_bf16 a[204:207], a[208:211], v[204:207], a[204:207]
  s_waitcnt lgkmcnt(0)
  v_mfma_f32_16x16x32_bf16 v[176:179], a[64:67], a[32:35], v[216:219]
  s_add_u32 m0, s40, 16384
  v_exp_f32 v172, v172
  v_mfma_f32_16x16x32_bf16 v[176:179], a[68:71], a[36:39], v[176:179]
  ds_read_b128 a[96:99], v224 offset:40960
  buffer_load_dwordx4 v236, s[16:19], s33 offen nt lds
  v_mfma_f32_16x16x32_bf16 v[176:179], a[72:75], a[40:43], v[176:179]
  v_exp_f32 v173, v173
  v_mfma_f32_16x16x32_bf16 v[176:179], a[76:79], a[44:47], v[176:179]
  v_cvt_pk_bf16_f32 v198, v172, v173
  ds_read_b128 a[100:103], v225 offset:40960
  v_mfma_f32_16x16x32_bf16 v[180:183], a[80:83], a[32:35], v[216:219]
  v_exp_f32 v174, v174
  v_mfma_f32_16x16x32_bf16 v[180:183], a[84:87], a[36:39], v[180:183]
  ds_read_b128 a[104:107], v226 offset:40960
  v_mfma_f32_16x16x32_bf16 v[180:183], a[88:91], a[40:43], v[180:183]
  v_exp_f32 v175, v175
  v_mfma_f32_16x16x32_bf16 v[180:183], a[92:95], a[44:47], v[180:183]
  ds_read_b128 a[108:111], v227 offset:40960
  v_cvt_pk_bf16_f32 v199, v174, v175
  v_mfma_f32_16x16x32_bf16 v[32:35], a[128:131], v[192:195], v[32:35]
  v_exp_f32 v176, v176
  v_mfma_f32_16x16x32_bf16 v[36:39], a[132:135], v[192:195], v[36:39]
  ds_read_b128 a[112:115], v224 offset:45056
  v_mfma_f32_16x16x32_bf16 v[40:43], a[136:139], v[192:195], v[40:43]
  v_exp_f32 v177, v177
  v_mfma_f32_16x16x32_bf16 v[44:47], a[140:143], v[192:195], v[44:47]
  v_cvt_pk_bf16_f32 v200, v176, v177
  ds_read_b128 a[116:119], v225 offset:45056
  v_mfma_f32_16x16x32_bf16 v[48:51], a[144:147], v[192:195], v[48:51]
  v_exp_f32 v178, v178
  v_mfma_f32_16x16x32_bf16 v[52:55], a[148:151], v[192:195], v[52:55]
  ds_read_b128 a[120:123], v226 offset:45056
  v_mfma_f32_16x16x32_bf16 v[56:59], a[152:155], v[192:195], v[56:59]
  v_exp_f32 v179, v179
  v_mfma_f32_16x16x32_bf16 v[60:63], a[156:159], v[192:195], v[60:63]
  ds_read_b128 a[124:127], v227 offset:45056
  v_cvt_pk_bf16_f32 v201, v178, v179
  v_mfma_f32_16x16x32_bf16 a[192:195], a[208:211], v[192:195], a[192:195]
  v_mfma_f32_16x16x32_bf16 v[184:187], a[64:67], a[48:51], v[220:223]
  v_exp_f32 v180, v180
  v_mfma_f32_16x16x32_bf16 v[184:187], a[68:71], a[52:55], v[184:187]
  buffer_load_dwordx4 v237, s[16:19], s33 offen offset:1024 nt lds
  v_mfma_f32_16x16x32_bf16 v[184:187], a[72:75], a[56:59], v[184:187]
  v_exp_f32 v181, v181
  v_mfma_f32_16x16x32_bf16 v[184:187], a[76:79], a[60:63], v[184:187]
  v_cvt_pk_bf16_f32 v202, v180, v181
  v_mfma_f32_16x16x32_bf16 v[188:191], a[80:83], a[48:51], v[220:223]
  v_exp_f32 v182, v182
  v_mfma_f32_16x16x32_bf16 v[188:191], a[84:87], a[52:55], v[188:191]
  v_mfma_f32_16x16x32_bf16 v[188:191], a[88:91], a[56:59], v[188:191]
  v_exp_f32 v183, v183
  v_mfma_f32_16x16x32_bf16 v[188:191], a[92:95], a[60:63], v[188:191]
  v_cvt_pk_bf16_f32 v203, v182, v183
  v_mfma_f32_16x16x32_bf16 v[64:67], a[128:131], v[196:199], v[64:67]
  v_exp_f32 v184, v184
  v_mfma_f32_16x16x32_bf16 v[68:71], a[132:135], v[196:199], v[68:71]
  v_mfma_f32_16x16x32_bf16 v[72:75], a[136:139], v[196:199], v[72:75]
  v_exp_f32 v185, v185
  v_mfma_f32_16x16x32_bf16 v[76:79], a[140:143], v[196:199], v[76:79]
  v_cvt_pk_bf16_f32 v204, v184, v185
  v_mfma_f32_16x16x32_bf16 v[80:83], a[144:147], v[196:199], v[80:83]
  v_exp_f32 v186, v186
  v_mfma_f32_16x16x32_bf16 v[84:87], a[148:151], v[196:199], v[84:87]
  v_mfma_f32_16x16x32_bf16 v[88:91], a[152:155], v[196:199], v[88:91]
  v_exp_f32 v187, v187
  v_mfma_f32_16x16x32_bf16 v[92:95], a[156:159], v[196:199], v[92:95]
  s_waitcnt lgkmcnt(0)
  v_cvt_pk_bf16_f32 v205, v186, v187
  v_mfma_f32_16x16x32_bf16 a[196:199], a[208:211], v[196:199], a[196:199]
  v_mfma_f32_16x16x32_bf16 v[160:163], a[96:99], a[0:3], v[208:211]
  v_exp_f32 v188, v188
  v_mfma_f32_16x16x32_bf16 v[160:163], a[100:103], a[4:7], v[160:163]
  ds_read_b64_tr_b16 a[160:161], v228 offset:40960
  buffer_load_dwordx4 v238, s[16:19], s33 offen offset:2048 nt lds
  v_mfma_f32_16x16x32_bf16 v[160:163], a[104:107], a[8:11], v[160:163]
  v_exp_f32 v189, v189
  v_mfma_f32_16x16x32_bf16 v[160:163], a[108:111], a[12:15], v[160:163]
  v_cvt_pk_bf16_f32 v206, v188, v189
  ds_read_b64_tr_b16 a[162:163], v228 offset:45056
  v_mfma_f32_16x16x32_bf16 v[164:167], a[112:115], a[0:3], v[208:211]
  v_exp_f32 v190, v190
  v_mfma_f32_16x16x32_bf16 v[164:167], a[116:119], a[4:7], v[164:167]
  ds_read_b64_tr_b16 a[164:165], v229 offset:40960
  ds_read_b64_tr_b16 a[166:167], v229 offset:45056
  v_mfma_f32_16x16x32_bf16 v[164:167], a[120:123], a[8:11], v[164:167]
  v_exp_f32 v191, v191
  v_mfma_f32_16x16x32_bf16 v[164:167], a[124:127], a[12:15], v[164:167]
  v_cvt_pk_bf16_f32 v207, v190, v191
  ds_read_b64_tr_b16 a[168:169], v230 offset:40960
  v_mfma_f32_16x16x32_bf16 v[96:99], a[128:131], v[200:203], v[96:99]
  v_exp_f32 v160, v160
  v_mfma_f32_16x16x32_bf16 v[100:103], a[132:135], v[200:203], v[100:103]
  ds_read_b64_tr_b16 a[170:171], v230 offset:45056
  ds_read_b64_tr_b16 a[172:173], v231 offset:40960
  v_mfma_f32_16x16x32_bf16 v[104:107], a[136:139], v[200:203], v[104:107]
  v_exp_f32 v161, v161
  v_mfma_f32_16x16x32_bf16 v[108:111], a[140:143], v[200:203], v[108:111]
  ds_read_b64_tr_b16 a[174:175], v231 offset:45056
  v_cvt_pk_bf16_f32 v192, v160, v161
  v_mfma_f32_16x16x32_bf16 v[112:115], a[144:147], v[200:203], v[112:115]
  v_exp_f32 v162, v162
  v_mfma_f32_16x16x32_bf16 v[116:119], a[148:151], v[200:203], v[116:119]
  ds_read_b64_tr_b16 a[176:177], v232 offset:40960
  ds_read_b64_tr_b16 a[178:179], v232 offset:45056
  v_mfma_f32_16x16x32_bf16 v[120:123], a[152:155], v[200:203], v[120:123]
  v_exp_f32 v163, v163
  v_mfma_f32_16x16x32_bf16 v[124:127], a[156:159], v[200:203], v[124:127]
  v_cvt_pk_bf16_f32 v193, v162, v163
  ds_read_b64_tr_b16 a[180:181], v233 offset:40960
  v_mfma_f32_16x16x32_bf16 a[200:203], a[208:211], v[200:203], a[200:203]
  ds_read_b64_tr_b16 a[182:183], v233 offset:45056
  v_mfma_f32_16x16x32_bf16 v[168:171], a[96:99], a[16:19], v[212:215]
  v_exp_f32 v164, v164
  v_mfma_f32_16x16x32_bf16 v[168:171], a[100:103], a[20:23], v[168:171]
  ds_read_b64_tr_b16 a[184:185], v234 offset:40960
  buffer_load_dwordx4 v239, s[16:19], s33 offen offset:3072 nt lds
  v_mfma_f32_16x16x32_bf16 v[168:171], a[104:107], a[24:27], v[168:171]
  v_exp_f32 v165, v165
  v_mfma_f32_16x16x32_bf16 v[168:171], a[108:111], a[28:31], v[168:171]
  ds_read_b64_tr_b16 a[186:187], v234 offset:45056
  v_cvt_pk_bf16_f32 v194, v164, v165
  v_mfma_f32_16x16x32_bf16 v[172:175], a[112:115], a[16:19], v[212:215]
  v_exp_f32 v166, v166
  v_mfma_f32_16x16x32_bf16 v[172:175], a[116:119], a[20:23], v[172:175]
  ds_read_b64_tr_b16 a[188:189], v235 offset:40960
  ds_read_b64_tr_b16 a[190:191], v235 offset:45056
  v_mfma_f32_16x16x32_bf16 v[172:175], a[120:123], a[24:27], v[172:175]
  v_exp_f32 v167, v167
  v_mfma_f32_16x16x32_bf16 v[172:175], a[124:127], a[28:31], v[172:175]
  v_cvt_pk_bf16_f32 v195, v166, v167
  v_mfma_f32_16x16x32_bf16 v[128:131], a[128:131], v[204:207], v[128:131]
  v_exp_f32 v168, v168
  v_mfma_f32_16x16x32_bf16 v[132:135], a[132:135], v[204:207], v[132:135]
  v_mfma_f32_16x16x32_bf16 v[136:139], a[136:139], v[204:207], v[136:139]
  v_exp_f32 v169, v169
  v_mfma_f32_16x16x32_bf16 v[140:143], a[140:143], v[204:207], v[140:143]
  v_cvt_pk_bf16_f32 v196, v168, v169
  v_mfma_f32_16x16x32_bf16 v[144:147], a[144:147], v[204:207], v[144:147]
  v_exp_f32 v170, v170
  v_mfma_f32_16x16x32_bf16 v[148:151], a[148:151], v[204:207], v[148:151]
  v_mfma_f32_16x16x32_bf16 v[152:155], a[152:155], v[204:207], v[152:155]
  v_exp_f32 v171, v171
  v_mfma_f32_16x16x32_bf16 v[156:159], a[156:159], v[204:207], v[156:159]
  v_cvt_pk_bf16_f32 v197, v170, v171
  v_mfma_f32_16x16x32_bf16 a[204:207], a[208:211], v[204:207], a[204:207]
  s_waitcnt vmcnt(12) lgkmcnt(0)
  s_barrier
  v_mfma_f32_16x16x32_bf16 v[176:179], a[96:99], a[32:35], v[216:219]
  s_add_u32 m0, s40, 81920
  v_exp_f32 v172, v172
  v_mfma_f32_16x16x32_bf16 v[176:179], a[100:103], a[36:39], v[176:179]
  ds_read_b128 a[64:67], v224 offset:49152
  buffer_load_dwordx4 v240, s[20:23], s33 offen nt lds
  v_mfma_f32_16x16x32_bf16 v[176:179], a[104:107], a[40:43], v[176:179]
  v_exp_f32 v173, v173
  v_mfma_f32_16x16x32_bf16 v[176:179], a[108:111], a[44:47], v[176:179]
  v_cvt_pk_bf16_f32 v198, v172, v173
  ds_read_b128 a[68:71], v225 offset:49152
  v_mfma_f32_16x16x32_bf16 v[180:183], a[112:115], a[32:35], v[216:219]
  v_exp_f32 v174, v174
  v_mfma_f32_16x16x32_bf16 v[180:183], a[116:119], a[36:39], v[180:183]
  ds_read_b128 a[72:75], v226 offset:49152
  v_mfma_f32_16x16x32_bf16 v[180:183], a[120:123], a[40:43], v[180:183]
  v_exp_f32 v175, v175
  v_mfma_f32_16x16x32_bf16 v[180:183], a[124:127], a[44:47], v[180:183]
  ds_read_b128 a[76:79], v227 offset:49152
  v_cvt_pk_bf16_f32 v199, v174, v175
  v_mfma_f32_16x16x32_bf16 v[32:35], a[160:163], v[192:195], v[32:35]
  v_exp_f32 v176, v176
  v_mfma_f32_16x16x32_bf16 v[36:39], a[164:167], v[192:195], v[36:39]
  ds_read_b128 a[80:83], v224 offset:53248
  v_mfma_f32_16x16x32_bf16 v[40:43], a[168:171], v[192:195], v[40:43]
  v_exp_f32 v177, v177
  v_mfma_f32_16x16x32_bf16 v[44:47], a[172:175], v[192:195], v[44:47]
  v_cvt_pk_bf16_f32 v200, v176, v177
  ds_read_b128 a[84:87], v225 offset:53248
  v_mfma_f32_16x16x32_bf16 v[48:51], a[176:179], v[192:195], v[48:51]
  v_exp_f32 v178, v178
  v_mfma_f32_16x16x32_bf16 v[52:55], a[180:183], v[192:195], v[52:55]
  ds_read_b128 a[88:91], v226 offset:53248
  v_mfma_f32_16x16x32_bf16 v[56:59], a[184:187], v[192:195], v[56:59]
  v_exp_f32 v179, v179
  v_mfma_f32_16x16x32_bf16 v[60:63], a[188:191], v[192:195], v[60:63]
  ds_read_b128 a[92:95], v227 offset:53248
  v_cvt_pk_bf16_f32 v201, v178, v179
  v_mfma_f32_16x16x32_bf16 a[192:195], a[208:211], v[192:195], a[192:195]
  v_mfma_f32_16x16x32_bf16 v[184:187], a[96:99], a[48:51], v[220:223]
  v_exp_f32 v180, v180
  v_mfma_f32_16x16x32_bf16 v[184:187], a[100:103], a[52:55], v[184:187]
  buffer_load_dwordx4 v241, s[20:23], s33 offen offset:1024 nt lds
  v_mfma_f32_16x16x32_bf16 v[184:187], a[104:107], a[56:59], v[184:187]
  v_exp_f32 v181, v181
  v_mfma_f32_16x16x32_bf16 v[184:187], a[108:111], a[60:63], v[184:187]
  v_cvt_pk_bf16_f32 v202, v180, v181
  v_mfma_f32_16x16x32_bf16 v[188:191], a[112:115], a[48:51], v[220:223]
  v_exp_f32 v182, v182
  v_mfma_f32_16x16x32_bf16 v[188:191], a[116:119], a[52:55], v[188:191]
  v_mfma_f32_16x16x32_bf16 v[188:191], a[120:123], a[56:59], v[188:191]
  v_exp_f32 v183, v183
  v_mfma_f32_16x16x32_bf16 v[188:191], a[124:127], a[60:63], v[188:191]
  v_cvt_pk_bf16_f32 v203, v182, v183
  v_mfma_f32_16x16x32_bf16 v[64:67], a[160:163], v[196:199], v[64:67]
  v_exp_f32 v184, v184
  v_mfma_f32_16x16x32_bf16 v[68:71], a[164:167], v[196:199], v[68:71]
  v_mfma_f32_16x16x32_bf16 v[72:75], a[168:171], v[196:199], v[72:75]
  v_exp_f32 v185, v185
  v_mfma_f32_16x16x32_bf16 v[76:79], a[172:175], v[196:199], v[76:79]
  v_cvt_pk_bf16_f32 v204, v184, v185
  v_mfma_f32_16x16x32_bf16 v[80:83], a[176:179], v[196:199], v[80:83]
  v_exp_f32 v186, v186
  v_mfma_f32_16x16x32_bf16 v[84:87], a[180:183], v[196:199], v[84:87]
  v_mfma_f32_16x16x32_bf16 v[88:91], a[184:187], v[196:199], v[88:91]
  v_exp_f32 v187, v187
  v_mfma_f32_16x16x32_bf16 v[92:95], a[188:191], v[196:199], v[92:95]
  s_waitcnt lgkmcnt(0)
  v_cvt_pk_bf16_f32 v205, v186, v187
  v_mfma_f32_16x16x32_bf16 a[196:199], a[208:211], v[196:199], a[196:199]
  v_mfma_f32_16x16x32_bf16 v[160:163], a[64:67], a[0:3], v[208:211]
  v_exp_f32 v188, v188
  v_mfma_f32_16x16x32_bf16 v[160:163], a[68:71], a[4:7], v[160:163]
  ds_read_b64_tr_b16 a[128:129], v228 offset:49152
  buffer_load_dwordx4 v240, s[20:23], s33 offen offset:2048 nt lds
  v_mfma_f32_16x16x32_bf16 v[160:163], a[72:75], a[8:11], v[160:163]
  v_exp_f32 v189, v189
  v_mfma_f32_16x16x32_bf16 v[160:163], a[76:79], a[12:15], v[160:163]
  v_cvt_pk_bf16_f32 v206, v188, v189
  ds_read_b64_tr_b16 a[130:131], v228 offset:53248
  v_mfma_f32_16x16x32_bf16 v[164:167], a[80:83], a[0:3], v[208:211]
  v_exp_f32 v190, v190
  v_mfma_f32_16x16x32_bf16 v[164:167], a[84:87], a[4:7], v[164:167]
  ds_read_b64_tr_b16 a[132:133], v229 offset:49152
  ds_read_b64_tr_b16 a[134:135], v229 offset:53248
  v_mfma_f32_16x16x32_bf16 v[164:167], a[88:91], a[8:11], v[164:167]
  v_exp_f32 v191, v191
  v_mfma_f32_16x16x32_bf16 v[164:167], a[92:95], a[12:15], v[164:167]
  v_cvt_pk_bf16_f32 v207, v190, v191
  ds_read_b64_tr_b16 a[136:137], v230 offset:49152
  v_mfma_f32_16x16x32_bf16 v[96:99], a[160:163], v[200:203], v[96:99]
  v_exp_f32 v160, v160
  v_mfma_f32_16x16x32_bf16 v[100:103], a[164:167], v[200:203], v[100:103]
  ds_read_b64_tr_b16 a[138:139], v230 offset:53248
  ds_read_b64_tr_b16 a[140:141], v231 offset:49152
  v_mfma_f32_16x16x32_bf16 v[104:107], a[168:171], v[200:203], v[104:107]
  v_exp_f32 v161, v161
  v_mfma_f32_16x16x32_bf16 v[108:111], a[172:175], v[200:203], v[108:111]
  ds_read_b64_tr_b16 a[142:143], v231 offset:53248
  v_cvt_pk_bf16_f32 v192, v160, v161
  v_mfma_f32_16x16x32_bf16 v[112:115], a[176:179], v[200:203], v[112:115]
  v_exp_f32 v162, v162
  v_mfma_f32_16x16x32_bf16 v[116:119], a[180:183], v[200:203], v[116:119]
  ds_read_b64_tr_b16 a[144:145], v232 offset:49152
  ds_read_b64_tr_b16 a[146:147], v232 offset:53248
  v_mfma_f32_16x16x32_bf16 v[120:123], a[184:187], v[200:203], v[120:123]
  v_exp_f32 v163, v163
  v_mfma_f32_16x16x32_bf16 v[124:127], a[188:191], v[200:203], v[124:127]
  v_cvt_pk_bf16_f32 v193, v162, v163
  ds_read_b64_tr_b16 a[148:149], v233 offset:49152
  v_mfma_f32_16x16x32_bf16 a[200:203], a[208:211], v[200:203], a[200:203]
  ds_read_b64_tr_b16 a[150:151], v233 offset:53248
  v_mfma_f32_16x16x32_bf16 v[168:171], a[64:67], a[16:19], v[212:215]
  v_exp_f32 v164, v164
  v_mfma_f32_16x16x32_bf16 v[168:171], a[68:71], a[20:23], v[168:171]
  ds_read_b64_tr_b16 a[152:153], v234 offset:49152
  buffer_load_dwordx4 v241, s[20:23], s33 offen offset:3072 nt lds
  v_mfma_f32_16x16x32_bf16 v[168:171], a[72:75], a[24:27], v[168:171]
  s_add_u32 s33, s33, 16384
  v_exp_f32 v165, v165
  v_mfma_f32_16x16x32_bf16 v[168:171], a[76:79], a[28:31], v[168:171]
  ds_read_b64_tr_b16 a[154:155], v234 offset:53248
  v_cvt_pk_bf16_f32 v194, v164, v165
  v_mfma_f32_16x16x32_bf16 v[172:175], a[80:83], a[16:19], v[212:215]
  v_exp_f32 v166, v166
  v_mfma_f32_16x16x32_bf16 v[172:175], a[84:87], a[20:23], v[172:175]
  ds_read_b64_tr_b16 a[156:157], v235 offset:49152
  ds_read_b64_tr_b16 a[158:159], v235 offset:53248
  v_mfma_f32_16x16x32_bf16 v[172:175], a[88:91], a[24:27], v[172:175]
  v_exp_f32 v167, v167
  v_mfma_f32_16x16x32_bf16 v[172:175], a[92:95], a[28:31], v[172:175]
  v_cvt_pk_bf16_f32 v195, v166, v167
  v_mfma_f32_16x16x32_bf16 v[128:131], a[160:163], v[204:207], v[128:131]
  v_exp_f32 v168, v168
  v_mfma_f32_16x16x32_bf16 v[132:135], a[164:167], v[204:207], v[132:135]
  v_mfma_f32_16x16x32_bf16 v[136:139], a[168:171], v[204:207], v[136:139]
  v_exp_f32 v169, v169
  v_mfma_f32_16x16x32_bf16 v[140:143], a[172:175], v[204:207], v[140:143]
  v_cvt_pk_bf16_f32 v196, v168, v169
  v_mfma_f32_16x16x32_bf16 v[144:147], a[176:179], v[204:207], v[144:147]
  v_exp_f32 v170, v170
  v_mfma_f32_16x16x32_bf16 v[148:151], a[180:183], v[204:207], v[148:151]
  v_mfma_f32_16x16x32_bf16 v[152:155], a[184:187], v[204:207], v[152:155]
  v_exp_f32 v171, v171
  v_mfma_f32_16x16x32_bf16 v[156:159], a[188:191], v[204:207], v[156:159]
  v_cvt_pk_bf16_f32 v197, v170, v171
  v_mfma_f32_16x16x32_bf16 a[204:207], a[208:211], v[204:207], a[204:207]
  s_waitcnt lgkmcnt(0)
  v_mfma_f32_16x16x32_bf16 v[176:179], a[64:67], a[32:35], v[216:219]
  s_add_u32 m0, s40, 32768
  v_exp_f32 v172, v172
  v_mfma_f32_16x16x32_bf16 v[176:179], a[68:71], a[36:39], v[176:179]
  ds_read_b128 a[96:99], v224 offset:57344
  buffer_load_dwordx4 v236, s[16:19], s33 offen nt lds
  v_mfma_f32_16x16x32_bf16 v[176:179], a[72:75], a[40:43], v[176:179]
  v_exp_f32 v173, v173
  v_mfma_f32_16x16x32_bf16 v[176:179], a[76:79], a[44:47], v[176:179]
  v_cvt_pk_bf16_f32 v198, v172, v173
  ds_read_b128 a[100:103], v225 offset:57344
  v_mfma_f32_16x16x32_bf16 v[180:183], a[80:83], a[32:35], v[216:219]
  v_exp_f32 v174, v174
  v_mfma_f32_16x16x32_bf16 v[180:183], a[84:87], a[36:39], v[180:183]
  ds_read_b128 a[104:107], v226 offset:57344
  v_mfma_f32_16x16x32_bf16 v[180:183], a[88:91], a[40:43], v[180:183]
  v_exp_f32 v175, v175
  v_mfma_f32_16x16x32_bf16 v[180:183], a[92:95], a[44:47], v[180:183]
  ds_read_b128 a[108:111], v227 offset:57344
  v_cvt_pk_bf16_f32 v199, v174, v175
  v_mfma_f32_16x16x32_bf16 v[32:35], a[128:131], v[192:195], v[32:35]
  v_exp_f32 v176, v176
  v_mfma_f32_16x16x32_bf16 v[36:39], a[132:135], v[192:195], v[36:39]
  ds_read_b128 a[112:115], v224 offset:61440
  v_mfma_f32_16x16x32_bf16 v[40:43], a[136:139], v[192:195], v[40:43]
  v_exp_f32 v177, v177
  v_mfma_f32_16x16x32_bf16 v[44:47], a[140:143], v[192:195], v[44:47]
  v_cvt_pk_bf16_f32 v200, v176, v177
  ds_read_b128 a[116:119], v225 offset:61440
  v_mfma_f32_16x16x32_bf16 v[48:51], a[144:147], v[192:195], v[48:51]
  v_exp_f32 v178, v178
  v_mfma_f32_16x16x32_bf16 v[52:55], a[148:151], v[192:195], v[52:55]
  ds_read_b128 a[120:123], v226 offset:61440
  v_mfma_f32_16x16x32_bf16 v[56:59], a[152:155], v[192:195], v[56:59]
  v_exp_f32 v179, v179
  v_mfma_f32_16x16x32_bf16 v[60:63], a[156:159], v[192:195], v[60:63]
  ds_read_b128 a[124:127], v227 offset:61440
  v_cvt_pk_bf16_f32 v201, v178, v179
  v_mfma_f32_16x16x32_bf16 a[192:195], a[208:211], v[192:195], a[192:195]
  v_mfma_f32_16x16x32_bf16 v[184:187], a[64:67], a[48:51], v[220:223]
  v_exp_f32 v180, v180
  v_mfma_f32_16x16x32_bf16 v[184:187], a[68:71], a[52:55], v[184:187]
  buffer_load_dwordx4 v237, s[16:19], s33 offen offset:1024 nt lds
  v_mfma_f32_16x16x32_bf16 v[184:187], a[72:75], a[56:59], v[184:187]
  v_exp_f32 v181, v181
  v_mfma_f32_16x16x32_bf16 v[184:187], a[76:79], a[60:63], v[184:187]
  v_cvt_pk_bf16_f32 v202, v180, v181
  v_mfma_f32_16x16x32_bf16 v[188:191], a[80:83], a[48:51], v[220:223]
  v_exp_f32 v182, v182
  v_mfma_f32_16x16x32_bf16 v[188:191], a[84:87], a[52:55], v[188:191]
  v_mfma_f32_16x16x32_bf16 v[188:191], a[88:91], a[56:59], v[188:191]
  v_exp_f32 v183, v183
  v_mfma_f32_16x16x32_bf16 v[188:191], a[92:95], a[60:63], v[188:191]
  v_cvt_pk_bf16_f32 v203, v182, v183
  v_mfma_f32_16x16x32_bf16 v[64:67], a[128:131], v[196:199], v[64:67]
  v_exp_f32 v184, v184
  v_mfma_f32_16x16x32_bf16 v[68:71], a[132:135], v[196:199], v[68:71]
  v_mfma_f32_16x16x32_bf16 v[72:75], a[136:139], v[196:199], v[72:75]
  v_exp_f32 v185, v185
  v_mfma_f32_16x16x32_bf16 v[76:79], a[140:143], v[196:199], v[76:79]
  v_cvt_pk_bf16_f32 v204, v184, v185
  v_mfma_f32_16x16x32_bf16 v[80:83], a[144:147], v[196:199], v[80:83]
  v_exp_f32 v186, v186
  v_mfma_f32_16x16x32_bf16 v[84:87], a[148:151], v[196:199], v[84:87]
  v_mfma_f32_16x16x32_bf16 v[88:91], a[152:155], v[196:199], v[88:91]
  v_exp_f32 v187, v187
  v_mfma_f32_16x16x32_bf16 v[92:95], a[156:159], v[196:199], v[92:95]
  s_waitcnt lgkmcnt(0)
  v_cvt_pk_bf16_f32 v205, v186, v187
  v_mfma_f32_16x16x32_bf16 a[196:199], a[208:211], v[196:199], a[196:199]
  v_mfma_f32_16x16x32_bf16 v[160:163], a[96:99], a[0:3], v[208:211]
  v_exp_f32 v188, v188
  v_mfma_f32_16x16x32_bf16 v[160:163], a[100:103], a[4:7], v[160:163]
  ds_read_b64_tr_b16 a[160:161], v228 offset:57344
  buffer_load_dwordx4 v238, s[16:19], s33 offen offset:2048 nt lds
  v_mfma_f32_16x16x32_bf16 v[160:163], a[104:107], a[8:11], v[160:163]
  v_exp_f32 v189, v189
  v_mfma_f32_16x16x32_bf16 v[160:163], a[108:111], a[12:15], v[160:163]
  v_cvt_pk_bf16_f32 v206, v188, v189
  ds_read_b64_tr_b16 a[162:163], v228 offset:61440
  v_mfma_f32_16x16x32_bf16 v[164:167], a[112:115], a[0:3], v[208:211]
  v_exp_f32 v190, v190
  v_mfma_f32_16x16x32_bf16 v[164:167], a[116:119], a[4:7], v[164:167]
  ds_read_b64_tr_b16 a[164:165], v229 offset:57344
  ds_read_b64_tr_b16 a[166:167], v229 offset:61440
  v_mfma_f32_16x16x32_bf16 v[164:167], a[120:123], a[8:11], v[164:167]
  v_exp_f32 v191, v191
  v_mfma_f32_16x16x32_bf16 v[164:167], a[124:127], a[12:15], v[164:167]
  v_cvt_pk_bf16_f32 v207, v190, v191
  ds_read_b64_tr_b16 a[168:169], v230 offset:57344
  v_mfma_f32_16x16x32_bf16 v[96:99], a[128:131], v[200:203], v[96:99]
  v_exp_f32 v160, v160
  v_mfma_f32_16x16x32_bf16 v[100:103], a[132:135], v[200:203], v[100:103]
  ds_read_b64_tr_b16 a[170:171], v230 offset:61440
  ds_read_b64_tr_b16 a[172:173], v231 offset:57344
  v_mfma_f32_16x16x32_bf16 v[104:107], a[136:139], v[200:203], v[104:107]
  v_exp_f32 v161, v161
  v_mfma_f32_16x16x32_bf16 v[108:111], a[140:143], v[200:203], v[108:111]
  ds_read_b64_tr_b16 a[174:175], v231 offset:61440
  v_cvt_pk_bf16_f32 v192, v160, v161
  v_mfma_f32_16x16x32_bf16 v[112:115], a[144:147], v[200:203], v[112:115]
  v_exp_f32 v162, v162
  v_mfma_f32_16x16x32_bf16 v[116:119], a[148:151], v[200:203], v[116:119]
  ds_read_b64_tr_b16 a[176:177], v232 offset:57344
  ds_read_b64_tr_b16 a[178:179], v232 offset:61440
  v_mfma_f32_16x16x32_bf16 v[120:123], a[152:155], v[200:203], v[120:123]
  v_exp_f32 v163, v163
  v_mfma_f32_16x16x32_bf16 v[124:127], a[156:159], v[200:203], v[124:127]
  v_cvt_pk_bf16_f32 v193, v162, v163
  ds_read_b64_tr_b16 a[180:181], v233 offset:57344
  v_mfma_f32_16x16x32_bf16 a[200:203], a[208:211], v[200:203], a[200:203]
  ds_read_b64_tr_b16 a[182:183], v233 offset:61440
  v_mfma_f32_16x16x32_bf16 v[168:171], a[96:99], a[16:19], v[212:215]
  v_exp_f32 v164, v164
  v_mfma_f32_16x16x32_bf16 v[168:171], a[100:103], a[20:23], v[168:171]
  ds_read_b64_tr_b16 a[184:185], v234 offset:57344
  buffer_load_dwordx4 v239, s[16:19], s33 offen offset:3072 nt lds
  v_mfma_f32_16x16x32_bf16 v[168:171], a[104:107], a[24:27], v[168:171]
  v_exp_f32 v165, v165
  v_mfma_f32_16x16x32_bf16 v[168:171], a[108:111], a[28:31], v[168:171]
  ds_read_b64_tr_b16 a[186:187], v234 offset:61440
  v_cvt_pk_bf16_f32 v194, v164, v165
  v_mfma_f32_16x16x32_bf16 v[172:175], a[112:115], a[16:19], v[212:215]
  v_exp_f32 v166, v166
  v_mfma_f32_16x16x32_bf16 v[172:175], a[116:119], a[20:23], v[172:175]
  ds_read_b64_tr_b16 a[188:189], v235 offset:57344
  ds_read_b64_tr_b16 a[190:191], v235 offset:61440
  v_mfma_f32_16x16x32_bf16 v[172:175], a[120:123], a[24:27], v[172:175]
  v_exp_f32 v167, v167
  v_mfma_f32_16x16x32_bf16 v[172:175], a[124:127], a[28:31], v[172:175]
  v_cvt_pk_bf16_f32 v195, v166, v167
  v_mfma_f32_16x16x32_bf16 v[128:131], a[128:131], v[204:207], v[128:131]
  v_exp_f32 v168, v168
  v_mfma_f32_16x16x32_bf16 v[132:135], a[132:135], v[204:207], v[132:135]
  v_mfma_f32_16x16x32_bf16 v[136:139], a[136:139], v[204:207], v[136:139]
  v_exp_f32 v169, v169
  v_mfma_f32_16x16x32_bf16 v[140:143], a[140:143], v[204:207], v[140:143]
  v_cvt_pk_bf16_f32 v196, v168, v169
  v_mfma_f32_16x16x32_bf16 v[144:147], a[144:147], v[204:207], v[144:147]
  v_exp_f32 v170, v170
  v_mfma_f32_16x16x32_bf16 v[148:151], a[148:151], v[204:207], v[148:151]
  v_mfma_f32_16x16x32_bf16 v[152:155], a[152:155], v[204:207], v[152:155]
  v_exp_f32 v171, v171
  v_mfma_f32_16x16x32_bf16 v[156:159], a[156:159], v[204:207], v[156:159]
  v_cvt_pk_bf16_f32 v197, v170, v171
  v_mfma_f32_16x16x32_bf16 a[204:207], a[208:211], v[204:207], a[204:207]
  s_waitcnt vmcnt(12) lgkmcnt(0)
  s_barrier
  v_mfma_f32_16x16x32_bf16 v[176:179], a[96:99], a[32:35], v[216:219]
  s_add_u32 m0, s40, 98304
  v_exp_f32 v172, v172
  v_mfma_f32_16x16x32_bf16 v[176:179], a[100:103], a[36:39], v[176:179]
  ds_read_b128 a[64:67], v224 offset:0
  buffer_load_dwordx4 v240, s[20:23], s33 offen nt lds
  v_mfma_f32_16x16x32_bf16 v[176:179], a[104:107], a[40:43], v[176:179]
  v_exp_f32 v173, v173
  v_mfma_f32_16x16x32_bf16 v[176:179], a[108:111], a[44:47], v[176:179]
  v_cvt_pk_bf16_f32 v198, v172, v173
  ds_read_b128 a[68:71], v225 offset:0
  v_mfma_f32_16x16x32_bf16 v[180:183], a[112:115], a[32:35], v[216:219]
  v_exp_f32 v174, v174
  v_mfma_f32_16x16x32_bf16 v[180:183], a[116:119], a[36:39], v[180:183]
  ds_read_b128 a[72:75], v226 offset:0
  v_mfma_f32_16x16x32_bf16 v[180:183], a[120:123], a[40:43], v[180:183]
  v_exp_f32 v175, v175
  v_mfma_f32_16x16x32_bf16 v[180:183], a[124:127], a[44:47], v[180:183]
  ds_read_b128 a[76:79], v227 offset:0
  v_cvt_pk_bf16_f32 v199, v174, v175
  v_mfma_f32_16x16x32_bf16 v[32:35], a[160:163], v[192:195], v[32:35]
  v_exp_f32 v176, v176
  v_mfma_f32_16x16x32_bf16 v[36:39], a[164:167], v[192:195], v[36:39]
  ds_read_b128 a[80:83], v224 offset:4096
  v_mfma_f32_16x16x32_bf16 v[40:43], a[168:171], v[192:195], v[40:43]
  v_exp_f32 v177, v177
  v_mfma_f32_16x16x32_bf16 v[44:47], a[172:175], v[192:195], v[44:47]
  v_cvt_pk_bf16_f32 v200, v176, v177
  ds_read_b128 a[84:87], v225 offset:4096
  v_mfma_f32_16x16x32_bf16 v[48:51], a[176:179], v[192:195], v[48:51]
  v_exp_f32 v178, v178
  v_mfma_f32_16x16x32_bf16 v[52:55], a[180:183], v[192:195], v[52:55]
  ds_read_b128 a[88:91], v226 offset:4096
  v_mfma_f32_16x16x32_bf16 v[56:59], a[184:187], v[192:195], v[56:59]
  v_exp_f32 v179, v179
  v_mfma_f32_16x16x32_bf16 v[60:63], a[188:191], v[192:195], v[60:63]
  ds_read_b128 a[92:95], v227 offset:4096
  v_cvt_pk_bf16_f32 v201, v178, v179
  v_mfma_f32_16x16x32_bf16 a[192:195], a[208:211], v[192:195], a[192:195]
  v_mfma_f32_16x16x32_bf16 v[184:187], a[96:99], a[48:51], v[220:223]
  v_exp_f32 v180, v180
  v_mfma_f32_16x16x32_bf16 v[184:187], a[100:103], a[52:55], v[184:187]
  buffer_load_dwordx4 v241, s[20:23], s33 offen offset:1024 nt lds
  v_mfma_f32_16x16x32_bf16 v[184:187], a[104:107], a[56:59], v[184:187]
  v_exp_f32 v181, v181
  v_mfma_f32_16x16x32_bf16 v[184:187], a[108:111], a[60:63], v[184:187]
  v_cvt_pk_bf16_f32 v202, v180, v181
  v_mfma_f32_16x16x32_bf16 v[188:191], a[112:115], a[48:51], v[220:223]
  v_exp_f32 v182, v182
  v_mfma_f32_16x16x32_bf16 v[188:191], a[116:119], a[52:55], v[188:191]
  v_mfma_f32_16x16x32_bf16 v[188:191], a[120:123], a[56:59], v[188:191]
  v_exp_f32 v183, v183
  v_mfma_f32_16x16x32_bf16 v[188:191], a[124:127], a[60:63], v[188:191]
  v_cvt_pk_bf16_f32 v203, v182, v183
  v_mfma_f32_16x16x32_bf16 v[64:67], a[160:163], v[196:199], v[64:67]
  v_exp_f32 v184, v184
  v_mfma_f32_16x16x32_bf16 v[68:71], a[164:167], v[196:199], v[68:71]
  v_mfma_f32_16x16x32_bf16 v[72:75], a[168:171], v[196:199], v[72:75]
  v_exp_f32 v185, v185
  v_mfma_f32_16x16x32_bf16 v[76:79], a[172:175], v[196:199], v[76:79]
  v_cvt_pk_bf16_f32 v204, v184, v185
  v_mfma_f32_16x16x32_bf16 v[80:83], a[176:179], v[196:199], v[80:83]
  v_exp_f32 v186, v186
  v_mfma_f32_16x16x32_bf16 v[84:87], a[180:183], v[196:199], v[84:87]
  v_mfma_f32_16x16x32_bf16 v[88:91], a[184:187], v[196:199], v[88:91]
  v_exp_f32 v187, v187
  v_mfma_f32_16x16x32_bf16 v[92:95], a[188:191], v[196:199], v[92:95]
  s_waitcnt lgkmcnt(0)
  v_cvt_pk_bf16_f32 v205, v186, v187
  v_mfma_f32_16x16x32_bf16 a[196:199], a[208:211], v[196:199], a[196:199]
  v_mfma_f32_16x16x32_bf16 v[160:163], a[64:67], a[0:3], v[208:211]
  v_exp_f32 v188, v188
  v_mfma_f32_16x16x32_bf16 v[160:163], a[68:71], a[4:7], v[160:163]
  ds_read_b64_tr_b16 a[128:129], v228 offset:0
  buffer_load_dwordx4 v240, s[20:23], s33 offen offset:2048 nt lds
  v_mfma_f32_16x16x32_bf16 v[160:163], a[72:75], a[8:11], v[160:163]
  v_exp_f32 v189, v189
  v_mfma_f32_16x16x32_bf16 v[160:163], a[76:79], a[12:15], v[160:163]
  v_cvt_pk_bf16_f32 v206, v188, v189
  ds_read_b64_tr_b16 a[130:131], v228 offset:4096
  v_mfma_f32_16x16x32_bf16 v[164:167], a[80:83], a[0:3], v[208:211]
  v_exp_f32 v190, v190
  v_mfma_f32_16x16x32_bf16 v[164:167], a[84:87], a[4:7], v[164:167]
  ds_read_b64_tr_b16 a[132:133], v229 offset:0
  ds_read_b64_tr_b16 a[134:135], v229 offset:4096
  v_mfma_f32_16x16x32_bf16 v[164:167], a[88:91], a[8:11], v[164:167]
  v_exp_f32 v191, v191
  v_mfma_f32_16x16x32_bf16 v[164:167], a[92:95], a[12:15], v[164:167]
  v_cvt_pk_bf16_f32 v207, v190, v191
  ds_read_b64_tr_b16 a[136:137], v230 offset:0
  v_mfma_f32_16x16x32_bf16 v[96:99], a[160:163], v[200:203], v[96:99]
  v_exp_f32 v160, v160
  v_mfma_f32_16x16x32_bf16 v[100:103], a[164:167], v[200:203], v[100:103]
  ds_read_b64_tr_b16 a[138:139], v230 offset:4096
  ds_read_b64_tr_b16 a[140:141], v231 offset:0
  v_mfma_f32_16x16x32_bf16 v[104:107], a[168:171], v[200:203], v[104:107]
  v_exp_f32 v161, v161
  v_mfma_f32_16x16x32_bf16 v[108:111], a[172:175], v[200:203], v[108:111]
  ds_read_b64_tr_b16 a[142:143], v231 offset:4096
  v_cvt_pk_bf16_f32 v192, v160, v161
  v_mfma_f32_16x16x32_bf16 v[112:115], a[176:179], v[200:203], v[112:115]
  v_exp_f32 v162, v162
  v_mfma_f32_16x16x32_bf16 v[116:119], a[180:183], v[200:203], v[116:119]
  ds_read_b64_tr_b16 a[144:145], v232 offset:0
  ds_read_b64_tr_b16 a[146:147], v232 offset:4096
  v_mfma_f32_16x16x32_bf16 v[120:123], a[184:187], v[200:203], v[120:123]
  v_exp_f32 v163, v163
  v_mfma_f32_16x16x32_bf16 v[124:127], a[188:191], v[200:203], v[124:127]
  v_cvt_pk_bf16_f32 v193, v162, v163
  ds_read_b64_tr_b16 a[148:149], v233 offset:0
  v_mfma_f32_16x16x32_bf16 a[200:203], a[208:211], v[200:203], a[200:203]
  ds_read_b64_tr_b16 a[150:151], v233 offset:4096
  v_mfma_f32_16x16x32_bf16 v[168:171], a[64:67], a[16:19], v[212:215]
  v_exp_f32 v164, v164
  v_mfma_f32_16x16x32_bf16 v[168:171], a[68:71], a[20:23], v[168:171]
  ds_read_b64_tr_b16 a[152:153], v234 offset:0
  buffer_load_dwordx4 v241, s[20:23], s33 offen offset:3072 nt lds
  v_mfma_f32_16x16x32_bf16 v[168:171], a[72:75], a[24:27], v[168:171]
  s_add_u32 s33, s33, 16384
  v_exp_f32 v165, v165
  v_mfma_f32_16x16x32_bf16 v[168:171], a[76:79], a[28:31], v[168:171]
  ds_read_b64_tr_b16 a[154:155], v234 offset:4096
  v_cvt_pk_bf16_f32 v194, v164, v165
  v_mfma_f32_16x16x32_bf16 v[172:175], a[80:83], a[16:19], v[212:215]
  v_exp_f32 v166, v166
  v_mfma_f32_16x16x32_bf16 v[172:175], a[84:87], a[20:23], v[172:175]
  ds_read_b64_tr_b16 a[156:157], v235 offset:0
  ds_read_b64_tr_b16 a[158:159], v235 offset:4096
  v_mfma_f32_16x16x32_bf16 v[172:175], a[88:91], a[24:27], v[172:175]
  v_exp_f32 v167, v167
  v_mfma_f32_16x16x32_bf16 v[172:175], a[92:95], a[28:31], v[172:175]
  v_cvt_pk_bf16_f32 v195, v166, v167
  v_mfma_f32_16x16x32_bf16 v[128:131], a[160:163], v[204:207], v[128:131]
  v_exp_f32 v168, v168
  v_mfma_f32_16x16x32_bf16 v[132:135], a[164:167], v[204:207], v[132:135]
  v_mfma_f32_16x16x32_bf16 v[136:139], a[168:171], v[204:207], v[136:139]
  v_exp_f32 v169, v169
  v_mfma_f32_16x16x32_bf16 v[140:143], a[172:175], v[204:207], v[140:143]
  v_cvt_pk_bf16_f32 v196, v168, v169
  v_mfma_f32_16x16x32_bf16 v[144:147], a[176:179], v[204:207], v[144:147]
  v_exp_f32 v170, v170
  v_mfma_f32_16x16x32_bf16 v[148:151], a[180:183], v[204:207], v[148:151]
  v_mfma_f32_16x16x32_bf16 v[152:155], a[184:187], v[204:207], v[152:155]
  v_exp_f32 v171, v171
  v_mfma_f32_16x16x32_bf16 v[156:159], a[188:191], v[204:207], v[156:159]
  v_cvt_pk_bf16_f32 v197, v170, v171
  v_mfma_f32_16x16x32_bf16 a[204:207], a[208:211], v[204:207], a[204:207]
  s_waitcnt lgkmcnt(0)
  v_mfma_f32_16x16x32_bf16 v[176:179], a[64:67], a[32:35], v[216:219]
  s_add_u32 m0, s40, 49152
  v_exp_f32 v172, v172
  v_mfma_f32_16x16x32_bf16 v[176:179], a[68:71], a[36:39], v[176:179]
  ds_read_b128 a[96:99], v224 offset:8192
  buffer_load_dwordx4 v236, s[16:19], s33 offen nt lds
  v_mfma_f32_16x16x32_bf16 v[176:179], a[72:75], a[40:43], v[176:179]
  v_exp_f32 v173, v173
  v_mfma_f32_16x16x32_bf16 v[176:179], a[76:79], a[44:47], v[176:179]
  v_cvt_pk_bf16_f32 v198, v172, v173
  ds_read_b128 a[100:103], v225 offset:8192
  v_mfma_f32_16x16x32_bf16 v[180:183], a[80:83], a[32:35], v[216:219]
  v_exp_f32 v174, v174
  v_mfma_f32_16x16x32_bf16 v[180:183], a[84:87], a[36:39], v[180:183]
  ds_read_b128 a[104:107], v226 offset:8192
  v_mfma_f32_16x16x32_bf16 v[180:183], a[88:91], a[40:43], v[180:183]
  v_exp_f32 v175, v175
  v_mfma_f32_16x16x32_bf16 v[180:183], a[92:95], a[44:47], v[180:183]
  ds_read_b128 a[108:111], v227 offset:8192
  v_cvt_pk_bf16_f32 v199, v174, v175
  v_mfma_f32_16x16x32_bf16 v[32:35], a[128:131], v[192:195], v[32:35]
  v_exp_f32 v176, v176
  v_mfma_f32_16x16x32_bf16 v[36:39], a[132:135], v[192:195], v[36:39]
  ds_read_b128 a[112:115], v224 offset:12288
  v_mfma_f32_16x16x32_bf16 v[40:43], a[136:139], v[192:195], v[40:43]
  v_exp_f32 v177, v177
  v_mfma_f32_16x16x32_bf16 v[44:47], a[140:143], v[192:195], v[44:47]
  v_cvt_pk_bf16_f32 v200, v176, v177
  ds_read_b128 a[116:119], v225 offset:12288
  v_mfma_f32_16x16x32_bf16 v[48:51], a[144:147], v[192:195], v[48:51]
  v_exp_f32 v178, v178
  v_mfma_f32_16x16x32_bf16 v[52:55], a[148:151], v[192:195], v[52:55]
  ds_read_b128 a[120:123], v226 offset:12288
  v_mfma_f32_16x16x32_bf16 v[56:59], a[152:155], v[192:195], v[56:59]
  v_exp_f32 v179, v179
  v_mfma_f32_16x16x32_bf16 v[60:63], a[156:159], v[192:195], v[60:63]
  ds_read_b128 a[124:127], v227 offset:12288
  v_cvt_pk_bf16_f32 v201, v178, v179
  v_mfma_f32_16x16x32_bf16 a[192:195], a[208:211], v[192:195], a[192:195]
  v_mfma_f32_16x16x32_bf16 v[184:187], a[64:67], a[48:51], v[220:223]
  v_exp_f32 v180, v180
  v_mfma_f32_16x16x32_bf16 v[184:187], a[68:71], a[52:55], v[184:187]
  buffer_load_dwordx4 v237, s[16:19], s33 offen offset:1024 nt lds
  v_mfma_f32_16x16x32_bf16 v[184:187], a[72:75], a[56:59], v[184:187]
  v_exp_f32 v181, v181
  v_mfma_f32_16x16x32_bf16 v[184:187], a[76:79], a[60:63], v[184:187]
  v_cvt_pk_bf16_f32 v202, v180, v181
  v_mfma_f32_16x16x32_bf16 v[188:191], a[80:83], a[48:51], v[220:223]
  v_exp_f32 v182, v182
  v_mfma_f32_16x16x32_bf16 v[188:191], a[84:87], a[52:55], v[188:191]
  v_mfma_f32_16x16x32_bf16 v[188:191], a[88:91], a[56:59], v[188:191]
  v_exp_f32 v183, v183
  v_mfma_f32_16x16x32_bf16 v[188:191], a[92:95], a[60:63], v[188:191]
  v_cvt_pk_bf16_f32 v203, v182, v183
  v_mfma_f32_16x16x32_bf16 v[64:67], a[128:131], v[196:199], v[64:67]
  v_exp_f32 v184, v184
  v_mfma_f32_16x16x32_bf16 v[68:71], a[132:135], v[196:199], v[68:71]
  v_mfma_f32_16x16x32_bf16 v[72:75], a[136:139], v[196:199], v[72:75]
  v_exp_f32 v185, v185
  v_mfma_f32_16x16x32_bf16 v[76:79], a[140:143], v[196:199], v[76:79]
  v_cvt_pk_bf16_f32 v204, v184, v185
  v_mfma_f32_16x16x32_bf16 v[80:83], a[144:147], v[196:199], v[80:83]
  v_exp_f32 v186, v186
  v_mfma_f32_16x16x32_bf16 v[84:87], a[148:151], v[196:199], v[84:87]
  v_mfma_f32_16x16x32_bf16 v[88:91], a[152:155], v[196:199], v[88:91]
  v_exp_f32 v187, v187
  v_mfma_f32_16x16x32_bf16 v[92:95], a[156:159], v[196:199], v[92:95]
  s_waitcnt lgkmcnt(0)
  v_cvt_pk_bf16_f32 v205, v186, v187
  v_mfma_f32_16x16x32_bf16 a[196:199], a[208:211], v[196:199], a[196:199]
  v_mfma_f32_16x16x32_bf16 v[160:163], a[96:99], a[0:3], v[208:211]
  v_exp_f32 v188, v188
  v_mfma_f32_16x16x32_bf16 v[160:163], a[100:103], a[4:7], v[160:163]
  ds_read_b64_tr_b16 a[160:161], v228 offset:8192
  buffer_load_dwordx4 v238, s[16:19], s33 offen offset:2048 nt lds
  v_mfma_f32_16x16x32_bf16 v[160:163], a[104:107], a[8:11], v[160:163]
  v_exp_f32 v189, v189
  v_mfma_f32_16x16x32_bf16 v[160:163], a[108:111], a[12:15], v[160:163]
  v_cvt_pk_bf16_f32 v206, v188, v189
  ds_read_b64_tr_b16 a[162:163], v228 offset:12288
  v_mfma_f32_16x16x32_bf16 v[164:167], a[112:115], a[0:3], v[208:211]
  v_exp_f32 v190, v190
  v_mfma_f32_16x16x32_bf16 v[164:167], a[116:119], a[4:7], v[164:167]
  ds_read_b64_tr_b16 a[164:165], v229 offset:8192
  ds_read_b64_tr_b16 a[166:167], v229 offset:12288
  v_mfma_f32_16x16x32_bf16 v[164:167], a[120:123], a[8:11], v[164:167]
  v_exp_f32 v191, v191
  v_mfma_f32_16x16x32_bf16 v[164:167], a[124:127], a[12:15], v[164:167]
  v_cvt_pk_bf16_f32 v207, v190, v191
  ds_read_b64_tr_b16 a[168:169], v230 offset:8192
  v_mfma_f32_16x16x32_bf16 v[96:99], a[128:131], v[200:203], v[96:99]
  v_exp_f32 v160, v160
  v_mfma_f32_16x16x32_bf16 v[100:103], a[132:135], v[200:203], v[100:103]
  ds_read_b64_tr_b16 a[170:171], v230 offset:12288
  ds_read_b64_tr_b16 a[172:173], v231 offset:8192
  v_mfma_f32_16x16x32_bf16 v[104:107], a[136:139], v[200:203], v[104:107]
  v_exp_f32 v161, v161
  v_mfma_f32_16x16x32_bf16 v[108:111], a[140:143], v[200:203], v[108:111]
  ds_read_b64_tr_b16 a[174:175], v231 offset:12288
  v_cvt_pk_bf16_f32 v192, v160, v161
  v_mfma_f32_16x16x32_bf16 v[112:115], a[144:147], v[200:203], v[112:115]
  v_exp_f32 v162, v162
  v_mfma_f32_16x16x32_bf16 v[116:119], a[148:151], v[200:203], v[116:119]
  ds_read_b64_tr_b16 a[176:177], v232 offset:8192
  ds_read_b64_tr_b16 a[178:179], v232 offset:12288
  v_mfma_f32_16x16x32_bf16 v[120:123], a[152:155], v[200:203], v[120:123]
  v_exp_f32 v163, v163
  v_mfma_f32_16x16x32_bf16 v[124:127], a[156:159], v[200:203], v[124:127]
  v_cvt_pk_bf16_f32 v193, v162, v163
  ds_read_b64_tr_b16 a[180:181], v233 offset:8192
  v_mfma_f32_16x16x32_bf16 a[200:203], a[208:211], v[200:203], a[200:203]
  ds_read_b64_tr_b16 a[182:183], v233 offset:12288
  v_mfma_f32_16x16x32_bf16 v[168:171], a[96:99], a[16:19], v[212:215]
  v_exp_f32 v164, v164
  v_mfma_f32_16x16x32_bf16 v[168:171], a[100:103], a[20:23], v[168:171]
  ds_read_b64_tr_b16 a[184:185], v234 offset:8192
  buffer_load_dwordx4 v239, s[16:19], s33 offen offset:3072 nt lds
  v_mfma_f32_16x16x32_bf16 v[168:171], a[104:107], a[24:27], v[168:171]
  v_exp_f32 v165, v165
  v_mfma_f32_16x16x32_bf16 v[168:171], a[108:111], a[28:31], v[168:171]
  ds_read_b64_tr_b16 a[186:187], v234 offset:12288
  v_cvt_pk_bf16_f32 v194, v164, v165
  v_mfma_f32_16x16x32_bf16 v[172:175], a[112:115], a[16:19], v[212:215]
  v_exp_f32 v166, v166
  v_mfma_f32_16x16x32_bf16 v[172:175], a[116:119], a[20:23], v[172:175]
  ds_read_b64_tr_b16 a[188:189], v235 offset:8192
  ds_read_b64_tr_b16 a[190:191], v235 offset:12288
  v_mfma_f32_16x16x32_bf16 v[172:175], a[120:123], a[24:27], v[172:175]
  v_exp_f32 v167, v167
  v_mfma_f32_16x16x32_bf16 v[172:175], a[124:127], a[28:31], v[172:175]
  v_cvt_pk_bf16_f32 v195, v166, v167
  v_mfma_f32_16x16x32_bf16 v[128:131], a[128:131], v[204:207], v[128:131]
  v_exp_f32 v168, v168
  v_mfma_f32_16x16x32_bf16 v[132:135], a[132:135], v[204:207], v[132:135]
  v_mfma_f32_16x16x32_bf16 v[136:139], a[136:139], v[204:207], v[136:139]
  v_exp_f32 v169, v169
  v_mfma_f32_16x16x32_bf16 v[140:143], a[140:143], v[204:207], v[140:143]
  v_cvt_pk_bf16_f32 v196, v168, v169
  v_mfma_f32_16x16x32_bf16 v[144:147], a[144:147], v[204:207], v[144:147]
  v_exp_f32 v170, v170
  v_mfma_f32_16x16x32_bf16 v[148:151], a[148:151], v[204:207], v[148:151]
  v_mfma_f32_16x16x32_bf16 v[152:155], a[152:155], v[204:207], v[152:155]
  v_exp_f32 v171, v171
  v_mfma_f32_16x16x32_bf16 v[156:159], a[156:159], v[204:207], v[156:159]
  v_cvt_pk_bf16_f32 v197, v170, v171
  v_mfma_f32_16x16x32_bf16 a[204:207], a[208:211], v[204:207], a[204:207]
  s_waitcnt vmcnt(12) lgkmcnt(0)
  s_barrier
  v_mfma_f32_16x16x32_bf16 v[176:179], a[96:99], a[32:35], v[216:219]
  s_add_u32 m0, s40, 114688
  v_exp_f32 v172, v172
  v_mfma_f32_16x16x32_bf16 v[176:179], a[100:103], a[36:39], v[176:179]
  ds_read_b128 a[64:67], v224 offset:16384
  buffer_load_dwordx4 v240, s[20:23], s33 offen nt lds
  v_mfma_f32_16x16x32_bf16 v[176:179], a[104:107], a[40:43], v[176:179]
  v_exp_f32 v173, v173
  v_mfma_f32_16x16x32_bf16 v[176:179], a[108:111], a[44:47], v[176:179]
  v_cvt_pk_bf16_f32 v198, v172, v173
  ds_read_b128 a[68:71], v225 offset:16384
  v_mfma_f32_16x16x32_bf16 v[180:183], a[112:115], a[32:35], v[216:219]
  v_exp_f32 v174, v174
  v_mfma_f32_16x16x32_bf16 v[180:183], a[116:119], a[36:39], v[180:183]
  ds_read_b128 a[72:75], v226 offset:16384
  v_mfma_f32_16x16x32_bf16 v[180:183], a[120:123], a[40:43], v[180:183]
  v_exp_f32 v175, v175
  v_mfma_f32_16x16x32_bf16 v[180:183], a[124:127], a[44:47], v[180:183]
  ds_read_b128 a[76:79], v227 offset:16384
  v_cvt_pk_bf16_f32 v199, v174, v175
  v_mfma_f32_16x16x32_bf16 v[32:35], a[160:163], v[192:195], v[32:35]
  v_exp_f32 v176, v176
  v_mfma_f32_16x16x32_bf16 v[36:39], a[164:167], v[192:195], v[36:39]
  ds_read_b128 a[80:83], v224 offset:20480
  v_mfma_f32_16x16x32_bf16 v[40:43], a[168:171], v[192:195], v[40:43]
  v_exp_f32 v177, v177
  v_mfma_f32_16x16x32_bf16 v[44:47], a[172:175], v[192:195], v[44:47]
  v_cvt_pk_bf16_f32 v200, v176, v177
  ds_read_b128 a[84:87], v225 offset:20480
  v_mfma_f32_16x16x32_bf16 v[48:51], a[176:179], v[192:195], v[48:51]
  v_exp_f32 v178, v178
  v_mfma_f32_16x16x32_bf16 v[52:55], a[180:183], v[192:195], v[52:55]
  ds_read_b128 a[88:91], v226 offset:20480
  v_mfma_f32_16x16x32_bf16 v[56:59], a[184:187], v[192:195], v[56:59]
  v_exp_f32 v179, v179
  v_mfma_f32_16x16x32_bf16 v[60:63], a[188:191], v[192:195], v[60:63]
  ds_read_b128 a[92:95], v227 offset:20480
  v_cvt_pk_bf16_f32 v201, v178, v179
  v_mfma_f32_16x16x32_bf16 a[192:195], a[208:211], v[192:195], a[192:195]
  v_mfma_f32_16x16x32_bf16 v[184:187], a[96:99], a[48:51], v[220:223]
  v_exp_f32 v180, v180
  v_mfma_f32_16x16x32_bf16 v[184:187], a[100:103], a[52:55], v[184:187]
  buffer_load_dwordx4 v241, s[20:23], s33 offen offset:1024 nt lds
  v_mfma_f32_16x16x32_bf16 v[184:187], a[104:107], a[56:59], v[184:187]
  v_exp_f32 v181, v181
  v_mfma_f32_16x16x32_bf16 v[184:187], a[108:111], a[60:63], v[184:187]
  v_cvt_pk_bf16_f32 v202, v180, v181
  v_mfma_f32_16x16x32_bf16 v[188:191], a[112:115], a[48:51], v[220:223]
  v_exp_f32 v182, v182
  v_mfma_f32_16x16x32_bf16 v[188:191], a[116:119], a[52:55], v[188:191]
  v_mfma_f32_16x16x32_bf16 v[188:191], a[120:123], a[56:59], v[188:191]
  v_exp_f32 v183, v183
  v_mfma_f32_16x16x32_bf16 v[188:191], a[124:127], a[60:63], v[188:191]
  v_cvt_pk_bf16_f32 v203, v182, v183
  v_mfma_f32_16x16x32_bf16 v[64:67], a[160:163], v[196:199], v[64:67]
  v_exp_f32 v184, v184
  v_mfma_f32_16x16x32_bf16 v[68:71], a[164:167], v[196:199], v[68:71]
  v_mfma_f32_16x16x32_bf16 v[72:75], a[168:171], v[196:199], v[72:75]
  v_exp_f32 v185, v185
  v_mfma_f32_16x16x32_bf16 v[76:79], a[172:175], v[196:199], v[76:79]
  v_cvt_pk_bf16_f32 v204, v184, v185
  v_mfma_f32_16x16x32_bf16 v[80:83], a[176:179], v[196:199], v[80:83]
  v_exp_f32 v186, v186
  v_mfma_f32_16x16x32_bf16 v[84:87], a[180:183], v[196:199], v[84:87]
  v_mfma_f32_16x16x32_bf16 v[88:91], a[184:187], v[196:199], v[88:91]
  s_sub_u32 s34, s34, 1
  v_exp_f32 v187, v187
  v_mfma_f32_16x16x32_bf16 v[92:95], a[188:191], v[196:199], v[92:95]
  s_waitcnt lgkmcnt(0)
  v_cvt_pk_bf16_f32 v205, v186, v187
  v_mfma_f32_16x16x32_bf16 a[196:199], a[208:211], v[196:199], a[196:199]
  s_cmp_lg_u32 s34, 0
  s_cbranch_scc1 L_loop
  v_mfma_f32_16x16x32_bf16 v[160:163], a[64:67], a[0:3], v[208:211]
  s_add_u32 m0, s40, 114688
  v_exp_f32 v188, v188
  v_mfma_f32_16x16x32_bf16 v[160:163], a[68:71], a[4:7], v[160:163]
  ds_read_b64_tr_b16 a[128:129], v228 offset:16384
  buffer_load_dwordx4 v240, s[20:23], s33 offen offset:2048 nt lds
  v_mfma_f32_16x16x32_bf16 v[160:163], a[72:75], a[8:11], v[160:163]
  v_exp_f32 v189, v189
  v_mfma_f32_16x16x32_bf16 v[160:163], a[76:79], a[12:15], v[160:163]
  v_cvt_pk_bf16_f32 v206, v188, v189
  ds_read_b64_tr_b16 a[130:131], v228 offset:20480
  v_mfma_f32_16x16x32_bf16 v[164:167], a[80:83], a[0:3], v[208:211]
  s_add_u32 m0, s40, 114688
  v_exp_f32 v190, v190
  v_mfma_f32_16x16x32_bf16 v[164:167], a[84:87], a[4:7], v[164:167]
  ds_read_b64_tr_b16 a[132:133], v229 offset:16384
  ds_read_b64_tr_b16 a[134:135], v229 offset:20480
  buffer_load_dwordx4 v241, s[20:23], s33 offen offset:3072 nt lds
  v_mfma_f32_16x16x32_bf16 v[164:167], a[88:91], a[8:11], v[164:167]
  s_add_u32 s33, s33, 16384
  v_exp_f32 v191, v191
  v_mfma_f32_16x16x32_bf16 v[164:167], a[92:95], a[12:15], v[164:167]
  v_cvt_pk_bf16_f32 v207, v190, v191
  ds_read_b64_tr_b16 a[136:137], v230 offset:16384
  v_mfma_f32_16x16x32_bf16 v[96:99], a[160:163], v[200:203], v[96:99]
  v_exp_f32 v160, v160
  v_mfma_f32_16x16x32_bf16 v[100:103], a[164:167], v[200:203], v[100:103]
  ds_read_b64_tr_b16 a[138:139], v230 offset:20480
  ds_read_b64_tr_b16 a[140:141], v231 offset:16384
  v_mfma_f32_16x16x32_bf16 v[104:107], a[168:171], v[200:203], v[104:107]
  v_exp_f32 v161, v161
  v_mfma_f32_16x16x32_bf16 v[108:111], a[172:175], v[200:203], v[108:111]
  ds_read_b64_tr_b16 a[142:143], v231 offset:20480
  v_cvt_pk_bf16_f32 v192, v160, v161
  v_mfma_f32_16x16x32_bf16 v[112:115], a[176:179], v[200:203], v[112:115]
  v_exp_f32 v162, v162
  v_mfma_f32_16x16x32_bf16 v[116:119], a[180:183], v[200:203], v[116:119]
  ds_read_b64_tr_b16 a[144:145], v232 offset:16384
  ds_read_b64_tr_b16 a[146:147], v232 offset:20480
  v_mfma_f32_16x16x32_bf16 v[120:123], a[184:187], v[200:203], v[120:123]
  v_exp_f32 v163, v163
  v_mfma_f32_16x16x32_bf16 v[124:127], a[188:191], v[200:203], v[124:127]
  v_cvt_pk_bf16_f32 v193, v162, v163
  ds_read_b64_tr_b16 a[148:149], v233 offset:16384
  v_mfma_f32_16x16x32_bf16 a[200:203], a[208:211], v[200:203], a[200:203]
  ds_read_b64_tr_b16 a[150:151], v233 offset:20480
  v_mfma_f32_16x16x32_bf16 v[168:171], a[64:67], a[16:19], v[212:215]
  v_exp_f32 v164, v164
  v_mfma_f32_16x16x32_bf16 v[168:171], a[68:71], a[20:23], v[168:171]
  ds_read_b64_tr_b16 a[152:153], v234 offset:16384
  v_mfma_f32_16x16x32_bf16 v[168:171], a[72:75], a[24:27], v[168:171]
  v_exp_f32 v165, v165
  v_mfma_f32_16x16x32_bf16 v[168:171], a[76:79], a[28:31], v[168:171]
  s_add_u32 s42, s41, 0
  ds_read_b64_tr_b16 a[154:155], v234 offset:20480
  v_cvt_pk_bf16_f32 v194, v164, v165
  v_mfma_f32_16x16x32_bf16 v[172:175], a[80:83], a[16:19], v[212:215]
  s_and_b32 s42, s42, 31
  v_exp_f32 v166, v166
  v_mfma_f32_16x16x32_bf16 v[172:175], a[84:87], a[20:23], v[172:175]
  s_mul_i32 s42, s42, 40960
  ds_read_b64_tr_b16 a[156:157], v235 offset:16384
  ds_read_b64_tr_b16 a[158:159], v235 offset:20480
  v_mfma_f32_16x16x32_bf16 v[172:175], a[88:91], a[24:27], v[172:175]
  s_add_u32 m0, s40, 0
  v_exp_f32 v167, v167
  v_mfma_f32_16x16x32_bf16 v[172:175], a[92:95], a[28:31], v[172:175]
  buffer_load_dwordx4 v246, s[8:11], s42 offen lds
  v_cvt_pk_bf16_f32 v195, v166, v167
  v_mfma_f32_16x16x32_bf16 v[128:131], a[160:163], v[204:207], v[128:131]
  v_exp_f32 v168, v168
  v_mfma_f32_16x16x32_bf16 v[132:135], a[164:167], v[204:207], v[132:135]
  global_load_dword v255, v0, s[46:47] sc1
  v_mfma_f32_16x16x32_bf16 v[136:139], a[168:171], v[204:207], v[136:139]
  v_exp_f32 v169, v169
  v_mfma_f32_16x16x32_bf16 v[140:143], a[172:175], v[204:207], v[140:143]
  v_cvt_pk_bf16_f32 v196, v168, v169
  v_mfma_f32_16x16x32_bf16 v[144:147], a[176:179], v[204:207], v[144:147]
  v_exp_f32 v170, v170
  v_mfma_f32_16x16x32_bf16 v[148:151], a[180:183], v[204:207], v[148:151]
  v_mfma_f32_16x16x32_bf16 v[152:155], a[184:187], v[204:207], v[152:155]
  v_exp_f32 v171, v171
  v_mfma_f32_16x16x32_bf16 v[156:159], a[188:191], v[204:207], v[156:159]
  v_cvt_pk_bf16_f32 v197, v170, v171
  v_mfma_f32_16x16x32_bf16 a[204:207], a[208:211], v[204:207], a[204:207]
  s_waitcnt lgkmcnt(0)
  v_mfma_f32_16x16x32_bf16 v[176:179], a[64:67], a[32:35], v[216:219]
  v_exp_f32 v172, v172
  v_mfma_f32_16x16x32_bf16 v[176:179], a[68:71], a[36:39], v[176:179]
  ds_read_b128 a[96:99], v224 offset:24576
  buffer_load_dwordx4 v247, s[8:11], s42 offen offset:1024 lds
  v_mfma_f32_16x16x32_bf16 v[176:179], a[72:75], a[40:43], v[176:179]
  v_exp_f32 v173, v173
  v_mfma_f32_16x16x32_bf16 v[176:179], a[76:79], a[44:47], v[176:179]
  v_cvt_pk_bf16_f32 v198, v172, v173
  ds_read_b128 a[100:103], v225 offset:24576
  v_mfma_f32_16x16x32_bf16 v[180:183], a[80:83], a[32:35], v[216:219]
  v_exp_f32 v174, v174
  v_mfma_f32_16x16x32_bf16 v[180:183], a[84:87], a[36:39], v[180:183]
  ds_read_b128 a[104:107], v226 offset:24576
  v_mfma_f32_16x16x32_bf16 v[180:183], a[88:91], a[40:43], v[180:183]
  v_exp_f32 v175, v175
  v_mfma_f32_16x16x32_bf16 v[180:183], a[92:95], a[44:47], v[180:183]
  ds_read_b128 a[108:111], v227 offset:24576
  v_cvt_pk_bf16_f32 v199, v174, v175
  v_mfma_f32_16x16x32_bf16 v[32:35], a[128:131], v[192:195], v[32:35]
  v_exp_f32 v176, v176
  v_mfma_f32_16x16x32_bf16 v[36:39], a[132:135], v[192:195], v[36:39]
  ds_read_b128 a[112:115], v224 offset:28672
  v_mfma_f32_16x16x32_bf16 v[40:43], a[136:139], v[192:195], v[40:43]
  v_exp_f32 v177, v177
  v_mfma_f32_16x16x32_bf16 v[44:47], a[140:143], v[192:195], v[44:47]
  v_cvt_pk_bf16_f32 v200, v176, v177
  ds_read_b128 a[116:119], v225 offset:28672
  v_mfma_f32_16x16x32_bf16 v[48:51], a[144:147], v[192:195], v[48:51]
  v_exp_f32 v178, v178
  v_mfma_f32_16x16x32_bf16 v[52:55], a[148:151], v[192:195], v[52:55]
  ds_read_b128 a[120:123], v226 offset:28672
  v_mfma_f32_16x16x32_bf16 v[56:59], a[152:155], v[192:195], v[56:59]
  v_exp_f32 v179, v179
  v_mfma_f32_16x16x32_bf16 v[60:63], a[156:159], v[192:195], v[60:63]
  ds_read_b128 a[124:127], v227 offset:28672
  v_cvt_pk_bf16_f32 v201, v178, v179
  v_mfma_f32_16x16x32_bf16 a[192:195], a[208:211], v[192:195], a[192:195]
  buffer_load_dwordx4 v248, s[8:11], s42 offen offset:2048 lds
  v_mfma_f32_16x16x32_bf16 v[184:187], a[64:67], a[48:51], v[220:223]
  v_exp_f32 v180, v180
  v_mfma_f32_16x16x32_bf16 v[184:187], a[68:71], a[52:55], v[184:187]
  v_mfma_f32_16x16x32_bf16 v[184:187], a[72:75], a[56:59], v[184:187]
  v_exp_f32 v181, v181
  v_mfma_f32_16x16x32_bf16 v[184:187], a[76:79], a[60:63], v[184:187]
  v_cvt_pk_bf16_f32 v202, v180, v181
  v_mfma_f32_16x16x32_bf16 v[188:191], a[80:83], a[48:51], v[220:223]
  v_exp_f32 v182, v182
  v_mfma_f32_16x16x32_bf16 v[188:191], a[84:87], a[52:55], v[188:191]
  v_mfma_f32_16x16x32_bf16 v[188:191], a[88:91], a[56:59], v[188:191]
  v_exp_f32 v183, v183
  v_mfma_f32_16x16x32_bf16 v[188:191], a[92:95], a[60:63], v[188:191]
  v_cvt_pk_bf16_f32 v203, v182, v183
  v_mfma_f32_16x16x32_bf16 v[64:67], a[128:131], v[196:199], v[64:67]
  v_exp_f32 v184, v184
  v_mfma_f32_16x16x32_bf16 v[68:71], a[132:135], v[196:199], v[68:71]
  buffer_load_dwordx4 v249, s[8:11], s42 offen offset:3072 lds
  v_mfma_f32_16x16x32_bf16 v[72:75], a[136:139], v[196:199], v[72:75]
  v_exp_f32 v185, v185
  v_mfma_f32_16x16x32_bf16 v[76:79], a[140:143], v[196:199], v[76:79]
  v_cvt_pk_bf16_f32 v204, v184, v185
  v_mfma_f32_16x16x32_bf16 v[80:83], a[144:147], v[196:199], v[80:83]
  v_exp_f32 v186, v186
  v_mfma_f32_16x16x32_bf16 v[84:87], a[148:151], v[196:199], v[84:87]
  v_mfma_f32_16x16x32_bf16 v[88:91], a[152:155], v[196:199], v[88:91]
  v_exp_f32 v187, v187
  v_mfma_f32_16x16x32_bf16 v[92:95], a[156:159], v[196:199], v[92:95]
  s_waitcnt lgkmcnt(0)
  v_cvt_pk_bf16_f32 v205, v186, v187
  v_mfma_f32_16x16x32_bf16 a[196:199], a[208:211], v[196:199], a[196:199]
  v_mfma_f32_16x16x32_bf16 v[160:163], a[96:99], a[0:3], v[208:211]
  v_exp_f32 v188, v188
  v_mfma_f32_16x16x32_bf16 v[160:163], a[100:103], a[4:7], v[160:163]
  s_add_u32 s42, s41, 1
  ds_read_b64_tr_b16 a[160:161], v228 offset:24576
  v_mfma_f32_16x16x32_bf16 v[160:163], a[104:107], a[8:11], v[160:163]
  s_and_b32 s42, s42, 31
  v_exp_f32 v189, v189
  v_mfma_f32_16x16x32_bf16 v[160:163], a[108:111], a[12:15], v[160:163]
  s_mul_i32 s42, s42, 40960
  v_cvt_pk_bf16_f32 v206, v188, v189
  ds_read_b64_tr_b16 a[162:163], v228 offset:28672
  v_mfma_f32_16x16x32_bf16 v[164:167], a[112:115], a[0:3], v[208:211]
  s_add_u32 m0, s40, 65536
  v_exp_f32 v190, v190
  v_mfma_f32_16x16x32_bf16 v[164:167], a[116:119], a[4:7], v[164:167]
  ds_read_b64_tr_b16 a[164:165], v229 offset:24576
  ds_read_b64_tr_b16 a[166:167], v229 offset:28672
  buffer_load_dwordx4 v246, s[8:11], s42 offen lds
  v_mfma_f32_16x16x32_bf16 v[164:167], a[120:123], a[8:11], v[164:167]
  v_exp_f32 v191, v191
  v_mfma_f32_16x16x32_bf16 v[164:167], a[124:127], a[12:15], v[164:167]
  v_cvt_pk_bf16_f32 v207, v190, v191
  ds_read_b64_tr_b16 a[168:169], v230 offset:24576
  v_mfma_f32_16x16x32_bf16 v[96:99], a[128:131], v[200:203], v[96:99]
  v_exp_f32 v160, v160
  v_mfma_f32_16x16x32_bf16 v[100:103], a[132:135], v[200:203], v[100:103]
  ds_read_b64_tr_b16 a[170:171], v230 offset:28672
  ds_read_b64_tr_b16 a[172:173], v231 offset:24576
  v_mfma_f32_16x16x32_bf16 v[104:107], a[136:139], v[200:203], v[104:107]
  v_exp_f32 v161, v161
  v_mfma_f32_16x16x32_bf16 v[108:111], a[140:143], v[200:203], v[108:111]
  ds_read_b64_tr_b16 a[174:175], v231 offset:28672
  v_cvt_pk_bf16_f32 v192, v160, v161
  v_mfma_f32_16x16x32_bf16 v[112:115], a[144:147], v[200:203], v[112:115]
  v_exp_f32 v162, v162
  v_mfma_f32_16x16x32_bf16 v[116:119], a[148:151], v[200:203], v[116:119]
  ds_read_b64_tr_b16 a[176:177], v232 offset:24576
  ds_read_b64_tr_b16 a[178:179], v232 offset:28672
  v_mfma_f32_16x16x32_bf16 v[120:123], a[152:155], v[200:203], v[120:123]
  v_exp_f32 v163, v163
  v_mfma_f32_16x16x32_bf16 v[124:127], a[156:159], v[200:203], v[124:127]
  v_cvt_pk_bf16_f32 v193, v162, v163
  ds_read_b64_tr_b16 a[180:181], v233 offset:24576
  v_mfma_f32_16x16x32_bf16 a[200:203], a[208:211], v[200:203], a[200:203]
  ds_read_b64_tr_b16 a[182:183], v233 offset:28672
  buffer_load_dwordx4 v247, s[8:11], s42 offen offset:1024 lds
  v_mfma_f32_16x16x32_bf16 v[168:171], a[96:99], a[16:19], v[212:215]
  v_exp_f32 v164, v164
  v_mfma_f32_16x16x32_bf16 v[168:171], a[100:103], a[20:23], v[168:171]
  ds_read_b64_tr_b16 a[184:185], v234 offset:24576
  v_mfma_f32_16x16x32_bf16 v[168:171], a[104:107], a[24:27], v[168:171]
  v_exp_f32 v165, v165
  v_mfma_f32_16x16x32_bf16 v[168:171], a[108:111], a[28:31], v[168:171]
  ds_read_b64_tr_b16 a[186:187], v234 offset:28672
  v_cvt_pk_bf16_f32 v194, v164, v165
  v_mfma_f32_16x16x32_bf16 v[172:175], a[112:115], a[16:19], v[212:215]
  v_exp_f32 v166, v166
  v_mfma_f32_16x16x32_bf16 v[172:175], a[116:119], a[20:23], v[172:175]
  ds_read_b64_tr_b16 a[188:189], v235 offset:24576
  ds_read_b64_tr_b16 a[190:191], v235 offset:28672
  v_mfma_f32_16x16x32_bf16 v[172:175], a[120:123], a[24:27], v[172:175]
  v_exp_f32 v167, v167
  v_mfma_f32_16x16x32_bf16 v[172:175], a[124:127], a[28:31], v[172:175]
  buffer_load_dwordx4 v248, s[8:11], s42 offen offset:2048 lds
  v_cvt_pk_bf16_f32 v195, v166, v167
  v_mfma_f32_16x16x32_bf16 v[128:131], a[128:131], v[204:207], v[128:131]
  v_exp_f32 v168, v168
  v_mfma_f32_16x16x32_bf16 v[132:135], a[132:135], v[204:207], v[132:135]
  v_mfma_f32_16x16x32_bf16 v[136:139], a[136:139], v[204:207], v[136:139]
  v_exp_f32 v169, v169
  v_mfma_f32_16x16x32_bf16 v[140:143], a[140:143], v[204:207], v[140:143]
  v_cvt_pk_bf16_f32 v196, v168, v169
  v_mfma_f32_16x16x32_bf16 v[144:147], a[144:147], v[204:207], v[144:147]
  v_exp_f32 v170, v170
  v_mfma_f32_16x16x32_bf16 v[148:151], a[148:151], v[204:207], v[148:151]
  buffer_load_dwordx4 v249, s[8:11], s42 offen offset:3072 lds
  v_mfma_f32_16x16x32_bf16 v[152:155], a[152:155], v[204:207], v[152:155]
  v_exp_f32 v171, v171
  v_mfma_f32_16x16x32_bf16 v[156:159], a[156:159], v[204:207], v[156:159]
  v_cvt_pk_bf16_f32 v197, v170, v171
  v_mfma_f32_16x16x32_bf16 a[204:207], a[208:211], v[204:207], a[204:207]
  s_waitcnt vmcnt(17) lgkmcnt(0)
  s_barrier
  v_mfma_f32_16x16x32_bf16 v[176:179], a[96:99], a[32:35], v[216:219]
  v_exp_f32 v172, v172
  v_mfma_f32_16x16x32_bf16 v[176:179], a[100:103], a[36:39], v[176:179]
  ds_read_b128 a[64:67], v224 offset:32768
  v_mfma_f32_16x16x32_bf16 v[176:179], a[104:107], a[40:43], v[176:179]
  v_exp_f32 v173, v173
  v_mfma_f32_16x16x32_bf16 v[176:179], a[108:111], a[44:47], v[176:179]
  v_cvt_pk_bf16_f32 v198, v172, v173
  ds_read_b128 a[68:71], v225 offset:32768
  v_mfma_f32_16x16x32_bf16 v[180:183], a[112:115], a[32:35], v[216:219]
  v_exp_f32 v174, v174
  v_mfma_f32_16x16x32_bf16 v[180:183], a[116:119], a[36:39], v[180:183]
  ds_read_b128 a[72:75], v226 offset:32768
  v_mfma_f32_16x16x32_bf16 v[180:183], a[120:123], a[40:43], v[180:183]
  v_exp_f32 v175, v175
  v_mfma_f32_16x16x32_bf16 v[180:183], a[124:127], a[44:47], v[180:183]
  ds_read_b128 a[76:79], v227 offset:32768
  v_cvt_pk_bf16_f32 v199, v174, v175
  v_mfma_f32_16x16x32_bf16 v[32:35], a[160:163], v[192:195], v[32:35]
  v_exp_f32 v176, v176
  v_mfma_f32_16x16x32_bf16 v[36:39], a[164:167], v[192:195], v[36:39]
  ds_read_b128 a[80:83], v224 offset:36864
  v_mfma_f32_16x16x32_bf16 v[40:43], a[168:171], v[192:195], v[40:43]
  v_exp_f32 v177, v177
  v_mfma_f32_16x16x32_bf16 v[44:47], a[172:175], v[192:195], v[44:47]
  v_cvt_pk_bf16_f32 v200, v176, v177
  ds_read_b128 a[84:87], v225 offset:36864
  v_mfma_f32_16x16x32_bf16 v[48:51], a[176:179], v[192:195], v[48:51]
  s_add_u32 s42, s41, 5
  v_exp_f32 v178, v178
  v_mfma_f32_16x16x32_bf16 v[52:55], a[180:183], v[192:195], v[52:55]
  s_and_b32 s42, s42, 31
  ds_read_b128 a[88:91], v226 offset:36864
  v_mfma_f32_16x16x32_bf16 v[56:59], a[184:187], v[192:195], v[56:59]
  s_mul_i32 s42, s42, 40960
  v_exp_f32 v179, v179
  v_mfma_f32_16x16x32_bf16 v[60:63], a[188:191], v[192:195], v[60:63]
  s_add_u32 m0, s40, 131072
  ds_read_b128 a[92:95], v227 offset:36864
  v_cvt_pk_bf16_f32 v201, v178, v179
  v_mfma_f32_16x16x32_bf16 a[192:195], a[208:211], v[192:195], a[192:195]
  buffer_load_dwordx4 v246, s[8:11], s42 offen lds
  v_mfma_f32_16x16x32_bf16 v[184:187], a[96:99], a[48:51], v[220:223]
  v_exp_f32 v180, v180
  v_mfma_f32_16x16x32_bf16 v[184:187], a[100:103], a[52:55], v[184:187]
  buffer_load_dwordx4 v247, s[8:11], s42 offen offset:1024 lds
  v_mfma_f32_16x16x32_bf16 v[184:187], a[104:107], a[56:59], v[184:187]
  v_exp_f32 v181, v181
  v_mfma_f32_16x16x32_bf16 v[184:187], a[108:111], a[60:63], v[184:187]
  v_cvt_pk_bf16_f32 v202, v180, v181
  v_mfma_f32_16x16x32_bf16 v[188:191], a[112:115], a[48:51], v[220:223]
  v_exp_f32 v182, v182
  v_mfma_f32_16x16x32_bf16 v[188:191], a[116:119], a[52:55], v[188:191]
  buffer_load_dwordx4 v248, s[8:11], s42 offen offset:2048 lds
  v_mfma_f32_16x16x32_bf16 v[188:191], a[120:123], a[56:59], v[188:191]
  v_exp_f32 v183, v183
  v_mfma_f32_16x16x32_bf16 v[188:191], a[124:127], a[60:63], v[188:191]
  v_cvt_pk_bf16_f32 v203, v182, v183
  v_mfma_f32_16x16x32_bf16 v[64:67], a[160:163], v[196:199], v[64:67]
  v_exp_f32 v184, v184
  v_mfma_f32_16x16x32_bf16 v[68:71], a[164:167], v[196:199], v[68:71]
  v_mfma_f32_16x16x32_bf16 v[72:75], a[168:171], v[196:199], v[72:75]
  v_exp_f32 v185, v185
  v_mfma_f32_16x16x32_bf16 v[76:79], a[172:175], v[196:199], v[76:79]
  v_cvt_pk_bf16_f32 v204, v184, v185
  v_mfma_f32_16x16x32_bf16 v[80:83], a[176:179], v[196:199], v[80:83]
  v_exp_f32 v186, v186
  v_mfma_f32_16x16x32_bf16 v[84:87], a[180:183], v[196:199], v[84:87]
  buffer_load_dwordx4 v249, s[8:11], s42 offen offset:3072 lds
  v_mfma_f32_16x16x32_bf16 v[88:91], a[184:187], v[196:199], v[88:91]
  v_exp_f32 v187, v187
  v_mfma_f32_16x16x32_bf16 v[92:95], a[188:191], v[196:199], v[92:95]
  s_waitcnt lgkmcnt(0)
  v_cvt_pk_bf16_f32 v205, v186, v187
  v_mfma_f32_16x16x32_bf16 a[196:199], a[208:211], v[196:199], a[196:199]
  v_mfma_f32_16x16x32_bf16 v[160:163], a[64:67], a[0:3], v[208:211]
  v_exp_f32 v188, v188
  v_mfma_f32_16x16x32_bf16 v[160:163], a[68:71], a[4:7], v[160:163]
  s_add_u32 s42, s41, 2
  ds_read_b64_tr_b16 a[128:129], v228 offset:32768
  v_mfma_f32_16x16x32_bf16 v[160:163], a[72:75], a[8:11], v[160:163]
  s_and_b32 s42, s42, 31
  v_exp_f32 v189, v189
  v_mfma_f32_16x16x32_bf16 v[160:163], a[76:79], a[12:15], v[160:163]
  s_mul_i32 s42, s42, 40960
  v_cvt_pk_bf16_f32 v206, v188, v189
  ds_read_b64_tr_b16 a[130:131], v228 offset:36864
  v_mfma_f32_16x16x32_bf16 v[164:167], a[80:83], a[0:3], v[208:211]
  s_add_u32 m0, s40, 147456
  v_exp_f32 v190, v190
  v_mfma_f32_16x16x32_bf16 v[164:167], a[84:87], a[4:7], v[164:167]
  ds_read_b64_tr_b16 a[132:133], v229 offset:32768
  ds_read_b64_tr_b16 a[134:135], v229 offset:36864
  buffer_load_dwordx4 v246, s[8:11], s42 offen lds
  v_mfma_f32_16x16x32_bf16 v[164:167], a[88:91], a[8:11], v[164:167]
  v_exp_f32 v191, v191
  v_mfma_f32_16x16x32_bf16 v[164:167], a[92:95], a[12:15], v[164:167]
  v_cvt_pk_bf16_f32 v207, v190, v191
  ds_read_b64_tr_b16 a[136:137], v230 offset:32768
  v_mfma_f32_16x16x32_bf16 v[96:99], a[160:163], v[200:203], v[96:99]
  v_exp_f32 v160, v160
  v_mfma_f32_16x16x32_bf16 v[100:103], a[164:167], v[200:203], v[100:103]
  ds_read_b64_tr_b16 a[138:139], v230 offset:36864
  ds_read_b64_tr_b16 a[140:141], v231 offset:32768
  v_mfma_f32_16x16x32_bf16 v[104:107], a[168:171], v[200:203], v[104:107]
  v_exp_f32 v161, v161
  v_mfma_f32_16x16x32_bf16 v[108:111], a[172:175], v[200:203], v[108:111]
  ds_read_b64_tr_b16 a[142:143], v231 offset:36864
  v_cvt_pk_bf16_f32 v192, v160, v161
  v_mfma_f32_16x16x32_bf16 v[112:115], a[176:179], v[200:203], v[112:115]
  v_exp_f32 v162, v162
  v_mfma_f32_16x16x32_bf16 v[116:119], a[180:183], v[200:203], v[116:119]
  ds_read_b64_tr_b16 a[144:145], v232 offset:32768
  ds_read_b64_tr_b16 a[146:147], v232 offset:36864
  v_mfma_f32_16x16x32_bf16 v[120:123], a[184:187], v[200:203], v[120:123]
  v_exp_f32 v163, v163
  v_mfma_f32_16x16x32_bf16 v[124:127], a[188:191], v[200:203], v[124:127]
  v_cvt_pk_bf16_f32 v193, v162, v163
  ds_read_b64_tr_b16 a[148:149], v233 offset:32768
  v_mfma_f32_16x16x32_bf16 a[200:203], a[208:211], v[200:203], a[200:203]
  ds_read_b64_tr_b16 a[150:151], v233 offset:36864
  buffer_load_dwordx4 v247, s[8:11], s42 offen offset:1024 lds
  v_mfma_f32_16x16x32_bf16 v[168:171], a[64:67], a[16:19], v[212:215]
  v_exp_f32 v164, v164
  v_mfma_f32_16x16x32_bf16 v[168:171], a[68:71], a[20:23], v[168:171]
  ds_read_b64_tr_b16 a[152:153], v234 offset:32768
  v_mfma_f32_16x16x32_bf16 v[168:171], a[72:75], a[24:27], v[168:171]
  v_exp_f32 v165, v165
  v_mfma_f32_16x16x32_bf16 v[168:171], a[76:79], a[28:31], v[168:171]
  ds_read_b64_tr_b16 a[154:155], v234 offset:36864
  v_cvt_pk_bf16_f32 v194, v164, v165
  v_mfma_f32_16x16x32_bf16 v[172:175], a[80:83], a[16:19], v[212:215]
  v_exp_f32 v166, v166
  v_mfma_f32_16x16x32_bf16 v[172:175], a[84:87], a[20:23], v[172:175]
  ds_read_b64_tr_b16 a[156:157], v235 offset:32768
  ds_read_b64_tr_b16 a[158:159], v235 offset:36864
  v_mfma_f32_16x16x32_bf16 v[172:175], a[88:91], a[24:27], v[172:175]
  v_exp_f32 v167, v167
  v_mfma_f32_16x16x32_bf16 v[172:175], a[92:95], a[28:31], v[172:175]
  buffer_load_dwordx4 v248, s[8:11], s42 offen offset:2048 lds
  v_cvt_pk_bf16_f32 v195, v166, v167
  v_mfma_f32_16x16x32_bf16 v[128:131], a[160:163], v[204:207], v[128:131]
  v_exp_f32 v168, v168
  v_mfma_f32_16x16x32_bf16 v[132:135], a[164:167], v[204:207], v[132:135]
  v_mfma_f32_16x16x32_bf16 v[136:139], a[168:171], v[204:207], v[136:139]
  v_exp_f32 v169, v169
  v_mfma_f32_16x16x32_bf16 v[140:143], a[172:175], v[204:207], v[140:143]
  v_cvt_pk_bf16_f32 v196, v168, v169
  v_mfma_f32_16x16x32_bf16 v[144:147], a[176:179], v[204:207], v[144:147]
  v_exp_f32 v170, v170
  v_mfma_f32_16x16x32_bf16 v[148:151], a[180:183], v[204:207], v[148:151]
  buffer_load_dwordx4 v249, s[8:11], s42 offen offset:3072 lds
  v_mfma_f32_16x16x32_bf16 v[152:155], a[184:187], v[204:207], v[152:155]
  v_exp_f32 v171, v171
  v_mfma_f32_16x16x32_bf16 v[156:159], a[188:191], v[204:207], v[156:159]
  v_cvt_pk_bf16_f32 v197, v170, v171
  v_mfma_f32_16x16x32_bf16 a[204:207], a[208:211], v[204:207], a[204:207]
  s_waitcnt lgkmcnt(0)
  v_mfma_f32_16x16x32_bf16 v[176:179], a[64:67], a[32:35], v[216:219]
  v_exp_f32 v172, v172
  v_mfma_f32_16x16x32_bf16 v[176:179], a[68:71], a[36:39], v[176:179]
  ds_read_b128 a[96:99], v224 offset:40960
  v_mfma_f32_16x16x32_bf16 v[176:179], a[72:75], a[40:43], v[176:179]
  v_exp_f32 v173, v173
  v_mfma_f32_16x16x32_bf16 v[176:179], a[76:79], a[44:47], v[176:179]
  v_cvt_pk_bf16_f32 v198, v172, v173
  ds_read_b128 a[100:103], v225 offset:40960
  v_mfma_f32_16x16x32_bf16 v[180:183], a[80:83], a[32:35], v[216:219]
  v_exp_f32 v174, v174
  v_mfma_f32_16x16x32_bf16 v[180:183], a[84:87], a[36:39], v[180:183]
  ds_read_b128 a[104:107], v226 offset:40960
  v_mfma_f32_16x16x32_bf16 v[180:183], a[88:91], a[40:43], v[180:183]
  v_exp_f32 v175, v175
  v_mfma_f32_16x16x32_bf16 v[180:183], a[92:95], a[44:47], v[180:183]
  ds_read_b128 a[108:111], v227 offset:40960
  v_cvt_pk_bf16_f32 v199, v174, v175
  v_mfma_f32_16x16x32_bf16 v[32:35], a[128:131], v[192:195], v[32:35]
  v_exp_f32 v176, v176
  v_mfma_f32_16x16x32_bf16 v[36:39], a[132:135], v[192:195], v[36:39]
  ds_read_b128 a[112:115], v224 offset:45056
  v_mfma_f32_16x16x32_bf16 v[40:43], a[136:139], v[192:195], v[40:43]
  v_exp_f32 v177, v177
  v_mfma_f32_16x16x32_bf16 v[44:47], a[140:143], v[192:195], v[44:47]
  v_cvt_pk_bf16_f32 v200, v176, v177
  ds_read_b128 a[116:119], v225 offset:45056
  v_mfma_f32_16x16x32_bf16 v[48:51], a[144:147], v[192:195], v[48:51]
  s_add_u32 s42, s41, 3
  v_exp_f32 v178, v178
  v_mfma_f32_16x16x32_bf16 v[52:55], a[148:151], v[192:195], v[52:55]
  s_and_b32 s42, s42, 31
  ds_read_b128 a[120:123], v226 offset:45056
  v_mfma_f32_16x16x32_bf16 v[56:59], a[152:155], v[192:195], v[56:59]
  s_mul_i32 s42, s42, 40960
  v_exp_f32 v179, v179
  v_mfma_f32_16x16x32_bf16 v[60:63], a[156:159], v[192:195], v[60:63]
  s_add_u32 m0, s40, 16384
  ds_read_b128 a[124:127], v227 offset:45056
  v_cvt_pk_bf16_f32 v201, v178, v179
  v_mfma_f32_16x16x32_bf16 a[192:195], a[208:211], v[192:195], a[192:195]
  s_waitcnt vmcnt(12)
  buffer_load_dwordx4 v246, s[8:11], s42 offen lds
  ds_read_b64_tr_b16 a[224:225], v28 offset:0
  v_mfma_f32_16x16x32_bf16 v[184:187], a[64:67], a[48:51], v[220:223]
  v_exp_f32 v180, v180
  v_mfma_f32_16x16x32_bf16 v[184:187], a[68:71], a[52:55], v[184:187]
  buffer_load_dwordx4 v247, s[8:11], s42 offen offset:1024 lds
  ds_read_b64_tr_b16 a[226:227], v28 offset:2048
  v_mfma_f32_16x16x32_bf16 v[184:187], a[72:75], a[56:59], v[184:187]
  v_exp_f32 v181, v181
  v_mfma_f32_16x16x32_bf16 v[184:187], a[76:79], a[60:63], v[184:187]
  ds_read_b64_tr_b16 a[228:229], v29 offset:0
  v_cvt_pk_bf16_f32 v202, v180, v181
  v_mfma_f32_16x16x32_bf16 v[188:191], a[80:83], a[48:51], v[220:223]
  v_exp_f32 v182, v182
  v_mfma_f32_16x16x32_bf16 v[188:191], a[84:87], a[52:55], v[188:191]
  buffer_load_dwordx4 v248, s[8:11], s42 offen offset:2048 lds
  ds_read_b64_tr_b16 a[230:231], v29 offset:2048
  v_mfma_f32_16x16x32_bf16 v[188:191], a[88:91], a[56:59], v[188:191]
  v_exp_f32 v183, v183
  v_mfma_f32_16x16x32_bf16 v[188:191], a[92:95], a[60:63], v[188:191]
  ds_read_b64_tr_b16 a[232:233], v30 offset:0
  v_cvt_pk_bf16_f32 v203, v182, v183
  v_mfma_f32_16x16x32_bf16 v[64:67], a[128:131], v[196:199], v[64:67]
  v_exp_f32 v184, v184
  v_mfma_f32_16x16x32_bf16 v[68:71], a[132:135], v[196:199], v[68:71]
  ds_read_b64_tr_b16 a[234:235], v30 offset:2048
  ds_read_b64_tr_b16 a[236:237], v31 offset:0
  v_mfma_f32_16x16x32_bf16 v[72:75], a[136:139], v[196:199], v[72:75]
  v_exp_f32 v185, v185
  v_mfma_f32_16x16x32_bf16 v[76:79], a[140:143], v[196:199], v[76:79]
  ds_read_b64_tr_b16 a[238:239], v31 offset:2048
  v_cvt_pk_bf16_f32 v204, v184, v185
  v_mfma_f32_16x16x32_bf16 v[80:83], a[144:147], v[196:199], v[80:83]
  v_exp_f32 v186, v186
  v_mfma_f32_16x16x32_bf16 v[84:87], a[148:151], v[196:199], v[84:87]
  buffer_load_dwordx4 v249, s[8:11], s42 offen offset:3072 lds
  v_mfma_f32_16x16x32_bf16 v[88:91], a[152:155], v[196:199], v[88:91]
  v_exp_f32 v187, v187
  v_mfma_f32_16x16x32_bf16 v[92:95], a[156:159], v[196:199], v[92:95]
  s_waitcnt lgkmcnt(8)
  v_cvt_pk_bf16_f32 v205, v186, v187
  v_mfma_f32_16x16x32_bf16 a[196:199], a[208:211], v[196:199], a[196:199]
  v_mfma_f32_16x16x32_bf16 v[160:163], a[96:99], a[0:3], v[208:211]
  v_exp_f32 v188, v188
  v_mfma_f32_16x16x32_bf16 v[160:163], a[100:103], a[4:7], v[160:163]
  s_add_u32 s42, s41, 6
  ds_read_b64_tr_b16 a[160:161], v228 offset:40960
  v_mfma_f32_16x16x32_bf16 v[160:163], a[104:107], a[8:11], v[160:163]
  s_and_b32 s42, s42, 31
  v_exp_f32 v189, v189
  v_mfma_f32_16x16x32_bf16 v[160:163], a[108:111], a[12:15], v[160:163]
  s_mul_i32 s42, s42, 40960
  v_cvt_pk_bf16_f32 v206, v188, v189
  ds_read_b64_tr_b16 a[162:163], v228 offset:45056
  v_mfma_f32_16x16x32_bf16 v[164:167], a[112:115], a[0:3], v[208:211]
  s_add_u32 m0, s40, 81920
  v_exp_f32 v190, v190
  v_mfma_f32_16x16x32_bf16 v[164:167], a[116:119], a[4:7], v[164:167]
  ds_read_b64_tr_b16 a[164:165], v229 offset:40960
  ds_read_b64_tr_b16 a[166:167], v229 offset:45056
  buffer_load_dwordx4 v246, s[8:11], s42 offen lds
  v_mfma_f32_16x16x32_bf16 v[164:167], a[120:123], a[8:11], v[164:167]
  v_exp_f32 v191, v191
  v_mfma_f32_16x16x32_bf16 v[164:167], a[124:127], a[12:15], v[164:167]
  v_cvt_pk_bf16_f32 v207, v190, v191
  ds_read_b64_tr_b16 a[168:169], v230 offset:40960
  v_mfma_f32_16x16x32_bf16 v[96:99], a[128:131], v[200:203], v[96:99]
  v_exp_f32 v160, v160
  v_mfma_f32_16x16x32_bf16 v[100:103], a[132:135], v[200:203], v[100:103]
  ds_read_b64_tr_b16 a[170:171], v230 offset:45056
  ds_read_b64_tr_b16 a[172:173], v231 offset:40960
  v_mfma_f32_16x16x32_bf16 v[104:107], a[136:139], v[200:203], v[104:107]
  v_exp_f32 v161, v161
  v_mfma_f32_16x16x32_bf16 v[108:111], a[140:143], v[200:203], v[108:111]
  ds_read_b64_tr_b16 a[174:175], v231 offset:45056
  v_cvt_pk_bf16_f32 v192, v160, v161
  v_mfma_f32_16x16x32_bf16 v[112:115], a[144:147], v[200:203], v[112:115]
  v_exp_f32 v162, v162
  v_mfma_f32_16x16x32_bf16 v[116:119], a[148:151], v[200:203], v[116:119]
  ds_read_b64_tr_b16 a[176:177], v232 offset:40960
  ds_read_b64_tr_b16 a[178:179], v232 offset:45056
  v_mfma_f32_16x16x32_bf16 v[120:123], a[152:155], v[200:203], v[120:123]
  v_exp_f32 v163, v163
  v_mfma_f32_16x16x32_bf16 v[124:127], a[156:159], v[200:203], v[124:127]
  s_waitcnt lgkmcnt(10)
  v_cvt_pk_bf16_f32 v193, v162, v163
  ds_read_b64_tr_b16 a[180:181], v233 offset:40960
  v_mfma_f32_16x16x32_bf16 a[200:203], a[208:211], v[200:203], a[200:203]
  ds_read_b64_tr_b16 a[182:183], v233 offset:45056
  buffer_load_dwordx4 v247, s[8:11], s42 offen offset:1024 lds
  v_mfma_f32_16x16x32_bf16 v[168:171], a[96:99], a[16:19], v[212:215]
  v_exp_f32 v164, v164
  v_mfma_f32_16x16x32_bf16 v[168:171], a[100:103], a[20:23], v[168:171]
  ds_read_b64_tr_b16 a[184:185], v234 offset:40960
  v_mfma_f32_16x16x32_bf16 v[168:171], a[104:107], a[24:27], v[168:171]
  v_exp_f32 v165, v165
  v_mfma_f32_16x16x32_bf16 v[168:171], a[108:111], a[28:31], v[168:171]
  ds_read_b64_tr_b16 a[186:187], v234 offset:45056
  v_cvt_pk_bf16_f32 v194, v164, v165
  v_mfma_f32_16x16x32_bf16 v[172:175], a[112:115], a[16:19], v[212:215]
  v_exp_f32 v166, v166
  v_mfma_f32_16x16x32_bf16 v[172:175], a[116:119], a[20:23], v[172:175]
  ds_read_b64_tr_b16 a[188:189], v235 offset:40960
  ds_read_b64_tr_b16 a[190:191], v235 offset:45056
  v_mfma_f32_16x16x32_bf16 v[172:175], a[120:123], a[24:27], v[172:175]
  v_exp_f32 v167, v167
  v_mfma_f32_16x16x32_bf16 v[172:175], a[124:127], a[28:31], v[172:175]
  buffer_load_dwordx4 v248, s[8:11], s42 offen offset:2048 lds
  v_cvt_pk_bf16_f32 v195, v166, v167
  v_mfma_f32_16x16x32_bf16 v[128:131], a[128:131], v[204:207], v[128:131]
  v_exp_f32 v168, v168
  v_mfma_f32_16x16x32_bf16 v[132:135], a[132:135], v[204:207], v[132:135]
  v_mfma_f32_16x16x32_bf16 v[136:139], a[136:139], v[204:207], v[136:139]
  v_exp_f32 v169, v169
  v_mfma_f32_16x16x32_bf16 v[140:143], a[140:143], v[204:207], v[140:143]
  v_cvt_pk_bf16_f32 v196, v168, v169
  v_mfma_f32_16x16x32_bf16 v[144:147], a[144:147], v[204:207], v[144:147]
  v_exp_f32 v170, v170
  v_mfma_f32_16x16x32_bf16 v[148:151], a[148:151], v[204:207], v[148:151]
  buffer_load_dwordx4 v249, s[8:11], s42 offen offset:3072 lds
  v_mfma_f32_16x16x32_bf16 v[152:155], a[152:155], v[204:207], v[152:155]
  v_exp_f32 v171, v171
  v_mfma_f32_16x16x32_bf16 v[156:159], a[156:159], v[204:207], v[156:159]
  v_cvt_pk_bf16_f32 v197, v170, v171
  v_mfma_f32_16x16x32_bf16 a[204:207], a[208:211], v[204:207], a[204:207]
  s_waitcnt vmcnt(29) lgkmcnt(0)
  s_barrier
  v_mfma_f32_16x16x32_bf16 v[176:179], a[96:99], a[32:35], v[216:219]
  s_waitcnt vmcnt(16)
  v_exp_f32 v172, v172
  v_mfma_f32_16x16x32_bf16 v[176:179], a[100:103], a[36:39], v[176:179]
  s_add_u32 s42, s41, 4
  ds_read_b128 a[64:67], v224 offset:49152
  ds_read_b64_tr_b16 a[240:241], v250 offset:0
  v_mfma_f32_16x16x32_bf16 v[176:179], a[104:107], a[40:43], v[176:179]
  s_and_b32 s42, s42, 31
  v_exp_f32 v173, v173
  v_mfma_f32_16x16x32_bf16 v[176:179], a[108:111], a[44:47], v[176:179]
  s_mul_i32 s42, s42, 40960
  v_cvt_pk_bf16_f32 v198, v172, v173
  ds_read_b128 a[68:71], v225 offset:49152
  v_mfma_f32_16x16x32_bf16 v[180:183], a[112:115], a[32:35], v[216:219]
  s_add_u32 m0, s40, 32768
  v_exp_f32 v174, v174
  v_mfma_f32_16x16x32_bf16 v[180:183], a[116:119], a[36:39], v[180:183]
  ds_read_b128 a[72:75], v226 offset:49152
  buffer_load_dwordx4 v246, s[8:11], s42 offen lds
  ds_read_b64_tr_b16 a[242:243], v250 offset:2048
  v_mfma_f32_16x16x32_bf16 v[180:183], a[120:123], a[40:43], v[180:183]
  v_exp_f32 v175, v175
  v_mfma_f32_16x16x32_bf16 v[180:183], a[124:127], a[44:47], v[180:183]
  ds_read_b128 a[76:79], v227 offset:49152
  buffer_load_dwordx4 v247, s[8:11], s42 offen offset:1024 lds
  v_cvt_pk_bf16_f32 v199, v174, v175
  v_mfma_f32_16x16x32_bf16 v[32:35], a[160:163], v[192:195], v[32:35]
  v_exp_f32 v176, v176
  v_mfma_f32_16x16x32_bf16 v[36:39], a[164:167], v[192:195], v[36:39]
  ds_read_b128 a[80:83], v224 offset:53248
  ds_read_b64_tr_b16 a[244:245], v251 offset:0
  v_mfma_f32_16x16x32_bf16 v[40:43], a[168:171], v[192:195], v[40:43]
  v_exp_f32 v177, v177
  v_mfma_f32_16x16x32_bf16 v[44:47], a[172:175], v[192:195], v[44:47]
  buffer_load_dwordx4 v248, s[8:11], s42 offen offset:2048 lds
  v_cvt_pk_bf16_f32 v200, v176, v177
  ds_read_b128 a[84:87], v225 offset:53248
  v_mfma_f32_16x16x32_bf16 v[48:51], a[176:179], v[192:195], v[48:51]
  v_exp_f32 v178, v178
  v_mfma_f32_16x16x32_bf16 v[52:55], a[180:183], v[192:195], v[52:55]
  ds_read_b128 a[88:91], v226 offset:53248
  ds_read_b64_tr_b16 a[246:247], v251 offset:2048
  v_mfma_f32_16x16x32_bf16 v[56:59], a[184:187], v[192:195], v[56:59]
  v_exp_f32 v179, v179
  v_mfma_f32_16x16x32_bf16 v[60:63], a[188:191], v[192:195], v[60:63]
  ds_read_b128 a[92:95], v227 offset:53248
  buffer_load_dwordx4 v249, s[8:11], s42 offen offset:3072 lds
  v_cvt_pk_bf16_f32 v201, v178, v179
  v_mfma_f32_16x16x32_bf16 a[192:195], a[208:211], v[192:195], a[192:195]
  ds_read_b64_tr_b16 a[248:249], v252 offset:0
  v_mfma_f32_16x16x32_bf16 v[184:187], a[96:99], a[48:51], v[220:223]
  v_exp_f32 v180, v180
  v_mfma_f32_16x16x32_bf16 v[184:187], a[100:103], a[52:55], v[184:187]
  s_add_u32 s42, s41, 7
  ds_read_b64_tr_b16 a[250:251], v252 offset:2048
  v_mfma_f32_16x16x32_bf16 v[184:187], a[104:107], a[56:59], v[184:187]
  s_and_b32 s42, s42, 31
  v_exp_f32 v181, v181
  v_mfma_f32_16x16x32_bf16 v[184:187], a[108:111], a[60:63], v[184:187]
  s_mul_i32 s42, s42, 40960
  ds_read_b64_tr_b16 a[252:253], v253 offset:0
  v_cvt_pk_bf16_f32 v202, v180, v181
  v_mfma_f32_16x16x32_bf16 v[188:191], a[112:115], a[48:51], v[220:223]
  s_add_u32 m0, s40, 98304
  v_exp_f32 v182, v182
  v_mfma_f32_16x16x32_bf16 v[188:191], a[116:119], a[52:55], v[188:191]
  buffer_load_dwordx4 v246, s[8:11], s42 offen lds
  ds_read_b64_tr_b16 a[254:255], v253 offset:2048
  v_mfma_f32_16x16x32_bf16 v[188:191], a[120:123], a[56:59], v[188:191]
  v_exp_f32 v183, v183
  v_mfma_f32_16x16x32_bf16 v[188:191], a[124:127], a[60:63], v[188:191]
  buffer_load_dwordx4 v247, s[8:11], s42 offen offset:1024 lds
  v_cvt_pk_bf16_f32 v203, v182, v183
  v_mfma_f32_16x16x32_bf16 v[64:67], a[160:163], v[196:199], v[64:67]
  s_waitcnt lgkmcnt(4)
  v_exp_f32 v184, v184
  v_mfma_f32_16x16x32_bf16 v[68:71], a[164:167], v[196:199], v[68:71]
  ds_read_b128 a[96:99], v224 offset:57344
  ds_read_b128 a[100:103], v225 offset:57344
  v_mfma_f32_16x16x32_bf16 v[72:75], a[168:171], v[196:199], v[72:75]
  v_exp_f32 v185, v185
  v_mfma_f32_16x16x32_bf16 v[76:79], a[172:175], v[196:199], v[76:79]
  buffer_load_dwordx4 v248, s[8:11], s42 offen offset:2048 lds
  ds_read_b128 a[104:107], v226 offset:57344
  v_cvt_pk_bf16_f32 v204, v184, v185
  v_mfma_f32_16x16x32_bf16 v[80:83], a[176:179], v[196:199], v[80:83]
  v_exp_f32 v186, v186
  v_mfma_f32_16x16x32_bf16 v[84:87], a[180:183], v[196:199], v[84:87]
  buffer_load_dwordx4 v249, s[8:11], s42 offen offset:3072 lds
  ds_read_b128 a[108:111], v227 offset:57344
  v_mfma_f32_16x16x32_bf16 v[88:91], a[184:187], v[196:199], v[88:91]
  v_exp_f32 v187, v187
  v_mfma_f32_16x16x32_bf16 v[92:95], a[188:191], v[196:199], v[92:95]
  ds_read_b128 a[112:115], v224 offset:61440
  v_cvt_pk_bf16_f32 v205, v186, v187
  v_mfma_f32_16x16x32_bf16 a[196:199], a[208:211], v[196:199], a[196:199]
  ds_read_b128 a[116:119], v225 offset:61440
  ds_read_b128 a[120:123], v226 offset:61440
L_sec1:
  v_mfma_f32_16x16x32_bf16 v[160:163], a[64:67], a[0:3], v[208:211]
  v_exp_f32 v188, v188
  v_mfma_f32_16x16x32_bf16 v[160:163], a[68:71], a[4:7], v[160:163]
  ds_read_b128 a[124:127], v227 offset:61440
  v_mfma_f32_16x16x32_bf16 v[160:163], a[72:75], a[8:11], v[160:163]
  v_exp_f32 v189, v189
  v_mfma_f32_16x16x32_bf16 v[160:163], a[76:79], a[12:15], v[160:163]
  v_cvt_pk_bf16_f32 v206, v188, v189
  v_mfma_f32_16x16x32_bf16 v[164:167], a[80:83], a[0:3], v[208:211]
  v_exp_f32 v190, v190
  v_mfma_f32_16x16x32_bf16 v[164:167], a[84:87], a[4:7], v[164:167]
  v_mfma_f32_16x16x32_bf16 v[164:167], a[88:91], a[8:11], v[164:167]
  v_exp_f32 v191, v191
  v_mfma_f32_16x16x32_bf16 v[164:167], a[92:95], a[12:15], v[164:167]
  v_cvt_pk_bf16_f32 v207, v190, v191
  v_mfma_f32_16x16x32_bf16 v[96:99], a[160:163], v[200:203], v[96:99]
  v_exp_f32 v160, v160
  v_mfma_f32_16x16x32_bf16 v[100:103], a[164:167], v[200:203], v[100:103]
  v_mfma_f32_16x16x32_bf16 v[104:107], a[168:171], v[200:203], v[104:107]
  v_exp_f32 v161, v161
  v_mfma_f32_16x16x32_bf16 v[108:111], a[172:175], v[200:203], v[108:111]
  v_cvt_pk_bf16_f32 v192, v160, v161
  v_mfma_f32_16x16x32_bf16 v[112:115], a[176:179], v[200:203], v[112:115]
  v_exp_f32 v162, v162
  v_mfma_f32_16x16x32_bf16 v[116:119], a[180:183], v[200:203], v[116:119]
  v_mfma_f32_16x16x32_bf16 v[120:123], a[184:187], v[200:203], v[120:123]
  v_exp_f32 v163, v163
  v_mfma_f32_16x16x32_bf16 v[124:127], a[188:191], v[200:203], v[124:127]
  v_cvt_pk_bf16_f32 v193, v162, v163
  v_mfma_f32_16x16x32_bf16 a[200:203], a[208:211], v[200:203], a[200:203]
  s_waitcnt vmcnt(33) lgkmcnt(0)
  s_barrier
  v_mfma_f32_16x16x32_bf16 v[168:171], a[96:99], a[0:3], v[208:211]
  s_add_u32 s42, s41, 10
  v_exp_f32 v164, v164
  v_mfma_f32_16x16x32_bf16 v[168:171], a[100:103], a[4:7], v[168:171]
  s_and_b32 s42, s42, 31
  ds_read_b64_tr_b16 a[128:129], v228 offset:49152
  ds_read_b64_tr_b16 a[130:131], v228 offset:53248
  v_mfma_f32_16x16x32_bf16 v[168:171], a[104:107], a[8:11], v[168:171]
  s_mul_i32 s42, s42, 40960
  v_exp_f32 v165, v165
  v_mfma_f32_16x16x32_bf16 v[168:171], a[108:111], a[12:15], v[168:171]
  s_add_u32 m0, s40, 0
  ds_read_b64_tr_b16 a[132:133], v229 offset:49152
  v_cvt_pk_bf16_f32 v194, v164, v165
  v_mfma_f32_16x16x32_bf16 v[172:175], a[112:115], a[0:3], v[208:211]
  buffer_load_dwordx4 v246, s[8:11], s42 offen lds
  v_exp_f32 v166, v166
  v_mfma_f32_16x16x32_bf16 v[172:175], a[116:119], a[4:7], v[172:175]
  ds_read_b64_tr_b16 a[134:135], v229 offset:53248
  ds_read_b64_tr_b16 a[136:137], v230 offset:49152
  v_mfma_f32_16x16x32_bf16 v[172:175], a[120:123], a[8:11], v[172:175]
  buffer_load_dwordx4 v247, s[8:11], s42 offen offset:1024 lds
  v_exp_f32 v167, v167
  v_mfma_f32_16x16x32_bf16 v[172:175], a[124:127], a[12:15], v[172:175]
  ds_read_b64_tr_b16 a[138:139], v230 offset:53248
  v_cvt_pk_bf16_f32 v195, v166, v167
  v_mfma_f32_16x16x32_bf16 v[128:131], a[160:163], v[204:207], v[128:131]
  buffer_load_dwordx4 v248, s[8:11], s42 offen offset:2048 lds
  v_exp_f32 v168, v168
  v_mfma_f32_16x16x32_bf16 v[132:135], a[164:167], v[204:207], v[132:135]
  ds_read_b64_tr_b16 a[140:141], v231 offset:49152
  ds_read_b64_tr_b16 a[142:143], v231 offset:53248
  v_mfma_f32_16x16x32_bf16 v[136:139], a[168:171], v[204:207], v[136:139]
  buffer_load_dwordx4 v249, s[8:11], s42 offen offset:3072 lds
  v_exp_f32 v169, v169
  v_mfma_f32_16x16x32_bf16 v[140:143], a[172:175], v[204:207], v[140:143]
  ds_read_b64_tr_b16 a[144:145], v232 offset:49152
  v_cvt_pk_bf16_f32 v196, v168, v169
  v_mfma_f32_16x16x32_bf16 v[144:147], a[176:179], v[204:207], v[144:147]
  v_exp_f32 v170, v170
  v_mfma_f32_16x16x32_bf16 v[148:151], a[180:183], v[204:207], v[148:151]
  s_add_u32 s42, s41, 11
  ds_read_b64_tr_b16 a[146:147], v232 offset:53248
  ds_read_b64_tr_b16 a[148:149], v233 offset:49152
  v_mfma_f32_16x16x32_bf16 v[152:155], a[184:187], v[204:207], v[152:155]
  s_and_b32 s42, s42, 31
  v_exp_f32 v171, v171
  v_mfma_f32_16x16x32_bf16 v[156:159], a[188:191], v[204:207], v[156:159]
  s_mul_i32 s42, s42, 40960
  ds_read_b64_tr_b16 a[150:151], v233 offset:53248
  v_cvt_pk_bf16_f32 v197, v170, v171
  v_mfma_f32_16x16x32_bf16 a[204:207], a[208:211], v[204:207], a[204:207]
  s_add_u32 m0, s40, 65536
  ds_read_b64_tr_b16 a[152:153], v234 offset:49152
  ds_read_b64_tr_b16 a[154:155], v234 offset:53248
  v_mfma_f32_16x16x32_bf16 v[176:179], a[64:67], a[16:19], v[212:215]
  buffer_load_dwordx4 v246, s[8:11], s42 offen lds
  v_exp_f32 v172, v172
  v_mfma_f32_16x16x32_bf16 v[176:179], a[68:71], a[20:23], v[176:179]
  ds_read_b64_tr_b16 a[156:157], v235 offset:49152
  ds_read_b64_tr_b16 a[158:159], v235 offset:53248
  v_mfma_f32_16x16x32_bf16 v[176:179], a[72:75], a[24:27], v[176:179]
  s_mov_b32 s36, 1400897536
  buffer_load_dwordx4 v247, s[8:11], s42 offen offset:1024 lds
  v_exp_f32 v173, v173
  v_mfma_f32_16x16x32_bf16 v[176:179], a[76:79], a[28:31], v[176:179]
  s_mov_b64 s[50:51], 0
  ds_read_b64_tr_b16 a[160:161], v228 offset:57344
  v_cvt_pk_bf16_f32 v198, v172, v173
  v_mfma_f32_16x16x32_bf16 v[180:183], a[80:83], a[16:19], v[212:215]
  s_lshl_b32 s30, s3, 19
  buffer_load_dwordx4 v248, s[8:11], s42 offen offset:2048 lds
  v_exp_f32 v174, v174
  v_mfma_f32_16x16x32_bf16 v[180:183], a[84:87], a[20:23], v[180:183]
  s_lshl_b32 s31, s29, 12
  ds_read_b64_tr_b16 a[162:163], v228 offset:61440
  ds_read_b64_tr_b16 a[164:165], v229 offset:57344
  v_mfma_f32_16x16x32_bf16 v[180:183], a[88:91], a[24:27], v[180:183]
  s_add_u32 s30, s30, s31
  buffer_load_dwordx4 v249, s[8:11], s42 offen offset:3072 lds
  v_exp_f32 v175, v175
  v_mfma_f32_16x16x32_bf16 v[180:183], a[92:95], a[28:31], v[180:183]
  ds_read_b64_tr_b16 a[166:167], v229 offset:61440
  s_waitcnt lgkmcnt(3)
  v_cvt_pk_bf16_f32 v199, v174, v175
  v_mfma_f32_16x16x32_bf16 v[32:35], a[128:131], v[192:195], v[32:35]
  v_exp_f32 v176, v176
  v_mfma_f32_16x16x32_bf16 v[36:39], a[132:135], v[192:195], v[36:39]
  ds_read_b64_tr_b16 a[168:169], v230 offset:57344
  ds_read_b64_tr_b16 a[170:171], v230 offset:61440
  v_mfma_f32_16x16x32_bf16 v[40:43], a[136:139], v[192:195], v[40:43]
  v_exp_f32 v177, v177
  v_mfma_f32_16x16x32_bf16 v[44:47], a[140:143], v[192:195], v[44:47]
  ds_read_b64_tr_b16 a[172:173], v231 offset:57344
  v_cvt_pk_bf16_f32 v200, v176, v177
  v_mfma_f32_16x16x32_bf16 v[48:51], a[144:147], v[192:195], v[48:51]
  v_exp_f32 v178, v178
  v_mfma_f32_16x16x32_bf16 v[52:55], a[148:151], v[192:195], v[52:55]
  ds_read_b64_tr_b16 a[174:175], v231 offset:61440
  ds_read_b64_tr_b16 a[176:177], v232 offset:57344
  v_mfma_f32_16x16x32_bf16 v[56:59], a[152:155], v[192:195], v[56:59]
  v_exp_f32 v179, v179
  v_mfma_f32_16x16x32_bf16 v[60:63], a[156:159], v[192:195], v[60:63]
  ds_read_b64_tr_b16 a[178:179], v232 offset:61440
  v_cvt_pk_bf16_f32 v201, v178, v179
  v_mfma_f32_16x16x32_bf16 a[192:195], a[208:211], v[192:195], a[192:195]
  ds_read_b64_tr_b16 a[180:181], v233 offset:57344
  ds_read_b64_tr_b16 a[182:183], v233 offset:61440
  v_mfma_f32_16x16x32_bf16 v[184:187], a[96:99], a[16:19], v[212:215]
  v_exp_f32 v180, v180
  v_mfma_f32_16x16x32_bf16 v[184:187], a[100:103], a[20:23], v[184:187]
  ds_read_b64_tr_b16 a[184:185], v234 offset:57344
  ds_read_b64_tr_b16 a[186:187], v234 offset:61440
  v_mfma_f32_16x16x32_bf16 v[184:187], a[104:107], a[24:27], v[184:187]
  v_exp_f32 v181, v181
  v_mfma_f32_16x16x32_bf16 v[184:187], a[108:111], a[28:31], v[184:187]
  ds_read_b64_tr_b16 a[188:189], v235 offset:57344
  ds_read_b64_tr_b16 a[190:191], v235 offset:61440
  v_cvt_pk_bf16_f32 v202, v180, v181
  v_mfma_f32_16x16x32_bf16 v[188:191], a[112:115], a[16:19], v[212:215]
  v_exp_f32 v182, v182
  v_mfma_f32_16x16x32_bf16 v[188:191], a[116:119], a[20:23], v[188:191]
  v_mfma_f32_16x16x32_bf16 v[188:191], a[120:123], a[24:27], v[188:191]
  v_exp_f32 v183, v183
  v_mfma_f32_16x16x32_bf16 v[188:191], a[124:127], a[28:31], v[188:191]
  s_waitcnt lgkmcnt(0)
  s_barrier
  v_cvt_pk_bf16_f32 v203, v182, v183
  v_mfma_f32_16x16x32_bf16 v[32:35], a[160:163], v[196:199], v[32:35]
  v_exp_f32 v184, v184
  v_mfma_f32_16x16x32_bf16 v[36:39], a[164:167], v[196:199], v[36:39]
  s_add_u32 s42, s41, 8
  v_mfma_f32_16x16x32_bf16 v[40:43], a[168:171], v[196:199], v[40:43]
  s_and_b32 s42, s42, 31
  v_exp_f32 v185, v185
  v_mfma_f32_16x16x32_bf16 v[44:47], a[172:175], v[196:199], v[44:47]
  s_mul_i32 s42, s42, 40960
  v_cvt_pk_bf16_f32 v204, v184, v185
  v_mfma_f32_16x16x32_bf16 v[48:51], a[176:179], v[196:199], v[48:51]
  s_add_u32 m0, s40, 49152
  v_exp_f32 v186, v186
  v_mfma_f32_16x16x32_bf16 v[52:55], a[180:183], v[196:199], v[52:55]
  buffer_load_dwordx4 v246, s[8:11], s42 offen lds
  v_mfma_f32_16x16x32_bf16 v[56:59], a[184:187], v[196:199], v[56:59]
  v_exp_f32 v187, v187
  v_mfma_f32_16x16x32_bf16 v[60:63], a[188:191], v[196:199], v[60:63]
  buffer_load_dwordx4 v247, s[8:11], s42 offen offset:1024 lds
  v_cvt_pk_bf16_f32 v205, v186, v187
  v_mfma_f32_16x16x32_bf16 a[192:195], a[208:211], v[196:199], a[192:195]
  buffer_load_dwordx4 v248, s[8:11], s42 offen offset:2048 lds
  v_mfma_f32_16x16x32_bf16 v[160:163], a[64:67], a[32:35], v[216:219]
  v_exp_f32 v188, v188
  v_mfma_f32_16x16x32_bf16 v[160:163], a[68:71], a[36:39], v[160:163]
  buffer_load_dwordx4 v249, s[8:11], s42 offen offset:3072 lds
  v_mfma_f32_16x16x32_bf16 v[160:163], a[72:75], a[40:43], v[160:163]
  v_exp_f32 v189, v189
  v_mfma_f32_16x16x32_bf16 v[160:163], a[76:79], a[44:47], v[160:163]
  s_add_u32 s42, s41, 9
  v_cvt_pk_bf16_f32 v206, v188, v189
  v_mfma_f32_16x16x32_bf16 v[164:167], a[80:83], a[32:35], v[216:219]
  s_and_b32 s42, s42, 31
  v_exp_f32 v190, v190
  v_accvgpr_read_b32 v16, a192
  v_mfma_f32_16x16x32_bf16 v[164:167], a[84:87], a[36:39], v[164:167]
  s_mul_i32 s42, s42, 40960
  v_cmp_ngt_f32 vcc, s36, v16
  v_rcp_f32 v16, v16
  s_or_b64 s[50:51], s[50:51], vcc
  v_mfma_f32_16x16x32_bf16 v[164:167], a[88:91], a[40:43], v[164:167]
  s_add_u32 m0, s40, 114688
  v_exp_f32 v191, v191
  v_mov_b32 v17, v16
  v_mfma_f32_16x16x32_bf16 v[164:167], a[92:95], a[44:47], v[164:167]
  buffer_load_dwordx4 v246, s[8:11], s42 offen lds
  v_cvt_pk_bf16_f32 v207, v190, v191
  v_mul_f32 v32, v16, v32
  v_mfma_f32_16x16x32_bf16 v[64:67], a[128:131], v[200:203], v[64:67]
  v_exp_f32 v160, v160
  v_mul_f32 v33, v16, v33
  v_mfma_f32_16x16x32_bf16 v[68:71], a[132:135], v[200:203], v[68:71]
  buffer_load_dwordx4 v247, s[8:11], s42 offen offset:1024 lds
  v_mul_f32 v34, v16, v34
  v_mul_f32 v35, v16, v35
  v_mfma_f32_16x16x32_bf16 v[72:75], a[136:139], v[200:203], v[72:75]
  v_exp_f32 v161, v161
  v_mul_f32 v36, v16, v36
  v_mfma_f32_16x16x32_bf16 v[76:79], a[140:143], v[200:203], v[76:79]
  buffer_load_dwordx4 v248, s[8:11], s42 offen offset:2048 lds
  v_cvt_pk_bf16_f32 v192, v160, v161
  v_mul_f32 v37, v16, v37
  v_mfma_f32_16x16x32_bf16 v[80:83], a[144:147], v[200:203], v[80:83]
  v_exp_f32 v162, v162
  v_mul_f32 v38, v16, v38
  v_mfma_f32_16x16x32_bf16 v[84:87], a[148:151], v[200:203], v[84:87]
  buffer_load_dwordx4 v249, s[8:11], s42 offen offset:3072 lds
  v_mul_f32 v39, v16, v39
  v_cvt_pk_bf16_f32 v32, v32, v33
  v_mfma_f32_16x16x32_bf16 v[88:91], a[152:155], v[200:203], v[88:91]
  v_exp_f32 v163, v163
  v_cvt_pk_bf16_f32 v33, v34, v35
  v_mfma_f32_16x16x32_bf16 v[92:95], a[156:159], v[200:203], v[92:95]
  v_cvt_pk_bf16_f32 v193, v162, v163
  v_cvt_pk_bf16_f32 v34, v36, v37
  v_cvt_pk_bf16_f32 v35, v38, v39
  v_mfma_f32_16x16x32_bf16 a[196:199], a[208:211], v[200:203], a[196:199]
  buffer_store_dwordx4 v[32:35], v15, s[24:27], s30 offen offset:0 sc1
  v_mul_f32 v40, v16, v40
  v_mul_f32 v41, v16, v41
  v_mfma_f32_16x16x32_bf16 v[168:171], a[96:99], a[32:35], v[216:219]
  v_exp_f32 v164, v164
  v_mul_f32 v42, v16, v42
  v_mfma_f32_16x16x32_bf16 v[168:171], a[100:103], a[36:39], v[168:171]
  v_mul_f32 v43, v16, v43
  v_mul_f32 v44, v16, v44
  v_mul_f32 v45, v16, v45
  v_mfma_f32_16x16x32_bf16 v[168:171], a[104:107], a[40:43], v[168:171]
  v_exp_f32 v165, v165
  v_mul_f32 v46, v16, v46
  v_mfma_f32_16x16x32_bf16 v[168:171], a[108:111], a[44:47], v[168:171]
  v_cvt_pk_bf16_f32 v194, v164, v165
  v_mul_f32 v47, v16, v47
  v_cvt_pk_bf16_f32 v36, v40, v41
  v_mfma_f32_16x16x32_bf16 v[172:175], a[112:115], a[32:35], v[216:219]
  v_exp_f32 v166, v166
  v_cvt_pk_bf16_f32 v37, v42, v43
  v_mfma_f32_16x16x32_bf16 v[172:175], a[116:119], a[36:39], v[172:175]
  v_cvt_pk_bf16_f32 v38, v44, v45
  v_cvt_pk_bf16_f32 v39, v46, v47
  buffer_store_dwordx4 v[36:39], v15, s[24:27], s30 offen offset:1024 sc1
  v_mfma_f32_16x16x32_bf16 v[172:175], a[120:123], a[40:43], v[172:175]
  v_exp_f32 v167, v167
  v_mul_f32 v48, v16, v48
  v_mfma_f32_16x16x32_bf16 v[172:175], a[124:127], a[44:47], v[172:175]
  v_cvt_pk_bf16_f32 v195, v166, v167
  v_mul_f32 v49, v16, v49
  v_mul_f32 v50, v16, v50
  v_mfma_f32_16x16x32_bf16 v[64:67], a[160:163], v[204:207], v[64:67]
  v_exp_f32 v168, v168
  v_mul_f32 v51, v16, v51
  v_mfma_f32_16x16x32_bf16 v[68:71], a[164:167], v[204:207], v[68:71]
  v_mul_f32 v52, v16, v52
  v_mul_f32 v53, v16, v53
  v_mul_f32 v54, v16, v54
  v_mfma_f32_16x16x32_bf16 v[72:75], a[168:171], v[204:207], v[72:75]
  v_exp_f32 v169, v169
  v_mul_f32 v55, v16, v55
  v_mfma_f32_16x16x32_bf16 v[76:79], a[172:175], v[204:207], v[76:79]
  v_cvt_pk_bf16_f32 v196, v168, v169
  v_cvt_pk_bf16_f32 v40, v48, v49
  v_cvt_pk_bf16_f32 v41, v50, v51
  v_mfma_f32_16x16x32_bf16 v[80:83], a[176:179], v[204:207], v[80:83]
  v_exp_f32 v170, v170
  v_cvt_pk_bf16_f32 v42, v52, v53
  v_mfma_f32_16x16x32_bf16 v[84:87], a[180:183], v[204:207], v[84:87]
  v_cvt_pk_bf16_f32 v43, v54, v55
  buffer_store_dwordx4 v[40:43], v15, s[24:27], s30 offen offset:2048 sc1
  v_mul_f32 v56, v16, v56
  v_mfma_f32_16x16x32_bf16 v[88:91], a[184:187], v[204:207], v[88:91]
  v_exp_f32 v171, v171
  v_mul_f32 v57, v16, v57
  v_mfma_f32_16x16x32_bf16 v[92:95], a[188:191], v[204:207], v[92:95]
  v_cvt_pk_bf16_f32 v197, v170, v171
  v_mul_f32 v58, v16, v58
  v_mul_f32 v59, v16, v59
  v_mfma_f32_16x16x32_bf16 a[196:199], a[208:211], v[204:207], a[196:199]
  v_mul_f32 v60, v16, v60
  v_mul_f32 v61, v16, v61
  v_mul_f32 v62, v16, v62
  v_mfma_f32_16x16x32_bf16 v[176:179], a[64:67], a[48:51], v[220:223]
  v_exp_f32 v172, v172
  v_mul_f32 v63, v16, v63
  v_mfma_f32_16x16x32_bf16 v[176:179], a[68:71], a[52:55], v[176:179]
  v_cvt_pk_bf16_f32 v44, v56, v57
  v_cvt_pk_bf16_f32 v45, v58, v59
  v_cvt_pk_bf16_f32 v46, v60, v61
  v_mfma_f32_16x16x32_bf16 v[176:179], a[72:75], a[56:59], v[176:179]
  v_exp_f32 v173, v173
  v_cvt_pk_bf16_f32 v47, v62, v63
  v_mfma_f32_16x16x32_bf16 v[176:179], a[76:79], a[60:63], v[176:179]
  v_cvt_pk_bf16_f32 v198, v172, v173
  buffer_store_dwordx4 v[44:47], v15, s[24:27], s30 offen offset:3072 sc1
  s_add_u32 s30, s30, 131072
  v_mfma_f32_16x16x32_bf16 v[180:183], a[80:83], a[48:51], v[220:223]
  v_exp_f32 v174, v174
  v_accvgpr_read_b32 v16, a196
  v_mfma_f32_16x16x32_bf16 v[180:183], a[84:87], a[52:55], v[180:183]
  v_cmp_ngt_f32 vcc, s36, v16
  v_rcp_f32 v16, v16
  s_or_b64 s[50:51], s[50:51], vcc
  v_mfma_f32_16x16x32_bf16 v[180:183], a[88:91], a[56:59], v[180:183]
  v_exp_f32 v175, v175
  v_mov_b32 v17, v16
  v_mfma_f32_16x16x32_bf16 v[180:183], a[92:95], a[60:63], v[180:183]
  v_cvt_pk_bf16_f32 v199, v174, v175
  v_mul_f32 v64, v16, v64
  v_mul_f32 v65, v16, v65
  v_mfma_f32_16x16x32_bf16 v[96:99], a[128:131], v[192:195], v[96:99]
  v_exp_f32 v176, v176
  v_mul_f32 v66, v16, v66
  v_mfma_f32_16x16x32_bf16 v[100:103], a[132:135], v[192:195], v[100:103]
  v_mul_f32 v67, v16, v67
  v_mul_f32 v68, v16, v68
  v_mul_f32 v69, v16, v69
  v_mfma_f32_16x16x32_bf16 v[104:107], a[136:139], v[192:195], v[104:107]
  s_waitcnt vmcnt(36)
  ds_read_b64_tr_b16 a[64:65], v7 offset:16384
  ds_read_b64_tr_b16 a[66:67], v7 offset:18432
  v_exp_f32 v177, v177
  v_mfma_f32_16x16x32_bf16 v[108:111], a[140:143], v[192:195], v[108:111]
  v_cvt_pk_bf16_f32 v200, v176, v177
  v_mul_f32 v70, v16, v70
  v_mul_f32 v71, v16, v71
  v_mfma_f32_16x16x32_bf16 v[112:115], a[144:147], v[192:195], v[112:115]
  ds_read_b64_tr_b16 a[68:69], v8 offset:16384
  ds_read_b64_tr_b16 a[70:71], v8 offset:18432
  v_exp_f32 v178, v178
  v_mfma_f32_16x16x32_bf16 v[116:119], a[148:151], v[192:195], v[116:119]
  v_cvt_pk_bf16_f32 v64, v64, v65
  v_cvt_pk_bf16_f32 v65, v66, v67
  v_cvt_pk_bf16_f32 v66, v68, v69
  v_mfma_f32_16x16x32_bf16 v[120:123], a[152:155], v[192:195], v[120:123]
  ds_read_b64_tr_b16 a[72:73], v9 offset:16384
  ds_read_b64_tr_b16 a[74:75], v9 offset:18432
  v_exp_f32 v179, v179
  v_mfma_f32_16x16x32_bf16 v[124:127], a[156:159], v[192:195], v[124:127]
  v_cvt_pk_bf16_f32 v201, v178, v179
  v_cvt_pk_bf16_f32 v67, v70, v71
  buffer_store_dwordx4 v[64:67], v15, s[24:27], s30 offen offset:0 sc1
  v_mfma_f32_16x16x32_bf16 a[200:203], a[208:211], v[192:195], a[200:203]
  ds_read_b64_tr_b16 a[76:77], v10 offset:16384
  ds_read_b64_tr_b16 a[78:79], v10 offset:18432
  v_mul_f32 v72, v16, v72
  v_mfma_f32_16x16x32_bf16 v[184:187], a[96:99], a[48:51], v[220:223]
  v_exp_f32 v180, v180
  v_mul_f32 v73, v16, v73
  v_mfma_f32_16x16x32_bf16 v[184:187], a[100:103], a[52:55], v[184:187]
  s_waitcnt vmcnt(33)
  ds_read_b64_tr_b16 a[80:81], v28 offset:16384
  ds_read_b64_tr_b16 a[82:83], v28 offset:18432
  v_mul_f32 v74, v16, v74
  v_mfma_f32_16x16x32_bf16 v[184:187], a[104:107], a[56:59], v[184:187]
  v_exp_f32 v181, v181
  v_mul_f32 v75, v16, v75
  v_mfma_f32_16x16x32_bf16 v[184:187], a[108:111], a[60:63], v[184:187]
  ds_read_b64_tr_b16 a[84:85], v29 offset:16384
  ds_read_b64_tr_b16 a[86:87], v29 offset:18432
  v_cvt_pk_bf16_f32 v202, v180, v181
  v_mfma_f32_16x16x32_bf16 v[188:191], a[112:115], a[48:51], v[220:223]
  v_exp_f32 v182, v182
  v_mul_f32 v76, v16, v76
  v_mfma_f32_16x16x32_bf16 v[188:191], a[116:119], a[52:55], v[188:191]
  ds_read_b64_tr_b16 a[88:89], v30 offset:16384
  ds_read_b64_tr_b16 a[90:91], v30 offset:18432
  v_mul_f32 v77, v16, v77
  v_mfma_f32_16x16x32_bf16 v[188:191], a[120:123], a[56:59], v[188:191]
  v_exp_f32 v183, v183
  v_mul_f32 v78, v16, v78
  v_mfma_f32_16x16x32_bf16 v[188:191], a[124:127], a[60:63], v[188:191]
  ds_read_b64_tr_b16 a[92:93], v31 offset:16384
  ds_read_b64_tr_b16 a[94:95], v31 offset:18432
  v_cvt_pk_bf16_f32 v203, v182, v183
  v_mfma_f32_16x16x32_bf16 v[96:99], a[160:163], v[196:199], v[96:99]
  v_exp_f32 v184, v184
  v_mul_f32 v79, v16, v79
  v_mfma_f32_16x16x32_bf16 v[100:103], a[164:167], v[196:199], v[100:103]
  v_cvt_pk_bf16_f32 v68, v72, v73
  v_cvt_pk_bf16_f32 v69, v74, v75
  v_cvt_pk_bf16_f32 v70, v76, v77
  v_mfma_f32_16x16x32_bf16 v[104:107], a[168:171], v[196:199], v[104:107]
  s_waitcnt vmcnt(25)
  ds_read_b64_tr_b16 a[96:97], v28 offset:32768
  ds_read_b64_tr_b16 a[98:99], v28 offset:34816
  v_exp_f32 v185, v185
  v_mfma_f32_16x16x32_bf16 v[108:111], a[172:175], v[196:199], v[108:111]
  v_cvt_pk_bf16_f32 v204, v184, v185
  v_cvt_pk_bf16_f32 v71, v78, v79
  buffer_store_dwordx4 v[68:71], v15, s[24:27], s30 offen offset:1024 sc1
  v_mfma_f32_16x16x32_bf16 v[112:115], a[176:179], v[196:199], v[112:115]
  ds_read_b64_tr_b16 a[100:101], v29 offset:32768
  ds_read_b64_tr_b16 a[102:103], v29 offset:34816
  v_exp_f32 v186, v186
  v_mfma_f32_16x16x32_bf16 v[116:119], a[180:183], v[196:199], v[116:119]
  v_mul_f32 v80, v16, v80
  v_mul_f32 v81, v16, v81
  v_mul_f32 v82, v16, v82
  v_mfma_f32_16x16x32_bf16 v[120:123], a[184:187], v[196:199], v[120:123]
  ds_read_b64_tr_b16 a[104:105], v30 offset:32768
  ds_read_b64_tr_b16 a[106:107], v30 offset:34816
  v_exp_f32 v187, v187
  v_mfma_f32_16x16x32_bf16 v[124:127], a[188:191], v[196:199], v[124:127]
  v_cvt_pk_bf16_f32 v205, v186, v187
  v_mul_f32 v83, v16, v83
  v_mul_f32 v84, v16, v84
  v_mfma_f32_16x16x32_bf16 a[200:203], a[208:211], v[196:199], a[200:203]
  ds_read_b64_tr_b16 a[108:109], v31 offset:32768
  ds_read_b64_tr_b16 a[110:111], v31 offset:34816
  v_mul_f32 v85, v16, v85
  v_mfma_f32_16x16x32_bf16 v[128:131], a[128:131], v[200:203], v[128:131]
  v_exp_f32 v188, v188
  v_mul_f32 v86, v16, v86
  v_mfma_f32_16x16x32_bf16 v[132:135], a[132:135], v[200:203], v[132:135]
  s_waitcnt vmcnt(42)
  ds_read_b64_tr_b16 a[112:113], v7 offset:0
  ds_read_b64_tr_b16 a[114:115], v7 offset:2048
  v_mul_f32 v87, v16, v87
  v_mfma_f32_16x16x32_bf16 v[136:139], a[136:139], v[200:203], v[136:139]
  v_exp_f32 v189, v189
  v_cvt_pk_bf16_f32 v72, v80, v81
  v_mfma_f32_16x16x32_bf16 v[140:143], a[140:143], v[200:203], v[140:143]
  ds_read_b64_tr_b16 a[116:117], v8 offset:0
  ds_read_b64_tr_b16 a[118:119], v8 offset:2048
  v_cvt_pk_bf16_f32 v206, v188, v189
  v_mfma_f32_16x16x32_bf16 v[144:147], a[144:147], v[200:203], v[144:147]
  v_exp_f32 v190, v190
  v_cvt_pk_bf16_f32 v73, v82, v83
  v_mfma_f32_16x16x32_bf16 v[148:151], a[148:151], v[200:203], v[148:151]
  ds_read_b64_tr_b16 a[120:121], v9 offset:0
  ds_read_b64_tr_b16 a[122:123], v9 offset:2048
  v_cvt_pk_bf16_f32 v74, v84, v85
  v_mfma_f32_16x16x32_bf16 v[152:155], a[152:155], v[200:203], v[152:155]
  v_exp_f32 v191, v191
  v_cvt_pk_bf16_f32 v75, v86, v87
  v_mfma_f32_16x16x32_bf16 v[156:159], a[156:159], v[200:203], v[156:159]
  ds_read_b64_tr_b16 a[124:125], v10 offset:0
  ds_read_b64_tr_b16 a[126:127], v10 offset:2048
  v_cvt_pk_bf16_f32 v207, v190, v191
  v_mfma_f32_16x16x32_bf16 a[204:207], a[208:211], v[200:203], a[204:207]
  buffer_store_dwordx4 v[72:75], v15, s[24:27], s30 offen offset:2048 sc1
  v_mul_f32 v88, v16, v88
  v_mul_f32 v89, v16, v89
  v_mfma_f32_16x16x32_bf16 v[128:131], a[160:163], v[204:207], v[128:131]
  v_mul_f32 v90, v16, v90
  v_mul_f32 v91, v16, v91
  v_mul_f32 v92, v16, v92
  v_mfma_f32_16x16x32_bf16 v[132:135], a[164:167], v[204:207], v[132:135]
  v_mul_f32 v93, v16, v93
  v_mul_f32 v94, v16, v94
  v_mul_f32 v95, v16, v95
  v_mfma_f32_16x16x32_bf16 v[136:139], a[168:171], v[204:207], v[136:139]
  v_cvt_pk_bf16_f32 v76, v88, v89
  v_cvt_pk_bf16_f32 v77, v90, v91
  v_cvt_pk_bf16_f32 v78, v92, v93
  v_mfma_f32_16x16x32_bf16 v[140:143], a[172:175], v[204:207], v[140:143]
  v_cvt_pk_bf16_f32 v79, v94, v95
  buffer_store_dwordx4 v[76:79], v15, s[24:27], s30 offen offset:3072 sc1
  s_add_u32 s30, s30, 131072
  v_accvgpr_read_b32 v16, a200
  v_cmp_ngt_f32 vcc, s36, v16
  v_mfma_f32_16x16x32_bf16 v[144:147], a[176:179], v[204:207], v[144:147]
  v_rcp_f32 v16, v16
  s_or_b64 s[50:51], s[50:51], vcc
  v_mov_b32 v17, v16
  v_mul_f32 v96, v16, v96
  v_mul_f32 v97, v16, v97
  v_mfma_f32_16x16x32_bf16 v[148:151], a[180:183], v[204:207], v[148:151]
  v_mul_f32 v98, v16, v98
  v_mul_f32 v99, v16, v99
  v_mul_f32 v100, v16, v100
  v_mul_f32 v101, v16, v101
  v_mul_f32 v102, v16, v102
  v_mfma_f32_16x16x32_bf16 v[152:155], a[184:187], v[204:207], v[152:155]
  v_mul_f32 v103, v16, v103
  v_cvt_pk_bf16_f32 v96, v96, v97
  v_cvt_pk_bf16_f32 v97, v98, v99
  v_cvt_pk_bf16_f32 v98, v100, v101
  v_cvt_pk_bf16_f32 v99, v102, v103
  v_mfma_f32_16x16x32_bf16 v[156:159], a[188:191], v[204:207], v[156:159]
  buffer_store_dwordx4 v[96:99], v15, s[24:27], s30 offen offset:0 sc1
  v_mul_f32 v104, v16, v104
  v_mul_f32 v105, v16, v105
  v_mul_f32 v106, v16, v106
  v_mul_f32 v107, v16, v107
  v_mfma_f32_16x16x32_bf16 a[204:207], a[208:211], v[204:207], a[204:207]
  v_mul_f32 v108, v16, v108
  v_mul_f32 v109, v16, v109
  v_mul_f32 v110, v16, v110
  v_mul_f32 v111, v16, v111
  v_cvt_pk_bf16_f32 v100, v104, v105
  v_cvt_pk_bf16_f32 v101, v106, v107
  v_cvt_pk_bf16_f32 v102, v108, v109
  v_cvt_pk_bf16_f32 v103, v110, v111
  buffer_store_dwordx4 v[100:103], v15, s[24:27], s30 offen offset:1024 sc1
  v_mul_f32 v112, v16, v112
  v_mul_f32 v113, v16, v113
  v_mul_f32 v114, v16, v114
  v_mul_f32 v115, v16, v115
  v_mul_f32 v116, v16, v116
  v_mul_f32 v117, v16, v117
  v_mul_f32 v118, v16, v118
  v_mul_f32 v119, v16, v119
  v_cvt_pk_bf16_f32 v104, v112, v113
  v_cvt_pk_bf16_f32 v105, v114, v115
  v_cvt_pk_bf16_f32 v106, v116, v117
  v_cvt_pk_bf16_f32 v107, v118, v119
  buffer_store_dwordx4 v[104:107], v15, s[24:27], s30 offen offset:2048 sc1
  v_mul_f32 v120, v16, v120
  v_mul_f32 v121, v16, v121
  v_mul_f32 v122, v16, v122
  v_mul_f32 v123, v16, v123
  v_mul_f32 v124, v16, v124
  v_mul_f32 v125, v16, v125
  v_mul_f32 v126, v16, v126
  v_mul_f32 v127, v16, v127
  v_cvt_pk_bf16_f32 v108, v120, v121
  v_cvt_pk_bf16_f32 v109, v122, v123
  v_cvt_pk_bf16_f32 v110, v124, v125
  v_cvt_pk_bf16_f32 v111, v126, v127
  buffer_store_dwordx4 v[108:111], v15, s[24:27], s30 offen offset:3072 sc1
  s_add_u32 s30, s30, 131072
  v_accvgpr_read_b32 v16, a204
  v_cmp_ngt_f32 vcc, s36, v16
  v_rcp_f32 v16, v16
  s_or_b64 s[50:51], s[50:51], vcc
  s_cmp_lg_u64 s[50:51], 0
  s_cselect_b32 s52, 1, 0
  s_add_u32 s53, s40, 147456
  v_mov_b32 v20, s52
  v_mov_b32 v21, s53
  s_waitcnt lgkmcnt(15)
  ds_write_b32 v21, v20
  v_mov_b32 v17, v16
  v_pk_mul_f32 v[128:129], v[128:129], v[16:17]
  v_pk_mul_f32 v[130:131], v[130:131], v[16:17]
  v_pk_mul_f32 v[132:133], v[132:133], v[16:17]
  v_pk_mul_f32 v[134:135], v[134:135], v[16:17]
  v_cvt_pk_bf16_f32 v128, v128, v129
  v_cvt_pk_bf16_f32 v129, v130, v131
  v_cvt_pk_bf16_f32 v130, v132, v133
  v_cvt_pk_bf16_f32 v131, v134, v135
  buffer_store_dwordx4 v[128:131], v15, s[24:27], s30 offen offset:0 sc1
  v_pk_mul_f32 v[136:137], v[136:137], v[16:17]
  v_pk_mul_f32 v[138:139], v[138:139], v[16:17]
  v_pk_mul_f32 v[140:141], v[140:141], v[16:17]
  v_pk_mul_f32 v[142:143], v[142:143], v[16:17]
  v_cvt_pk_bf16_f32 v132, v136, v137
  v_cvt_pk_bf16_f32 v133, v138, v139
  v_cvt_pk_bf16_f32 v134, v140, v141
  v_cvt_pk_bf16_f32 v135, v142, v143
  buffer_store_dwordx4 v[132:135], v15, s[24:27], s30 offen offset:1024 sc1
  v_pk_mul_f32 v[144:145], v[144:145], v[16:17]
  v_pk_mul_f32 v[146:147], v[146:147], v[16:17]
  v_pk_mul_f32 v[148:149], v[148:149], v[16:17]
  v_pk_mul_f32 v[150:151], v[150:151], v[16:17]
  v_cvt_pk_bf16_f32 v136, v144, v145
  v_cvt_pk_bf16_f32 v137, v146, v147
  v_cvt_pk_bf16_f32 v138, v148, v149
  v_cvt_pk_bf16_f32 v139, v150, v151
  buffer_store_dwordx4 v[136:139], v15, s[24:27], s30 offen offset:2048 sc1
  v_pk_mul_f32 v[152:153], v[152:153], v[16:17]
  v_pk_mul_f32 v[154:155], v[154:155], v[16:17]
  v_pk_mul_f32 v[156:157], v[156:157], v[16:17]
  v_pk_mul_f32 v[158:159], v[158:159], v[16:17]
  v_cvt_pk_bf16_f32 v140, v152, v153
  v_cvt_pk_bf16_f32 v141, v154, v155
  v_cvt_pk_bf16_f32 v142, v156, v157
  v_cvt_pk_bf16_f32 v143, v158, v159
  buffer_store_dwordx4 v[140:143], v15, s[24:27], s30 offen offset:3072 sc1
  s_add_u32 s30, s30, 131072
  v_and_b32 v18, 3, v1
  v_lshlrev_b32 v18, 12, v18
  v_add_u32 v18, 147456, v18
  s_waitcnt lgkmcnt(0)
  s_barrier
  ds_read_b32 v20, v18
  s_add_u32 s42, s41, 13
  s_and_b32 s42, s42, 31
  s_mul_i32 s42, s42, 40960
  s_add_u32 m0, s40, 16384
  s_nop 0
  buffer_load_dwordx4 v246, s[8:11], s42 offen lds
  buffer_load_dwordx4 v247, s[8:11], s42 offen offset:1024 lds
  buffer_load_dwordx4 v248, s[8:11], s42 offen offset:2048 lds
  buffer_load_dwordx4 v249, s[8:11], s42 offen offset:3072 lds
  s_add_u32 s42, s41, 14
  s_and_b32 s42, s42, 31
  s_mul_i32 s42, s42, 40960
  s_add_u32 m0, s40, 32768
  s_nop 0
  buffer_load_dwordx4 v246, s[8:11], s42 offen lds
  buffer_load_dwordx4 v247, s[8:11], s42 offen offset:1024 lds
  buffer_load_dwordx4 v248, s[8:11], s42 offen offset:2048 lds
  buffer_load_dwordx4 v249, s[8:11], s42 offen offset:3072 lds
  s_waitcnt lgkmcnt(0)
  v_cmp_ne_u32 vcc, 0, v20
  s_cmp_eq_u32 s35, 0
  s_cselect_b64 s[52:53], vcc, 0
  s_cmp_lg_u64 s[52:53], 0
  s_cbranch_scc1 L_exact
  s_waitcnt vmcnt(48)
  ds_read_b64_tr_b16 a[128:129], v250 offset:16384
  ds_read_b64_tr_b16 a[130:131], v250 offset:18432
  ds_read_b64_tr_b16 a[132:133], v251 offset:16384
  ds_read_b64_tr_b16 a[134:135], v251 offset:18432
  ds_read_b64_tr_b16 a[136:137], v252 offset:16384
  ds_read_b64_tr_b16 a[138:139], v252 offset:18432
  ds_read_b64_tr_b16 a[140:141], v253 offset:16384
  ds_read_b64_tr_b16 a[142:143], v253 offset:18432
  s_waitcnt vmcnt(40)
  ds_read_b64_tr_b16 a[144:145], v250 offset:32768
  ds_read_b64_tr_b16 a[146:147], v250 offset:34816
  ds_read_b64_tr_b16 a[148:149], v251 offset:32768
  ds_read_b64_tr_b16 a[150:151], v251 offset:34816
  ds_read_b64_tr_b16 a[152:153], v252 offset:32768
  ds_read_b64_tr_b16 a[154:155], v252 offset:34816
  ds_read_b64_tr_b16 a[156:157], v253 offset:32768
  ds_read_b64_tr_b16 a[158:159], v253 offset:34816
  s_lshl_b32 s52, s28, 5
  s_add_u32 s52, s52, s29
  s_lshl_b32 s52, s52, 7
  s_add_u32 s52, s52, 25165824
  v_mov_b32 v16, s52
  v_mov_b32 v17, 1
  s_add_u32 s42, s41, 15
  s_and_b32 s42, s42, 31
  s_mul_i32 s42, s42, 40960
  s_add_u32 m0, s40, 131072
  s_nop 0
  buffer_load_dwordx4 v246, s[8:11], s42 offen lds
  buffer_load_dwordx4 v247, s[8:11], s42 offen offset:1024 lds
  buffer_load_dwordx4 v248, s[8:11], s42 offen offset:2048 lds
  buffer_load_dwordx4 v249, s[8:11], s42 offen offset:3072 lds
  s_waitcnt vmcnt(12)
  s_barrier
  s_cmp_lg_u32 s3, 0
  s_cbranch_scc1 L_nosig
  s_mov_b64 exec, 1
  global_store_dword v16, v17, s[48:49] sc1
  s_mov_b64 exec, -1
L_nosig:
  s_lshr_b32 s52, s2, 3
  s_cmp_ge_u32 s52, 30
  s_cbranch_scc1 L_fin
  s_add_u32 s42, s41, 12
  s_and_b32 s42, s42, 31
  s_mul_i32 s42, s42, 40960
  s_add_u32 m0, s40, 147456
  s_nop 0
  buffer_load_dwordx4 v246, s[8:11], s42 offen lds
  buffer_load_dwordx4 v247, s[8:11], s42 offen offset:1024 lds
  buffer_load_dwordx4 v248, s[8:11], s42 offen offset:2048 lds
  buffer_load_dwordx4 v249, s[8:11], s42 offen offset:3072 lds
  s_waitcnt vmcnt(36)
  ds_read_b64_tr_b16 a[160:161], v28 offset:49152
  ds_read_b64_tr_b16 a[162:163], v28 offset:51200
  ds_read_b64_tr_b16 a[164:165], v29 offset:49152
  ds_read_b64_tr_b16 a[166:167], v29 offset:51200
  ds_read_b64_tr_b16 a[168:169], v30 offset:49152
  ds_read_b64_tr_b16 a[170:171], v30 offset:51200
  ds_read_b64_tr_b16 a[172:173], v31 offset:49152
  ds_read_b64_tr_b16 a[174:175], v31 offset:51200
  s_waitcnt vmcnt(32)
  ds_read_b64_tr_b16 a[176:177], v250 offset:49152
  ds_read_b64_tr_b16 a[178:179], v250 offset:51200
  ds_read_b64_tr_b16 a[180:181], v251 offset:49152
  ds_read_b64_tr_b16 a[182:183], v251 offset:51200
  ds_read_b64_tr_b16 a[184:185], v252 offset:49152
  ds_read_b64_tr_b16 a[186:187], v252 offset:51200
  ds_read_b64_tr_b16 a[188:189], v253 offset:49152
  ds_read_b64_tr_b16 a[190:191], v253 offset:51200
  s_waitcnt lgkmcnt(15)
  s_add_u32 s42, s41, 16
  s_and_b32 s42, s42, 31
  s_mul_i32 s42, s42, 40960
  s_add_u32 m0, s40, 81920
  s_nop 0
  buffer_load_dwordx4 v246, s[8:11], s42 offen lds
  buffer_load_dwordx4 v247, s[8:11], s42 offen offset:1024 lds
  buffer_load_dwordx4 v248, s[8:11], s42 offen offset:2048 lds
  buffer_load_dwordx4 v249, s[8:11], s42 offen offset:3072 lds
  s_waitcnt vmcnt(48)
  ds_read_b64_tr_b16 a[208:209], v28 offset:0
  ds_read_b64_tr_b16 a[210:211], v28 offset:2048
  ds_read_b64_tr_b16 a[212:213], v29 offset:0
  ds_read_b64_tr_b16 a[214:215], v29 offset:2048
  ds_read_b64_tr_b16 a[216:217], v30 offset:0
  ds_read_b64_tr_b16 a[218:219], v30 offset:2048
  ds_read_b64_tr_b16 a[220:221], v31 offset:0
  ds_read_b64_tr_b16 a[222:223], v31 offset:2048
  s_waitcnt vmcnt(44)
  ds_read_b64_tr_b16 a[192:193], v250 offset:0
  ds_read_b64_tr_b16 a[194:195], v250 offset:2048
  ds_read_b64_tr_b16 a[196:197], v251 offset:0
  ds_read_b64_tr_b16 a[198:199], v251 offset:2048
  ds_read_b64_tr_b16 a[200:201], v252 offset:0
  ds_read_b64_tr_b16 a[202:203], v252 offset:2048
  ds_read_b64_tr_b16 a[204:205], v253 offset:0
  ds_read_b64_tr_b16 a[206:207], v253 offset:2048
  s_add_u32 s42, s41, 17
  s_and_b32 s42, s42, 31
  s_mul_i32 s42, s42, 40960
  s_add_u32 m0, s40, 98304
  s_nop 0
  buffer_load_dwordx4 v246, s[8:11], s42 offen lds
  buffer_load_dwordx4 v247, s[8:11], s42 offen offset:1024 lds
  buffer_load_dwordx4 v248, s[8:11], s42 offen offset:2048 lds
  buffer_load_dwordx4 v249, s[8:11], s42 offen offset:3072 lds
  s_waitcnt lgkmcnt(0)
  s_add_u32 s42, s41, 18
  s_and_b32 s42, s42, 31
  s_mul_i32 s42, s42, 40960
  s_add_u32 m0, s40, 49152
  s_nop 0
  buffer_load_dwordx4 v246, s[8:11], s42 offen lds
  buffer_load_dwordx4 v247, s[8:11], s42 offen offset:1024 lds
  buffer_load_dwordx4 v248, s[8:11], s42 offen offset:2048 lds
  buffer_load_dwordx4 v249, s[8:11], s42 offen offset:3072 lds
  s_add_u32 s42, s41, 19
  s_and_b32 s42, s42, 31
  s_mul_i32 s42, s42, 40960
  s_add_u32 m0, s40, 114688
  s_nop 0
  buffer_load_dwordx4 v246, s[8:11], s42 offen lds
  buffer_load_dwordx4 v247, s[8:11], s42 offen offset:1024 lds
  buffer_load_dwordx4 v248, s[8:11], s42 offen offset:2048 lds
  buffer_load_dwordx4 v249, s[8:11], s42 offen offset:3072 lds
  s_add_u32 s42, s41, 20
  s_and_b32 s42, s42, 31
  s_mul_i32 s42, s42, 40960
  s_add_u32 m0, s40, 0
  s_nop 0
  buffer_load_dwordx4 v246, s[8:11], s42 offen lds
  buffer_load_dwordx4 v247, s[8:11], s42 offen offset:1024 lds
  buffer_load_dwordx4 v248, s[8:11], s42 offen offset:2048 lds
  buffer_load_dwordx4 v249, s[8:11], s42 offen offset:3072 lds
  s_add_u32 s42, s41, 21
  s_and_b32 s42, s42, 31
  s_mul_i32 s42, s42, 40960
  s_add_u32 m0, s40, 65536
  s_nop 0
  buffer_load_dwordx4 v246, s[8:11], s42 offen lds
  buffer_load_dwordx4 v247, s[8:11], s42 offen offset:1024 lds
  buffer_load_dwordx4 v248, s[8:11], s42 offen offset:2048 lds
  buffer_load_dwordx4 v249, s[8:11], s42 offen offset:3072 lds
  s_lshl_b32 s52, s43, 2
  s_add_u32 s52, s52, s3
  s_lshl_b32 s52, s52, 10
  s_add_u32 s52, s52, 25165824
  v_and_b32 v16, 7, v1
  v_lshlrev_b32 v16, 7, v16
  v_add_u32 v16, s52, v16
  s_waitcnt vmcnt(24)
  ds_read_b64_tr_b16 a[0:1], v7 offset:16384
  ds_read_b64_tr_b16 a[2:3], v7 offset:18432
  ds_read_b64_tr_b16 a[4:5], v8 offset:16384
  ds_read_b64_tr_b16 a[6:7], v8 offset:18432
  ds_read_b64_tr_b16 a[8:9], v9 offset:16384
  ds_read_b64_tr_b16 a[10:11], v9 offset:18432
  ds_read_b64_tr_b16 a[12:13], v10 offset:16384
  ds_read_b64_tr_b16 a[14:15], v10 offset:18432
  s_waitcnt vmcnt(36)
  ds_read_b64_tr_b16 a[16:17], v28 offset:16384
  ds_read_b64_tr_b16 a[18:19], v28 offset:18432
  ds_read_b64_tr_b16 a[20:21], v29 offset:16384
  ds_read_b64_tr_b16 a[22:23], v29 offset:18432
  ds_read_b64_tr_b16 a[24:25], v30 offset:16384
  ds_read_b64_tr_b16 a[26:27], v30 offset:18432
  ds_read_b64_tr_b16 a[28:29], v31 offset:16384
  ds_read_b64_tr_b16 a[30:31], v31 offset:18432
  s_waitcnt lgkmcnt(8)
  s_add_u32 s42, s41, 22
  s_and_b32 s42, s42, 31
  s_mul_i32 s42, s42, 40960
  s_add_u32 m0, s40, 147456
  s_nop 0
  buffer_load_dwordx4 v246, s[8:11], s42 offen lds
  buffer_load_dwordx4 v247, s[8:11], s42 offen offset:1024 lds
  buffer_load_dwordx4 v248, s[8:11], s42 offen offset:2048 lds
  buffer_load_dwordx4 v249, s[8:11], s42 offen offset:3072 lds
  s_waitcnt vmcnt(36)
  ds_read_b64_tr_b16 a[32:33], v28 offset:32768
  ds_read_b64_tr_b16 a[34:35], v28 offset:34816
  ds_read_b64_tr_b16 a[36:37], v29 offset:32768
  ds_read_b64_tr_b16 a[38:39], v29 offset:34816
  ds_read_b64_tr_b16 a[40:41], v30 offset:32768
  ds_read_b64_tr_b16 a[42:43], v30 offset:34816
  ds_read_b64_tr_b16 a[44:45], v31 offset:32768
  ds_read_b64_tr_b16 a[46:47], v31 offset:34816
  s_waitcnt lgkmcnt(8)
  s_add_u32 s42, s41, 23
  s_and_b32 s42, s42, 31
  s_mul_i32 s42, s42, 40960
  s_add_u32 m0, s40, 16384
  s_nop 0
  buffer_load_dwordx4 v246, s[8:11], s42 offen lds
  buffer_load_dwordx4 v247, s[8:11], s42 offen offset:1024 lds
  buffer_load_dwordx4 v248, s[8:11], s42 offen offset:2048 lds
  buffer_load_dwordx4 v249, s[8:11], s42 offen offset:3072 lds
  global_load_dword v17, v16, s[48:49] sc1
  s_waitcnt vmcnt(37)
  ds_read_b64_tr_b16 a[48:49], v7 offset:0
  ds_read_b64_tr_b16 a[50:51], v7 offset:2048
  ds_read_b64_tr_b16 a[52:53], v8 offset:0
  ds_read_b64_tr_b16 a[54:55], v8 offset:2048
  ds_read_b64_tr_b16 a[56:57], v9 offset:0
  ds_read_b64_tr_b16 a[58:59], v9 offset:2048
  ds_read_b64_tr_b16 a[60:61], v10 offset:0
  ds_read_b64_tr_b16 a[62:63], v10 offset:2048
  s_waitcnt lgkmcnt(8)
  s_add_u32 s42, s41, 24
  s_and_b32 s42, s42, 31
  s_mul_i32 s42, s42, 40960
  s_add_u32 m0, s40, 32768
  s_nop 0
  buffer_load_dwordx4 v246, s[8:11], s42 offen lds
  buffer_load_dwordx4 v247, s[8:11], s42 offen offset:1024 lds
  buffer_load_dwordx4 v248, s[8:11], s42 offen offset:2048 lds
  buffer_load_dwordx4 v249, s[8:11], s42 offen offset:3072 lds
  s_waitcnt vmcnt(33)
  ds_read_b64_tr_b16 v[224:225], v250 offset:16384
  ds_read_b64_tr_b16 v[226:227], v250 offset:18432
  ds_read_b64_tr_b16 v[228:229], v251 offset:16384
  ds_read_b64_tr_b16 v[230:231], v251 offset:18432
  ds_read_b64_tr_b16 v[232:233], v252 offset:16384
  ds_read_b64_tr_b16 v[234:235], v252 offset:18432
  ds_read_b64_tr_b16 v[236:237], v253 offset:16384
  ds_read_b64_tr_b16 v[238:239], v253 offset:18432
  s_waitcnt lgkmcnt(8)
  s_add_u32 s42, s41, 25
  s_and_b32 s42, s42, 31
  s_mul_i32 s42, s42, 40960
  s_add_u32 m0, s40, 131072
  s_nop 0
  buffer_load_dwordx4 v246, s[8:11], s42 offen lds
  buffer_load_dwordx4 v247, s[8:11], s42 offen offset:1024 lds
  buffer_load_dwordx4 v248, s[8:11], s42 offen offset:2048 lds
  buffer_load_dwordx4 v249, s[8:11], s42 offen offset:3072 lds
  s_waitcnt vmcnt(33)
  ds_read_b64_tr_b16 v[208:209], v250 offset:32768
  ds_read_b64_tr_b16 v[210:211], v250 offset:34816
  ds_read_b64_tr_b16 v[212:213], v251 offset:32768
  ds_read_b64_tr_b16 v[214:215], v251 offset:34816
  ds_read_b64_tr_b16 v[216:217], v252 offset:32768
  ds_read_b64_tr_b16 v[218:219], v252 offset:34816
  ds_read_b64_tr_b16 v[220:221], v253 offset:32768
  ds_read_b64_tr_b16 v[222:223], v253 offset:34816
  s_waitcnt lgkmcnt(8)
  s_add_u32 s42, s41, 26
  s_and_b32 s42, s42, 31
  s_mul_i32 s42, s42, 40960
  s_add_u32 m0, s40, 81920
  s_nop 0
  buffer_load_dwordx4 v246, s[8:11], s42 offen lds
  buffer_load_dwordx4 v247, s[8:11], s42 offen offset:1024 lds
  buffer_load_dwordx4 v248, s[8:11], s42 offen offset:2048 lds
  buffer_load_dwordx4 v249, s[8:11], s42 offen offset:3072 lds
  s_waitcnt vmcnt(33)
  ds_read_b64_tr_b16 v[192:193], v28 offset:49152
  ds_read_b64_tr_b16 v[194:195], v28 offset:51200
  ds_read_b64_tr_b16 v[196:197], v29 offset:49152
  ds_read_b64_tr_b16 v[198:199], v29 offset:51200
  ds_read_b64_tr_b16 v[200:201], v30 offset:49152
  ds_read_b64_tr_b16 v[202:203], v30 offset:51200
  ds_read_b64_tr_b16 v[204:205], v31 offset:49152
  ds_read_b64_tr_b16 v[206:207], v31 offset:51200
  s_waitcnt lgkmcnt(8)
  s_add_u32 s42, s41, 27
  s_and_b32 s42, s42, 31
  s_mul_i32 s42, s42, 40960
  s_add_u32 m0, s40, 98304
  s_nop 0
  buffer_load_dwordx4 v246, s[8:11], s42 offen lds
  buffer_load_dwordx4 v247, s[8:11], s42 offen offset:1024 lds
  buffer_load_dwordx4 v248, s[8:11], s42 offen offset:2048 lds
  buffer_load_dwordx4 v249, s[8:11], s42 offen offset:3072 lds
  s_waitcnt lgkmcnt(0)
  s_add_u32 s42, s41, 28
  s_and_b32 s42, s42, 31
  s_mul_i32 s42, s42, 40960
  s_add_u32 m0, s40, 49152
  s_nop 0
  buffer_load_dwordx4 v246, s[8:11], s42 offen lds
  buffer_load_dwordx4 v247, s[8:11], s42 offen offset:1024 lds
  buffer_load_dwordx4 v248, s[8:11], s42 offen offset:2048 lds
  buffer_load_dwordx4 v249, s[8:11], s42 offen offset:3072 lds
  s_mov_b32 s34, 0x100000
  s_waitcnt vmcnt(63)
  v_cmp_gt_u32 vcc, 8, v255
  s_cbranch_vccz L_cleared
L_wclr:
  global_load_dword v255, v0, s[46:47] sc1
  s_waitcnt vmcnt(0)
  v_cmp_gt_u32 vcc, 8, v255
  s_sub_u32 s34, s34, 1
  s_cselect_b64 vcc, 0, vcc
  s_cbranch_vccnz L_wclr
  s_branch L_poll
L_cleared:
  s_waitcnt vmcnt(20)
  v_cmp_ne_u32 vcc, 1, v17
  s_cbranch_vccz L_ready
L_poll:
  global_load_dword v17, v16, s[48:49] sc1
  s_waitcnt vmcnt(0)
  v_cmp_ne_u32 vcc, 1, v17
  s_sub_u32 s34, s34, 1
  s_cselect_b64 vcc, 0, vcc
  s_cbranch_vccnz L_poll
L_ready:
  s_add_u32 s30, s41, 0
  s_lshl_b32 s30, s30, 10
  s_and_b32 s30, s30, 0x7fff
  buffer_load_dwordx4 v[112:115], v4, s[12:15], s30 offen sc1
  buffer_load_dwordx4 v[116:119], v5, s[12:15], s30 offen sc1
  buffer_load_dwordx4 v[120:123], v13, s[12:15], s30 offen sc1
  buffer_load_dwordx4 v[124:127], v14, s[12:15], s30 offen sc1
  buffer_load_dwordx4 v[128:131], v254, s[12:15], s30 offen sc1
  s_add_u32 s30, s41, 1
  s_lshl_b32 s30, s30, 10
  s_and_b32 s30, s30, 0x7fff
  buffer_load_dwordx4 v[132:135], v4, s[12:15], s30 offen sc1
  buffer_load_dwordx4 v[136:139], v5, s[12:15], s30 offen sc1
  buffer_load_dwordx4 v[140:143], v13, s[12:15], s30 offen sc1
  buffer_load_dwordx4 v[144:147], v14, s[12:15], s30 offen sc1
  buffer_load_dwordx4 v[148:151], v254, s[12:15], s30 offen sc1
  s_add_u32 s30, s41, 2
  s_lshl_b32 s30, s30, 10
  s_and_b32 s30, s30, 0x7fff
  buffer_load_dwordx4 v[152:155], v4, s[12:15], s30 offen sc1
  buffer_load_dwordx4 v[156:159], v5, s[12:15], s30 offen sc1
  buffer_load_dwordx4 v[160:163], v13, s[12:15], s30 offen sc1
  buffer_load_dwordx4 v[164:167], v14, s[12:15], s30 offen sc1
  buffer_load_dwordx4 v[168:171], v254, s[12:15], s30 offen sc1
  s_mul_i32 s52, s43, 240
  s_mul_i32 s53, s54, 80
  s_add_u32 s52, s52, s53
  s_mul_i32 s52, s52, 1280
  s_lshl_b32 s53, s55, 7
  s_add_u32 s52, s52, s53
  s_add_u32 s4, s58, s52
  s_addc_u32 s5, s59, 0
  s_mov_b32 s6, 101248
  s_mov_b32 s7, 0x20000
  s_add_u32 s52, s3, 1
  s_and_b32 s52, s52, 3
  s_mul_i32 s52, s52, 15360
  v_add_u32 v241, s52, v15
  s_add_u32 s52, s3, 2
  s_and_b32 s52, s52, 3
  s_mul_i32 s52, s52, 15360
  v_add_u32 v242, s52, v15
  s_add_u32 s52, s3, 3
  s_and_b32 s52, s52, 3
  s_mul_i32 s52, s52, 15360
  v_add_u32 v243, s52, v15
  s_mul_i32 s52, s3, 15360
  v_add_u32 v240, s52, v15
  v_mul_u32_u24 v244, 1280, v2
  v_lshl_add_u32 v244, v3, 3, v244
  s_waitcnt vmcnt(10) lgkmcnt(0)
  v_mfma_f32_16x16x32_bf16 v[32:35], a[224:227], v[112:115], 0
  v_mfma_f32_16x16x32_bf16 v[36:39], a[228:231], v[112:115], 0
  s_add_u32 s30, s41, 3
  v_mfma_f32_16x16x32_bf16 v[40:43], a[232:235], v[112:115], 0
  s_lshl_b32 s30, s30, 10
  v_mfma_f32_16x16x32_bf16 v[44:47], a[236:239], v[112:115], 0
  s_and_b32 s30, s30, 0x7fff
  v_mfma_f32_16x16x32_bf16 v[48:51], a[224:227], v[116:119], 0
  buffer_load_dwordx4 v[172:175], v4, s[12:15], s30 offen sc1
  v_mfma_f32_16x16x32_bf16 v[52:55], a[228:231], v[116:119], 0
  v_mfma_f32_16x16x32_bf16 v[56:59], a[232:235], v[116:119], 0
  buffer_load_dwordx4 v[176:179], v5, s[12:15], s30 offen sc1
  v_mfma_f32_16x16x32_bf16 v[60:63], a[236:239], v[116:119], 0
  v_mfma_f32_16x16x32_bf16 v[64:67], a[224:227], v[120:123], 0
  v_mfma_f32_16x16x32_bf16 v[68:71], a[228:231], v[120:123], 0
  buffer_load_dwordx4 v[180:183], v13, s[12:15], s30 offen sc1
  v_mfma_f32_16x16x32_bf16 v[72:75], a[232:235], v[120:123], 0
  v_mfma_f32_16x16x32_bf16 v[76:79], a[236:239], v[120:123], 0
  v_mfma_f32_16x16x32_bf16 v[80:83], a[224:227], v[124:127], 0
  buffer_load_dwordx4 v[184:187], v14, s[12:15], s30 offen sc1
  v_mfma_f32_16x16x32_bf16 v[84:87], a[228:231], v[124:127], 0
  v_mfma_f32_16x16x32_bf16 v[88:91], a[232:235], v[124:127], 0
  v_mfma_f32_16x16x32_bf16 v[92:95], a[236:239], v[124:127], 0
  buffer_load_dwordx4 v[188:191], v254, s[12:15], s30 offen sc1
  v_mfma_f32_16x16x32_bf16 v[96:99], a[224:227], v[128:131], 0
  v_mfma_f32_16x16x32_bf16 v[100:103], a[228:231], v[128:131], 0
  v_mfma_f32_16x16x32_bf16 v[104:107], a[232:235], v[128:131], 0
  v_mfma_f32_16x16x32_bf16 v[108:111], a[236:239], v[128:131], 0
  s_waitcnt vmcnt(10) lgkmcnt(0)
  v_mfma_f32_16x16x32_bf16 v[32:35], a[240:243], v[132:135], v[32:35]
  s_waitcnt vmcnt(56)
  v_mfma_f32_16x16x32_bf16 v[36:39], a[244:247], v[132:135], v[36:39]
  s_add_u32 s30, s41, 4
  ds_read_b64_tr_b16 a[224:225], v250 offset:49152
  v_mfma_f32_16x16x32_bf16 v[40:43], a[248:251], v[132:135], v[40:43]
  s_lshl_b32 s30, s30, 10
  ds_read_b64_tr_b16 a[226:227], v250 offset:51200
  v_mfma_f32_16x16x32_bf16 v[44:47], a[252:255], v[132:135], v[44:47]
  s_and_b32 s30, s30, 0x7fff
  ds_read_b64_tr_b16 a[228:229], v251 offset:49152
  v_mfma_f32_16x16x32_bf16 v[48:51], a[240:243], v[136:139], v[48:51]
  buffer_load_dwordx4 v[112:115], v4, s[12:15], s30 offen sc1
  ds_read_b64_tr_b16 a[230:231], v251 offset:51200
  v_mfma_f32_16x16x32_bf16 v[52:55], a[244:247], v[136:139], v[52:55]
  ds_read_b64_tr_b16 a[232:233], v252 offset:49152
  v_mfma_f32_16x16x32_bf16 v[56:59], a[248:251], v[136:139], v[56:59]
  buffer_load_dwordx4 v[116:119], v5, s[12:15], s30 offen sc1
  ds_read_b64_tr_b16 a[234:235], v252 offset:51200
  v_mfma_f32_16x16x32_bf16 v[60:63], a[252:255], v[136:139], v[60:63]
  ds_read_b64_tr_b16 a[236:237], v253 offset:49152
  v_mfma_f32_16x16x32_bf16 v[64:67], a[240:243], v[140:143], v[64:67]
  ds_read_b64_tr_b16 a[238:239], v253 offset:51200
  v_mfma_f32_16x16x32_bf16 v[68:71], a[244:247], v[140:143], v[68:71]
  buffer_load_dwordx4 v[120:123], v13, s[12:15], s30 offen sc1
  v_mfma_f32_16x16x32_bf16 v[72:75], a[248:251], v[140:143], v[72:75]
  v_mfma_f32_16x16x32_bf16 v[76:79], a[252:255], v[140:143], v[76:79]
  v_mfma_f32_16x16x32_bf16 v[80:83], a[240:243], v[144:147], v[80:83]
  buffer_load_dwordx4 v[124:127], v14, s[12:15], s30 offen sc1
  v_mfma_f32_16x16x32_bf16 v[84:87], a[244:247], v[144:147], v[84:87]
  v_mfma_f32_16x16x32_bf16 v[88:91], a[248:251], v[144:147], v[88:91]
  v_mfma_f32_16x16x32_bf16 v[92:95], a[252:255], v[144:147], v[92:95]
  buffer_load_dwordx4 v[128:131], v254, s[12:15], s30 offen sc1
  v_mfma_f32_16x16x32_bf16 v[96:99], a[240:243], v[148:151], v[96:99]
  v_mfma_f32_16x16x32_bf16 v[100:103], a[244:247], v[148:151], v[100:103]
  v_mfma_f32_16x16x32_bf16 v[104:107], a[248:251], v[148:151], v[104:107]
  v_mfma_f32_16x16x32_bf16 v[108:111], a[252:255], v[148:151], v[108:111]
  s_waitcnt vmcnt(10) lgkmcnt(0)
  v_mfma_f32_16x16x32_bf16 v[32:35], a[64:67], v[152:155], v[32:35]
  s_waitcnt vmcnt(57)
  v_mfma_f32_16x16x32_bf16 v[36:39], a[68:71], v[152:155], v[36:39]
  s_add_u32 s30, s41, 5
  ds_read_b64_tr_b16 a[240:241], v28 offset:0
  v_mfma_f32_16x16x32_bf16 v[40:43], a[72:75], v[152:155], v[40:43]
  s_lshl_b32 s30, s30, 10
  ds_read_b64_tr_b16 a[242:243], v28 offset:2048
  v_mfma_f32_16x16x32_bf16 v[44:47], a[76:79], v[152:155], v[44:47]
  s_and_b32 s30, s30, 0x7fff
  ds_read_b64_tr_b16 a[244:245], v29 offset:0
  v_mfma_f32_16x16x32_bf16 v[48:51], a[64:67], v[156:159], v[48:51]
  buffer_load_dwordx4 v[132:135], v4, s[12:15], s30 offen sc1
  ds_read_b64_tr_b16 a[246:247], v29 offset:2048
  v_mfma_f32_16x16x32_bf16 v[52:55], a[68:71], v[156:159], v[52:55]
  ds_read_b64_tr_b16 a[248:249], v30 offset:0
  v_mfma_f32_16x16x32_bf16 v[56:59], a[72:75], v[156:159], v[56:59]
  s_add_u32 s42, s41, 29
  buffer_load_dwordx4 v[136:139], v5, s[12:15], s30 offen sc1
  ds_read_b64_tr_b16 a[250:251], v30 offset:2048
  v_mfma_f32_16x16x32_bf16 v[60:63], a[76:79], v[156:159], v[60:63]
  s_and_b32 s42, s42, 31
  ds_read_b64_tr_b16 a[252:253], v31 offset:0
  v_mfma_f32_16x16x32_bf16 v[64:67], a[64:67], v[160:163], v[64:67]
  s_mul_i32 s42, s42, 40960
  ds_read_b64_tr_b16 a[254:255], v31 offset:2048
  v_mfma_f32_16x16x32_bf16 v[68:71], a[68:71], v[160:163], v[68:71]
  s_add_u32 m0, s40, 114688
  buffer_load_dwordx4 v[140:143], v13, s[12:15], s30 offen sc1
  v_mfma_f32_16x16x32_bf16 v[72:75], a[72:75], v[160:163], v[72:75]
  buffer_load_dwordx4 v246, s[8:11], s42 offen lds
  v_mfma_f32_16x16x32_bf16 v[76:79], a[76:79], v[160:163], v[76:79]
  v_mfma_f32_16x16x32_bf16 v[80:83], a[64:67], v[164:167], v[80:83]
  buffer_load_dwordx4 v[144:147], v14, s[12:15], s30 offen sc1
  v_mfma_f32_16x16x32_bf16 v[84:87], a[68:71], v[164:167], v[84:87]
  buffer_load_dwordx4 v247, s[8:11], s42 offen offset:1024 lds
  v_mfma_f32_16x16x32_bf16 v[88:91], a[72:75], v[164:167], v[88:91]
  v_mfma_f32_16x16x32_bf16 v[92:95], a[76:79], v[164:167], v[92:95]
  buffer_load_dwordx4 v[148:151], v254, s[12:15], s30 offen sc1
  v_mfma_f32_16x16x32_bf16 v[96:99], a[64:67], v[168:171], v[96:99]
  buffer_load_dwordx4 v248, s[8:11], s42 offen offset:2048 lds
  v_mfma_f32_16x16x32_bf16 v[100:103], a[68:71], v[168:171], v[100:103]
  v_mfma_f32_16x16x32_bf16 v[104:107], a[72:75], v[168:171], v[104:107]
  buffer_load_dwordx4 v249, s[8:11], s42 offen offset:3072 lds
  v_mfma_f32_16x16x32_bf16 v[108:111], a[76:79], v[168:171], v[108:111]
  s_waitcnt vmcnt(14) lgkmcnt(0)
  v_mfma_f32_16x16x32_bf16 v[32:35], a[80:83], v[172:175], v[32:35]
  s_waitcnt vmcnt(62)
  v_mfma_f32_16x16x32_bf16 v[36:39], a[84:87], v[172:175], v[36:39]
  s_add_u32 s30, s41, 6
  ds_read_b64_tr_b16 a[64:65], v250 offset:0
  v_mfma_f32_16x16x32_bf16 v[40:43], a[88:91], v[172:175], v[40:43]
  s_lshl_b32 s30, s30, 10
  ds_read_b64_tr_b16 a[66:67], v250 offset:2048
  v_mfma_f32_16x16x32_bf16 v[44:47], a[92:95], v[172:175], v[44:47]
  s_and_b32 s30, s30, 0x7fff
  ds_read_b64_tr_b16 a[68:69], v251 offset:0
  v_mfma_f32_16x16x32_bf16 v[48:51], a[80:83], v[176:179], v[48:51]
  buffer_load_dwordx4 v[152:155], v4, s[12:15], s30 offen sc1
  ds_read_b64_tr_b16 a[70:71], v251 offset:2048
  v_mfma_f32_16x16x32_bf16 v[52:55], a[84:87], v[176:179], v[52:55]
  ds_read_b64_tr_b16 a[72:73], v252 offset:0
  v_mfma_f32_16x16x32_bf16 v[56:59], a[88:91], v[176:179], v[56:59]
  s_add_u32 s42, s41, 30
  buffer_load_dwordx4 v[156:159], v5, s[12:15], s30 offen sc1
  ds_read_b64_tr_b16 a[74:75], v252 offset:2048
  v_mfma_f32_16x16x32_bf16 v[60:63], a[92:95], v[176:179], v[60:63]
  s_and_b32 s42, s42, 31
  ds_read_b64_tr_b16 a[76:77], v253 offset:0
  v_mfma_f32_16x16x32_bf16 v[64:67], a[80:83], v[180:183], v[64:67]
  s_mul_i32 s42, s42, 40960
  ds_read_b64_tr_b16 a[78:79], v253 offset:2048
  v_mfma_f32_16x16x32_bf16 v[68:71], a[84:87], v[180:183], v[68:71]
  s_add_u32 m0, s40, 0
  buffer_load_dwordx4 v[160:163], v13, s[12:15], s30 offen sc1
  v_mfma_f32_16x16x32_bf16 v[72:75], a[88:91], v[180:183], v[72:75]
  buffer_load_dwordx4 v246, s[8:11], s42 offen lds
  v_mfma_f32_16x16x32_bf16 v[76:79], a[92:95], v[180:183], v[76:79]
  v_mfma_f32_16x16x32_bf16 v[80:83], a[80:83], v[184:187], v[80:83]
  buffer_load_dwordx4 v[164:167], v14, s[12:15], s30 offen sc1
  v_mfma_f32_16x16x32_bf16 v[84:87], a[84:87], v[184:187], v[84:87]
  buffer_load_dwordx4 v247, s[8:11], s42 offen offset:1024 lds
  v_mfma_f32_16x16x32_bf16 v[88:91], a[88:91], v[184:187], v[88:91]
  v_mfma_f32_16x16x32_bf16 v[92:95], a[92:95], v[184:187], v[92:95]
  buffer_load_dwordx4 v[168:171], v254, s[12:15], s30 offen sc1
  v_mfma_f32_16x16x32_bf16 v[96:99], a[80:83], v[188:191], v[96:99]
  buffer_load_dwordx4 v248, s[8:11], s42 offen offset:2048 lds
  v_mfma_f32_16x16x32_bf16 v[100:103], a[84:87], v[188:191], v[100:103]
  v_mfma_f32_16x16x32_bf16 v[104:107], a[88:91], v[188:191], v[104:107]
  buffer_load_dwordx4 v249, s[8:11], s42 offen offset:3072 lds
  v_mfma_f32_16x16x32_bf16 v[108:111], a[92:95], v[188:191], v[108:111]
  s_waitcnt vmcnt(18) lgkmcnt(0)
  v_mfma_f32_16x16x32_bf16 v[32:35], a[96:99], v[112:115], v[32:35]
  s_waitcnt vmcnt(63)
  v_mfma_f32_16x16x32_bf16 v[36:39], a[100:103], v[112:115], v[36:39]
  s_add_u32 s30, s41, 7
  ds_read_b64_tr_b16 a[80:81], v7 offset:16384
  v_mfma_f32_16x16x32_bf16 v[40:43], a[104:107], v[112:115], v[40:43]
  s_lshl_b32 s30, s30, 10
  ds_read_b64_tr_b16 a[82:83], v7 offset:18432
  v_mfma_f32_16x16x32_bf16 v[44:47], a[108:111], v[112:115], v[44:47]
  s_and_b32 s30, s30, 0x7fff
  ds_read_b64_tr_b16 a[84:85], v8 offset:16384
  v_mfma_f32_16x16x32_bf16 v[48:51], a[96:99], v[116:119], v[48:51]
  buffer_load_dwordx4 v[172:175], v4, s[12:15], s30 offen sc1
  ds_read_b64_tr_b16 a[86:87], v8 offset:18432
  v_mfma_f32_16x16x32_bf16 v[52:55], a[100:103], v[116:119], v[52:55]
  ds_read_b64_tr_b16 a[88:89], v9 offset:16384
  v_mfma_f32_16x16x32_bf16 v[56:59], a[104:107], v[116:119], v[56:59]
  s_add_u32 s42, s41, 31
  buffer_load_dwordx4 v[176:179], v5, s[12:15], s30 offen sc1
  ds_read_b64_tr_b16 a[90:91], v9 offset:18432
  v_mfma_f32_16x16x32_bf16 v[60:63], a[108:111], v[116:119], v[60:63]
  s_and_b32 s42, s42, 31
  ds_read_b64_tr_b16 a[92:93], v10 offset:16384
  v_mfma_f32_16x16x32_bf16 v[64:67], a[96:99], v[120:123], v[64:67]
  s_mul_i32 s42, s42, 40960
  ds_read_b64_tr_b16 a[94:95], v10 offset:18432
  v_mfma_f32_16x16x32_bf16 v[68:71], a[100:103], v[120:123], v[68:71]
  s_add_u32 m0, s40, 65536
  buffer_load_dwordx4 v[180:183], v13, s[12:15], s30 offen sc1
  v_mfma_f32_16x16x32_bf16 v[72:75], a[104:107], v[120:123], v[72:75]
  buffer_load_dwordx4 v246, s[8:11], s42 offen lds
  v_mfma_f32_16x16x32_bf16 v[76:79], a[108:111], v[120:123], v[76:79]
  v_mfma_f32_16x16x32_bf16 v[80:83], a[96:99], v[124:127], v[80:83]
  buffer_load_dwordx4 v[184:187], v14, s[12:15], s30 offen sc1
  v_mfma_f32_16x16x32_bf16 v[84:87], a[100:103], v[124:127], v[84:87]
  buffer_load_dwordx4 v247, s[8:11], s42 offen offset:1024 lds
  v_mfma_f32_16x16x32_bf16 v[88:91], a[104:107], v[124:127], v[88:91]
  v_mfma_f32_16x16x32_bf16 v[92:95], a[108:111], v[124:127], v[92:95]
  buffer_load_dwordx4 v[188:191], v254, s[12:15], s30 offen sc1
  v_mfma_f32_16x16x32_bf16 v[96:99], a[96:99], v[128:131], v[96:99]
  buffer_load_dwordx4 v248, s[8:11], s42 offen offset:2048 lds
  v_mfma_f32_16x16x32_bf16 v[100:103], a[100:103], v[128:131], v[100:103]
  v_mfma_f32_16x16x32_bf16 v[104:107], a[104:107], v[128:131], v[104:107]
  buffer_load_dwordx4 v249, s[8:11], s42 offen offset:3072 lds
  v_mfma_f32_16x16x32_bf16 v[108:111], a[108:111], v[128:131], v[108:111]
  s_waitcnt vmcnt(20) lgkmcnt(0)
  v_mfma_f32_16x16x32_bf16 v[32:35], a[112:115], v[132:135], v[32:35]
  s_waitcnt vmcnt(63)
  v_mfma_f32_16x16x32_bf16 v[36:39], a[116:119], v[132:135], v[36:39]
  s_add_u32 s30, s41, 8
  ds_read_b64_tr_b16 a[96:97], v28 offset:16384
  v_mfma_f32_16x16x32_bf16 v[40:43], a[120:123], v[132:135], v[40:43]
  s_lshl_b32 s30, s30, 10
  ds_read_b64_tr_b16 a[98:99], v28 offset:18432
  v_mfma_f32_16x16x32_bf16 v[44:47], a[124:127], v[132:135], v[44:47]
  s_and_b32 s30, s30, 0x7fff
  ds_read_b64_tr_b16 a[100:101], v29 offset:16384
  v_mfma_f32_16x16x32_bf16 v[48:51], a[112:115], v[136:139], v[48:51]
  buffer_load_dwordx4 v[112:115], v4, s[12:15], s30 offen sc1
  ds_read_b64_tr_b16 a[102:103], v29 offset:18432
  v_mfma_f32_16x16x32_bf16 v[52:55], a[116:119], v[136:139], v[52:55]
  ds_read_b64_tr_b16 a[104:105], v30 offset:16384
  v_mfma_f32_16x16x32_bf16 v[56:59], a[120:123], v[136:139], v[56:59]
  buffer_load_dwordx4 v[116:119], v5, s[12:15], s30 offen sc1
  ds_read_b64_tr_b16 a[106:107], v30 offset:18432
  v_mfma_f32_16x16x32_bf16 v[60:63], a[124:127], v[136:139], v[60:63]
  ds_read_b64_tr_b16 a[108:109], v31 offset:16384
  v_mfma_f32_16x16x32_bf16 v[64:67], a[112:115], v[140:143], v[64:67]
  ds_read_b64_tr_b16 a[110:111], v31 offset:18432
  v_mfma_f32_16x16x32_bf16 v[68:71], a[116:119], v[140:143], v[68:71]
  buffer_load_dwordx4 v[120:123], v13, s[12:15], s30 offen sc1
  v_mfma_f32_16x16x32_bf16 v[72:75], a[120:123], v[140:143], v[72:75]
  v_mfma_f32_16x16x32_bf16 v[76:79], a[124:127], v[140:143], v[76:79]
  v_mfma_f32_16x16x32_bf16 v[80:83], a[112:115], v[144:147], v[80:83]
  buffer_load_dwordx4 v[124:127], v14, s[12:15], s30 offen sc1
  v_mfma_f32_16x16x32_bf16 v[84:87], a[116:119], v[144:147], v[84:87]
  v_mfma_f32_16x16x32_bf16 v[88:91], a[120:123], v[144:147], v[88:91]
  v_mfma_f32_16x16x32_bf16 v[92:95], a[124:127], v[144:147], v[92:95]
  buffer_load_dwordx4 v[128:131], v254, s[12:15], s30 offen sc1
  v_mfma_f32_16x16x32_bf16 v[96:99], a[112:115], v[148:151], v[96:99]
  v_mfma_f32_16x16x32_bf16 v[100:103], a[116:119], v[148:151], v[100:103]
  v_mfma_f32_16x16x32_bf16 v[104:107], a[120:123], v[148:151], v[104:107]
  v_mfma_f32_16x16x32_bf16 v[108:111], a[124:127], v[148:151], v[108:111]
  s_waitcnt vmcnt(16) lgkmcnt(0)
  v_mfma_f32_16x16x32_bf16 v[32:35], a[128:131], v[152:155], v[32:35]
  s_waitcnt vmcnt(63)
  v_mfma_f32_16x16x32_bf16 v[36:39], a[132:135], v[152:155], v[36:39]
  s_add_u32 s30, s41, 9
  ds_read_b64_tr_b16 a[112:113], v28 offset:32768
  v_mfma_f32_16x16x32_bf16 v[40:43], a[136:139], v[152:155], v[40:43]
  s_lshl_b32 s30, s30, 10
  ds_read_b64_tr_b16 a[114:115], v28 offset:34816
  v_mfma_f32_16x16x32_bf16 v[44:47], a[140:143], v[152:155], v[44:47]
  s_and_b32 s30, s30, 0x7fff
  ds_read_b64_tr_b16 a[116:117], v29 offset:32768
  v_mfma_f32_16x16x32_bf16 v[48:51], a[128:131], v[156:159], v[48:51]
  buffer_load_dwordx4 v[132:135], v4, s[12:15], s30 offen sc1
  ds_read_b64_tr_b16 a[118:119], v29 offset:34816
  v_mfma_f32_16x16x32_bf16 v[52:55], a[132:135], v[156:159], v[52:55]
  ds_read_b64_tr_b16 a[120:121], v30 offset:32768
  v_mfma_f32_16x16x32_bf16 v[56:59], a[136:139], v[156:159], v[56:59]
  buffer_load_dwordx4 v[136:139], v5, s[12:15], s30 offen sc1
  ds_read_b64_tr_b16 a[122:123], v30 offset:34816
  v_mfma_f32_16x16x32_bf16 v[60:63], a[140:143], v[156:159], v[60:63]
  ds_read_b64_tr_b16 a[124:125], v31 offset:32768
  v_mfma_f32_16x16x32_bf16 v[64:67], a[128:131], v[160:163], v[64:67]
  ds_read_b64_tr_b16 a[126:127], v31 offset:34816
  v_mfma_f32_16x16x32_bf16 v[68:71], a[132:135], v[160:163], v[68:71]
  buffer_load_dwordx4 v[140:143], v13, s[12:15], s30 offen sc1
  v_mfma_f32_16x16x32_bf16 v[72:75], a[136:139], v[160:163], v[72:75]
  v_mfma_f32_16x16x32_bf16 v[76:79], a[140:143], v[160:163], v[76:79]
  v_mfma_f32_16x16x32_bf16 v[80:83], a[128:131], v[164:167], v[80:83]
  buffer_load_dwordx4 v[144:147], v14, s[12:15], s30 offen sc1
  v_mfma_f32_16x16x32_bf16 v[84:87], a[132:135], v[164:167], v[84:87]
  v_mfma_f32_16x16x32_bf16 v[88:91], a[136:139], v[164:167], v[88:91]
  v_mfma_f32_16x16x32_bf16 v[92:95], a[140:143], v[164:167], v[92:95]
  buffer_load_dwordx4 v[148:151], v254, s[12:15], s30 offen sc1
  v_mfma_f32_16x16x32_bf16 v[96:99], a[128:131], v[168:171], v[96:99]
  v_mfma_f32_16x16x32_bf16 v[100:103], a[132:135], v[168:171], v[100:103]
  v_mfma_f32_16x16x32_bf16 v[104:107], a[136:139], v[168:171], v[104:107]
  v_mfma_f32_16x16x32_bf16 v[108:111], a[140:143], v[168:171], v[108:111]
  s_waitcnt vmcnt(12) lgkmcnt(0)
  v_mfma_f32_16x16x32_bf16 v[32:35], a[144:147], v[172:175], v[32:35]
  s_waitcnt vmcnt(63)
  v_mfma_f32_16x16x32_bf16 v[36:39], a[148:151], v[172:175], v[36:39]
  s_add_u32 s30, s41, 10
  ds_read_b64_tr_b16 a[128:129], v7 offset:0
  v_mfma_f32_16x16x32_bf16 v[40:43], a[152:155], v[172:175], v[40:43]
  s_lshl_b32 s30, s30, 10
  ds_read_b64_tr_b16 a[130:131], v7 offset:2048
  v_mfma_f32_16x16x32_bf16 v[44:47], a[156:159], v[172:175], v[44:47]
  s_and_b32 s30, s30, 0x7fff
  ds_read_b64_tr_b16 a[132:133], v8 offset:0
  v_mfma_f32_16x16x32_bf16 v[48:51], a[144:147], v[176:179], v[48:51]
  buffer_load_dwordx4 v[152:155], v4, s[12:15], s30 offen sc1
  ds_read_b64_tr_b16 a[134:135], v8 offset:2048
  v_mfma_f32_16x16x32_bf16 v[52:55], a[148:151], v[176:179], v[52:55]
  ds_read_b64_tr_b16 a[136:137], v9 offset:0
  v_mfma_f32_16x16x32_bf16 v[56:59], a[152:155], v[176:179], v[56:59]
  buffer_load_dwordx4 v[156:159], v5, s[12:15], s30 offen sc1
  ds_read_b64_tr_b16 a[138:139], v9 offset:2048
  v_mfma_f32_16x16x32_bf16 v[60:63], a[156:159], v[176:179], v[60:63]
  ds_read_b64_tr_b16 a[140:141], v10 offset:0
  v_mfma_f32_16x16x32_bf16 v[64:67], a[144:147], v[180:183], v[64:67]
  ds_read_b64_tr_b16 a[142:143], v10 offset:2048
  v_mfma_f32_16x16x32_bf16 v[68:71], a[148:151], v[180:183], v[68:71]
  buffer_load_dwordx4 v[160:163], v13, s[12:15], s30 offen sc1
  v_mfma_f32_16x16x32_bf16 v[72:75], a[152:155], v[180:183], v[72:75]
  v_mfma_f32_16x16x32_bf16 v[76:79], a[156:159], v[180:183], v[76:79]
  v_mfma_f32_16x16x32_bf16 v[80:83], a[144:147], v[184:187], v[80:83]
  buffer_load_dwordx4 v[164:167], v14, s[12:15], s30 offen sc1
  v_mfma_f32_16x16x32_bf16 v[84:87], a[148:151], v[184:187], v[84:87]
  v_mfma_f32_16x16x32_bf16 v[88:91], a[152:155], v[184:187], v[88:91]
  v_mfma_f32_16x16x32_bf16 v[92:95], a[156:159], v[184:187], v[92:95]
  buffer_load_dwordx4 v[168:171], v254, s[12:15], s30 offen sc1
  v_mfma_f32_16x16x32_bf16 v[96:99], a[144:147], v[188:191], v[96:99]
  v_mfma_f32_16x16x32_bf16 v[100:103], a[148:151], v[188:191], v[100:103]
  v_mfma_f32_16x16x32_bf16 v[104:107], a[152:155], v[188:191], v[104:107]
  v_mfma_f32_16x16x32_bf16 v[108:111], a[156:159], v[188:191], v[108:111]
  s_waitcnt vmcnt(10) lgkmcnt(0)
  v_mfma_f32_16x16x32_bf16 v[32:35], a[160:163], v[112:115], v[32:35]
  s_waitcnt vmcnt(63)
  v_mfma_f32_16x16x32_bf16 v[36:39], a[164:167], v[112:115], v[36:39]
  s_add_u32 s30, s41, 11
  ds_read_b64_tr_b16 a[144:145], v250 offset:16384
  v_mfma_f32_16x16x32_bf16 v[40:43], a[168:171], v[112:115], v[40:43]
  s_lshl_b32 s30, s30, 10
  ds_read_b64_tr_b16 a[146:147], v250 offset:18432
  v_mfma_f32_16x16x32_bf16 v[44:47], a[172:175], v[112:115], v[44:47]
  s_and_b32 s30, s30, 0x7fff
  ds_read_b64_tr_b16 a[148:149], v251 offset:16384
  v_mfma_f32_16x16x32_bf16 v[48:51], a[160:163], v[116:119], v[48:51]
  buffer_load_dwordx4 v[172:175], v4, s[12:15], s30 offen sc1
  ds_read_b64_tr_b16 a[150:151], v251 offset:18432
  v_mfma_f32_16x16x32_bf16 v[52:55], a[164:167], v[116:119], v[52:55]
  ds_read_b64_tr_b16 a[152:153], v252 offset:16384
  v_mfma_f32_16x16x32_bf16 v[56:59], a[168:171], v[116:119], v[56:59]
  buffer_load_dwordx4 v[176:179], v5, s[12:15], s30 offen sc1
  ds_read_b64_tr_b16 a[154:155], v252 offset:18432
  v_mfma_f32_16x16x32_bf16 v[60:63], a[172:175], v[116:119], v[60:63]
  ds_read_b64_tr_b16 a[156:157], v253 offset:16384
  v_mfma_f32_16x16x32_bf16 v[64:67], a[160:163], v[120:123], v[64:67]
  ds_read_b64_tr_b16 a[158:159], v253 offset:18432
  v_mfma_f32_16x16x32_bf16 v[68:71], a[164:167], v[120:123], v[68:71]
  buffer_load_dwordx4 v[180:183], v13, s[12:15], s30 offen sc1
  v_mfma_f32_16x16x32_bf16 v[72:75], a[168:171], v[120:123], v[72:75]
  v_mfma_f32_16x16x32_bf16 v[76:79], a[172:175], v[120:123], v[76:79]
  v_mfma_f32_16x16x32_bf16 v[80:83], a[160:163], v[124:127], v[80:83]
  buffer_load_dwordx4 v[184:187], v14, s[12:15], s30 offen sc1
  v_mfma_f32_16x16x32_bf16 v[84:87], a[164:167], v[124:127], v[84:87]
  v_mfma_f32_16x16x32_bf16 v[88:91], a[168:171], v[124:127], v[88:91]
  v_mfma_f32_16x16x32_bf16 v[92:95], a[172:175], v[124:127], v[92:95]
  buffer_load_dwordx4 v[188:191], v254, s[12:15], s30 offen sc1
  v_mfma_f32_16x16x32_bf16 v[96:99], a[160:163], v[128:131], v[96:99]
  v_mfma_f32_16x16x32_bf16 v[100:103], a[164:167], v[128:131], v[100:103]
  v_mfma_f32_16x16x32_bf16 v[104:107], a[168:171], v[128:131], v[104:107]
  v_mfma_f32_16x16x32_bf16 v[108:111], a[172:175], v[128:131], v[108:111]
  s_waitcnt vmcnt(10) lgkmcnt(0)
  v_mfma_f32_16x16x32_bf16 v[32:35], a[176:179], v[132:135], v[32:35]
  s_waitcnt vmcnt(63)
  v_mfma_f32_16x16x32_bf16 v[36:39], a[180:183], v[132:135], v[36:39]
  s_add_u32 s30, s41, 12
  ds_read_b64_tr_b16 a[160:161], v250 offset:32768
  v_mfma_f32_16x16x32_bf16 v[40:43], a[184:187], v[132:135], v[40:43]
  s_lshl_b32 s30, s30, 10
  ds_read_b64_tr_b16 a[162:163], v250 offset:34816
  v_mfma_f32_16x16x32_bf16 v[44:47], a[188:191], v[132:135], v[44:47]
  s_and_b32 s30, s30, 0x7fff
  ds_read_b64_tr_b16 a[164:165], v251 offset:32768
  v_mfma_f32_16x16x32_bf16 v[48:51], a[176:179], v[136:139], v[48:51]
  buffer_load_dwordx4 v[112:115], v4, s[12:15], s30 offen sc1
  ds_read_b64_tr_b16 a[166:167], v251 offset:34816
  v_mfma_f32_16x16x32_bf16 v[52:55], a[180:183], v[136:139], v[52:55]
  ds_read_b64_tr_b16 a[168:169], v252 offset:32768
  v_mfma_f32_16x16x32_bf16 v[56:59], a[184:187], v[136:139], v[56:59]
  buffer_load_dwordx4 v[116:119], v5, s[12:15], s30 offen sc1
  ds_read_b64_tr_b16 a[170:171], v252 offset:34816
  v_mfma_f32_16x16x32_bf16 v[60:63], a[188:191], v[136:139], v[60:63]
  ds_read_b64_tr_b16 a[172:173], v253 offset:32768
  v_mfma_f32_16x16x32_bf16 v[64:67], a[176:179], v[140:143], v[64:67]
  ds_read_b64_tr_b16 a[174:175], v253 offset:34816
  v_mfma_f32_16x16x32_bf16 v[68:71], a[180:183], v[140:143], v[68:71]
  buffer_load_dwordx4 v[120:123], v13, s[12:15], s30 offen sc1
  v_mfma_f32_16x16x32_bf16 v[72:75], a[184:187], v[140:143], v[72:75]
  v_mfma_f32_16x16x32_bf16 v[76:79], a[188:191], v[140:143], v[76:79]
  v_mfma_f32_16x16x32_bf16 v[80:83], a[176:179], v[144:147], v[80:83]
  buffer_load_dwordx4 v[124:127], v14, s[12:15], s30 offen sc1
  v_mfma_f32_16x16x32_bf16 v[84:87], a[180:183], v[144:147], v[84:87]
  v_mfma_f32_16x16x32_bf16 v[88:91], a[184:187], v[144:147], v[88:91]
  v_mfma_f32_16x16x32_bf16 v[92:95], a[188:191], v[144:147], v[92:95]
  buffer_load_dwordx4 v[128:131], v254, s[12:15], s30 offen sc1
  v_mfma_f32_16x16x32_bf16 v[96:99], a[176:179], v[148:151], v[96:99]
  v_mfma_f32_16x16x32_bf16 v[100:103], a[180:183], v[148:151], v[100:103]
  v_mfma_f32_16x16x32_bf16 v[104:107], a[184:187], v[148:151], v[104:107]
  v_mfma_f32_16x16x32_bf16 v[108:111], a[188:191], v[148:151], v[108:111]
  s_waitcnt vmcnt(10) lgkmcnt(0)
  v_mfma_f32_16x16x32_bf16 v[32:35], a[208:211], v[152:155], v[32:35]
  s_waitcnt vmcnt(63)
  v_mfma_f32_16x16x32_bf16 v[36:39], a[212:215], v[152:155], v[36:39]
  s_add_u32 s30, s41, 13
  ds_read_b64_tr_b16 a[176:177], v28 offset:49152
  v_mfma_f32_16x16x32_bf16 v[40:43], a[216:219], v[152:155], v[40:43]
  s_lshl_b32 s30, s30, 10
  ds_read_b64_tr_b16 a[178:179], v28 offset:51200
  v_mfma_f32_16x16x32_bf16 v[44:47], a[220:223], v[152:155], v[44:47]
  s_and_b32 s30, s30, 0x7fff
  ds_read_b64_tr_b16 a[180:181], v29 offset:49152
  v_mfma_f32_16x16x32_bf16 v[48:51], a[208:211], v[156:159], v[48:51]
  buffer_load_dwordx4 v[132:135], v4, s[12:15], s30 offen sc1
  ds_read_b64_tr_b16 a[182:183], v29 offset:51200
  v_mfma_f32_16x16x32_bf16 v[52:55], a[212:215], v[156:159], v[52:55]
  ds_read_b64_tr_b16 a[184:185], v30 offset:49152
  v_mfma_f32_16x16x32_bf16 v[56:59], a[216:219], v[156:159], v[56:59]
  buffer_load_dwordx4 v[136:139], v5, s[12:15], s30 offen sc1
  ds_read_b64_tr_b16 a[186:187], v30 offset:51200
  v_mfma_f32_16x16x32_bf16 v[60:63], a[220:223], v[156:159], v[60:63]
  ds_read_b64_tr_b16 a[188:189], v31 offset:49152
  v_mfma_f32_16x16x32_bf16 v[64:67], a[208:211], v[160:163], v[64:67]
  ds_read_b64_tr_b16 a[190:191], v31 offset:51200
  v_mfma_f32_16x16x32_bf16 v[68:71], a[212:215], v[160:163], v[68:71]
  buffer_load_dwordx4 v[140:143], v13, s[12:15], s30 offen sc1
  v_mfma_f32_16x16x32_bf16 v[72:75], a[216:219], v[160:163], v[72:75]
  v_mfma_f32_16x16x32_bf16 v[76:79], a[220:223], v[160:163], v[76:79]
  v_mfma_f32_16x16x32_bf16 v[80:83], a[208:211], v[164:167], v[80:83]
  buffer_load_dwordx4 v[144:147], v14, s[12:15], s30 offen sc1
  v_mfma_f32_16x16x32_bf16 v[84:87], a[212:215], v[164:167], v[84:87]
  v_mfma_f32_16x16x32_bf16 v[88:91], a[216:219], v[164:167], v[88:91]
  v_mfma_f32_16x16x32_bf16 v[92:95], a[220:223], v[164:167], v[92:95]
  buffer_load_dwordx4 v[148:151], v254, s[12:15], s30 offen sc1
  v_mfma_f32_16x16x32_bf16 v[96:99], a[208:211], v[168:171], v[96:99]
  v_mfma_f32_16x16x32_bf16 v[100:103], a[212:215], v[168:171], v[100:103]
  v_mfma_f32_16x16x32_bf16 v[104:107], a[216:219], v[168:171], v[104:107]
  v_mfma_f32_16x16x32_bf16 v[108:111], a[220:223], v[168:171], v[108:111]
  s_waitcnt vmcnt(10) lgkmcnt(0)
  v_mfma_f32_16x16x32_bf16 v[32:35], a[192:195], v[172:175], v[32:35]
  s_waitcnt vmcnt(48)
  v_mfma_f32_16x16x32_bf16 v[36:39], a[196:199], v[172:175], v[36:39]
  s_add_u32 s30, s41, 14
  ds_read_b64_tr_b16 a[208:209], v250 offset:49152
  v_mfma_f32_16x16x32_bf16 v[40:43], a[200:203], v[172:175], v[40:43]
  s_lshl_b32 s30, s30, 10
  ds_read_b64_tr_b16 a[210:211], v250 offset:51200
  v_mfma_f32_16x16x32_bf16 v[44:47], a[204:207], v[172:175], v[44:47]
  s_and_b32 s30, s30, 0x7fff
  ds_read_b64_tr_b16 a[212:213], v251 offset:49152
  v_mfma_f32_16x16x32_bf16 v[48:51], a[192:195], v[176:179], v[48:51]
  buffer_load_dwordx4 v[152:155], v4, s[12:15], s30 offen sc1
  ds_read_b64_tr_b16 a[214:215], v251 offset:51200
  v_mfma_f32_16x16x32_bf16 v[52:55], a[196:199], v[176:179], v[52:55]
  ds_read_b64_tr_b16 a[216:217], v252 offset:49152
  v_mfma_f32_16x16x32_bf16 v[56:59], a[200:203], v[176:179], v[56:59]
  buffer_load_dwordx4 v[156:159], v5, s[12:15], s30 offen sc1
  ds_read_b64_tr_b16 a[218:219], v252 offset:51200
  v_mfma_f32_16x16x32_bf16 v[60:63], a[204:207], v[176:179], v[60:63]
  ds_read_b64_tr_b16 a[220:221], v253 offset:49152
  v_mfma_f32_16x16x32_bf16 v[64:67], a[192:195], v[180:183], v[64:67]
  ds_read_b64_tr_b16 a[222:223], v253 offset:51200
  v_mfma_f32_16x16x32_bf16 v[68:71], a[196:199], v[180:183], v[68:71]
  buffer_load_dwordx4 v[160:163], v13, s[12:15], s30 offen sc1
  v_mfma_f32_16x16x32_bf16 v[72:75], a[200:203], v[180:183], v[72:75]
  v_mfma_f32_16x16x32_bf16 v[76:79], a[204:207], v[180:183], v[76:79]
  v_mfma_f32_16x16x32_bf16 v[80:83], a[192:195], v[184:187], v[80:83]
  buffer_load_dwordx4 v[164:167], v14, s[12:15], s30 offen sc1
  v_mfma_f32_16x16x32_bf16 v[84:87], a[196:199], v[184:187], v[84:87]
  v_mfma_f32_16x16x32_bf16 v[88:91], a[200:203], v[184:187], v[88:91]
  v_mfma_f32_16x16x32_bf16 v[92:95], a[204:207], v[184:187], v[92:95]
  buffer_load_dwordx4 v[168:171], v254, s[12:15], s30 offen sc1
  v_mfma_f32_16x16x32_bf16 v[96:99], a[192:195], v[188:191], v[96:99]
  v_mfma_f32_16x16x32_bf16 v[100:103], a[196:199], v[188:191], v[100:103]
  v_mfma_f32_16x16x32_bf16 v[104:107], a[200:203], v[188:191], v[104:107]
  v_mfma_f32_16x16x32_bf16 v[108:111], a[204:207], v[188:191], v[108:111]
  s_waitcnt vmcnt(10) lgkmcnt(0)
  v_mfma_f32_16x16x32_bf16 v[32:35], a[0:3], v[112:115], v[32:35]
  s_waitcnt vmcnt(44)
  v_mfma_f32_16x16x32_bf16 v[36:39], a[4:7], v[112:115], v[36:39]
  s_add_u32 s30, s41, 15
  ds_read_b64_tr_b16 a[192:193], v28 offset:0
  v_mfma_f32_16x16x32_bf16 v[40:43], a[8:11], v[112:115], v[40:43]
  s_lshl_b32 s30, s30, 10
  ds_read_b64_tr_b16 a[194:195], v28 offset:2048
  v_mfma_f32_16x16x32_bf16 v[44:47], a[12:15], v[112:115], v[44:47]
  s_and_b32 s30, s30, 0x7fff
  ds_read_b64_tr_b16 a[196:197], v29 offset:0
  v_mfma_f32_16x16x32_bf16 v[48:51], a[0:3], v[116:119], v[48:51]
  buffer_load_dwordx4 v[172:175], v4, s[12:15], s30 offen sc1
  ds_read_b64_tr_b16 a[198:199], v29 offset:2048
  v_mfma_f32_16x16x32_bf16 v[52:55], a[4:7], v[116:119], v[52:55]
  ds_read_b64_tr_b16 a[200:201], v30 offset:0
  v_mfma_f32_16x16x32_bf16 v[56:59], a[8:11], v[116:119], v[56:59]
  buffer_load_dwordx4 v[176:179], v5, s[12:15], s30 offen sc1
  ds_read_b64_tr_b16 a[202:203], v30 offset:2048
  v_mfma_f32_16x16x32_bf16 v[60:63], a[12:15], v[116:119], v[60:63]
  ds_read_b64_tr_b16 a[204:205], v31 offset:0
  v_mfma_f32_16x16x32_bf16 v[64:67], a[0:3], v[120:123], v[64:67]
  ds_read_b64_tr_b16 a[206:207], v31 offset:2048
  v_mfma_f32_16x16x32_bf16 v[68:71], a[4:7], v[120:123], v[68:71]
  buffer_load_dwordx4 v[180:183], v13, s[12:15], s30 offen sc1
  v_mfma_f32_16x16x32_bf16 v[72:75], a[8:11], v[120:123], v[72:75]
  v_mfma_f32_16x16x32_bf16 v[76:79], a[12:15], v[120:123], v[76:79]
  v_mfma_f32_16x16x32_bf16 v[80:83], a[0:3], v[124:127], v[80:83]
  buffer_load_dwordx4 v[184:187], v14, s[12:15], s30 offen sc1
  v_mfma_f32_16x16x32_bf16 v[84:87], a[4:7], v[124:127], v[84:87]
  v_mfma_f32_16x16x32_bf16 v[88:91], a[8:11], v[124:127], v[88:91]
  v_mfma_f32_16x16x32_bf16 v[92:95], a[12:15], v[124:127], v[92:95]
  buffer_load_dwordx4 v[188:191], v254, s[12:15], s30 offen sc1
  v_mfma_f32_16x16x32_bf16 v[96:99], a[0:3], v[128:131], v[96:99]
  v_mfma_f32_16x16x32_bf16 v[100:103], a[4:7], v[128:131], v[100:103]
  v_mfma_f32_16x16x32_bf16 v[104:107], a[8:11], v[128:131], v[104:107]
  v_mfma_f32_16x16x32_bf16 v[108:111], a[12:15], v[128:131], v[108:111]
  s_waitcnt vmcnt(10) lgkmcnt(0)
  v_mfma_f32_16x16x32_bf16 v[32:35], a[16:19], v[132:135], v[32:35]
  s_waitcnt vmcnt(40)
  v_mfma_f32_16x16x32_bf16 v[36:39], a[20:23], v[132:135], v[36:39]
  s_add_u32 s30, s41, 16
  ds_read_b64_tr_b16 a[0:1], v250 offset:0
  v_mfma_f32_16x16x32_bf16 v[40:43], a[24:27], v[132:135], v[40:43]
  s_lshl_b32 s30, s30, 10
  ds_read_b64_tr_b16 a[2:3], v250 offset:2048
  v_mfma_f32_16x16x32_bf16 v[44:47], a[28:31], v[132:135], v[44:47]
  s_and_b32 s30, s30, 0x7fff
  ds_read_b64_tr_b16 a[4:5], v251 offset:0
  v_mfma_f32_16x16x32_bf16 v[48:51], a[16:19], v[136:139], v[48:51]
  buffer_load_dwordx4 v[112:115], v4, s[12:15], s30 offen sc1
  ds_read_b64_tr_b16 a[6:7], v251 offset:2048
  v_mfma_f32_16x16x32_bf16 v[52:55], a[20:23], v[136:139], v[52:55]
  ds_read_b64_tr_b16 a[8:9], v252 offset:0
  v_mfma_f32_16x16x32_bf16 v[56:59], a[24:27], v[136:139], v[56:59]
  buffer_load_dwordx4 v[116:119], v5, s[12:15], s30 offen sc1
  ds_read_b64_tr_b16 a[10:11], v252 offset:2048
  v_mfma_f32_16x16x32_bf16 v[60:63], a[28:31], v[136:139], v[60:63]
  ds_read_b64_tr_b16 a[12:13], v253 offset:0
  v_mfma_f32_16x16x32_bf16 v[64:67], a[16:19], v[140:143], v[64:67]
  ds_read_b64_tr_b16 a[14:15], v253 offset:2048
  v_mfma_f32_16x16x32_bf16 v[68:71], a[20:23], v[140:143], v[68:71]
  buffer_load_dwordx4 v[120:123], v13, s[12:15], s30 offen sc1
  v_mfma_f32_16x16x32_bf16 v[72:75], a[24:27], v[140:143], v[72:75]
  v_mfma_f32_16x16x32_bf16 v[76:79], a[28:31], v[140:143], v[76:79]
  v_mfma_f32_16x16x32_bf16 v[80:83], a[16:19], v[144:147], v[80:83]
  buffer_load_dwordx4 v[124:127], v14, s[12:15], s30 offen sc1
  v_mfma_f32_16x16x32_bf16 v[84:87], a[20:23], v[144:147], v[84:87]
  v_mfma_f32_16x16x32_bf16 v[88:91], a[24:27], v[144:147], v[88:91]
  v_mfma_f32_16x16x32_bf16 v[92:95], a[28:31], v[144:147], v[92:95]
  buffer_load_dwordx4 v[128:131], v254, s[12:15], s30 offen sc1
  v_mfma_f32_16x16x32_bf16 v[96:99], a[16:19], v[148:151], v[96:99]
  v_mfma_f32_16x16x32_bf16 v[100:103], a[20:23], v[148:151], v[100:103]
  v_mfma_f32_16x16x32_bf16 v[104:107], a[24:27], v[148:151], v[104:107]
  v_mfma_f32_16x16x32_bf16 v[108:111], a[28:31], v[148:151], v[108:111]
  s_waitcnt vmcnt(10) lgkmcnt(0)
  v_mfma_f32_16x16x32_bf16 v[32:35], a[32:35], v[152:155], v[32:35]
  v_mfma_f32_16x16x32_bf16 v[36:39], a[36:39], v[152:155], v[36:39]
  s_add_u32 s30, s41, 17
  v_mfma_f32_16x16x32_bf16 v[40:43], a[40:43], v[152:155], v[40:43]
  s_lshl_b32 s30, s30, 10
  v_mfma_f32_16x16x32_bf16 v[44:47], a[44:47], v[152:155], v[44:47]
  s_and_b32 s30, s30, 0x7fff
  v_mfma_f32_16x16x32_bf16 v[48:51], a[32:35], v[156:159], v[48:51]
  buffer_load_dwordx4 v[132:135], v4, s[12:15], s30 offen sc1
  v_mfma_f32_16x16x32_bf16 v[52:55], a[36:39], v[156:159], v[52:55]
  v_mfma_f32_16x16x32_bf16 v[56:59], a[40:43], v[156:159], v[56:59]
  buffer_load_dwordx4 v[136:139], v5, s[12:15], s30 offen sc1
  v_mfma_f32_16x16x32_bf16 v[60:63], a[44:47], v[156:159], v[60:63]
  v_mfma_f32_16x16x32_bf16 v[64:67], a[32:35], v[160:163], v[64:67]
  v_mfma_f32_16x16x32_bf16 v[68:71], a[36:39], v[160:163], v[68:71]
  buffer_load_dwordx4 v[140:143], v13, s[12:15], s30 offen sc1
  v_mfma_f32_16x16x32_bf16 v[72:75], a[40:43], v[160:163], v[72:75]
  v_mfma_f32_16x16x32_bf16 v[76:79], a[44:47], v[160:163], v[76:79]
  v_mfma_f32_16x16x32_bf16 v[80:83], a[32:35], v[164:167], v[80:83]
  buffer_load_dwordx4 v[144:147], v14, s[12:15], s30 offen sc1
  v_mfma_f32_16x16x32_bf16 v[84:87], a[36:39], v[164:167], v[84:87]
  v_mfma_f32_16x16x32_bf16 v[88:91], a[40:43], v[164:167], v[88:91]
  v_mfma_f32_16x16x32_bf16 v[92:95], a[44:47], v[164:167], v[92:95]
  buffer_load_dwordx4 v[148:151], v254, s[12:15], s30 offen sc1
  v_mfma_f32_16x16x32_bf16 v[96:99], a[32:35], v[168:171], v[96:99]
  v_mfma_f32_16x16x32_bf16 v[100:103], a[36:39], v[168:171], v[100:103]
  v_mfma_f32_16x16x32_bf16 v[104:107], a[40:43], v[168:171], v[104:107]
  v_mfma_f32_16x16x32_bf16 v[108:111], a[44:47], v[168:171], v[108:111]
  s_waitcnt vmcnt(10) lgkmcnt(0)
  v_mfma_f32_16x16x32_bf16 v[32:35], a[48:51], v[172:175], v[32:35]
  v_mfma_f32_16x16x32_bf16 v[36:39], a[52:55], v[172:175], v[36:39]
  s_add_u32 s30, s41, 18
  v_mfma_f32_16x16x32_bf16 v[40:43], a[56:59], v[172:175], v[40:43]
  s_lshl_b32 s30, s30, 10
  v_mfma_f32_16x16x32_bf16 v[44:47], a[60:63], v[172:175], v[44:47]
  s_and_b32 s30, s30, 0x7fff
  v_mfma_f32_16x16x32_bf16 v[48:51], a[48:51], v[176:179], v[48:51]
  buffer_load_dwordx4 v[152:155], v4, s[12:15], s30 offen sc1
  v_mfma_f32_16x16x32_bf16 v[52:55], a[52:55], v[176:179], v[52:55]
  v_mfma_f32_16x16x32_bf16 v[56:59], a[56:59], v[176:179], v[56:59]
  buffer_load_dwordx4 v[156:159], v5, s[12:15], s30 offen sc1
  v_mfma_f32_16x16x32_bf16 v[60:63], a[60:63], v[176:179], v[60:63]
  v_mfma_f32_16x16x32_bf16 v[64:67], a[48:51], v[180:183], v[64:67]
  v_mfma_f32_16x16x32_bf16 v[68:71], a[52:55], v[180:183], v[68:71]
  buffer_load_dwordx4 v[160:163], v13, s[12:15], s30 offen sc1
  v_mfma_f32_16x16x32_bf16 v[72:75], a[56:59], v[180:183], v[72:75]
  v_mfma_f32_16x16x32_bf16 v[76:79], a[60:63], v[180:183], v[76:79]
  v_mfma_f32_16x16x32_bf16 v[80:83], a[48:51], v[184:187], v[80:83]
  buffer_load_dwordx4 v[164:167], v14, s[12:15], s30 offen sc1
  v_mfma_f32_16x16x32_bf16 v[84:87], a[52:55], v[184:187], v[84:87]
  v_mfma_f32_16x16x32_bf16 v[88:91], a[56:59], v[184:187], v[88:91]
  v_mfma_f32_16x16x32_bf16 v[92:95], a[60:63], v[184:187], v[92:95]
  buffer_load_dwordx4 v[168:171], v254, s[12:15], s30 offen sc1
  v_mfma_f32_16x16x32_bf16 v[96:99], a[48:51], v[188:191], v[96:99]
  v_mfma_f32_16x16x32_bf16 v[100:103], a[52:55], v[188:191], v[100:103]
  v_mfma_f32_16x16x32_bf16 v[104:107], a[56:59], v[188:191], v[104:107]
  v_mfma_f32_16x16x32_bf16 v[108:111], a[60:63], v[188:191], v[108:111]
  s_waitcnt vmcnt(10) lgkmcnt(0)
  v_mfma_f32_16x16x32_bf16 v[32:35], v[224:227], v[112:115], v[32:35]
  v_mfma_f32_16x16x32_bf16 v[36:39], v[228:231], v[112:115], v[36:39]
  s_add_u32 s30, s41, 19
  v_mfma_f32_16x16x32_bf16 v[40:43], v[232:235], v[112:115], v[40:43]
  s_lshl_b32 s30, s30, 10
  v_mfma_f32_16x16x32_bf16 v[44:47], v[236:239], v[112:115], v[44:47]
  s_and_b32 s30, s30, 0x7fff
  v_mfma_f32_16x16x32_bf16 v[48:51], v[224:227], v[116:119], v[48:51]
  buffer_load_dwordx4 v[172:175], v4, s[12:15], s30 offen sc1
  v_mfma_f32_16x16x32_bf16 v[52:55], v[228:231], v[116:119], v[52:55]
  v_mfma_f32_16x16x32_bf16 v[56:59], v[232:235], v[116:119], v[56:59]
  buffer_load_dwordx4 v[176:179], v5, s[12:15], s30 offen sc1
  v_mfma_f32_16x16x32_bf16 v[60:63], v[236:239], v[116:119], v[60:63]
  v_mfma_f32_16x16x32_bf16 v[64:67], v[224:227], v[120:123], v[64:67]
  v_mfma_f32_16x16x32_bf16 v[68:71], v[228:231], v[120:123], v[68:71]
  buffer_load_dwordx4 v[180:183], v13, s[12:15], s30 offen sc1
  v_mfma_f32_16x16x32_bf16 v[72:75], v[232:235], v[120:123], v[72:75]
  v_mfma_f32_16x16x32_bf16 v[76:79], v[236:239], v[120:123], v[76:79]
  v_mfma_f32_16x16x32_bf16 v[80:83], v[224:227], v[124:127], v[80:83]
  buffer_load_dwordx4 v[184:187], v14, s[12:15], s30 offen sc1
  v_mfma_f32_16x16x32_bf16 v[84:87], v[228:231], v[124:127], v[84:87]
  v_mfma_f32_16x16x32_bf16 v[88:91], v[232:235], v[124:127], v[88:91]
  v_mfma_f32_16x16x32_bf16 v[92:95], v[236:239], v[124:127], v[92:95]
  buffer_load_dwordx4 v[188:191], v254, s[12:15], s30 offen sc1
  v_mfma_f32_16x16x32_bf16 v[96:99], v[224:227], v[128:131], v[96:99]
  v_mfma_f32_16x16x32_bf16 v[100:103], v[228:231], v[128:131], v[100:103]
  v_mfma_f32_16x16x32_bf16 v[104:107], v[232:235], v[128:131], v[104:107]
  v_mfma_f32_16x16x32_bf16 v[108:111], v[236:239], v[128:131], v[108:111]
  s_waitcnt vmcnt(10) lgkmcnt(0)
  v_mfma_f32_16x16x32_bf16 v[32:35], v[208:211], v[132:135], v[32:35]
  v_mfma_f32_16x16x32_bf16 v[36:39], v[212:215], v[132:135], v[36:39]
  s_add_u32 s30, s41, 20
  v_mfma_f32_16x16x32_bf16 v[40:43], v[216:219], v[132:135], v[40:43]
  s_lshl_b32 s30, s30, 10
  v_mfma_f32_16x16x32_bf16 v[44:47], v[220:223], v[132:135], v[44:47]
  s_and_b32 s30, s30, 0x7fff
  v_mfma_f32_16x16x32_bf16 v[48:51], v[208:211], v[136:139], v[48:51]
  buffer_load_dwordx4 v[112:115], v4, s[12:15], s30 offen sc1
  v_mfma_f32_16x16x32_bf16 v[52:55], v[212:215], v[136:139], v[52:55]
  v_mfma_f32_16x16x32_bf16 v[56:59], v[216:219], v[136:139], v[56:59]
  buffer_load_dwordx4 v[116:119], v5, s[12:15], s30 offen sc1
  v_mfma_f32_16x16x32_bf16 v[60:63], v[220:223], v[136:139], v[60:63]
  v_mfma_f32_16x16x32_bf16 v[64:67], v[208:211], v[140:143], v[64:67]
  v_mfma_f32_16x16x32_bf16 v[68:71], v[212:215], v[140:143], v[68:71]
  buffer_load_dwordx4 v[120:123], v13, s[12:15], s30 offen sc1
  v_mfma_f32_16x16x32_bf16 v[72:75], v[216:219], v[140:143], v[72:75]
  v_mfma_f32_16x16x32_bf16 v[76:79], v[220:223], v[140:143], v[76:79]
  v_mfma_f32_16x16x32_bf16 v[80:83], v[208:211], v[144:147], v[80:83]
  buffer_load_dwordx4 v[124:127], v14, s[12:15], s30 offen sc1
  v_mfma_f32_16x16x32_bf16 v[84:87], v[212:215], v[144:147], v[84:87]
  v_mfma_f32_16x16x32_bf16 v[88:91], v[216:219], v[144:147], v[88:91]
  v_mfma_f32_16x16x32_bf16 v[92:95], v[220:223], v[144:147], v[92:95]
  buffer_load_dwordx4 v[128:131], v254, s[12:15], s30 offen sc1
  v_mfma_f32_16x16x32_bf16 v[96:99], v[208:211], v[148:151], v[96:99]
  v_mfma_f32_16x16x32_bf16 v[100:103], v[212:215], v[148:151], v[100:103]
  v_mfma_f32_16x16x32_bf16 v[104:107], v[216:219], v[148:151], v[104:107]
  v_mfma_f32_16x16x32_bf16 v[108:111], v[220:223], v[148:151], v[108:111]
  s_waitcnt vmcnt(10) lgkmcnt(0)
  v_mfma_f32_16x16x32_bf16 v[32:35], v[192:195], v[152:155], v[32:35]
  v_mfma_f32_16x16x32_bf16 v[36:39], v[196:199], v[152:155], v[36:39]
  s_add_u32 s30, s41, 21
  v_mfma_f32_16x16x32_bf16 v[40:43], v[200:203], v[152:155], v[40:43]
  s_lshl_b32 s30, s30, 10
  v_mfma_f32_16x16x32_bf16 v[44:47], v[204:207], v[152:155], v[44:47]
  s_and_b32 s30, s30, 0x7fff
  v_mfma_f32_16x16x32_bf16 v[48:51], v[192:195], v[156:159], v[48:51]
  buffer_load_dwordx4 v[132:135], v4, s[12:15], s30 offen sc1
  v_mfma_f32_16x16x32_bf16 v[52:55], v[196:199], v[156:159], v[52:55]
  v_mfma_f32_16x16x32_bf16 v[56:59], v[200:203], v[156:159], v[56:59]
  buffer_load_dwordx4 v[136:139], v5, s[12:15], s30 offen sc1
  v_mfma_f32_16x16x32_bf16 v[60:63], v[204:207], v[156:159], v[60:63]
  v_mfma_f32_16x16x32_bf16 v[64:67], v[192:195], v[160:163], v[64:67]
  v_mfma_f32_16x16x32_bf16 v[68:71], v[196:199], v[160:163], v[68:71]
  buffer_load_dwordx4 v[140:143], v13, s[12:15], s30 offen sc1
  v_mfma_f32_16x16x32_bf16 v[72:75], v[200:203], v[160:163], v[72:75]
  v_mfma_f32_16x16x32_bf16 v[76:79], v[204:207], v[160:163], v[76:79]
  v_mfma_f32_16x16x32_bf16 v[80:83], v[192:195], v[164:167], v[80:83]
  buffer_load_dwordx4 v[144:147], v14, s[12:15], s30 offen sc1
  v_mfma_f32_16x16x32_bf16 v[84:87], v[196:199], v[164:167], v[84:87]
  v_mfma_f32_16x16x32_bf16 v[88:91], v[200:203], v[164:167], v[88:91]
  v_mfma_f32_16x16x32_bf16 v[92:95], v[204:207], v[164:167], v[92:95]
  buffer_load_dwordx4 v[148:151], v254, s[12:15], s30 offen sc1
  v_mfma_f32_16x16x32_bf16 v[96:99], v[192:195], v[168:171], v[96:99]
  v_mfma_f32_16x16x32_bf16 v[100:103], v[196:199], v[168:171], v[100:103]
  v_mfma_f32_16x16x32_bf16 v[104:107], v[200:203], v[168:171], v[104:107]
  v_mfma_f32_16x16x32_bf16 v[108:111], v[204:207], v[168:171], v[108:111]
  s_waitcnt vmcnt(10) lgkmcnt(0)
  v_mfma_f32_16x16x32_bf16 v[32:35], a[224:227], v[172:175], v[32:35]
  v_mfma_f32_16x16x32_bf16 v[36:39], a[228:231], v[172:175], v[36:39]
  s_add_u32 s30, s41, 22
  v_mfma_f32_16x16x32_bf16 v[40:43], a[232:235], v[172:175], v[40:43]
  s_lshl_b32 s30, s30, 10
  v_mfma_f32_16x16x32_bf16 v[44:47], a[236:239], v[172:175], v[44:47]
  s_and_b32 s30, s30, 0x7fff
  v_mfma_f32_16x16x32_bf16 v[48:51], a[224:227], v[176:179], v[48:51]
  buffer_load_dwordx4 v[152:155], v4, s[12:15], s30 offen sc1
  v_mfma_f32_16x16x32_bf16 v[52:55], a[228:231], v[176:179], v[52:55]
  v_mfma_f32_16x16x32_bf16 v[56:59], a[232:235], v[176:179], v[56:59]
  buffer_load_dwordx4 v[156:159], v5, s[12:15], s30 offen sc1
  v_mfma_f32_16x16x32_bf16 v[60:63], a[236:239], v[176:179], v[60:63]
  v_mfma_f32_16x16x32_bf16 v[64:67], a[224:227], v[180:183], v[64:67]
  v_mfma_f32_16x16x32_bf16 v[68:71], a[228:231], v[180:183], v[68:71]
  buffer_load_dwordx4 v[160:163], v13, s[12:15], s30 offen sc1
  v_mfma_f32_16x16x32_bf16 v[72:75], a[232:235], v[180:183], v[72:75]
  v_mfma_f32_16x16x32_bf16 v[76:79], a[236:239], v[180:183], v[76:79]
  v_mfma_f32_16x16x32_bf16 v[80:83], a[224:227], v[184:187], v[80:83]
  buffer_load_dwordx4 v[164:167], v14, s[12:15], s30 offen sc1
  v_mfma_f32_16x16x32_bf16 v[84:87], a[228:231], v[184:187], v[84:87]
  v_mfma_f32_16x16x32_bf16 v[88:91], a[232:235], v[184:187], v[88:91]
  v_mfma_f32_16x16x32_bf16 v[92:95], a[236:239], v[184:187], v[92:95]
  buffer_load_dwordx4 v[168:171], v254, s[12:15], s30 offen sc1
  v_mfma_f32_16x16x32_bf16 v[96:99], a[224:227], v[188:191], v[96:99]
  v_mfma_f32_16x16x32_bf16 v[100:103], a[228:231], v[188:191], v[100:103]
  v_mfma_f32_16x16x32_bf16 v[104:107], a[232:235], v[188:191], v[104:107]
  v_mfma_f32_16x16x32_bf16 v[108:111], a[236:239], v[188:191], v[108:111]
  s_waitcnt vmcnt(10) lgkmcnt(0)
  v_mfma_f32_16x16x32_bf16 v[32:35], a[240:243], v[112:115], v[32:35]
  v_mfma_f32_16x16x32_bf16 v[36:39], a[244:247], v[112:115], v[36:39]
  s_add_u32 s30, s41, 23
  v_mfma_f32_16x16x32_bf16 v[40:43], a[248:251], v[112:115], v[40:43]
  s_lshl_b32 s30, s30, 10
  v_mfma_f32_16x16x32_bf16 v[44:47], a[252:255], v[112:115], v[44:47]
  s_and_b32 s30, s30, 0x7fff
  v_mfma_f32_16x16x32_bf16 v[48:51], a[240:243], v[116:119], v[48:51]
  buffer_load_dwordx4 v[172:175], v4, s[12:15], s30 offen sc1
  v_mfma_f32_16x16x32_bf16 v[52:55], a[244:247], v[116:119], v[52:55]
  v_mfma_f32_16x16x32_bf16 v[56:59], a[248:251], v[116:119], v[56:59]
  buffer_load_dwordx4 v[176:179], v5, s[12:15], s30 offen sc1
  v_mfma_f32_16x16x32_bf16 v[60:63], a[252:255], v[116:119], v[60:63]
  v_mfma_f32_16x16x32_bf16 v[64:67], a[240:243], v[120:123], v[64:67]
  v_mfma_f32_16x16x32_bf16 v[68:71], a[244:247], v[120:123], v[68:71]
  buffer_load_dwordx4 v[180:183], v13, s[12:15], s30 offen sc1
  v_mfma_f32_16x16x32_bf16 v[72:75], a[248:251], v[120:123], v[72:75]
  v_mfma_f32_16x16x32_bf16 v[76:79], a[252:255], v[120:123], v[76:79]
  v_mfma_f32_16x16x32_bf16 v[80:83], a[240:243], v[124:127], v[80:83]
  buffer_load_dwordx4 v[184:187], v14, s[12:15], s30 offen sc1
  v_mfma_f32_16x16x32_bf16 v[84:87], a[244:247], v[124:127], v[84:87]
  v_mfma_f32_16x16x32_bf16 v[88:91], a[248:251], v[124:127], v[88:91]
  v_mfma_f32_16x16x32_bf16 v[92:95], a[252:255], v[124:127], v[92:95]
  buffer_load_dwordx4 v[188:191], v254, s[12:15], s30 offen sc1
  v_mfma_f32_16x16x32_bf16 v[96:99], a[240:243], v[128:131], v[96:99]
  v_mfma_f32_16x16x32_bf16 v[100:103], a[244:247], v[128:131], v[100:103]
  v_mfma_f32_16x16x32_bf16 v[104:107], a[248:251], v[128:131], v[104:107]
  v_mfma_f32_16x16x32_bf16 v[108:111], a[252:255], v[128:131], v[108:111]
  s_barrier
  s_waitcnt vmcnt(10) lgkmcnt(0)
  v_mfma_f32_16x16x32_bf16 v[32:35], a[64:67], v[132:135], v[32:35]
  v_mfma_f32_16x16x32_bf16 v[36:39], a[68:71], v[132:135], v[36:39]
  s_add_u32 s30, s41, 24
  v_mfma_f32_16x16x32_bf16 v[40:43], a[72:75], v[132:135], v[40:43]
  s_lshl_b32 s30, s30, 10
  v_mfma_f32_16x16x32_bf16 v[44:47], a[76:79], v[132:135], v[44:47]
  s_and_b32 s30, s30, 0x7fff
  v_mfma_f32_16x16x32_bf16 v[48:51], a[64:67], v[136:139], v[48:51]
  buffer_load_dwordx4 v[112:115], v4, s[12:15], s30 offen sc1
  v_mfma_f32_16x16x32_bf16 v[52:55], a[68:71], v[136:139], v[52:55]
  v_mfma_f32_16x16x32_bf16 v[56:59], a[72:75], v[136:139], v[56:59]
  buffer_load_dwordx4 v[116:119], v5, s[12:15], s30 offen sc1
  v_mfma_f32_16x16x32_bf16 v[60:63], a[76:79], v[136:139], v[60:63]
  v_mfma_f32_16x16x32_bf16 v[64:67], a[64:67], v[140:143], v[64:67]
  v_mfma_f32_16x16x32_bf16 v[68:71], a[68:71], v[140:143], v[68:71]
  buffer_load_dwordx4 v[120:123], v13, s[12:15], s30 offen sc1
  v_mfma_f32_16x16x32_bf16 v[72:75], a[72:75], v[140:143], v[72:75]
  v_mfma_f32_16x16x32_bf16 v[76:79], a[76:79], v[140:143], v[76:79]
  v_mfma_f32_16x16x32_bf16 v[80:83], a[64:67], v[144:147], v[80:83]
  buffer_load_dwordx4 v[124:127], v14, s[12:15], s30 offen sc1
  v_mfma_f32_16x16x32_bf16 v[84:87], a[68:71], v[144:147], v[84:87]
  v_mfma_f32_16x16x32_bf16 v[88:91], a[72:75], v[144:147], v[88:91]
  v_mfma_f32_16x16x32_bf16 v[92:95], a[76:79], v[144:147], v[92:95]
  buffer_load_dwordx4 v[128:131], v254, s[12:15], s30 offen sc1
  v_mfma_f32_16x16x32_bf16 v[96:99], a[64:67], v[148:151], v[96:99]
  v_mfma_f32_16x16x32_bf16 v[100:103], a[68:71], v[148:151], v[100:103]
  v_mfma_f32_16x16x32_bf16 v[104:107], a[72:75], v[148:151], v[104:107]
  v_mfma_f32_16x16x32_bf16 v[108:111], a[76:79], v[148:151], v[108:111]
  s_waitcnt vmcnt(10) lgkmcnt(0)
  v_mfma_f32_16x16x32_bf16 v[32:35], a[80:83], v[152:155], v[32:35]
  v_mfma_f32_16x16x32_bf16 v[36:39], a[84:87], v[152:155], v[36:39]
  s_add_u32 s30, s41, 25
  v_mfma_f32_16x16x32_bf16 v[40:43], a[88:91], v[152:155], v[40:43]
  s_lshl_b32 s30, s30, 10
  v_mfma_f32_16x16x32_bf16 v[44:47], a[92:95], v[152:155], v[44:47]
  s_and_b32 s30, s30, 0x7fff
  v_mfma_f32_16x16x32_bf16 v[48:51], a[80:83], v[156:159], v[48:51]
  buffer_load_dwordx4 v[132:135], v4, s[12:15], s30 offen sc1
  v_mfma_f32_16x16x32_bf16 v[52:55], a[84:87], v[156:159], v[52:55]
  v_mfma_f32_16x16x32_bf16 v[56:59], a[88:91], v[156:159], v[56:59]
  buffer_load_dwordx4 v[136:139], v5, s[12:15], s30 offen sc1
  v_mfma_f32_16x16x32_bf16 v[60:63], a[92:95], v[156:159], v[60:63]
  v_mfma_f32_16x16x32_bf16 v[64:67], a[80:83], v[160:163], v[64:67]
  v_mfma_f32_16x16x32_bf16 v[68:71], a[84:87], v[160:163], v[68:71]
  buffer_load_dwordx4 v[140:143], v13, s[12:15], s30 offen sc1
  v_mfma_f32_16x16x32_bf16 v[72:75], a[88:91], v[160:163], v[72:75]
  v_mfma_f32_16x16x32_bf16 v[76:79], a[92:95], v[160:163], v[76:79]
  v_mfma_f32_16x16x32_bf16 v[80:83], a[80:83], v[164:167], v[80:83]
  buffer_load_dwordx4 v[144:147], v14, s[12:15], s30 offen sc1
  v_mfma_f32_16x16x32_bf16 v[84:87], a[84:87], v[164:167], v[84:87]
  v_mfma_f32_16x16x32_bf16 v[88:91], a[88:91], v[164:167], v[88:91]
  v_mfma_f32_16x16x32_bf16 v[92:95], a[92:95], v[164:167], v[92:95]
  buffer_load_dwordx4 v[148:151], v254, s[12:15], s30 offen sc1
  v_mfma_f32_16x16x32_bf16 v[96:99], a[80:83], v[168:171], v[96:99]
  v_mfma_f32_16x16x32_bf16 v[100:103], a[84:87], v[168:171], v[100:103]
  v_mfma_f32_16x16x32_bf16 v[104:107], a[88:91], v[168:171], v[104:107]
  v_mfma_f32_16x16x32_bf16 v[108:111], a[92:95], v[168:171], v[108:111]
  s_waitcnt vmcnt(10) lgkmcnt(0)
  v_mfma_f32_16x16x32_bf16 v[32:35], a[96:99], v[172:175], v[32:35]
  v_mfma_f32_16x16x32_bf16 v[36:39], a[100:103], v[172:175], v[36:39]
  s_add_u32 s30, s41, 26
  v_mfma_f32_16x16x32_bf16 v[40:43], a[104:107], v[172:175], v[40:43]
  s_lshl_b32 s30, s30, 10
  v_mfma_f32_16x16x32_bf16 v[44:47], a[108:111], v[172:175], v[44:47]
  s_and_b32 s30, s30, 0x7fff
  v_mfma_f32_16x16x32_bf16 v[48:51], a[96:99], v[176:179], v[48:51]
  buffer_load_dwordx4 v[152:155], v4, s[12:15], s30 offen sc1
  v_mfma_f32_16x16x32_bf16 v[52:55], a[100:103], v[176:179], v[52:55]
  v_mfma_f32_16x16x32_bf16 v[56:59], a[104:107], v[176:179], v[56:59]
  buffer_load_dwordx4 v[156:159], v5, s[12:15], s30 offen sc1
  v_mfma_f32_16x16x32_bf16 v[60:63], a[108:111], v[176:179], v[60:63]
  v_mfma_f32_16x16x32_bf16 v[64:67], a[96:99], v[180:183], v[64:67]
  v_mfma_f32_16x16x32_bf16 v[68:71], a[100:103], v[180:183], v[68:71]
  buffer_load_dwordx4 v[160:163], v13, s[12:15], s30 offen sc1
  v_mfma_f32_16x16x32_bf16 v[72:75], a[104:107], v[180:183], v[72:75]
  v_mfma_f32_16x16x32_bf16 v[76:79], a[108:111], v[180:183], v[76:79]
  v_mfma_f32_16x16x32_bf16 v[80:83], a[96:99], v[184:187], v[80:83]
  buffer_load_dwordx4 v[164:167], v14, s[12:15], s30 offen sc1
  v_mfma_f32_16x16x32_bf16 v[84:87], a[100:103], v[184:187], v[84:87]
  v_mfma_f32_16x16x32_bf16 v[88:91], a[104:107], v[184:187], v[88:91]
  v_mfma_f32_16x16x32_bf16 v[92:95], a[108:111], v[184:187], v[92:95]
  buffer_load_dwordx4 v[168:171], v254, s[12:15], s30 offen sc1
  v_mfma_f32_16x16x32_bf16 v[96:99], a[96:99], v[188:191], v[96:99]
  v_mfma_f32_16x16x32_bf16 v[100:103], a[100:103], v[188:191], v[100:103]
  v_mfma_f32_16x16x32_bf16 v[104:107], a[104:107], v[188:191], v[104:107]
  v_mfma_f32_16x16x32_bf16 v[108:111], a[108:111], v[188:191], v[108:111]
  s_waitcnt vmcnt(10) lgkmcnt(0)
  v_mfma_f32_16x16x32_bf16 v[32:35], a[112:115], v[112:115], v[32:35]
  v_mfma_f32_16x16x32_bf16 v[36:39], a[116:119], v[112:115], v[36:39]
  s_add_u32 s30, s41, 27
  v_mfma_f32_16x16x32_bf16 v[40:43], a[120:123], v[112:115], v[40:43]
  s_lshl_b32 s30, s30, 10
  v_mfma_f32_16x16x32_bf16 v[44:47], a[124:127], v[112:115], v[44:47]
  s_and_b32 s30, s30, 0x7fff
  v_mfma_f32_16x16x32_bf16 v[48:51], a[112:115], v[116:119], v[48:51]
  buffer_load_dwordx4 v[172:175], v4, s[12:15], s30 offen sc1
  v_mfma_f32_16x16x32_bf16 v[52:55], a[116:119], v[116:119], v[52:55]
  v_mfma_f32_16x16x32_bf16 v[56:59], a[120:123], v[116:119], v[56:59]
  buffer_load_dwordx4 v[176:179], v5, s[12:15], s30 offen sc1
  v_mfma_f32_16x16x32_bf16 v[60:63], a[124:127], v[116:119], v[60:63]
  v_mfma_f32_16x16x32_bf16 v[64:67], a[112:115], v[120:123], v[64:67]
  v_mfma_f32_16x16x32_bf16 v[68:71], a[116:119], v[120:123], v[68:71]
  buffer_load_dwordx4 v[180:183], v13, s[12:15], s30 offen sc1
  v_mfma_f32_16x16x32_bf16 v[72:75], a[120:123], v[120:123], v[72:75]
  v_mfma_f32_16x16x32_bf16 v[76:79], a[124:127], v[120:123], v[76:79]
  v_mfma_f32_16x16x32_bf16 v[80:83], a[112:115], v[124:127], v[80:83]
  buffer_load_dwordx4 v[184:187], v14, s[12:15], s30 offen sc1
  v_mfma_f32_16x16x32_bf16 v[84:87], a[116:119], v[124:127], v[84:87]
  v_mfma_f32_16x16x32_bf16 v[88:91], a[120:123], v[124:127], v[88:91]
  v_mfma_f32_16x16x32_bf16 v[92:95], a[124:127], v[124:127], v[92:95]
  buffer_load_dwordx4 v[188:191], v254, s[12:15], s30 offen sc1
  v_mfma_f32_16x16x32_bf16 v[96:99], a[112:115], v[128:131], v[96:99]
  v_mfma_f32_16x16x32_bf16 v[100:103], a[116:119], v[128:131], v[100:103]
  v_mfma_f32_16x16x32_bf16 v[104:107], a[120:123], v[128:131], v[104:107]
  v_mfma_f32_16x16x32_bf16 v[108:111], a[124:127], v[128:131], v[108:111]
  s_waitcnt vmcnt(10) lgkmcnt(0)
  v_mfma_f32_16x16x32_bf16 v[32:35], a[128:131], v[132:135], v[32:35]
  v_mfma_f32_16x16x32_bf16 v[36:39], a[132:135], v[132:135], v[36:39]
  s_add_u32 s30, s41, 28
  v_mfma_f32_16x16x32_bf16 v[40:43], a[136:139], v[132:135], v[40:43]
  s_lshl_b32 s30, s30, 10
  v_mfma_f32_16x16x32_bf16 v[44:47], a[140:143], v[132:135], v[44:47]
  s_and_b32 s30, s30, 0x7fff
  v_mfma_f32_16x16x32_bf16 v[48:51], a[128:131], v[136:139], v[48:51]
  buffer_load_dwordx4 v[112:115], v4, s[12:15], s30 offen sc1
  v_mfma_f32_16x16x32_bf16 v[52:55], a[132:135], v[136:139], v[52:55]
  v_mfma_f32_16x16x32_bf16 v[56:59], a[136:139], v[136:139], v[56:59]
  buffer_load_dwordx4 v[116:119], v5, s[12:15], s30 offen sc1
  v_mfma_f32_16x16x32_bf16 v[60:63], a[140:143], v[136:139], v[60:63]
  v_mfma_f32_16x16x32_bf16 v[64:67], a[128:131], v[140:143], v[64:67]
  v_mfma_f32_16x16x32_bf16 v[68:71], a[132:135], v[140:143], v[68:71]
  buffer_load_dwordx4 v[120:123], v13, s[12:15], s30 offen sc1
  v_mfma_f32_16x16x32_bf16 v[72:75], a[136:139], v[140:143], v[72:75]
  v_mfma_f32_16x16x32_bf16 v[76:79], a[140:143], v[140:143], v[76:79]
  v_mfma_f32_16x16x32_bf16 v[80:83], a[128:131], v[144:147], v[80:83]
  buffer_load_dwordx4 v[124:127], v14, s[12:15], s30 offen sc1
  v_mfma_f32_16x16x32_bf16 v[84:87], a[132:135], v[144:147], v[84:87]
  v_mfma_f32_16x16x32_bf16 v[88:91], a[136:139], v[144:147], v[88:91]
  v_mfma_f32_16x16x32_bf16 v[92:95], a[140:143], v[144:147], v[92:95]
  buffer_load_dwordx4 v[128:131], v254, s[12:15], s30 offen sc1
  v_mfma_f32_16x16x32_bf16 v[96:99], a[128:131], v[148:151], v[96:99]
  v_mfma_f32_16x16x32_bf16 v[100:103], a[132:135], v[148:151], v[100:103]
  v_mfma_f32_16x16x32_bf16 v[104:107], a[136:139], v[148:151], v[104:107]
  v_mfma_f32_16x16x32_bf16 v[108:111], a[140:143], v[148:151], v[108:111]
  s_waitcnt vmcnt(10) lgkmcnt(0)
  v_mfma_f32_16x16x32_bf16 v[32:35], a[144:147], v[152:155], v[32:35]
  v_mfma_f32_16x16x32_bf16 v[36:39], a[148:151], v[152:155], v[36:39]
  s_add_u32 s30, s41, 29
  v_mfma_f32_16x16x32_bf16 v[40:43], a[152:155], v[152:155], v[40:43]
  s_lshl_b32 s30, s30, 10
  v_mfma_f32_16x16x32_bf16 v[44:47], a[156:159], v[152:155], v[44:47]
  s_and_b32 s30, s30, 0x7fff
  v_mfma_f32_16x16x32_bf16 v[48:51], a[144:147], v[156:159], v[48:51]
  buffer_load_dwordx4 v[132:135], v4, s[12:15], s30 offen sc1
  v_mfma_f32_16x16x32_bf16 v[52:55], a[148:151], v[156:159], v[52:55]
  v_mfma_f32_16x16x32_bf16 v[56:59], a[152:155], v[156:159], v[56:59]
  buffer_load_dwordx4 v[136:139], v5, s[12:15], s30 offen sc1
  v_mfma_f32_16x16x32_bf16 v[60:63], a[156:159], v[156:159], v[60:63]
  v_mfma_f32_16x16x32_bf16 v[64:67], a[144:147], v[160:163], v[64:67]
  v_mfma_f32_16x16x32_bf16 v[68:71], a[148:151], v[160:163], v[68:71]
  buffer_load_dwordx4 v[140:143], v13, s[12:15], s30 offen sc1
  v_mfma_f32_16x16x32_bf16 v[72:75], a[152:155], v[160:163], v[72:75]
  v_mfma_f32_16x16x32_bf16 v[76:79], a[156:159], v[160:163], v[76:79]
  v_mfma_f32_16x16x32_bf16 v[80:83], a[144:147], v[164:167], v[80:83]
  buffer_load_dwordx4 v[144:147], v14, s[12:15], s30 offen sc1
  v_mfma_f32_16x16x32_bf16 v[84:87], a[148:151], v[164:167], v[84:87]
  v_mfma_f32_16x16x32_bf16 v[88:91], a[152:155], v[164:167], v[88:91]
  v_mfma_f32_16x16x32_bf16 v[92:95], a[156:159], v[164:167], v[92:95]
  buffer_load_dwordx4 v[148:151], v254, s[12:15], s30 offen sc1
  v_mfma_f32_16x16x32_bf16 v[96:99], a[144:147], v[168:171], v[96:99]
  v_mfma_f32_16x16x32_bf16 v[100:103], a[148:151], v[168:171], v[100:103]
  v_mfma_f32_16x16x32_bf16 v[104:107], a[152:155], v[168:171], v[104:107]
  v_mfma_f32_16x16x32_bf16 v[108:111], a[156:159], v[168:171], v[108:111]
  s_waitcnt vmcnt(10) lgkmcnt(0)
  v_mfma_f32_16x16x32_bf16 v[32:35], a[160:163], v[172:175], v[32:35]
  v_mfma_f32_16x16x32_bf16 v[36:39], a[164:167], v[172:175], v[36:39]
  s_add_u32 s30, s41, 30
  v_mfma_f32_16x16x32_bf16 v[40:43], a[168:171], v[172:175], v[40:43]
  s_lshl_b32 s30, s30, 10
  v_mfma_f32_16x16x32_bf16 v[44:47], a[172:175], v[172:175], v[44:47]
  s_and_b32 s30, s30, 0x7fff
  v_mfma_f32_16x16x32_bf16 v[48:51], a[160:163], v[176:179], v[48:51]
  buffer_load_dwordx4 v[152:155], v4, s[12:15], s30 offen sc1
  v_mfma_f32_16x16x32_bf16 v[52:55], a[164:167], v[176:179], v[52:55]
  v_mfma_f32_16x16x32_bf16 v[56:59], a[168:171], v[176:179], v[56:59]
  buffer_load_dwordx4 v[156:159], v5, s[12:15], s30 offen sc1
  v_mfma_f32_16x16x32_bf16 v[60:63], a[172:175], v[176:179], v[60:63]
  v_mfma_f32_16x16x32_bf16 v[64:67], a[160:163], v[180:183], v[64:67]
  v_mfma_f32_16x16x32_bf16 v[68:71], a[164:167], v[180:183], v[68:71]
  buffer_load_dwordx4 v[160:163], v13, s[12:15], s30 offen sc1
  v_mfma_f32_16x16x32_bf16 v[72:75], a[168:171], v[180:183], v[72:75]
  v_mfma_f32_16x16x32_bf16 v[76:79], a[172:175], v[180:183], v[76:79]
  v_mfma_f32_16x16x32_bf16 v[80:83], a[160:163], v[184:187], v[80:83]
  buffer_load_dwordx4 v[164:167], v14, s[12:15], s30 offen sc1
  v_mfma_f32_16x16x32_bf16 v[84:87], a[164:167], v[184:187], v[84:87]
  v_mfma_f32_16x16x32_bf16 v[88:91], a[168:171], v[184:187], v[88:91]
  v_mfma_f32_16x16x32_bf16 v[92:95], a[172:175], v[184:187], v[92:95]
  buffer_load_dwordx4 v[168:171], v254, s[12:15], s30 offen sc1
  v_mfma_f32_16x16x32_bf16 v[96:99], a[160:163], v[188:191], v[96:99]
  v_mfma_f32_16x16x32_bf16 v[100:103], a[164:167], v[188:191], v[100:103]
  v_mfma_f32_16x16x32_bf16 v[104:107], a[168:171], v[188:191], v[104:107]
  v_mfma_f32_16x16x32_bf16 v[108:111], a[172:175], v[188:191], v[108:111]
  s_waitcnt vmcnt(10) lgkmcnt(0)
  v_mfma_f32_16x16x32_bf16 v[32:35], a[176:179], v[112:115], v[32:35]
  v_mfma_f32_16x16x32_bf16 v[36:39], a[180:183], v[112:115], v[36:39]
  s_add_u32 s30, s41, 31
  v_mfma_f32_16x16x32_bf16 v[40:43], a[184:187], v[112:115], v[40:43]
  s_lshl_b32 s30, s30, 10
  v_mfma_f32_16x16x32_bf16 v[44:47], a[188:191], v[112:115], v[44:47]
  s_and_b32 s30, s30, 0x7fff
  v_mfma_f32_16x16x32_bf16 v[48:51], a[176:179], v[116:119], v[48:51]
  buffer_load_dwordx4 v[172:175], v4, s[12:15], s30 offen sc1
  v_mfma_f32_16x16x32_bf16 v[52:55], a[180:183], v[116:119], v[52:55]
  v_mfma_f32_16x16x32_bf16 v[56:59], a[184:187], v[116:119], v[56:59]
  buffer_load_dwordx4 v[176:179], v5, s[12:15], s30 offen sc1
  v_mfma_f32_16x16x32_bf16 v[60:63], a[188:191], v[116:119], v[60:63]
  v_mfma_f32_16x16x32_bf16 v[64:67], a[176:179], v[120:123], v[64:67]
  v_mfma_f32_16x16x32_bf16 v[68:71], a[180:183], v[120:123], v[68:71]
  buffer_load_dwordx4 v[180:183], v13, s[12:15], s30 offen sc1
  v_mfma_f32_16x16x32_bf16 v[72:75], a[184:187], v[120:123], v[72:75]
  v_mfma_f32_16x16x32_bf16 v[76:79], a[188:191], v[120:123], v[76:79]
  v_mfma_f32_16x16x32_bf16 v[80:83], a[176:179], v[124:127], v[80:83]
  buffer_load_dwordx4 v[184:187], v14, s[12:15], s30 offen sc1
  v_mfma_f32_16x16x32_bf16 v[84:87], a[180:183], v[124:127], v[84:87]
  v_mfma_f32_16x16x32_bf16 v[88:91], a[184:187], v[124:127], v[88:91]
  v_mfma_f32_16x16x32_bf16 v[92:95], a[188:191], v[124:127], v[92:95]
  buffer_load_dwordx4 v[188:191], v254, s[12:15], s30 offen sc1
  v_mfma_f32_16x16x32_bf16 v[96:99], a[176:179], v[128:131], v[96:99]
  v_mfma_f32_16x16x32_bf16 v[100:103], a[180:183], v[128:131], v[100:103]
  v_mfma_f32_16x16x32_bf16 v[104:107], a[184:187], v[128:131], v[104:107]
  v_mfma_f32_16x16x32_bf16 v[108:111], a[188:191], v[128:131], v[108:111]
  s_waitcnt vmcnt(10) lgkmcnt(0)
  v_mfma_f32_16x16x32_bf16 v[32:35], a[208:211], v[132:135], v[32:35]
  v_mfma_f32_16x16x32_bf16 v[36:39], a[212:215], v[132:135], v[36:39]
  v_mfma_f32_16x16x32_bf16 v[40:43], a[216:219], v[132:135], v[40:43]
  v_mfma_f32_16x16x32_bf16 v[44:47], a[220:223], v[132:135], v[44:47]
  v_mfma_f32_16x16x32_bf16 v[48:51], a[208:211], v[136:139], v[48:51]
  v_mfma_f32_16x16x32_bf16 v[52:55], a[212:215], v[136:139], v[52:55]
  v_mfma_f32_16x16x32_bf16 v[56:59], a[216:219], v[136:139], v[56:59]
  v_mfma_f32_16x16x32_bf16 v[60:63], a[220:223], v[136:139], v[60:63]
  v_mfma_f32_16x16x32_bf16 v[64:67], a[208:211], v[140:143], v[64:67]
  v_mfma_f32_16x16x32_bf16 v[68:71], a[212:215], v[140:143], v[68:71]
  v_mfma_f32_16x16x32_bf16 v[72:75], a[216:219], v[140:143], v[72:75]
  v_mfma_f32_16x16x32_bf16 v[76:79], a[220:223], v[140:143], v[76:79]
  v_mfma_f32_16x16x32_bf16 v[80:83], a[208:211], v[144:147], v[80:83]
  v_mfma_f32_16x16x32_bf16 v[84:87], a[212:215], v[144:147], v[84:87]
  v_mfma_f32_16x16x32_bf16 v[88:91], a[216:219], v[144:147], v[88:91]
  v_mfma_f32_16x16x32_bf16 v[92:95], a[220:223], v[144:147], v[92:95]
  v_mfma_f32_16x16x32_bf16 v[96:99], a[208:211], v[148:151], v[96:99]
  v_mfma_f32_16x16x32_bf16 v[100:103], a[212:215], v[148:151], v[100:103]
  v_mfma_f32_16x16x32_bf16 v[104:107], a[216:219], v[148:151], v[104:107]
  v_mfma_f32_16x16x32_bf16 v[108:111], a[220:223], v[148:151], v[108:111]
  s_waitcnt vmcnt(5) lgkmcnt(0)
  v_mfma_f32_16x16x32_bf16 v[36:39], a[196:199], v[152:155], v[36:39]
  s_waitcnt vmcnt(0)
  v_mfma_f32_16x16x32_bf16 v[36:39], a[4:7], v[172:175], v[36:39]
  v_mfma_f32_16x16x32_bf16 v[40:43], a[200:203], v[152:155], v[40:43]
  v_mfma_f32_16x16x32_bf16 v[40:43], a[8:11], v[172:175], v[40:43]
  v_mfma_f32_16x16x32_bf16 v[44:47], a[204:207], v[152:155], v[44:47]
  v_mfma_f32_16x16x32_bf16 v[44:47], a[12:15], v[172:175], v[44:47]
  v_mfma_f32_16x16x32_bf16 v[32:35], a[192:195], v[152:155], v[32:35]
  v_mfma_f32_16x16x32_bf16 v[32:35], a[0:3], v[172:175], v[32:35]
  v_mfma_f32_16x16x32_bf16 v[52:55], a[196:199], v[156:159], v[52:55]
  v_mfma_f32_16x16x32_bf16 v[52:55], a[4:7], v[176:179], v[52:55]
  v_mfma_f32_16x16x32_bf16 v[56:59], a[200:203], v[156:159], v[56:59]
  ds_write_b128 v241, v[36:39] offset:0
  v_mfma_f32_16x16x32_bf16 v[56:59], a[8:11], v[176:179], v[56:59]
  v_mfma_f32_16x16x32_bf16 v[60:63], a[204:207], v[156:159], v[60:63]
  ds_write_b128 v242, v[40:43] offset:5120
  v_mfma_f32_16x16x32_bf16 v[60:63], a[12:15], v[176:179], v[60:63]
  v_mfma_f32_16x16x32_bf16 v[48:51], a[192:195], v[156:159], v[48:51]
  ds_write_b128 v243, v[44:47] offset:10240
  v_mfma_f32_16x16x32_bf16 v[48:51], a[0:3], v[176:179], v[48:51]
  v_mfma_f32_16x16x32_bf16 v[68:71], a[196:199], v[160:163], v[68:71]
  v_mfma_f32_16x16x32_bf16 v[68:71], a[4:7], v[180:183], v[68:71]
  v_mfma_f32_16x16x32_bf16 v[72:75], a[200:203], v[160:163], v[72:75]
  ds_write_b128 v241, v[52:55] offset:1024
  v_mfma_f32_16x16x32_bf16 v[72:75], a[8:11], v[180:183], v[72:75]
  v_mfma_f32_16x16x32_bf16 v[76:79], a[204:207], v[160:163], v[76:79]
  ds_write_b128 v242, v[56:59] offset:6144
  v_mfma_f32_16x16x32_bf16 v[76:79], a[12:15], v[180:183], v[76:79]
  v_mfma_f32_16x16x32_bf16 v[64:67], a[192:195], v[160:163], v[64:67]
  ds_write_b128 v243, v[60:63] offset:11264
  v_mfma_f32_16x16x32_bf16 v[64:67], a[0:3], v[180:183], v[64:67]
  v_mfma_f32_16x16x32_bf16 v[84:87], a[196:199], v[164:167], v[84:87]
  v_mfma_f32_16x16x32_bf16 v[84:87], a[4:7], v[184:187], v[84:87]
  v_mfma_f32_16x16x32_bf16 v[88:91], a[200:203], v[164:167], v[88:91]
  ds_write_b128 v241, v[68:71] offset:2048
  v_mfma_f32_16x16x32_bf16 v[88:91], a[8:11], v[184:187], v[88:91]
  v_mfma_f32_16x16x32_bf16 v[92:95], a[204:207], v[164:167], v[92:95]
  ds_write_b128 v242, v[72:75] offset:7168
  v_mfma_f32_16x16x32_bf16 v[92:95], a[12:15], v[184:187], v[92:95]
  v_mfma_f32_16x16x32_bf16 v[80:83], a[192:195], v[164:167], v[80:83]
  ds_write_b128 v243, v[76:79] offset:12288
  v_mfma_f32_16x16x32_bf16 v[80:83], a[0:3], v[184:187], v[80:83]
  v_mfma_f32_16x16x32_bf16 v[100:103], a[196:199], v[168:171], v[100:103]
  v_mfma_f32_16x16x32_bf16 v[100:103], a[4:7], v[188:191], v[100:103]
  s_waitcnt lgkmcnt(0)
  s_barrier
  ds_read_b128 v[112:115], v240 offset:0
  ds_read_b128 v[116:119], v240 offset:5120
  v_mfma_f32_16x16x32_bf16 v[104:107], a[200:203], v[168:171], v[104:107]
  ds_write_b128 v241, v[84:87] offset:3072
  ds_read_b128 v[120:123], v240 offset:10240
  ds_read_b128 v[124:127], v240 offset:1024
  v_mfma_f32_16x16x32_bf16 v[104:107], a[8:11], v[188:191], v[104:107]
  v_mfma_f32_16x16x32_bf16 v[108:111], a[204:207], v[168:171], v[108:111]
  ds_write_b128 v242, v[88:91] offset:8192
  ds_read_b128 v[128:131], v240 offset:6144
  ds_read_b128 v[132:135], v240 offset:11264
  v_mfma_f32_16x16x32_bf16 v[108:111], a[12:15], v[188:191], v[108:111]
  ds_read_b128 v[136:139], v240 offset:2048
  ds_read_b128 v[140:143], v240 offset:7168
  v_mfma_f32_16x16x32_bf16 v[96:99], a[192:195], v[168:171], v[96:99]
  ds_write_b128 v243, v[92:95] offset:13312
  ds_read_b128 v[144:147], v240 offset:12288
  v_mfma_f32_16x16x32_bf16 v[96:99], a[0:3], v[188:191], v[96:99]
  s_lshl_b32 s52, s3, 5
  ds_write_b128 v241, v[100:103] offset:4096
  ds_write_b128 v242, v[104:107] offset:9216
  s_waitcnt lgkmcnt(10)
  v_pk_add_f32 v[32:33], v[32:33], v[112:113]
  v_pk_add_f32 v[116:117], v[116:117], v[120:121]
  v_pk_add_f32 v[34:35], v[34:35], v[114:115]
  v_pk_add_f32 v[118:119], v[118:119], v[122:123]
  ds_write_b128 v243, v[108:111] offset:14336
  v_pk_add_f32 v[32:33], v[32:33], v[116:117]
  v_pk_add_f32 v[34:35], v[34:35], v[118:119]
  v_cvt_pk_bf16_f32 v32, v32, v33
  v_cvt_pk_bf16_f32 v33, v34, v35
  buffer_store_dwordx2 v[32:33], v244, s[4:7], s52 offen
  s_add_u32 s52, s52, 20480
  s_waitcnt lgkmcnt(7)
  v_pk_add_f32 v[48:49], v[48:49], v[124:125]
  v_pk_add_f32 v[128:129], v[128:129], v[132:133]
  v_pk_add_f32 v[50:51], v[50:51], v[126:127]
  v_pk_add_f32 v[130:131], v[130:131], v[134:135]
  v_pk_add_f32 v[48:49], v[48:49], v[128:129]
  v_pk_add_f32 v[50:51], v[50:51], v[130:131]
  v_cvt_pk_bf16_f32 v48, v48, v49
  v_cvt_pk_bf16_f32 v49, v50, v51
  buffer_store_dwordx2 v[48:49], v244, s[4:7], s52 offen
  s_add_u32 s52, s52, 20480
  s_waitcnt lgkmcnt(0)
  s_barrier
  ds_read_b128 v[192:195], v240 offset:3072
  ds_read_b128 v[196:199], v240 offset:8192
  ds_read_b128 v[200:203], v240 offset:13312
  ds_read_b128 v[204:207], v240 offset:4096
  ds_read_b128 v[208:211], v240 offset:9216
  ds_read_b128 v[212:215], v240 offset:14336
  s_waitcnt lgkmcnt(9)
  v_pk_add_f32 v[64:65], v[64:65], v[136:137]
  v_pk_add_f32 v[140:141], v[140:141], v[144:145]
  v_pk_add_f32 v[66:67], v[66:67], v[138:139]
  v_pk_add_f32 v[142:143], v[142:143], v[146:147]
  v_pk_add_f32 v[64:65], v[64:65], v[140:141]
  v_pk_add_f32 v[66:67], v[66:67], v[142:143]
  v_cvt_pk_bf16_f32 v64, v64, v65
  v_cvt_pk_bf16_f32 v65, v66, v67
  buffer_store_dwordx2 v[64:65], v244, s[4:7], s52 offen
  s_add_u32 s52, s52, 20480
  s_waitcnt lgkmcnt(3)
  v_pk_add_f32 v[80:81], v[80:81], v[192:193]
  v_pk_add_f32 v[196:197], v[196:197], v[200:201]
  v_pk_add_f32 v[82:83], v[82:83], v[194:195]
  v_pk_add_f32 v[198:199], v[198:199], v[202:203]
  v_pk_add_f32 v[80:81], v[80:81], v[196:197]
  v_pk_add_f32 v[82:83], v[82:83], v[198:199]
  v_cvt_pk_bf16_f32 v80, v80, v81
  v_cvt_pk_bf16_f32 v81, v82, v83
  buffer_store_dwordx2 v[80:81], v244, s[4:7], s52 offen
  s_add_u32 s52, s52, 20480
  s_waitcnt lgkmcnt(0)
  v_pk_add_f32 v[96:97], v[96:97], v[204:205]
  v_pk_add_f32 v[208:209], v[208:209], v[212:213]
  v_pk_add_f32 v[98:99], v[98:99], v[206:207]
  v_pk_add_f32 v[210:211], v[210:211], v[214:215]
  v_pk_add_f32 v[96:97], v[96:97], v[208:209]
  v_pk_add_f32 v[98:99], v[98:99], v[210:211]
  v_cvt_pk_bf16_f32 v96, v96, v97
  v_cvt_pk_bf16_f32 v97, v98, v99
  buffer_store_dwordx2 v[96:97], v244, s[4:7], s52 offen
  s_add_u32 s52, s52, 20480
L_fin:
L_end:
  s_endpgm
L_w3:
  v_mfma_f32_16x16x32_bf16 v[32:35], a[160:163], a[224:227], 0
  ds_read_b64_tr_b16 a[172:173], v213 offset:32768
  ds_read_b64_tr_b16 a[174:175], v213 offset:33792
  v_mfma_f32_16x16x32_bf16 v[32:35], a[192:195], a[240:243], v[32:35]
  s_waitcnt lgkmcnt(6)
  ds_read_b64_tr_b16 a[204:205], v213 offset:40960
  ds_read_b64_tr_b16 a[206:207], v213 offset:41984
  v_mfma_f32_16x16x32_bf16 v[36:39], a[164:167], a[224:227], 0
  ds_read_b64_tr_b16 a[176:177], v214 offset:32768
  ds_read_b64_tr_b16 a[178:179], v214 offset:33792
  v_mfma_f32_16x16x32_bf16 v[36:39], a[196:199], a[240:243], v[36:39]
  s_waitcnt lgkmcnt(6)
  ds_read_b64_tr_b16 a[208:209], v214 offset:40960
  ds_read_b64_tr_b16 a[210:211], v214 offset:41984
  v_mfma_f32_16x16x32_bf16 v[40:43], a[168:171], a[224:227], 0
  ds_read_b64_tr_b16 a[180:181], v215 offset:32768
  ds_read_b64_tr_b16 a[182:183], v215 offset:33792
  v_mfma_f32_16x16x32_bf16 v[40:43], a[200:203], a[240:243], v[40:43]
  s_waitcnt lgkmcnt(6)
  ds_read_b64_tr_b16 a[212:213], v215 offset:40960
  ds_read_b64_tr_b16 a[214:215], v215 offset:41984
  v_mfma_f32_16x16x32_bf16 v[44:47], a[172:175], a[224:227], 0
  ds_read_b64_tr_b16 a[184:185], v216 offset:32768
  ds_read_b64_tr_b16 a[186:187], v216 offset:33792
  v_mfma_f32_16x16x32_bf16 v[44:47], a[204:207], a[240:243], v[44:47]
  s_mov_b32 m0, s38
  s_waitcnt lgkmcnt(6)
  ds_read_b64_tr_b16 a[216:217], v216 offset:40960
  ds_read_b64_tr_b16 a[218:219], v216 offset:41984
  v_mfma_f32_16x16x32_bf16 v[48:51], a[176:179], a[224:227], 0
  ds_read_b64_tr_b16 a[188:189], v217 offset:32768
  ds_read_b64_tr_b16 a[190:191], v217 offset:33792
  buffer_load_dwordx4 v192, s[8:11], s30 offen lds
  v_mfma_f32_16x16x32_bf16 v[48:51], a[208:211], a[240:243], v[48:51]
  s_waitcnt lgkmcnt(6)
  ds_read_b64_tr_b16 a[220:221], v217 offset:40960
  ds_read_b64_tr_b16 a[222:223], v217 offset:41984
  v_mfma_f32_16x16x32_bf16 v[52:55], a[180:183], a[224:227], 0
  ds_read_b128 a[228:231], v204 offset:2048
  ds_read_b128 a[244:247], v205 offset:2048
  v_mfma_f32_16x16x32_bf16 v[52:55], a[212:215], a[240:243], v[52:55]
  s_waitcnt lgkmcnt(6)
  ds_read_b128 a[232:235], v204 offset:4096
  ds_read_b128 a[248:251], v205 offset:4096
  v_mfma_f32_16x16x32_bf16 v[56:59], a[184:187], a[224:227], 0
  ds_read_b128 a[236:239], v204 offset:6144
  ds_read_b128 a[252:255], v205 offset:6144
  buffer_load_dwordx4 v193, s[8:11], s30 offen offset:1024 lds
  v_mfma_f32_16x16x32_bf16 v[56:59], a[216:219], a[240:243], v[56:59]
  s_waitcnt lgkmcnt(6)
  v_mfma_f32_16x16x32_bf16 v[60:63], a[188:191], a[224:227], 0
  v_mfma_f32_16x16x32_bf16 v[60:63], a[220:223], a[240:243], v[60:63]
  s_waitcnt lgkmcnt(0)
  v_mfma_f32_16x16x32_bf16 v[64:67], a[160:163], a[228:231], 0
  buffer_load_dwordx4 v194, s[8:11], s30 offen offset:2048 lds
  v_mfma_f32_16x16x32_bf16 v[64:67], a[192:195], a[244:247], v[64:67]
  v_mfma_f32_16x16x32_bf16 v[68:71], a[164:167], a[228:231], 0
  v_mfma_f32_16x16x32_bf16 v[68:71], a[196:199], a[244:247], v[68:71]
  v_mfma_f32_16x16x32_bf16 v[72:75], a[168:171], a[228:231], 0
  buffer_load_dwordx4 v195, s[8:11], s30 offen offset:3072 lds
  v_mfma_f32_16x16x32_bf16 v[72:75], a[200:203], a[244:247], v[72:75]
  v_mfma_f32_16x16x32_bf16 v[76:79], a[172:175], a[228:231], 0
  s_waitcnt lgkmcnt(0)
  s_barrier
  v_mfma_f32_16x16x32_bf16 v[76:79], a[204:207], a[244:247], v[76:79]
  s_add_u32 m0, s38, 4096
  v_mfma_f32_16x16x32_bf16 v[80:83], a[176:179], a[228:231], 0
  buffer_load_dwordx4 v196, s[8:11], s30 offen lds
  v_mfma_f32_16x16x32_bf16 v[80:83], a[208:211], a[244:247], v[80:83]
  v_mfma_f32_16x16x32_bf16 v[84:87], a[180:183], a[228:231], 0
  v_mfma_f32_16x16x32_bf16 v[84:87], a[212:215], a[244:247], v[84:87]
  v_mfma_f32_16x16x32_bf16 v[88:91], a[184:187], a[228:231], 0
  buffer_load_dwordx4 v197, s[8:11], s30 offen offset:1024 lds
  v_mfma_f32_16x16x32_bf16 v[88:91], a[216:219], a[244:247], v[88:91]
  v_mfma_f32_16x16x32_bf16 v[92:95], a[188:191], a[228:231], 0
  v_mfma_f32_16x16x32_bf16 v[92:95], a[220:223], a[244:247], v[92:95]
  v_mfma_f32_16x16x32_bf16 v[96:99], a[160:163], a[232:235], 0
  v_mfma_f32_16x16x32_bf16 v[96:99], a[192:195], a[248:251], v[96:99]
  buffer_load_dwordx4 v198, s[8:11], s30 offen offset:2048 lds
  v_mfma_f32_16x16x32_bf16 v[100:103], a[164:167], a[232:235], 0
  v_mfma_f32_16x16x32_bf16 v[100:103], a[196:199], a[248:251], v[100:103]
  v_mfma_f32_16x16x32_bf16 v[104:107], a[168:171], a[232:235], 0
  v_mfma_f32_16x16x32_bf16 v[104:107], a[200:203], a[248:251], v[104:107]
  buffer_load_dwordx4 v199, s[8:11], s30 offen offset:3072 lds
  v_mfma_f32_16x16x32_bf16 v[108:111], a[172:175], a[232:235], 0
  v_mfma_f32_16x16x32_bf16 v[108:111], a[204:207], a[248:251], v[108:111]
  v_mfma_f32_16x16x32_bf16 v[112:115], a[176:179], a[232:235], 0
  s_add_u32 m0, s39, 16384
  s_waitcnt vmcnt(8)
  s_barrier
  v_mfma_f32_16x16x32_bf16 v[112:115], a[208:211], a[248:251], v[112:115]
  ds_read_b128 a[64:67], v206
  ds_read_b128 a[80:83], v207
  buffer_load_dwordx4 v200, s[12:15], s31 offen lds
  v_mfma_f32_16x16x32_bf16 v[116:119], a[180:183], a[232:235], 0
  ds_read_b64_tr_b16 a[0:1], v210 offset:0
  ds_read_b64_tr_b16 a[2:3], v210 offset:1024
  v_mfma_f32_16x16x32_bf16 v[116:119], a[212:215], a[248:251], v[116:119]
  ds_read_b64_tr_b16 a[32:33], v210 offset:8192
  ds_read_b64_tr_b16 a[34:35], v210 offset:9216
  v_mfma_f32_16x16x32_bf16 v[120:123], a[184:187], a[232:235], 0
  ds_read_b64_tr_b16 a[4:5], v211 offset:0
  ds_read_b64_tr_b16 a[6:7], v211 offset:1024
  v_mfma_f32_16x16x32_bf16 v[120:123], a[216:219], a[248:251], v[120:123]
  ds_read_b64_tr_b16 a[36:37], v211 offset:8192
  ds_read_b64_tr_b16 a[38:39], v211 offset:9216
  buffer_load_dwordx4 v201, s[12:15], s31 offen offset:1024 lds
  v_mfma_f32_16x16x32_bf16 v[124:127], a[188:191], a[232:235], 0
  ds_read_b64_tr_b16 a[8:9], v212 offset:0
  ds_read_b64_tr_b16 a[10:11], v212 offset:1024
  v_mfma_f32_16x16x32_bf16 v[124:127], a[220:223], a[248:251], v[124:127]
  ds_read_b64_tr_b16 a[40:41], v212 offset:8192
  ds_read_b64_tr_b16 a[42:43], v212 offset:9216
  ds_read_b64_tr_b16 a[12:13], v213 offset:0
  ds_read_b64_tr_b16 a[14:15], v213 offset:1024
  ds_read_b64_tr_b16 a[44:45], v213 offset:8192
  ds_read_b64_tr_b16 a[46:47], v213 offset:9216
  buffer_load_dwordx4 v202, s[12:15], s31 offen offset:2048 lds
  ds_read_b64_tr_b16 a[16:17], v214 offset:0
  ds_read_b64_tr_b16 a[18:19], v214 offset:1024
  ds_read_b64_tr_b16 a[48:49], v214 offset:8192
  ds_read_b64_tr_b16 a[50:51], v214 offset:9216
  ds_read_b64_tr_b16 a[20:21], v215 offset:0
  ds_read_b64_tr_b16 a[22:23], v215 offset:1024
  ds_read_b64_tr_b16 a[52:53], v215 offset:8192
  ds_read_b64_tr_b16 a[54:55], v215 offset:9216
  buffer_load_dwordx4 v203, s[12:15], s31 offen offset:3072 lds
  s_add_u32 s32, s32, 1
  ds_read_b64_tr_b16 a[24:25], v216 offset:0
  ds_read_b64_tr_b16 a[26:27], v216 offset:1024
  s_cmp_eq_u32 s32, 10
  s_cselect_b32 s32, 0, s32
  ds_read_b64_tr_b16 a[56:57], v216 offset:8192
  ds_read_b64_tr_b16 a[58:59], v216 offset:9216
  s_lshl_b32 s30, s32, 7
  ds_read_b64_tr_b16 a[28:29], v217 offset:0
  ds_read_b64_tr_b16 a[30:31], v217 offset:1024
  s_lshl_b32 s31, s32, 19
  s_mov_b32 m0, s36
  ds_read_b64_tr_b16 a[60:61], v217 offset:8192
  ds_read_b64_tr_b16 a[62:63], v217 offset:9216
  ds_read_b128 a[68:71], v206 offset:2048
  ds_read_b128 a[84:87], v207 offset:2048
  buffer_load_dwordx4 v192, s[8:11], s30 offen lds
  ds_read_b128 a[72:75], v206 offset:4096
  ds_read_b128 a[88:91], v207 offset:4096
  ds_read_b128 a[76:79], v206 offset:6144
  ds_read_b128 a[92:95], v207 offset:6144
  buffer_load_dwordx4 v193, s[8:11], s30 offen offset:1024 lds
  s_waitcnt lgkmcnt(0)
  s_barrier
  v_mfma_f32_16x16x32_bf16 v[32:35], a[0:3], a[64:67], v[32:35]
  v_mfma_f32_16x16x32_bf16 v[32:35], a[32:35], a[80:83], v[32:35]
  v_mfma_f32_16x16x32_bf16 v[36:39], a[4:7], a[64:67], v[36:39]
  buffer_load_dwordx4 v194, s[8:11], s30 offen offset:2048 lds
  s_lshl_b32 s52, s28, 5
  v_mfma_f32_16x16x32_bf16 v[36:39], a[36:39], a[80:83], v[36:39]
  s_add_u32 s52, s52, s29
  v_mfma_f32_16x16x32_bf16 v[40:43], a[8:11], a[64:67], v[40:43]
  s_lshl_b32 s52, s52, 7
  v_mfma_f32_16x16x32_bf16 v[40:43], a[40:43], a[80:83], v[40:43]
  s_add_u32 s52, s52, 25165824
  v_mfma_f32_16x16x32_bf16 v[44:47], a[12:15], a[64:67], v[44:47]
  buffer_load_dwordx4 v195, s[8:11], s30 offen offset:3072 lds
  v_mov_b32 v18, s52
  v_mfma_f32_16x16x32_bf16 v[44:47], a[44:47], a[80:83], v[44:47]
  v_mov_b32 v19, 0
  s_mov_b64 exec, 1
  global_store_dword v18, v19, s[48:49] sc1
  s_mov_b64 exec, -1
  v_mfma_f32_16x16x32_bf16 v[48:51], a[16:19], a[64:67], v[48:51]
  v_and_b32 v0, 31, v1
  v_lshlrev_b32 v0, 3, v0
  v_mfma_f32_16x16x32_bf16 v[48:51], a[48:51], a[80:83], v[48:51]
  s_add_u32 m0, s36, 4096
  s_lshl_b32 s52, s28, 5
  v_mfma_f32_16x16x32_bf16 v[52:55], a[20:23], a[64:67], v[52:55]
  buffer_load_dwordx4 v196, s[8:11], s30 offen lds
  s_add_u32 s52, s52, s29
  v_mfma_f32_16x16x32_bf16 v[52:55], a[52:55], a[80:83], v[52:55]
  s_lshl_b32 s52, s52, 18
  v_mfma_f32_16x16x32_bf16 v[56:59], a[24:27], a[64:67], v[56:59]
  s_add_u32 s16, s6, s52
  s_addc_u32 s17, s7, 0
  v_mfma_f32_16x16x32_bf16 v[56:59], a[56:59], a[80:83], v[56:59]
  s_mov_b32 s18, 262144
  v_mfma_f32_16x16x32_bf16 v[60:63], a[28:31], a[64:67], v[60:63]
  buffer_load_dwordx4 v197, s[8:11], s30 offen offset:1024 lds
  s_mov_b32 s19, 0x20000
  v_mfma_f32_16x16x32_bf16 v[60:63], a[60:63], a[80:83], v[60:63]
  s_add_u32 s20, s44, s52
  s_addc_u32 s21, s45, 0
  v_mfma_f32_16x16x32_bf16 v[64:67], a[0:3], a[68:71], v[64:67]
  s_mov_b32 s22, 262144
  v_mfma_f32_16x16x32_bf16 v[64:67], a[32:35], a[84:87], v[64:67]
  s_mov_b32 s23, 0x20000
  v_mfma_f32_16x16x32_bf16 v[68:71], a[4:7], a[68:71], v[68:71]
  buffer_load_dwordx4 v198, s[8:11], s30 offen offset:2048 lds
  s_mul_i32 s52, s28, 1966080
  v_mfma_f32_16x16x32_bf16 v[68:71], a[36:39], a[84:87], v[68:71]
  s_add_u32 s24, s48, s52
  s_addc_u32 s25, s49, 0
  v_mfma_f32_16x16x32_bf16 v[72:75], a[8:11], a[68:71], v[72:75]
  s_mov_b32 s26, 1966080
  v_mfma_f32_16x16x32_bf16 v[72:75], a[40:43], a[84:87], v[72:75]
  s_mov_b32 s27, 0x20000
  v_mfma_f32_16x16x32_bf16 v[76:79], a[12:15], a[68:71], v[76:79]
  buffer_load_dwordx4 v199, s[8:11], s30 offen offset:3072 lds
  v_lshlrev_b32 v10, 8, v3
  v_mfma_f32_16x16x32_bf16 v[76:79], a[44:47], a[84:87], v[76:79]
  v_add_u32 v9, 0, v3
  v_xor_b32 v9, v9, v2
  v_mfma_f32_16x16x32_bf16 v[80:83], a[16:19], a[68:71], v[80:83]
  v_lshl_add_u32 v236, v9, 4, v10
  v_add_u32 v9, 4, v3
  v_mfma_f32_16x16x32_bf16 v[80:83], a[48:51], a[84:87], v[80:83]
  s_add_u32 m0, s39, 32768
  v_xor_b32 v9, v9, v2
  v_lshl_add_u32 v237, v9, 4, v10
  v_mfma_f32_16x16x32_bf16 v[84:87], a[20:23], a[68:71], v[84:87]
  buffer_load_dwordx4 v200, s[12:15], s31 offen lds
  v_add_u32 v9, 8, v3
  v_mfma_f32_16x16x32_bf16 v[84:87], a[52:55], a[84:87], v[84:87]
  v_xor_b32 v9, v9, v2
  v_lshl_add_u32 v238, v9, 4, v10
  v_mfma_f32_16x16x32_bf16 v[88:91], a[24:27], a[68:71], v[88:91]
  v_add_u32 v9, 12, v3
  v_xor_b32 v9, v9, v2
  v_mfma_f32_16x16x32_bf16 v[88:91], a[56:59], a[84:87], v[88:91]
  v_lshl_add_u32 v239, v9, 4, v10
  v_add_u32 v9, 0, v3
  v_mfma_f32_16x16x32_bf16 v[92:95], a[28:31], a[68:71], v[92:95]
  buffer_load_dwordx4 v201, s[12:15], s31 offen offset:1024 lds
  v_lshlrev_b32 v9, 1, v9
  v_mfma_f32_16x16x32_bf16 v[92:95], a[60:63], a[84:87], v[92:95]
  v_xor_b32 v9, v9, v2
  v_lshl_add_u32 v240, v9, 4, v10
  v_mfma_f32_16x16x32_bf16 v[96:99], a[0:3], a[72:75], v[96:99]
  v_add_u32 v9, 4, v3
  v_lshlrev_b32 v9, 1, v9
  v_mfma_f32_16x16x32_bf16 v[96:99], a[32:35], a[88:91], v[96:99]
  v_xor_b32 v9, v9, v2
  v_lshl_add_u32 v241, v9, 4, v10
  v_mfma_f32_16x16x32_bf16 v[100:103], a[4:7], a[72:75], v[100:103]
  buffer_load_dwordx4 v202, s[12:15], s31 offen offset:2048 lds
  v_and_b32 v10, 1, v3
  v_mfma_f32_16x16x32_bf16 v[100:103], a[36:39], a[88:91], v[100:103]
  v_lshl_or_b32 v9, v10, 2, v6
  v_lshl_or_b32 v9, v9, 1, v11
  v_mfma_f32_16x16x32_bf16 v[104:107], a[8:11], a[72:75], v[104:107]
  v_lshl_add_u32 v14, v3, 2, v6
  v_lshl_add_u32 v14, v14, 8, v12
  v_mfma_f32_16x16x32_bf16 v[104:107], a[40:43], a[88:91], v[104:107]
  v_add_u32 v14, 65536, v14
  v_xor_b32 v8, 0, v9
  v_mfma_f32_16x16x32_bf16 v[108:111], a[12:15], a[72:75], v[108:111]
  buffer_load_dwordx4 v203, s[12:15], s31 offen offset:3072 lds
  v_lshl_add_u32 v228, v8, 4, v14
  v_mfma_f32_16x16x32_bf16 v[108:111], a[44:47], a[88:91], v[108:111]
  s_add_u32 s32, s32, 1
  v_xor_b32 v8, 2, v9
  v_lshl_add_u32 v229, v8, 4, v14
  v_mfma_f32_16x16x32_bf16 v[112:115], a[16:19], a[72:75], v[112:115]
  s_cmp_eq_u32 s32, 10
  s_cselect_b32 s32, 0, s32
  s_waitcnt vmcnt(13)
  s_barrier
  v_mfma_f32_16x16x32_bf16 v[112:115], a[48:51], a[88:91], v[112:115]
  s_lshl_b32 s30, s32, 7
  ds_read_b128 v[160:163], v208
  ds_read_b128 v[176:179], v209
  v_mfma_f32_16x16x32_bf16 v[116:119], a[20:23], a[72:75], v[116:119]
  s_mov_b32 m0, s37
  s_lshl_b32 s31, s32, 19
  ds_read_b64_tr_b16 a[96:97], v210 offset:16384
  ds_read_b64_tr_b16 a[98:99], v210 offset:17408
  v_mfma_f32_16x16x32_bf16 v[116:119], a[52:55], a[88:91], v[116:119]
  ds_read_b64_tr_b16 a[128:129], v210 offset:24576
  ds_read_b64_tr_b16 a[130:131], v210 offset:25600
  buffer_load_dwordx4 v192, s[8:11], s30 offen lds
  v_mfma_f32_16x16x32_bf16 v[120:123], a[24:27], a[72:75], v[120:123]
  ds_read_b64_tr_b16 a[100:101], v211 offset:16384
  ds_read_b64_tr_b16 a[102:103], v211 offset:17408
  v_mfma_f32_16x16x32_bf16 v[120:123], a[56:59], a[88:91], v[120:123]
  ds_read_b64_tr_b16 a[132:133], v211 offset:24576
  ds_read_b64_tr_b16 a[134:135], v211 offset:25600
  v_mfma_f32_16x16x32_bf16 v[124:127], a[28:31], a[72:75], v[124:127]
  ds_read_b64_tr_b16 a[104:105], v212 offset:16384
  ds_read_b64_tr_b16 a[106:107], v212 offset:17408
  v_mfma_f32_16x16x32_bf16 v[124:127], a[60:63], a[88:91], v[124:127]
  ds_read_b64_tr_b16 a[136:137], v212 offset:24576
  ds_read_b64_tr_b16 a[138:139], v212 offset:25600
  buffer_load_dwordx4 v193, s[8:11], s30 offen offset:1024 lds
  ds_read_b64_tr_b16 a[108:109], v213 offset:16384
  ds_read_b64_tr_b16 a[110:111], v213 offset:17408
  ds_read_b64_tr_b16 a[140:141], v213 offset:24576
  ds_read_b64_tr_b16 a[142:143], v213 offset:25600
  ds_read_b64_tr_b16 a[112:113], v214 offset:16384
  ds_read_b64_tr_b16 a[114:115], v214 offset:17408
  ds_read_b64_tr_b16 a[144:145], v214 offset:24576
  ds_read_b64_tr_b16 a[146:147], v214 offset:25600
  buffer_load_dwordx4 v194, s[8:11], s30 offen offset:2048 lds
  ds_read_b64_tr_b16 a[116:117], v215 offset:16384
  ds_read_b64_tr_b16 a[118:119], v215 offset:17408
  ds_read_b64_tr_b16 a[148:149], v215 offset:24576
  ds_read_b64_tr_b16 a[150:151], v215 offset:25600
  ds_read_b64_tr_b16 a[120:121], v216 offset:16384
  ds_read_b64_tr_b16 a[122:123], v216 offset:17408
  ds_read_b64_tr_b16 a[152:153], v216 offset:24576
  ds_read_b64_tr_b16 a[154:155], v216 offset:25600
  buffer_load_dwordx4 v195, s[8:11], s30 offen offset:3072 lds
  ds_read_b64_tr_b16 a[124:125], v217 offset:16384
  ds_read_b64_tr_b16 a[126:127], v217 offset:17408
  ds_read_b64_tr_b16 a[156:157], v217 offset:24576
  ds_read_b64_tr_b16 a[158:159], v217 offset:25600
  s_add_u32 m0, s37, 4096
  ds_read_b128 v[164:167], v208 offset:2048
  ds_read_b128 v[180:183], v209 offset:2048
  ds_read_b128 v[168:171], v208 offset:4096
  ds_read_b128 v[184:187], v209 offset:4096
  buffer_load_dwordx4 v196, s[8:11], s30 offen lds
  ds_read_b128 v[172:175], v208 offset:6144
  ds_read_b128 v[188:191], v209 offset:6144
  v_xor_b32 v8, 4, v9
  v_lshl_add_u32 v230, v8, 4, v14
  v_xor_b32 v8, 6, v9
  v_lshl_add_u32 v231, v8, 4, v14
  buffer_load_dwordx4 v197, s[8:11], s30 offen offset:1024 lds
  s_waitcnt lgkmcnt(0)
  s_barrier
  v_mfma_f32_16x16x32_bf16 v[32:35], a[96:99], v[160:163], v[32:35]
  v_xor_b32 v8, 8, v9
  v_lshl_add_u32 v232, v8, 4, v14
  v_mfma_f32_16x16x32_bf16 v[32:35], a[128:131], v[176:179], v[32:35]
  v_xor_b32 v8, 10, v9
  v_lshl_add_u32 v233, v8, 4, v14
  v_mfma_f32_16x16x32_bf16 v[36:39], a[100:103], v[160:163], v[36:39]
  v_xor_b32 v8, 12, v9
  v_lshl_add_u32 v234, v8, 4, v14
  v_mfma_f32_16x16x32_bf16 v[36:39], a[132:135], v[176:179], v[36:39]
  buffer_load_dwordx4 v198, s[8:11], s30 offen offset:2048 lds
  v_xor_b32 v8, 14, v9
  v_mfma_f32_16x16x32_bf16 v[40:43], a[104:107], v[160:163], v[40:43]
  v_lshl_add_u32 v235, v8, 4, v14
  v_or_b32 v8, 0, v3
  v_mfma_f32_16x16x32_bf16 v[40:43], a[136:139], v[176:179], v[40:43]
  v_xor_b32 v8, v8, v2
  v_lshlrev_b32 v8, 4, v8
  v_mfma_f32_16x16x32_bf16 v[44:47], a[108:111], v[160:163], v[44:47]
  v_lshl_add_u32 v224, v2, 8, v8
  v_or_b32 v8, 4, v3
  v_mfma_f32_16x16x32_bf16 v[44:47], a[140:143], v[176:179], v[44:47]
  buffer_load_dwordx4 v199, s[8:11], s30 offen offset:3072 lds
  v_xor_b32 v8, v8, v2
  v_mfma_f32_16x16x32_bf16 v[48:51], a[112:115], v[160:163], v[48:51]
  v_lshlrev_b32 v8, 4, v8
  v_lshl_add_u32 v225, v2, 8, v8
  v_mfma_f32_16x16x32_bf16 v[48:51], a[144:147], v[176:179], v[48:51]
  v_or_b32 v8, 8, v3
  v_xor_b32 v8, v8, v2
  v_mfma_f32_16x16x32_bf16 v[52:55], a[116:119], v[160:163], v[52:55]
  s_add_u32 m0, s39, 0
  v_lshlrev_b32 v8, 4, v8
  v_lshl_add_u32 v226, v2, 8, v8
  v_mfma_f32_16x16x32_bf16 v[52:55], a[148:151], v[176:179], v[52:55]
  buffer_load_dwordx4 v200, s[12:15], s31 offen lds
  v_or_b32 v8, 12, v3
  v_mfma_f32_16x16x32_bf16 v[56:59], a[120:123], v[160:163], v[56:59]
  v_xor_b32 v8, v8, v2
  v_lshlrev_b32 v8, 4, v8
  v_mfma_f32_16x16x32_bf16 v[56:59], a[152:155], v[176:179], v[56:59]
  v_lshl_add_u32 v227, v2, 8, v8
  v_mov_b32 v242, 0xff800000
  v_mfma_f32_16x16x32_bf16 v[60:63], a[124:127], v[160:163], v[60:63]
  v_mov_b32 v243, 0xff800000
  v_mov_b32 v244, 0xff800000
  v_mfma_f32_16x16x32_bf16 v[60:63], a[156:159], v[176:179], v[60:63]
  buffer_load_dwordx4 v201, s[12:15], s31 offen offset:1024 lds
  v_mov_b32 v245, 0xff800000
  v_mfma_f32_16x16x32_bf16 v[64:67], a[96:99], v[164:167], v[64:67]
  v_lshlrev_b32 v15, 4, v1
  v_lshlrev_b32 v9, 1, v3
  v_mfma_f32_16x16x32_bf16 v[64:67], a[128:131], v[180:183], v[64:67]
  v_xor_b32 v9, v9, v5
  v_lshlrev_b32 v9, 4, v9
  v_mfma_f32_16x16x32_bf16 v[68:71], a[100:103], v[164:167], v[68:71]
  v_mul_u32_u24 v8, 1280, v4
  v_add_u32 v8, v8, v9
  v_mfma_f32_16x16x32_bf16 v[68:71], a[132:135], v[180:183], v[68:71]
  buffer_load_dwordx4 v202, s[12:15], s31 offen offset:2048 lds
  v_add_u32 v246, 0, v8
  v_mfma_f32_16x16x32_bf16 v[72:75], a[104:107], v[164:167], v[72:75]
  v_add_u32 v247, 9216, v8
  v_add_u32 v248, 18432, v8
  v_mfma_f32_16x16x32_bf16 v[72:75], a[136:139], v[180:183], v[72:75]
  v_add_u32 v249, 27648, v8
  v_lshl_add_u32 v14, v3, 2, v6
  v_mfma_f32_16x16x32_bf16 v[76:79], a[108:111], v[164:167], v[76:79]
  s_waitcnt vmcnt(11)
  s_barrier
  v_mfma_f32_16x16x32_bf16 v[76:79], a[140:143], v[180:183], v[76:79]
  ds_read_b128 a[224:227], v204
  ds_read_b128 a[240:243], v205
  buffer_load_dwordx4 v203, s[12:15], s31 offen offset:3072 lds
  v_mfma_f32_16x16x32_bf16 v[80:83], a[112:115], v[164:167], v[80:83]
  s_add_u32 s32, s32, 1
  ds_read_b64_tr_b16 a[160:161], v210 offset:32768
  v_bfe_u32 v13, v14, 1, 2
  v_mfma_f32_16x16x32_bf16 v[80:83], a[144:147], v[180:183], v[80:83]
  s_cmp_eq_u32 s32, 10
  s_cselect_b32 s32, 0, s32
  ds_read_b64_tr_b16 a[162:163], v210 offset:33792
  v_lshl_or_b32 v13, v13, 1, v11
  v_mfma_f32_16x16x32_bf16 v[84:87], a[116:119], v[164:167], v[84:87]
  s_lshl_b32 s30, s32, 7
  ds_read_b64_tr_b16 a[192:193], v210 offset:40960
  ds_read_b64_tr_b16 a[194:195], v210 offset:41984
  v_mfma_f32_16x16x32_bf16 v[84:87], a[148:151], v[180:183], v[84:87]
  s_mov_b32 m0, s38
  s_lshl_b32 s31, s32, 19
  ds_read_b64_tr_b16 a[164:165], v211 offset:32768
  v_lshl_add_u32 v14, v14, 7, v12
  v_mfma_f32_16x16x32_bf16 v[88:91], a[120:123], v[164:167], v[88:91]
  ds_read_b64_tr_b16 a[166:167], v211 offset:33792
  buffer_load_dwordx4 v192, s[8:11], s30 offen lds
  v_mfma_f32_16x16x32_bf16 v[88:91], a[152:155], v[180:183], v[88:91]
  ds_read_b64_tr_b16 a[196:197], v211 offset:40960
  ds_read_b64_tr_b16 a[198:199], v211 offset:41984
  v_mfma_f32_16x16x32_bf16 v[92:95], a[124:127], v[164:167], v[92:95]
  ds_read_b64_tr_b16 a[168:169], v212 offset:32768
  v_add_u32 v14, s40, v14
  v_mfma_f32_16x16x32_bf16 v[92:95], a[156:159], v[180:183], v[92:95]
  ds_read_b64_tr_b16 a[170:171], v212 offset:33792
  s_add_u32 s53, s3, 0
  v_mfma_f32_16x16x32_bf16 v[96:99], a[96:99], v[168:171], v[96:99]
  ds_read_b64_tr_b16 a[200:201], v212 offset:40960
  ds_read_b64_tr_b16 a[202:203], v212 offset:41984
  buffer_load_dwordx4 v193, s[8:11], s30 offen offset:1024 lds
  v_mfma_f32_16x16x32_bf16 v[96:99], a[128:131], v[184:187], v[96:99]
  ds_read_b64_tr_b16 a[172:173], v213 offset:32768
  s_and_b32 s53, s53, 3
  v_mfma_f32_16x16x32_bf16 v[100:103], a[100:103], v[168:171], v[100:103]
  ds_read_b64_tr_b16 a[174:175], v213 offset:33792
  s_lshl_b32 s53, s53, 1
  v_mfma_f32_16x16x32_bf16 v[100:103], a[132:135], v[184:187], v[100:103]
  ds_read_b64_tr_b16 a[204:205], v213 offset:40960
  ds_read_b64_tr_b16 a[206:207], v213 offset:41984
  v_mfma_f32_16x16x32_bf16 v[104:107], a[104:107], v[168:171], v[104:107]
  ds_read_b64_tr_b16 a[176:177], v214 offset:32768
  buffer_load_dwordx4 v194, s[8:11], s30 offen offset:2048 lds
  v_mfma_f32_16x16x32_bf16 v[104:107], a[136:139], v[184:187], v[104:107]
  ds_read_b64_tr_b16 a[178:179], v214 offset:33792
  v_xor_b32 v16, s53, v13
  v_mfma_f32_16x16x32_bf16 v[108:111], a[108:111], v[168:171], v[108:111]
  ds_read_b64_tr_b16 a[208:209], v214 offset:40960
  ds_read_b64_tr_b16 a[210:211], v214 offset:41984
  v_mfma_f32_16x16x32_bf16 v[108:111], a[140:143], v[184:187], v[108:111]
  ds_read_b64_tr_b16 a[180:181], v215 offset:32768
  v_lshl_add_u32 v28, v16, 4, v14
  v_mfma_f32_16x16x32_bf16 v[112:115], a[112:115], v[168:171], v[112:115]
  ds_read_b64_tr_b16 a[182:183], v215 offset:33792
  buffer_load_dwordx4 v195, s[8:11], s30 offen offset:3072 lds
  v_mfma_f32_16x16x32_bf16 v[112:115], a[144:147], v[184:187], v[112:115]
  ds_read_b64_tr_b16 a[212:213], v215 offset:40960
  ds_read_b64_tr_b16 a[214:215], v215 offset:41984
  v_mfma_f32_16x16x32_bf16 v[116:119], a[116:119], v[168:171], v[116:119]
  ds_read_b64_tr_b16 a[184:185], v216 offset:32768
  v_add_u32 v250, 65536, v28
  v_mfma_f32_16x16x32_bf16 v[116:119], a[148:151], v[184:187], v[116:119]
  s_add_u32 m0, s38, 4096
  ds_read_b64_tr_b16 a[186:187], v216 offset:33792
  v_add_u32 v7, 131072, v28
  v_mfma_f32_16x16x32_bf16 v[120:123], a[120:123], v[168:171], v[120:123]
  ds_read_b64_tr_b16 a[216:217], v216 offset:40960
  ds_read_b64_tr_b16 a[218:219], v216 offset:41984
  buffer_load_dwordx4 v196, s[8:11], s30 offen lds
  v_mfma_f32_16x16x32_bf16 v[120:123], a[152:155], v[184:187], v[120:123]
  ds_read_b64_tr_b16 a[188:189], v217 offset:32768
  s_add_u32 s53, s3, 1
  v_mfma_f32_16x16x32_bf16 v[124:127], a[124:127], v[168:171], v[124:127]
  ds_read_b64_tr_b16 a[190:191], v217 offset:33792
  s_and_b32 s53, s53, 3
  v_mfma_f32_16x16x32_bf16 v[124:127], a[156:159], v[184:187], v[124:127]
  ds_read_b64_tr_b16 a[220:221], v217 offset:40960
  ds_read_b64_tr_b16 a[222:223], v217 offset:41984
  ds_read_b128 a[228:231], v204 offset:2048
  buffer_load_dwordx4 v197, s[8:11], s30 offen offset:1024 lds
  ds_read_b128 a[244:247], v205 offset:2048
  s_lshl_b32 s53, s53, 1
  ds_read_b128 a[232:235], v204 offset:4096
  ds_read_b128 a[248:251], v205 offset:4096
  ds_read_b128 a[236:239], v204 offset:6144
  v_xor_b32 v16, s53, v13
  ds_read_b128 a[252:255], v205 offset:6144
  buffer_load_dwordx4 v198, s[8:11], s30 offen offset:2048 lds
  v_lshl_add_u32 v29, v16, 4, v14
  v_add_u32 v251, 65536, v29
  v_add_u32 v8, 131072, v29
  s_add_u32 s53, s3, 2
  s_and_b32 s53, s53, 3
  buffer_load_dwordx4 v199, s[8:11], s30 offen offset:3072 lds
  s_lshl_b32 s53, s53, 1
  v_xor_b32 v16, s53, v13
  v_lshl_add_u32 v30, v16, 4, v14
  v_add_u32 v252, 65536, v30
  v_add_u32 v9, 131072, v30
  s_add_u32 m0, s39, 16384
  s_add_u32 s53, s3, 3
  buffer_load_dwordx4 v200, s[12:15], s31 offen lds
  s_and_b32 s53, s53, 3
  s_lshl_b32 s53, s53, 1
  s_waitcnt vmcnt(9) lgkmcnt(0)
  s_barrier
  ds_read_b128 a[64:67], v206
  ds_read_b128 a[80:83], v207
  v_mfma_f32_16x16x32_bf16 v[32:35], a[160:163], a[224:227], v[32:35]
  ds_read_b64_tr_b16 a[0:1], v210 offset:0
  buffer_load_dwordx4 v201, s[12:15], s31 offen offset:1024 lds
  v_mfma_f32_16x16x32_bf16 v[32:35], a[192:195], a[240:243], v[32:35]
  ds_read_b64_tr_b16 a[2:3], v210 offset:1024
  v_xor_b32 v16, s53, v13
  v_mfma_f32_16x16x32_bf16 v[36:39], a[164:167], a[224:227], v[36:39]
  ds_read_b64_tr_b16 a[32:33], v210 offset:8192
  ds_read_b64_tr_b16 a[34:35], v210 offset:9216
  v_mfma_f32_16x16x32_bf16 v[36:39], a[196:199], a[240:243], v[36:39]
  ds_read_b64_tr_b16 a[4:5], v211 offset:0
  v_lshl_add_u32 v31, v16, 4, v14
  v_mfma_f32_16x16x32_bf16 v[40:43], a[168:171], a[224:227], v[40:43]
  ds_read_b64_tr_b16 a[6:7], v211 offset:1024
  buffer_load_dwordx4 v202, s[12:15], s31 offen offset:2048 lds
  v_mfma_f32_16x16x32_bf16 v[40:43], a[200:203], a[240:243], v[40:43]
  ds_read_b64_tr_b16 a[36:37], v211 offset:8192
  ds_read_b64_tr_b16 a[38:39], v211 offset:9216
  v_mfma_f32_16x16x32_bf16 v[44:47], a[172:175], a[224:227], v[44:47]
  ds_read_b64_tr_b16 a[8:9], v212 offset:0
  v_add_u32 v253, 65536, v31
  v_mfma_f32_16x16x32_bf16 v[44:47], a[204:207], a[240:243], v[44:47]
  ds_read_b64_tr_b16 a[10:11], v212 offset:1024
  v_add_u32 v10, 131072, v31
  v_mfma_f32_16x16x32_bf16 v[48:51], a[176:179], a[224:227], v[48:51]
  ds_read_b64_tr_b16 a[40:41], v212 offset:8192
  ds_read_b64_tr_b16 a[42:43], v212 offset:9216
  buffer_load_dwordx4 v203, s[12:15], s31 offen offset:3072 lds
  v_mfma_f32_16x16x32_bf16 v[48:51], a[208:211], a[240:243], v[48:51]
  s_add_u32 s32, s32, 1
  ds_read_b64_tr_b16 a[12:13], v213 offset:0
  v_add_u32 v4, 0, v15
  v_mfma_f32_16x16x32_bf16 v[52:55], a[180:183], a[224:227], v[52:55]
  s_cmp_eq_u32 s32, 10
  s_cselect_b32 s32, 0, s32
  ds_read_b64_tr_b16 a[14:15], v213 offset:1024
  v_add_u32 v5, 131072, v15
  v_mfma_f32_16x16x32_bf16 v[52:55], a[212:215], a[240:243], v[52:55]
  s_lshl_b32 s30, s32, 7
  ds_read_b64_tr_b16 a[44:45], v213 offset:8192
  ds_read_b64_tr_b16 a[46:47], v213 offset:9216
  v_mfma_f32_16x16x32_bf16 v[56:59], a[184:187], a[224:227], v[56:59]
  s_mov_b32 m0, s36
  s_lshl_b32 s31, s32, 19
  ds_read_b64_tr_b16 a[16:17], v214 offset:0
  v_add_u32 v13, 262144, v15
  v_mfma_f32_16x16x32_bf16 v[56:59], a[216:219], a[240:243], v[56:59]
  ds_read_b64_tr_b16 a[18:19], v214 offset:1024
  buffer_load_dwordx4 v192, s[8:11], s30 offen lds
  v_mfma_f32_16x16x32_bf16 v[60:63], a[188:191], a[224:227], v[60:63]
  ds_read_b64_tr_b16 a[48:49], v214 offset:8192
  ds_read_b64_tr_b16 a[50:51], v214 offset:9216
  v_mfma_f32_16x16x32_bf16 v[60:63], a[220:223], a[240:243], v[60:63]
  ds_read_b64_tr_b16 a[20:21], v215 offset:0
  v_add_u32 v14, 393216, v15
  v_mfma_f32_16x16x32_bf16 v[64:67], a[160:163], a[228:231], v[64:67]
  ds_read_b64_tr_b16 a[22:23], v215 offset:1024
  v_add_u32 v254, 524288, v15
  v_mfma_f32_16x16x32_bf16 v[64:67], a[192:195], a[244:247], v[64:67]
  ds_read_b64_tr_b16 a[52:53], v215 offset:8192
  ds_read_b64_tr_b16 a[54:55], v215 offset:9216
  buffer_load_dwordx4 v193, s[8:11], s30 offen offset:1024 lds
  v_mfma_f32_16x16x32_bf16 v[68:71], a[164:167], a[228:231], v[68:71]
  ds_read_b64_tr_b16 a[24:25], v216 offset:0
  s_min_u32 s51, s51, 29
  v_mfma_f32_16x16x32_bf16 v[68:71], a[196:199], a[244:247], v[68:71]
  ds_read_b64_tr_b16 a[26:27], v216 offset:1024
  s_cmp_ge_u32 s51, 15
  s_cselect_b32 s52, 1, 0
  s_cselect_b32 s53, 15, 0
  v_mfma_f32_16x16x32_bf16 v[72:75], a[168:171], a[228:231], v[72:75]
  ds_read_b64_tr_b16 a[56:57], v216 offset:8192
  ds_read_b64_tr_b16 a[58:59], v216 offset:9216
  v_mfma_f32_16x16x32_bf16 v[72:75], a[200:203], a[244:247], v[72:75]
  ds_read_b64_tr_b16 a[28:29], v217 offset:0
  buffer_load_dwordx4 v194, s[8:11], s30 offen offset:2048 lds
  v_mfma_f32_16x16x32_bf16 v[76:79], a[172:175], a[228:231], v[76:79]
  ds_read_b64_tr_b16 a[30:31], v217 offset:1024
  s_sub_u32 s53, s51, s53
  v_mfma_f32_16x16x32_bf16 v[76:79], a[204:207], a[244:247], v[76:79]
  ds_read_b64_tr_b16 a[60:61], v217 offset:8192
  ds_read_b64_tr_b16 a[62:63], v217 offset:9216
  v_mfma_f32_16x16x32_bf16 v[80:83], a[176:179], a[228:231], v[80:83]
  ds_read_b128 a[68:71], v206 offset:2048
  s_and_b32 s43, s50, 6
  v_mfma_f32_16x16x32_bf16 v[80:83], a[208:211], a[244:247], v[80:83]
  ds_read_b128 a[84:87], v207 offset:2048
  buffer_load_dwordx4 v195, s[8:11], s30 offen offset:3072 lds
  v_mfma_f32_16x16x32_bf16 v[84:87], a[180:183], a[228:231], v[84:87]
  ds_read_b128 a[72:75], v206 offset:4096
  ds_read_b128 a[88:91], v207 offset:4096
  v_mfma_f32_16x16x32_bf16 v[84:87], a[212:215], a[244:247], v[84:87]
  ds_read_b128 a[76:79], v206 offset:6144
  s_add_u32 s43, s43, s52
  v_mfma_f32_16x16x32_bf16 v[88:91], a[184:187], a[228:231], v[88:91]
  s_add_u32 m0, s36, 4096
  ds_read_b128 a[92:95], v207 offset:6144
  s_mul_i32 s54, s53, 52
  v_mfma_f32_16x16x32_bf16 v[88:91], a[216:219], a[244:247], v[88:91]
  buffer_load_dwordx4 v196, s[8:11], s30 offen lds
  s_lshr_b32 s54, s54, 8
  v_mfma_f32_16x16x32_bf16 v[92:95], a[188:191], a[228:231], v[92:95]
  s_mul_i32 s41, s54, 5
  v_mfma_f32_16x16x32_bf16 v[92:95], a[220:223], a[244:247], v[92:95]
  s_sub_u32 s53, s53, s41
  v_mfma_f32_16x16x32_bf16 v[96:99], a[160:163], a[232:235], v[96:99]
  s_and_b32 s55, s50, 1
  v_mfma_f32_16x16x32_bf16 v[96:99], a[192:195], a[248:251], v[96:99]
  buffer_load_dwordx4 v197, s[8:11], s30 offen offset:1024 lds
  s_mul_i32 s55, s55, 5
  v_mfma_f32_16x16x32_bf16 v[100:103], a[164:167], a[232:235], v[100:103]
  s_add_u32 s55, s55, s53
  v_mfma_f32_16x16x32_bf16 v[100:103], a[196:199], a[248:251], v[100:103]
  s_mul_i32 s52, s52, 3
  v_mfma_f32_16x16x32_bf16 v[104:107], a[168:171], a[232:235], v[104:107]
  s_add_u32 s41, s54, s52
  v_mfma_f32_16x16x32_bf16 v[104:107], a[200:203], a[248:251], v[104:107]
  buffer_load_dwordx4 v198, s[8:11], s30 offen offset:2048 lds
  s_mul_i32 s41, s41, 43
  v_mfma_f32_16x16x32_bf16 v[108:111], a[172:175], a[232:235], v[108:111]
  s_lshr_b32 s41, s41, 3
  v_mfma_f32_16x16x32_bf16 v[108:111], a[204:207], a[248:251], v[108:111]
  s_and_b32 s41, s41, 31
  v_mfma_f32_16x16x32_bf16 v[112:115], a[176:179], a[232:235], v[112:115]
  s_mov_b32 s44, 1040356334
  v_mfma_f32_16x16x32_bf16 v[112:115], a[208:211], a[248:251], v[112:115]
  buffer_load_dwordx4 v199, s[8:11], s30 offen offset:3072 lds
  s_mov_b32 s45, 1040356334
  v_mfma_f32_16x16x32_bf16 v[116:119], a[180:183], a[232:235], v[116:119]
  v_mfma_f32_16x16x32_bf16 v[116:119], a[212:215], a[248:251], v[116:119]
  v_mfma_f32_16x16x32_bf16 v[120:123], a[184:187], a[232:235], v[120:123]
  s_add_u32 m0, s39, 32768
  v_mfma_f32_16x16x32_bf16 v[120:123], a[216:219], a[248:251], v[120:123]
  buffer_load_dwordx4 v200, s[12:15], s31 offen lds
  v_mfma_f32_16x16x32_bf16 v[124:127], a[188:191], a[232:235], v[124:127]
  v_mfma_f32_16x16x32_bf16 v[124:127], a[220:223], a[248:251], v[124:127]
  buffer_load_dwordx4 v201, s[12:15], s31 offen offset:1024 lds
  s_waitcnt vmcnt(10) lgkmcnt(0)
  s_barrier
  ds_read_b128 v[160:163], v208
  ds_read_b128 v[176:179], v209
  ds_read_b64_tr_b16 a[96:97], v210 offset:16384
  buffer_load_dwordx4 v202, s[12:15], s31 offen offset:2048 lds
  ds_read_b64_tr_b16 a[98:99], v210 offset:17408
  ds_read_b64_tr_b16 a[128:129], v210 offset:24576
  ds_read_b64_tr_b16 a[130:131], v210 offset:25600
  ds_read_b64_tr_b16 a[100:101], v211 offset:16384
  ds_read_b64_tr_b16 a[102:103], v211 offset:17408
  buffer_load_dwordx4 v203, s[12:15], s31 offen offset:3072 lds
  s_add_u32 s32, s32, 1
  ds_read_b64_tr_b16 a[132:133], v211 offset:24576
  ds_read_b64_tr_b16 a[134:135], v211 offset:25600
  s_cmp_eq_u32 s32, 10
  s_cselect_b32 s32, 0, s32
  ds_read_b64_tr_b16 a[104:105], v212 offset:16384
  s_lshl_b32 s30, s32, 7
  ds_read_b64_tr_b16 a[106:107], v212 offset:17408
  s_mov_b32 m0, s37
  s_lshl_b32 s31, s32, 19
  ds_read_b64_tr_b16 a[136:137], v212 offset:24576
  ds_read_b64_tr_b16 a[138:139], v212 offset:25600
  ds_read_b64_tr_b16 a[108:109], v213 offset:16384
  buffer_load_dwordx4 v192, s[8:11], s30 offen lds
  ds_read_b64_tr_b16 a[110:111], v213 offset:17408
  v_mfma_f32_16x16x32_bf16 v[32:35], a[0:3], a[64:67], v[32:35]
  ds_read_b64_tr_b16 a[140:141], v213 offset:24576
  ds_read_b64_tr_b16 a[142:143], v213 offset:25600
  v_mfma_f32_16x16x32_bf16 v[32:35], a[32:35], a[80:83], v[32:35]
  ds_read_b64_tr_b16 a[112:113], v214 offset:16384
  v_mfma_f32_16x16x32_bf16 v[36:39], a[4:7], a[64:67], v[36:39]
  ds_read_b64_tr_b16 a[114:115], v214 offset:17408
  buffer_load_dwordx4 v193, s[8:11], s30 offen offset:1024 lds
  v_mfma_f32_16x16x32_bf16 v[36:39], a[36:39], a[80:83], v[36:39]
  ds_read_b64_tr_b16 a[144:145], v214 offset:24576
  ds_read_b64_tr_b16 a[146:147], v214 offset:25600
  v_mfma_f32_16x16x32_bf16 v[40:43], a[8:11], a[64:67], v[40:43]
  ds_read_b64_tr_b16 a[116:117], v215 offset:16384
  v_mfma_f32_16x16x32_bf16 v[40:43], a[40:43], a[80:83], v[40:43]
  ds_read_b64_tr_b16 a[118:119], v215 offset:17408
  v_mfma_f32_16x16x32_bf16 v[44:47], a[12:15], a[64:67], v[44:47]
  ds_read_b64_tr_b16 a[148:149], v215 offset:24576
  ds_read_b64_tr_b16 a[150:151], v215 offset:25600
  buffer_load_dwordx4 v194, s[8:11], s30 offen offset:2048 lds
  v_mfma_f32_16x16x32_bf16 v[44:47], a[44:47], a[80:83], v[44:47]
  ds_read_b64_tr_b16 a[120:121], v216 offset:16384
  v_mfma_f32_16x16x32_bf16 v[48:51], a[16:19], a[64:67], v[48:51]
  ds_read_b64_tr_b16 a[122:123], v216 offset:17408
  v_mfma_f32_16x16x32_bf16 v[48:51], a[48:51], a[80:83], v[48:51]
  ds_read_b64_tr_b16 a[152:153], v216 offset:24576
  ds_read_b64_tr_b16 a[154:155], v216 offset:25600
  v_mfma_f32_16x16x32_bf16 v[52:55], a[20:23], a[64:67], v[52:55]
  ds_read_b64_tr_b16 a[124:125], v217 offset:16384
  buffer_load_dwordx4 v195, s[8:11], s30 offen offset:3072 lds
  v_mfma_f32_16x16x32_bf16 v[52:55], a[52:55], a[80:83], v[52:55]
  ds_read_b64_tr_b16 a[126:127], v217 offset:17408
  v_mfma_f32_16x16x32_bf16 v[56:59], a[24:27], a[64:67], v[56:59]
  ds_read_b64_tr_b16 a[156:157], v217 offset:24576
  ds_read_b64_tr_b16 a[158:159], v217 offset:25600
  v_mfma_f32_16x16x32_bf16 v[56:59], a[56:59], a[80:83], v[56:59]
  s_add_u32 m0, s37, 4096
  ds_read_b128 v[164:167], v208 offset:2048
  v_mfma_f32_16x16x32_bf16 v[60:63], a[28:31], a[64:67], v[60:63]
  ds_read_b128 v[180:183], v209 offset:2048
  buffer_load_dwordx4 v196, s[8:11], s30 offen lds
  v_mfma_f32_16x16x32_bf16 v[60:63], a[60:63], a[80:83], v[60:63]
  ds_read_b128 v[168:171], v208 offset:4096
  ds_read_b128 v[184:187], v209 offset:4096
  v_mfma_f32_16x16x32_bf16 v[64:67], a[0:3], a[68:71], v[64:67]
  ds_read_b128 v[172:175], v208 offset:6144
  v_mfma_f32_16x16x32_bf16 v[64:67], a[32:35], a[84:87], v[64:67]
  ds_read_b128 v[188:191], v209 offset:6144
  v_mfma_f32_16x16x32_bf16 v[68:71], a[4:7], a[68:71], v[68:71]
  buffer_load_dwordx4 v197, s[8:11], s30 offen offset:1024 lds
  v_mfma_f32_16x16x32_bf16 v[68:71], a[36:39], a[84:87], v[68:71]
  v_mfma_f32_16x16x32_bf16 v[72:75], a[8:11], a[68:71], v[72:75]
  v_mfma_f32_16x16x32_bf16 v[72:75], a[40:43], a[84:87], v[72:75]
  v_mfma_f32_16x16x32_bf16 v[76:79], a[12:15], a[68:71], v[76:79]
  buffer_load_dwordx4 v198, s[8:11], s30 offen offset:2048 lds
  v_mfma_f32_16x16x32_bf16 v[76:79], a[44:47], a[84:87], v[76:79]
  v_mfma_f32_16x16x32_bf16 v[80:83], a[16:19], a[68:71], v[80:83]
  v_mfma_f32_16x16x32_bf16 v[80:83], a[48:51], a[84:87], v[80:83]
  v_mfma_f32_16x16x32_bf16 v[84:87], a[20:23], a[68:71], v[84:87]
  buffer_load_dwordx4 v199, s[8:11], s30 offen offset:3072 lds
  v_mfma_f32_16x16x32_bf16 v[84:87], a[52:55], a[84:87], v[84:87]
  v_mfma_f32_16x16x32_bf16 v[88:91], a[24:27], a[68:71], v[88:91]
  v_mfma_f32_16x16x32_bf16 v[88:91], a[56:59], a[84:87], v[88:91]
  s_add_u32 m0, s39, 0
  v_mfma_f32_16x16x32_bf16 v[92:95], a[28:31], a[68:71], v[92:95]
  buffer_load_dwordx4 v200, s[12:15], s31 offen lds
  v_mfma_f32_16x16x32_bf16 v[92:95], a[60:63], a[84:87], v[92:95]
  v_mfma_f32_16x16x32_bf16 v[96:99], a[0:3], a[72:75], v[96:99]
  v_mfma_f32_16x16x32_bf16 v[96:99], a[32:35], a[88:91], v[96:99]
  v_mfma_f32_16x16x32_bf16 v[100:103], a[4:7], a[72:75], v[100:103]
  buffer_load_dwordx4 v201, s[12:15], s31 offen offset:1024 lds
  v_mfma_f32_16x16x32_bf16 v[100:103], a[36:39], a[88:91], v[100:103]
  v_mfma_f32_16x16x32_bf16 v[104:107], a[8:11], a[72:75], v[104:107]
  s_waitcnt vmcnt(10) lgkmcnt(0)
  s_barrier
  v_mfma_f32_16x16x32_bf16 v[104:107], a[40:43], a[88:91], v[104:107]
  ds_read_b128 a[224:227], v204
  ds_read_b128 a[240:243], v205
  v_mfma_f32_16x16x32_bf16 v[108:111], a[12:15], a[72:75], v[108:111]
  ds_read_b64_tr_b16 a[160:161], v210 offset:32768
  buffer_load_dwordx4 v202, s[12:15], s31 offen offset:2048 lds
  v_mfma_f32_16x16x32_bf16 v[108:111], a[44:47], a[88:91], v[108:111]
  ds_read_b64_tr_b16 a[162:163], v210 offset:33792
  v_mfma_f32_16x16x32_bf16 v[112:115], a[16:19], a[72:75], v[112:115]
  ds_read_b64_tr_b16 a[192:193], v210 offset:40960
  ds_read_b64_tr_b16 a[194:195], v210 offset:41984
  v_mfma_f32_16x16x32_bf16 v[112:115], a[48:51], a[88:91], v[112:115]
  ds_read_b64_tr_b16 a[164:165], v211 offset:32768
  v_mfma_f32_16x16x32_bf16 v[116:119], a[20:23], a[72:75], v[116:119]
  ds_read_b64_tr_b16 a[166:167], v211 offset:33792
  buffer_load_dwordx4 v203, s[12:15], s31 offen offset:3072 lds
  v_mfma_f32_16x16x32_bf16 v[116:119], a[52:55], a[88:91], v[116:119]
  s_add_u32 s32, s32, 1
  ds_read_b64_tr_b16 a[196:197], v211 offset:40960
  ds_read_b64_tr_b16 a[198:199], v211 offset:41984
  v_mfma_f32_16x16x32_bf16 v[120:123], a[24:27], a[72:75], v[120:123]
  s_cmp_eq_u32 s32, 10
  s_cselect_b32 s32, 0, s32
  ds_read_b64_tr_b16 a[168:169], v212 offset:32768
  v_mfma_f32_16x16x32_bf16 v[120:123], a[56:59], a[88:91], v[120:123]
  s_lshl_b32 s30, s32, 7
  ds_read_b64_tr_b16 a[170:171], v212 offset:33792
  v_mfma_f32_16x16x32_bf16 v[124:127], a[28:31], a[72:75], v[124:127]
  s_mov_b32 m0, s38
  s_lshl_b32 s31, s32, 19
  ds_read_b64_tr_b16 a[200:201], v212 offset:40960
  ds_read_b64_tr_b16 a[202:203], v212 offset:41984
  v_mfma_f32_16x16x32_bf16 v[124:127], a[60:63], a[88:91], v[124:127]
  ds_read_b64_tr_b16 a[172:173], v213 offset:32768
  buffer_load_dwordx4 v192, s[8:11], s30 offen lds
  ds_read_b64_tr_b16 a[174:175], v213 offset:33792
  ds_read_b64_tr_b16 a[204:205], v213 offset:40960
  ds_read_b64_tr_b16 a[206:207], v213 offset:41984
  ds_read_b64_tr_b16 a[176:177], v214 offset:32768
  ds_read_b64_tr_b16 a[178:179], v214 offset:33792
  buffer_load_dwordx4 v193, s[8:11], s30 offen offset:1024 lds
  ds_read_b64_tr_b16 a[208:209], v214 offset:40960
  ds_read_b64_tr_b16 a[210:211], v214 offset:41984
  ds_read_b64_tr_b16 a[180:181], v215 offset:32768
  ds_read_b64_tr_b16 a[182:183], v215 offset:33792
  ds_read_b64_tr_b16 a[212:213], v215 offset:40960
  ds_read_b64_tr_b16 a[214:215], v215 offset:41984
  buffer_load_dwordx4 v194, s[8:11], s30 offen offset:2048 lds
  ds_read_b64_tr_b16 a[184:185], v216 offset:32768
  ds_read_b64_tr_b16 a[186:187], v216 offset:33792
  ds_read_b64_tr_b16 a[216:217], v216 offset:40960
  ds_read_b64_tr_b16 a[218:219], v216 offset:41984
  ds_read_b64_tr_b16 a[188:189], v217 offset:32768
  buffer_load_dwordx4 v195, s[8:11], s30 offen offset:3072 lds
  ds_read_b64_tr_b16 a[190:191], v217 offset:33792
  ds_read_b64_tr_b16 a[220:221], v217 offset:40960
  ds_read_b64_tr_b16 a[222:223], v217 offset:41984
  s_add_u32 m0, s38, 4096
  ds_read_b128 a[228:231], v204 offset:2048
  ds_read_b128 a[244:247], v205 offset:2048
  buffer_load_dwordx4 v196, s[8:11], s30 offen lds
  v_mfma_f32_16x16x32_bf16 v[32:35], a[96:99], v[160:163], v[32:35]
  ds_read_b128 a[232:235], v204 offset:4096
  ds_read_b128 a[248:251], v205 offset:4096
  v_mfma_f32_16x16x32_bf16 v[32:35], a[128:131], v[176:179], v[32:35]
  ds_read_b128 a[236:239], v204 offset:6144
  v_mfma_f32_16x16x32_bf16 v[36:39], a[100:103], v[160:163], v[36:39]
  ds_read_b128 a[252:255], v205 offset:6144
  v_mfma_f32_16x16x32_bf16 v[36:39], a[132:135], v[176:179], v[36:39]
  buffer_load_dwordx4 v197, s[8:11], s30 offen offset:1024 lds
  v_mfma_f32_16x16x32_bf16 v[40:43], a[104:107], v[160:163], v[40:43]
  v_mfma_f32_16x16x32_bf16 v[40:43], a[136:139], v[176:179], v[40:43]
  v_mfma_f32_16x16x32_bf16 v[44:47], a[108:111], v[160:163], v[44:47]
  v_mfma_f32_16x16x32_bf16 v[44:47], a[140:143], v[176:179], v[44:47]
  buffer_load_dwordx4 v198, s[8:11], s30 offen offset:2048 lds
  v_mfma_f32_16x16x32_bf16 v[48:51], a[112:115], v[160:163], v[48:51]
  v_mfma_f32_16x16x32_bf16 v[48:51], a[144:147], v[176:179], v[48:51]
  v_mfma_f32_16x16x32_bf16 v[52:55], a[116:119], v[160:163], v[52:55]
  v_mfma_f32_16x16x32_bf16 v[52:55], a[148:151], v[176:179], v[52:55]
  buffer_load_dwordx4 v199, s[8:11], s30 offen offset:3072 lds
  v_mfma_f32_16x16x32_bf16 v[56:59], a[120:123], v[160:163], v[56:59]
  v_mfma_f32_16x16x32_bf16 v[56:59], a[152:155], v[176:179], v[56:59]
  v_mfma_f32_16x16x32_bf16 v[60:63], a[124:127], v[160:163], v[60:63]
  s_add_u32 m0, s39, 16384
  v_mfma_f32_16x16x32_bf16 v[60:63], a[156:159], v[176:179], v[60:63]
  buffer_load_dwordx4 v200, s[12:15], s31 offen lds
  v_mfma_f32_16x16x32_bf16 v[64:67], a[96:99], v[164:167], v[64:67]
  v_mfma_f32_16x16x32_bf16 v[64:67], a[128:131], v[180:183], v[64:67]
  v_mfma_f32_16x16x32_bf16 v[68:71], a[100:103], v[164:167], v[68:71]
  v_mfma_f32_16x16x32_bf16 v[68:71], a[132:135], v[180:183], v[68:71]
  buffer_load_dwordx4 v201, s[12:15], s31 offen offset:1024 lds
  v_mfma_f32_16x16x32_bf16 v[72:75], a[104:107], v[164:167], v[72:75]
  v_mfma_f32_16x16x32_bf16 v[72:75], a[136:139], v[180:183], v[72:75]
  s_waitcnt vmcnt(10) lgkmcnt(0)
  s_barrier
  v_mfma_f32_16x16x32_bf16 v[76:79], a[108:111], v[164:167], v[76:79]
  ds_read_b128 a[64:67], v206
  ds_read_b128 a[80:83], v207
  v_mfma_f32_16x16x32_bf16 v[76:79], a[140:143], v[180:183], v[76:79]
  ds_read_b64_tr_b16 a[0:1], v210 offset:0
  buffer_load_dwordx4 v202, s[12:15], s31 offen offset:2048 lds
  v_mfma_f32_16x16x32_bf16 v[80:83], a[112:115], v[164:167], v[80:83]
  ds_read_b64_tr_b16 a[2:3], v210 offset:1024
  v_mfma_f32_16x16x32_bf16 v[80:83], a[144:147], v[180:183], v[80:83]
  ds_read_b64_tr_b16 a[32:33], v210 offset:8192
  ds_read_b64_tr_b16 a[34:35], v210 offset:9216
  v_mfma_f32_16x16x32_bf16 v[84:87], a[116:119], v[164:167], v[84:87]
  ds_read_b64_tr_b16 a[4:5], v211 offset:0
  v_mfma_f32_16x16x32_bf16 v[84:87], a[148:151], v[180:183], v[84:87]
  ds_read_b64_tr_b16 a[6:7], v211 offset:1024
  buffer_load_dwordx4 v203, s[12:15], s31 offen offset:3072 lds
  v_mfma_f32_16x16x32_bf16 v[88:91], a[120:123], v[164:167], v[88:91]
  s_add_u32 s32, s32, 1
  ds_read_b64_tr_b16 a[36:37], v211 offset:8192
  ds_read_b64_tr_b16 a[38:39], v211 offset:9216
  v_mfma_f32_16x16x32_bf16 v[88:91], a[152:155], v[180:183], v[88:91]
  s_cmp_eq_u32 s32, 10
  s_cselect_b32 s32, 0, s32
  ds_read_b64_tr_b16 a[8:9], v212 offset:0
  v_mfma_f32_16x16x32_bf16 v[92:95], a[124:127], v[164:167], v[92:95]
  s_lshl_b32 s30, s32, 7
  ds_read_b64_tr_b16 a[10:11], v212 offset:1024
  v_mfma_f32_16x16x32_bf16 v[92:95], a[156:159], v[180:183], v[92:95]
  s_mov_b32 m0, s36
  s_lshl_b32 s31, s32, 19
  ds_read_b64_tr_b16 a[40:41], v212 offset:8192
  ds_read_b64_tr_b16 a[42:43], v212 offset:9216
  v_mfma_f32_16x16x32_bf16 v[96:99], a[96:99], v[168:171], v[96:99]
  ds_read_b64_tr_b16 a[12:13], v213 offset:0
  buffer_load_dwordx4 v192, s[8:11], s30 offen lds
  v_mfma_f32_16x16x32_bf16 v[96:99], a[128:131], v[184:187], v[96:99]
  ds_read_b64_tr_b16 a[14:15], v213 offset:1024
  v_mfma_f32_16x16x32_bf16 v[100:103], a[100:103], v[168:171], v[100:103]
  ds_read_b64_tr_b16 a[44:45], v213 offset:8192
  ds_read_b64_tr_b16 a[46:47], v213 offset:9216
  v_mfma_f32_16x16x32_bf16 v[100:103], a[132:135], v[184:187], v[100:103]
  ds_read_b64_tr_b16 a[16:17], v214 offset:0
  v_mfma_f32_16x16x32_bf16 v[104:107], a[104:107], v[168:171], v[104:107]
  ds_read_b64_tr_b16 a[18:19], v214 offset:1024
  buffer_load_dwordx4 v193, s[8:11], s30 offen offset:1024 lds
  v_mfma_f32_16x16x32_bf16 v[104:107], a[136:139], v[184:187], v[104:107]
  ds_read_b64_tr_b16 a[48:49], v214 offset:8192
  ds_read_b64_tr_b16 a[50:51], v214 offset:9216
  v_mfma_f32_16x16x32_bf16 v[108:111], a[108:111], v[168:171], v[108:111]
  ds_read_b64_tr_b16 a[20:21], v215 offset:0
  v_mfma_f32_16x16x32_bf16 v[108:111], a[140:143], v[184:187], v[108:111]
  ds_read_b64_tr_b16 a[22:23], v215 offset:1024
  v_mfma_f32_16x16x32_bf16 v[112:115], a[112:115], v[168:171], v[112:115]
  ds_read_b64_tr_b16 a[52:53], v215 offset:8192
  ds_read_b64_tr_b16 a[54:55], v215 offset:9216
  buffer_load_dwordx4 v194, s[8:11], s30 offen offset:2048 lds
  v_mfma_f32_16x16x32_bf16 v[112:115], a[144:147], v[184:187], v[112:115]
  ds_read_b64_tr_b16 a[24:25], v216 offset:0
  v_mfma_f32_16x16x32_bf16 v[116:119], a[116:119], v[168:171], v[116:119]
  ds_read_b64_tr_b16 a[26:27], v216 offset:1024
  v_mfma_f32_16x16x32_bf16 v[116:119], a[148:151], v[184:187], v[116:119]
  ds_read_b64_tr_b16 a[56:57], v216 offset:8192
  ds_read_b64_tr_b16 a[58:59], v216 offset:9216
  v_mfma_f32_16x16x32_bf16 v[120:123], a[120:123], v[168:171], v[120:123]
  ds_read_b64_tr_b16 a[28:29], v217 offset:0
  buffer_load_dwordx4 v195, s[8:11], s30 offen offset:3072 lds
  v_mfma_f32_16x16x32_bf16 v[120:123], a[152:155], v[184:187], v[120:123]
  ds_read_b64_tr_b16 a[30:31], v217 offset:1024
  v_mfma_f32_16x16x32_bf16 v[124:127], a[124:127], v[168:171], v[124:127]
  ds_read_b64_tr_b16 a[60:61], v217 offset:8192
  ds_read_b64_tr_b16 a[62:63], v217 offset:9216
  v_mfma_f32_16x16x32_bf16 v[124:127], a[156:159], v[184:187], v[124:127]
  s_add_u32 m0, s36, 4096
  ds_read_b128 a[68:71], v206 offset:2048
  ds_read_b128 a[84:87], v207 offset:2048
  buffer_load_dwordx4 v196, s[8:11], s30 offen lds
  ds_read_b128 a[72:75], v206 offset:4096
  ds_read_b128 a[88:91], v207 offset:4096
  ds_read_b128 a[76:79], v206 offset:6144
  ds_read_b128 a[92:95], v207 offset:6144
  buffer_load_dwordx4 v197, s[8:11], s30 offen offset:1024 lds
  buffer_load_dwordx4 v198, s[8:11], s30 offen offset:2048 lds
  buffer_load_dwordx4 v199, s[8:11], s30 offen offset:3072 lds
  s_add_u32 m0, s39, 32768
  v_mfma_f32_16x16x32_bf16 v[32:35], a[160:163], a[224:227], v[32:35]
  buffer_load_dwordx4 v200, s[12:15], s31 offen lds
  v_mfma_f32_16x16x32_bf16 v[32:35], a[192:195], a[240:243], v[32:35]
  v_mfma_f32_16x16x32_bf16 v[36:39], a[164:167], a[224:227], v[36:39]
  v_mfma_f32_16x16x32_bf16 v[36:39], a[196:199], a[240:243], v[36:39]
  v_mfma_f32_16x16x32_bf16 v[40:43], a[168:171], a[224:227], v[40:43]
  buffer_load_dwordx4 v201, s[12:15], s31 offen offset:1024 lds
  v_mfma_f32_16x16x32_bf16 v[40:43], a[200:203], a[240:243], v[40:43]
  v_mfma_f32_16x16x32_bf16 v[44:47], a[172:175], a[224:227], v[44:47]
  s_waitcnt vmcnt(10) lgkmcnt(0)
  s_barrier
  v_mfma_f32_16x16x32_bf16 v[44:47], a[204:207], a[240:243], v[44:47]
  ds_read_b128 v[160:163], v208
  ds_read_b128 v[176:179], v209
  v_mfma_f32_16x16x32_bf16 v[48:51], a[176:179], a[224:227], v[48:51]
  ds_read_b64_tr_b16 a[96:97], v210 offset:16384
  buffer_load_dwordx4 v202, s[12:15], s31 offen offset:2048 lds
  v_mfma_f32_16x16x32_bf16 v[48:51], a[208:211], a[240:243], v[48:51]
  ds_read_b64_tr_b16 a[98:99], v210 offset:17408
  v_mfma_f32_16x16x32_bf16 v[52:55], a[180:183], a[224:227], v[52:55]
  ds_read_b64_tr_b16 a[128:129], v210 offset:24576
  ds_read_b64_tr_b16 a[130:131], v210 offset:25600
  v_mfma_f32_16x16x32_bf16 v[52:55], a[212:215], a[240:243], v[52:55]
  ds_read_b64_tr_b16 a[100:101], v211 offset:16384
  v_mfma_f32_16x16x32_bf16 v[56:59], a[184:187], a[224:227], v[56:59]
  ds_read_b64_tr_b16 a[102:103], v211 offset:17408
  buffer_load_dwordx4 v203, s[12:15], s31 offen offset:3072 lds
  v_mfma_f32_16x16x32_bf16 v[56:59], a[216:219], a[240:243], v[56:59]
  s_add_u32 s32, s32, 1
  ds_read_b64_tr_b16 a[132:133], v211 offset:24576
  ds_read_b64_tr_b16 a[134:135], v211 offset:25600
  v_mfma_f32_16x16x32_bf16 v[60:63], a[188:191], a[224:227], v[60:63]
  s_cmp_eq_u32 s32, 10
  s_cselect_b32 s32, 0, s32
  ds_read_b64_tr_b16 a[104:105], v212 offset:16384
  v_mfma_f32_16x16x32_bf16 v[60:63], a[220:223], a[240:243], v[60:63]
  s_lshl_b32 s30, s32, 7
  ds_read_b64_tr_b16 a[106:107], v212 offset:17408
  v_mfma_f32_16x16x32_bf16 v[64:67], a[160:163], a[228:231], v[64:67]
  s_lshl_b32 s31, s32, 19
  ds_read_b64_tr_b16 a[136:137], v212 offset:24576
  ds_read_b64_tr_b16 a[138:139], v212 offset:25600
  v_mfma_f32_16x16x32_bf16 v[64:67], a[192:195], a[244:247], v[64:67]
  s_add_u32 m0, s40, 0
  ds_read_b64_tr_b16 a[108:109], v213 offset:16384
  v_mfma_f32_16x16x32_bf16 v[68:71], a[164:167], a[228:231], v[68:71]
  ds_read_b64_tr_b16 a[110:111], v213 offset:17408
  buffer_load_dwordx4 v236, s[16:19], s33 offen nt lds
  v_mfma_f32_16x16x32_bf16 v[68:71], a[196:199], a[244:247], v[68:71]
  ds_read_b64_tr_b16 a[140:141], v213 offset:24576
  ds_read_b64_tr_b16 a[142:143], v213 offset:25600
  v_mfma_f32_16x16x32_bf16 v[72:75], a[168:171], a[228:231], v[72:75]
  ds_read_b64_tr_b16 a[112:113], v214 offset:16384
  v_mfma_f32_16x16x32_bf16 v[72:75], a[200:203], a[244:247], v[72:75]
  ds_read_b64_tr_b16 a[114:115], v214 offset:17408
  v_mfma_f32_16x16x32_bf16 v[76:79], a[172:175], a[228:231], v[76:79]
  ds_read_b64_tr_b16 a[144:145], v214 offset:24576
  ds_read_b64_tr_b16 a[146:147], v214 offset:25600
  v_mfma_f32_16x16x32_bf16 v[76:79], a[204:207], a[244:247], v[76:79]
  ds_read_b64_tr_b16 a[116:117], v215 offset:16384
  v_mfma_f32_16x16x32_bf16 v[80:83], a[176:179], a[228:231], v[80:83]
  ds_read_b64_tr_b16 a[118:119], v215 offset:17408
  v_mfma_f32_16x16x32_bf16 v[80:83], a[208:211], a[244:247], v[80:83]
  ds_read_b64_tr_b16 a[148:149], v215 offset:24576
  ds_read_b64_tr_b16 a[150:151], v215 offset:25600
  v_mfma_f32_16x16x32_bf16 v[84:87], a[180:183], a[228:231], v[84:87]
  ds_read_b64_tr_b16 a[120:121], v216 offset:16384
  v_mfma_f32_16x16x32_bf16 v[84:87], a[212:215], a[244:247], v[84:87]
  ds_read_b64_tr_b16 a[122:123], v216 offset:17408
  v_mfma_f32_16x16x32_bf16 v[88:91], a[184:187], a[228:231], v[88:91]
  ds_read_b64_tr_b16 a[152:153], v216 offset:24576
  ds_read_b64_tr_b16 a[154:155], v216 offset:25600
  v_mfma_f32_16x16x32_bf16 v[88:91], a[216:219], a[244:247], v[88:91]
  ds_read_b64_tr_b16 a[124:125], v217 offset:16384
  v_mfma_f32_16x16x32_bf16 v[92:95], a[188:191], a[228:231], v[92:95]
  ds_read_b64_tr_b16 a[126:127], v217 offset:17408
  buffer_load_dwordx4 v237, s[16:19], s33 offen offset:1024 nt lds
  v_mfma_f32_16x16x32_bf16 v[92:95], a[220:223], a[244:247], v[92:95]
  ds_read_b64_tr_b16 a[156:157], v217 offset:24576
  ds_read_b64_tr_b16 a[158:159], v217 offset:25600
  v_mfma_f32_16x16x32_bf16 v[96:99], a[160:163], a[232:235], v[96:99]
  ds_read_b128 v[164:167], v208 offset:2048
  v_mfma_f32_16x16x32_bf16 v[96:99], a[192:195], a[248:251], v[96:99]
  ds_read_b128 v[180:183], v209 offset:2048
  v_mfma_f32_16x16x32_bf16 v[100:103], a[164:167], a[232:235], v[100:103]
  ds_read_b128 v[168:171], v208 offset:4096
  ds_read_b128 v[184:187], v209 offset:4096
  v_mfma_f32_16x16x32_bf16 v[100:103], a[196:199], a[248:251], v[100:103]
  ds_read_b128 v[172:175], v208 offset:6144
  v_mfma_f32_16x16x32_bf16 v[104:107], a[168:171], a[232:235], v[104:107]
  ds_read_b128 v[188:191], v209 offset:6144
  v_mfma_f32_16x16x32_bf16 v[104:107], a[200:203], a[248:251], v[104:107]
  v_mfma_f32_16x16x32_bf16 v[108:111], a[172:175], a[232:235], v[108:111]
  v_mfma_f32_16x16x32_bf16 v[108:111], a[204:207], a[248:251], v[108:111]
  v_mfma_f32_16x16x32_bf16 v[112:115], a[176:179], a[232:235], v[112:115]
  v_mfma_f32_16x16x32_bf16 v[112:115], a[208:211], a[248:251], v[112:115]
  v_mfma_f32_16x16x32_bf16 v[116:119], a[180:183], a[232:235], v[116:119]
  buffer_load_dwordx4 v238, s[16:19], s33 offen offset:2048 nt lds
  v_mfma_f32_16x16x32_bf16 v[116:119], a[212:215], a[248:251], v[116:119]
  v_mfma_f32_16x16x32_bf16 v[120:123], a[184:187], a[232:235], v[120:123]
  v_mfma_f32_16x16x32_bf16 v[120:123], a[216:219], a[248:251], v[120:123]
  v_mfma_f32_16x16x32_bf16 v[124:127], a[188:191], a[232:235], v[124:127]
  v_mfma_f32_16x16x32_bf16 v[124:127], a[220:223], a[248:251], v[124:127]
  buffer_load_dwordx4 v239, s[16:19], s33 offen offset:3072 nt lds
  v_mfma_f32_16x16x32_bf16 v[32:35], a[0:3], a[64:67], v[32:35]
  s_waitcnt vmcnt(4) lgkmcnt(0)
  s_barrier
  v_mfma_f32_16x16x32_bf16 v[32:35], a[32:35], a[80:83], v[32:35]
  s_add_u32 m0, s40, 65536
  ds_read_b128 a[224:227], v204
  ds_read_b128 a[240:243], v205
  v_mfma_f32_16x16x32_bf16 v[36:39], a[4:7], a[64:67], v[36:39]
  ds_read_b64_tr_b16 a[160:161], v210 offset:32768
  buffer_load_dwordx4 v240, s[20:23], s33 offen nt lds
  v_mfma_f32_16x16x32_bf16 v[36:39], a[36:39], a[80:83], v[36:39]
  ds_read_b64_tr_b16 a[162:163], v210 offset:33792
  v_mfma_f32_16x16x32_bf16 v[40:43], a[8:11], a[64:67], v[40:43]
  ds_read_b64_tr_b16 a[192:193], v210 offset:40960
  ds_read_b64_tr_b16 a[194:195], v210 offset:41984
  v_mfma_f32_16x16x32_bf16 v[40:43], a[40:43], a[80:83], v[40:43]
  ds_read_b64_tr_b16 a[164:165], v211 offset:32768
  v_mfma_f32_16x16x32_bf16 v[44:47], a[12:15], a[64:67], v[44:47]
  ds_read_b64_tr_b16 a[166:167], v211 offset:33792
  v_mfma_f32_16x16x32_bf16 v[44:47], a[44:47], a[80:83], v[44:47]
  ds_read_b64_tr_b16 a[196:197], v211 offset:40960
  ds_read_b64_tr_b16 a[198:199], v211 offset:41984
  v_mfma_f32_16x16x32_bf16 v[48:51], a[16:19], a[64:67], v[48:51]
  ds_read_b64_tr_b16 a[168:169], v212 offset:32768
  v_mfma_f32_16x16x32_bf16 v[48:51], a[48:51], a[80:83], v[48:51]
  ds_read_b64_tr_b16 a[170:171], v212 offset:33792
  v_mfma_f32_16x16x32_bf16 v[52:55], a[20:23], a[64:67], v[52:55]
  ds_read_b64_tr_b16 a[200:201], v212 offset:40960
  ds_read_b64_tr_b16 a[202:203], v212 offset:41984
  v_mfma_f32_16x16x32_bf16 v[52:55], a[52:55], a[80:83], v[52:55]
  ds_read_b64_tr_b16 a[172:173], v213 offset:32768
  v_mfma_f32_16x16x32_bf16 v[56:59], a[24:27], a[64:67], v[56:59]
  ds_read_b64_tr_b16 a[174:175], v213 offset:33792
  v_mfma_f32_16x16x32_bf16 v[56:59], a[56:59], a[80:83], v[56:59]
  ds_read_b64_tr_b16 a[204:205], v213 offset:40960
  ds_read_b64_tr_b16 a[206:207], v213 offset:41984
  v_mfma_f32_16x16x32_bf16 v[60:63], a[28:31], a[64:67], v[60:63]
  ds_read_b64_tr_b16 a[176:177], v214 offset:32768
  buffer_load_dwordx4 v241, s[20:23], s33 offen offset:1024 nt lds
  v_mfma_f32_16x16x32_bf16 v[60:63], a[60:63], a[80:83], v[60:63]
  ds_read_b64_tr_b16 a[178:179], v214 offset:33792
  v_mfma_f32_16x16x32_bf16 v[64:67], a[0:3], a[68:71], v[64:67]
  ds_read_b64_tr_b16 a[208:209], v214 offset:40960
  ds_read_b64_tr_b16 a[210:211], v214 offset:41984
  v_mfma_f32_16x16x32_bf16 v[64:67], a[32:35], a[84:87], v[64:67]
  ds_read_b64_tr_b16 a[180:181], v215 offset:32768
  v_mfma_f32_16x16x32_bf16 v[68:71], a[4:7], a[68:71], v[68:71]
  ds_read_b64_tr_b16 a[182:183], v215 offset:33792
  v_mfma_f32_16x16x32_bf16 v[68:71], a[36:39], a[84:87], v[68:71]
  ds_read_b64_tr_b16 a[212:213], v215 offset:40960
  ds_read_b64_tr_b16 a[214:215], v215 offset:41984
  v_mfma_f32_16x16x32_bf16 v[72:75], a[8:11], a[68:71], v[72:75]
  ds_read_b64_tr_b16 a[184:185], v216 offset:32768
  v_mfma_f32_16x16x32_bf16 v[72:75], a[40:43], a[84:87], v[72:75]
  ds_read_b64_tr_b16 a[186:187], v216 offset:33792
  v_mfma_f32_16x16x32_bf16 v[76:79], a[12:15], a[68:71], v[76:79]
  ds_read_b64_tr_b16 a[216:217], v216 offset:40960
  ds_read_b64_tr_b16 a[218:219], v216 offset:41984
  v_mfma_f32_16x16x32_bf16 v[76:79], a[44:47], a[84:87], v[76:79]
  ds_read_b64_tr_b16 a[188:189], v217 offset:32768
  v_mfma_f32_16x16x32_bf16 v[80:83], a[16:19], a[68:71], v[80:83]
  ds_read_b64_tr_b16 a[190:191], v217 offset:33792
  v_mfma_f32_16x16x32_bf16 v[80:83], a[48:51], a[84:87], v[80:83]
  ds_read_b64_tr_b16 a[220:221], v217 offset:40960
  ds_read_b64_tr_b16 a[222:223], v217 offset:41984
  v_mfma_f32_16x16x32_bf16 v[84:87], a[20:23], a[68:71], v[84:87]
  ds_read_b128 a[228:231], v204 offset:2048
  buffer_load_dwordx4 v240, s[20:23], s33 offen offset:2048 nt lds
  v_mfma_f32_16x16x32_bf16 v[84:87], a[52:55], a[84:87], v[84:87]
  ds_read_b128 a[244:247], v205 offset:2048
  v_mfma_f32_16x16x32_bf16 v[88:91], a[24:27], a[68:71], v[88:91]
  ds_read_b128 a[232:235], v204 offset:4096
  ds_read_b128 a[248:251], v205 offset:4096
  v_mfma_f32_16x16x32_bf16 v[88:91], a[56:59], a[84:87], v[88:91]
  ds_read_b128 a[236:239], v204 offset:6144
  v_mfma_f32_16x16x32_bf16 v[92:95], a[28:31], a[68:71], v[92:95]
  ds_read_b128 a[252:255], v205 offset:6144
  v_mfma_f32_16x16x32_bf16 v[92:95], a[60:63], a[84:87], v[92:95]
  v_mfma_f32_16x16x32_bf16 v[96:99], a[0:3], a[72:75], v[96:99]
  v_mfma_f32_16x16x32_bf16 v[96:99], a[32:35], a[88:91], v[96:99]
  v_mfma_f32_16x16x32_bf16 v[100:103], a[4:7], a[72:75], v[100:103]
  v_mfma_f32_16x16x32_bf16 v[100:103], a[36:39], a[88:91], v[100:103]
  v_mfma_f32_16x16x32_bf16 v[104:107], a[8:11], a[72:75], v[104:107]
  s_waitcnt lgkmcnt(0)
  s_barrier
  v_mfma_f32_16x16x32_bf16 v[104:107], a[40:43], a[88:91], v[104:107]
  v_mfma_f32_16x16x32_bf16 v[108:111], a[12:15], a[72:75], v[108:111]
  buffer_load_dwordx4 v241, s[20:23], s33 offen offset:3072 nt lds
  v_mfma_f32_16x16x32_bf16 v[108:111], a[44:47], a[88:91], v[108:111]
  v_mfma_f32_16x16x32_bf16 v[112:115], a[16:19], a[72:75], v[112:115]
  v_mfma_f32_16x16x32_bf16 v[112:115], a[48:51], a[88:91], v[112:115]
  v_mfma_f32_16x16x32_bf16 v[116:119], a[20:23], a[72:75], v[116:119]
  v_mfma_f32_16x16x32_bf16 v[116:119], a[52:55], a[88:91], v[116:119]
  v_mfma_f32_16x16x32_bf16 v[120:123], a[24:27], a[72:75], v[120:123]
  v_mfma_f32_16x16x32_bf16 v[120:123], a[56:59], a[88:91], v[120:123]
  v_mfma_f32_16x16x32_bf16 v[124:127], a[28:31], a[72:75], v[124:127]
  v_mfma_f32_16x16x32_bf16 v[124:127], a[60:63], a[88:91], v[124:127]
  s_add_u32 s33, s33, 16384
  s_add_u32 m0, s40, 16384
  s_nop 0
  buffer_load_dwordx4 v236, s[16:19], s33 offen nt lds
  buffer_load_dwordx4 v237, s[16:19], s33 offen offset:1024 nt lds
  v_mfma_f32_16x16x32_bf16 v[32:35], a[96:99], v[160:163], v[32:35]
  v_mfma_f32_16x16x32_bf16 v[32:35], a[128:131], v[176:179], v[32:35]
  v_mfma_f32_16x16x32_bf16 v[32:35], a[160:163], a[224:227], v[32:35]
  s_mul_i32 s52, s3, 1310720
  v_mfma_f32_16x16x32_bf16 v[32:35], a[192:195], a[240:243], v[32:35]
  v_mfma_f32_16x16x32_bf16 v[36:39], a[100:103], v[160:163], v[36:39]
  s_lshl_b32 s53, s55, 7
  v_mfma_f32_16x16x32_bf16 v[36:39], a[132:135], v[176:179], v[36:39]
  v_mfma_f32_16x16x32_bf16 v[36:39], a[164:167], a[224:227], v[36:39]
  s_add_u32 s52, s52, s53
  v_mfma_f32_16x16x32_bf16 v[36:39], a[196:199], a[240:243], v[36:39]
  v_mfma_f32_16x16x32_bf16 v[40:43], a[104:107], v[160:163], v[40:43]
  s_add_u32 s8, s56, s52
  s_addc_u32 s9, s57, 0
  v_mfma_f32_16x16x32_bf16 v[40:43], a[136:139], v[176:179], v[40:43]
  v_mfma_f32_16x16x32_bf16 v[40:43], a[168:171], a[224:227], v[40:43]
  s_mov_b32 s10, 1309568
  buffer_load_dwordx4 v238, s[16:19], s33 offen offset:2048 nt lds
  v_mfma_f32_16x16x32_bf16 v[40:43], a[200:203], a[240:243], v[40:43]
  v_mfma_f32_16x16x32_bf16 v[44:47], a[108:111], v[160:163], v[44:47]
  s_mov_b32 s11, 0x20000
  v_mfma_f32_16x16x32_bf16 v[44:47], a[140:143], v[176:179], v[44:47]
  v_mfma_f32_16x16x32_bf16 v[44:47], a[172:175], a[224:227], v[44:47]
  s_mul_i32 s52, s43, 15
  v_mfma_f32_16x16x32_bf16 v[44:47], a[204:207], a[240:243], v[44:47]
  v_mfma_f32_16x16x32_bf16 v[48:51], a[112:115], v[160:163], v[48:51]
  s_mul_i32 s53, s54, 5
  v_mfma_f32_16x16x32_bf16 v[48:51], a[144:147], v[176:179], v[48:51]
  v_mfma_f32_16x16x32_bf16 v[48:51], a[176:179], a[224:227], v[48:51]
  s_add_u32 s52, s52, s53
  v_mfma_f32_16x16x32_bf16 v[48:51], a[208:211], a[240:243], v[48:51]
  v_mfma_f32_16x16x32_bf16 v[52:55], a[116:119], v[160:163], v[52:55]
  s_lshl_b32 s52, s52, 17
  v_mfma_f32_16x16x32_bf16 v[52:55], a[148:151], v[176:179], v[52:55]
  v_mfma_f32_16x16x32_bf16 v[52:55], a[180:183], a[224:227], v[52:55]
  s_lshl_b32 s53, s3, 15
  buffer_load_dwordx4 v239, s[16:19], s33 offen offset:3072 nt lds
  v_mfma_f32_16x16x32_bf16 v[52:55], a[212:215], a[240:243], v[52:55]
  v_mfma_f32_16x16x32_bf16 v[56:59], a[120:123], v[160:163], v[56:59]
  s_add_u32 s52, s52, s53
  v_mfma_f32_16x16x32_bf16 v[56:59], a[152:155], v[176:179], v[56:59]
  v_mfma_f32_16x16x32_bf16 v[56:59], a[184:187], a[224:227], v[56:59]
  s_add_u32 s12, s48, s52
  s_addc_u32 s13, s49, 0
  v_mfma_f32_16x16x32_bf16 v[56:59], a[216:219], a[240:243], v[56:59]
  v_mfma_f32_16x16x32_bf16 v[60:63], a[124:127], v[160:163], v[60:63]
  s_mov_b32 s14, 557056
  v_mfma_f32_16x16x32_bf16 v[60:63], a[156:159], v[176:179], v[60:63]
  v_mfma_f32_16x16x32_bf16 v[60:63], a[188:191], a[224:227], v[60:63]
  s_mov_b32 s15, 0x20000
  v_mfma_f32_16x16x32_bf16 v[60:63], a[220:223], a[240:243], v[60:63]
  v_mfma_f32_16x16x32_bf16 v[64:67], a[96:99], v[164:167], v[64:67]
  v_mfma_f32_16x16x32_bf16 v[64:67], a[128:131], v[180:183], v[64:67]
  s_add_u32 m0, s40, 81920
  v_mfma_f32_16x16x32_bf16 v[64:67], a[160:163], a[228:231], v[64:67]
  buffer_load_dwordx4 v240, s[20:23], s33 offen nt lds
  v_mfma_f32_16x16x32_bf16 v[64:67], a[192:195], a[244:247], v[64:67]
  v_mfma_f32_16x16x32_bf16 v[68:71], a[100:103], v[164:167], v[68:71]
  v_mul_f32 v32, s44, v32
  v_mul_f32 v33, s44, v33
  v_mfma_f32_16x16x32_bf16 v[68:71], a[132:135], v[180:183], v[68:71]
  v_mul_f32 v34, s44, v34
  v_mul_f32 v35, s44, v35
  v_mfma_f32_16x16x32_bf16 v[68:71], a[164:167], a[228:231], v[68:71]
  v_mul_f32 v36, s44, v36
  v_mul_f32 v37, s44, v37
  v_mfma_f32_16x16x32_bf16 v[68:71], a[196:199], a[244:247], v[68:71]
  v_mul_f32 v38, s44, v38
  v_mul_f32 v39, s44, v39
  v_mfma_f32_16x16x32_bf16 v[72:75], a[104:107], v[164:167], v[72:75]
  v_cvt_pk_bf16_f32 v16, v32, v33
  v_cvt_pk_bf16_f32 v17, v34, v35
  v_mfma_f32_16x16x32_bf16 v[72:75], a[136:139], v[180:183], v[72:75]
  v_cvt_pk_bf16_f32 v18, v36, v37
  v_cvt_pk_bf16_f32 v19, v38, v39
  v_mfma_f32_16x16x32_bf16 v[72:75], a[168:171], a[228:231], v[72:75]
  v_permlane16_swap_b32 v16, v18
  v_permlane16_swap_b32 v17, v19
  v_mfma_f32_16x16x32_bf16 v[72:75], a[200:203], a[244:247], v[72:75]
  v_mul_f32 v40, s44, v40
  v_mul_f32 v41, s44, v41
  v_mfma_f32_16x16x32_bf16 v[76:79], a[108:111], v[164:167], v[76:79]
  v_mul_f32 v42, s44, v42
  v_mul_f32 v43, s44, v43
  v_mfma_f32_16x16x32_bf16 v[76:79], a[140:143], v[180:183], v[76:79]
  v_mul_f32 v44, s44, v44
  v_mul_f32 v45, s44, v45
  v_mfma_f32_16x16x32_bf16 v[76:79], a[172:175], a[228:231], v[76:79]
  buffer_load_dwordx4 v241, s[20:23], s33 offen offset:1024 nt lds
  v_mul_f32 v46, s44, v46
  v_mul_f32 v47, s44, v47
  v_mfma_f32_16x16x32_bf16 v[76:79], a[204:207], a[244:247], v[76:79]
  v_cvt_pk_bf16_f32 v20, v40, v41
  v_cvt_pk_bf16_f32 v21, v42, v43
  v_mfma_f32_16x16x32_bf16 v[80:83], a[112:115], v[164:167], v[80:83]
  v_cvt_pk_bf16_f32 v22, v44, v45
  v_cvt_pk_bf16_f32 v23, v46, v47
  v_mfma_f32_16x16x32_bf16 v[80:83], a[144:147], v[180:183], v[80:83]
  v_accvgpr_write_b32 a0, v16
  v_accvgpr_write_b32 a1, v17
  v_mfma_f32_16x16x32_bf16 v[80:83], a[176:179], a[228:231], v[80:83]
  v_accvgpr_write_b32 a2, v18
  v_accvgpr_write_b32 a3, v19
  v_mfma_f32_16x16x32_bf16 v[80:83], a[208:211], a[244:247], v[80:83]
  v_permlane16_swap_b32 v20, v22
  v_permlane16_swap_b32 v21, v23
  v_mfma_f32_16x16x32_bf16 v[84:87], a[116:119], v[164:167], v[84:87]
  v_mul_f32 v48, s44, v48
  v_mul_f32 v49, s44, v49
  v_mfma_f32_16x16x32_bf16 v[84:87], a[148:151], v[180:183], v[84:87]
  v_mul_f32 v50, s44, v50
  v_mul_f32 v51, s44, v51
  v_mfma_f32_16x16x32_bf16 v[84:87], a[180:183], a[228:231], v[84:87]
  v_mul_f32 v52, s44, v52
  v_mul_f32 v53, s44, v53
  v_mfma_f32_16x16x32_bf16 v[84:87], a[212:215], a[244:247], v[84:87]
  v_mul_f32 v54, s44, v54
  v_mul_f32 v55, s44, v55
  v_mfma_f32_16x16x32_bf16 v[88:91], a[120:123], v[164:167], v[88:91]
  v_cvt_pk_bf16_f32 v16, v48, v49
  v_cvt_pk_bf16_f32 v17, v50, v51
  v_mfma_f32_16x16x32_bf16 v[88:91], a[152:155], v[180:183], v[88:91]
  v_cvt_pk_bf16_f32 v18, v52, v53
  v_cvt_pk_bf16_f32 v19, v54, v55
  v_mfma_f32_16x16x32_bf16 v[88:91], a[184:187], a[228:231], v[88:91]
  buffer_load_dwordx4 v240, s[20:23], s33 offen offset:2048 nt lds
  v_accvgpr_write_b32 a4, v20
  v_accvgpr_write_b32 a5, v21
  v_mfma_f32_16x16x32_bf16 v[88:91], a[216:219], a[244:247], v[88:91]
  v_accvgpr_write_b32 a6, v22
  v_accvgpr_write_b32 a7, v23
  v_mfma_f32_16x16x32_bf16 v[92:95], a[124:127], v[164:167], v[92:95]
  v_permlane16_swap_b32 v16, v18
  v_permlane16_swap_b32 v17, v19
  v_mfma_f32_16x16x32_bf16 v[92:95], a[156:159], v[180:183], v[92:95]
  v_mul_f32 v56, s44, v56
  v_mul_f32 v57, s44, v57
  v_mfma_f32_16x16x32_bf16 v[92:95], a[188:191], a[228:231], v[92:95]
  v_mul_f32 v58, s44, v58
  v_mul_f32 v59, s44, v59
  v_mfma_f32_16x16x32_bf16 v[92:95], a[220:223], a[244:247], v[92:95]
  v_mul_f32 v60, s44, v60
  v_mul_f32 v61, s44, v61
  v_mfma_f32_16x16x32_bf16 v[96:99], a[96:99], v[168:171], v[96:99]
  v_mul_f32 v62, s44, v62
  v_mul_f32 v63, s44, v63
  v_mfma_f32_16x16x32_bf16 v[96:99], a[128:131], v[184:187], v[96:99]
  v_cvt_pk_bf16_f32 v20, v56, v57
  v_cvt_pk_bf16_f32 v21, v58, v59
  v_mfma_f32_16x16x32_bf16 v[96:99], a[160:163], a[232:235], v[96:99]
  v_cvt_pk_bf16_f32 v22, v60, v61
  v_cvt_pk_bf16_f32 v23, v62, v63
  v_mfma_f32_16x16x32_bf16 v[96:99], a[192:195], a[248:251], v[96:99]
  v_accvgpr_write_b32 a8, v16
  v_accvgpr_write_b32 a9, v17
  v_mfma_f32_16x16x32_bf16 v[100:103], a[100:103], v[168:171], v[100:103]
  v_accvgpr_write_b32 a10, v18
  v_accvgpr_write_b32 a11, v19
  v_mfma_f32_16x16x32_bf16 v[100:103], a[132:135], v[184:187], v[100:103]
  v_permlane16_swap_b32 v20, v22
  v_permlane16_swap_b32 v21, v23
  v_mfma_f32_16x16x32_bf16 v[100:103], a[164:167], a[232:235], v[100:103]
  buffer_load_dwordx4 v241, s[20:23], s33 offen offset:3072 nt lds
  v_accvgpr_write_b32 a12, v20
  v_accvgpr_write_b32 a13, v21
  v_mfma_f32_16x16x32_bf16 v[100:103], a[196:199], a[248:251], v[100:103]
  v_accvgpr_write_b32 a14, v22
  v_accvgpr_write_b32 a15, v23
  v_mfma_f32_16x16x32_bf16 v[104:107], a[104:107], v[168:171], v[104:107]
  v_mul_f32 v64, s44, v64
  v_mul_f32 v65, s44, v65
  v_mfma_f32_16x16x32_bf16 v[104:107], a[136:139], v[184:187], v[104:107]
  v_mul_f32 v66, s44, v66
  v_mul_f32 v67, s44, v67
  v_mfma_f32_16x16x32_bf16 v[104:107], a[168:171], a[232:235], v[104:107]
  v_mul_f32 v68, s44, v68
  v_mul_f32 v69, s44, v69
  v_mfma_f32_16x16x32_bf16 v[104:107], a[200:203], a[248:251], v[104:107]
  v_mul_f32 v70, s44, v70
  v_mul_f32 v71, s44, v71
  v_mfma_f32_16x16x32_bf16 v[108:111], a[108:111], v[168:171], v[108:111]
  v_cvt_pk_bf16_f32 v16, v64, v65
  v_cvt_pk_bf16_f32 v17, v66, v67
  v_mfma_f32_16x16x32_bf16 v[108:111], a[140:143], v[184:187], v[108:111]
  v_cvt_pk_bf16_f32 v18, v68, v69
  v_cvt_pk_bf16_f32 v19, v70, v71
  v_mfma_f32_16x16x32_bf16 v[108:111], a[172:175], a[232:235], v[108:111]
  v_permlane16_swap_b32 v16, v18
  v_permlane16_swap_b32 v17, v19
  v_mfma_f32_16x16x32_bf16 v[108:111], a[204:207], a[248:251], v[108:111]
  v_mul_f32 v72, s44, v72
  v_mul_f32 v73, s44, v73
  v_mfma_f32_16x16x32_bf16 v[112:115], a[112:115], v[168:171], v[112:115]
  s_add_u32 s33, s33, 16384
  v_mul_f32 v74, s44, v74
  v_mul_f32 v75, s44, v75
  v_mfma_f32_16x16x32_bf16 v[112:115], a[144:147], v[184:187], v[112:115]
  s_add_u32 m0, s40, 32768
  v_mul_f32 v76, s44, v76
  v_mul_f32 v77, s44, v77
  v_mfma_f32_16x16x32_bf16 v[112:115], a[176:179], a[232:235], v[112:115]
  buffer_load_dwordx4 v236, s[16:19], s33 offen nt lds
  v_mul_f32 v78, s44, v78
  v_mul_f32 v79, s44, v79
  v_mfma_f32_16x16x32_bf16 v[112:115], a[208:211], a[248:251], v[112:115]
  v_cvt_pk_bf16_f32 v20, v72, v73
  v_cvt_pk_bf16_f32 v21, v74, v75
  v_mfma_f32_16x16x32_bf16 v[116:119], a[116:119], v[168:171], v[116:119]
  v_cvt_pk_bf16_f32 v22, v76, v77
  v_cvt_pk_bf16_f32 v23, v78, v79
  v_mfma_f32_16x16x32_bf16 v[116:119], a[148:151], v[184:187], v[116:119]
  v_accvgpr_write_b32 a16, v16
  v_accvgpr_write_b32 a17, v17
  v_mfma_f32_16x16x32_bf16 v[116:119], a[180:183], a[232:235], v[116:119]
  v_accvgpr_write_b32 a18, v18
  v_accvgpr_write_b32 a19, v19
  v_mfma_f32_16x16x32_bf16 v[116:119], a[212:215], a[248:251], v[116:119]
  v_permlane16_swap_b32 v20, v22
  v_permlane16_swap_b32 v21, v23
  v_mfma_f32_16x16x32_bf16 v[120:123], a[120:123], v[168:171], v[120:123]
  v_mul_f32 v80, s44, v80
  v_mul_f32 v81, s44, v81
  v_mfma_f32_16x16x32_bf16 v[120:123], a[152:155], v[184:187], v[120:123]
  v_mul_f32 v82, s44, v82
  v_mul_f32 v83, s44, v83
  v_mfma_f32_16x16x32_bf16 v[120:123], a[184:187], a[232:235], v[120:123]
  v_mul_f32 v84, s44, v84
  v_mul_f32 v85, s44, v85
  v_mfma_f32_16x16x32_bf16 v[120:123], a[216:219], a[248:251], v[120:123]
  v_mul_f32 v86, s44, v86
  v_mul_f32 v87, s44, v87
  v_mfma_f32_16x16x32_bf16 v[124:127], a[124:127], v[168:171], v[124:127]
  v_cvt_pk_bf16_f32 v16, v80, v81
  v_cvt_pk_bf16_f32 v17, v82, v83
  v_mfma_f32_16x16x32_bf16 v[124:127], a[156:159], v[184:187], v[124:127]
  v_cvt_pk_bf16_f32 v18, v84, v85
  v_cvt_pk_bf16_f32 v19, v86, v87
  v_mfma_f32_16x16x32_bf16 v[124:127], a[188:191], a[232:235], v[124:127]
  buffer_load_dwordx4 v237, s[16:19], s33 offen offset:1024 nt lds
  v_accvgpr_write_b32 a20, v20
  v_accvgpr_write_b32 a21, v21
  v_mfma_f32_16x16x32_bf16 v[124:127], a[220:223], a[248:251], v[124:127]
  s_waitcnt vmcnt(10)
  s_barrier
  v_accvgpr_write_b32 a22, v22
  v_accvgpr_write_b32 a23, v23
  ds_read_b128 a[64:67], v224 offset:0
  v_permlane16_swap_b32 v16, v18
  v_permlane16_swap_b32 v17, v19
  v_mul_f32 v88, s44, v88
  ds_read_b128 a[68:71], v225 offset:0
  v_mul_f32 v89, s44, v89
  v_mul_f32 v90, s44, v90
  v_mul_f32 v91, s44, v91
  ds_read_b128 a[72:75], v226 offset:0
  v_mul_f32 v92, s44, v92
  v_mul_f32 v93, s44, v93
  v_mul_f32 v94, s44, v94
  ds_read_b128 a[76:79], v227 offset:0
  v_mul_f32 v95, s44, v95
  v_cvt_pk_bf16_f32 v20, v88, v89
  v_cvt_pk_bf16_f32 v21, v90, v91
  ds_read_b128 a[80:83], v224 offset:4096
  v_cvt_pk_bf16_f32 v22, v92, v93
  v_cvt_pk_bf16_f32 v23, v94, v95
  v_accvgpr_write_b32 a24, v16
  ds_read_b128 a[84:87], v225 offset:4096
  buffer_load_dwordx4 v238, s[16:19], s33 offen offset:2048 nt lds
  v_accvgpr_write_b32 a25, v17
  v_accvgpr_write_b32 a26, v18
  v_accvgpr_write_b32 a27, v19
  ds_read_b128 a[88:91], v226 offset:4096
  v_permlane16_swap_b32 v20, v22
  v_permlane16_swap_b32 v21, v23
  v_accvgpr_write_b32 a28, v20
  ds_read_b128 a[92:95], v227 offset:4096
  v_accvgpr_write_b32 a29, v21
  v_accvgpr_write_b32 a30, v22
  v_accvgpr_write_b32 a31, v23
  v_mul_f32 v96, s44, v96
  v_mul_f32 v97, s44, v97
  v_mul_f32 v98, s44, v98
  v_mul_f32 v99, s44, v99
  v_mul_f32 v100, s44, v100
  v_mul_f32 v101, s44, v101
  v_mul_f32 v102, s44, v102
  v_mul_f32 v103, s44, v103
  v_cvt_pk_bf16_f32 v16, v96, v97
  v_cvt_pk_bf16_f32 v17, v98, v99
  v_cvt_pk_bf16_f32 v18, v100, v101
  v_cvt_pk_bf16_f32 v19, v102, v103
  buffer_load_dwordx4 v239, s[16:19], s33 offen offset:3072 nt lds
  v_permlane16_swap_b32 v16, v18
  v_permlane16_swap_b32 v17, v19
  v_mul_f32 v104, s44, v104
  v_mul_f32 v105, s44, v105
  v_mul_f32 v106, s44, v106
  v_mul_f32 v107, s44, v107
  v_mul_f32 v108, s44, v108
  v_mul_f32 v109, s44, v109
  v_mul_f32 v110, s44, v110
  v_mul_f32 v111, s44, v111
  v_cvt_pk_bf16_f32 v20, v104, v105
  v_cvt_pk_bf16_f32 v21, v106, v107
  v_cvt_pk_bf16_f32 v22, v108, v109
  v_cvt_pk_bf16_f32 v23, v110, v111
  v_accvgpr_write_b32 a32, v16
  v_accvgpr_write_b32 a33, v17
  s_waitcnt lgkmcnt(0)
  v_accvgpr_write_b32 a34, v18
  v_accvgpr_write_b32 a35, v19
  v_permlane16_swap_b32 v20, v22
  v_permlane16_swap_b32 v21, v23
  v_mul_f32 v112, s44, v112
  v_mul_f32 v113, s44, v113
  v_mul_f32 v114, s44, v114
  v_mul_f32 v115, s44, v115
  v_mul_f32 v116, s44, v116
  v_mul_f32 v117, s44, v117
  v_mul_f32 v118, s44, v118
  v_mul_f32 v119, s44, v119
  v_cvt_pk_bf16_f32 v16, v112, v113
  v_cvt_pk_bf16_f32 v17, v114, v115
  v_cvt_pk_bf16_f32 v18, v116, v117
  v_cvt_pk_bf16_f32 v19, v118, v119
  v_accvgpr_write_b32 a36, v20
  v_accvgpr_write_b32 a37, v21
  v_accvgpr_write_b32 a38, v22
  v_accvgpr_write_b32 a39, v23
  v_permlane16_swap_b32 v16, v18
  v_permlane16_swap_b32 v17, v19
  v_mul_f32 v120, s44, v120
  v_mul_f32 v121, s44, v121
  v_mul_f32 v122, s44, v122
  v_mul_f32 v123, s44, v123
  v_mul_f32 v124, s44, v124
  v_mul_f32 v125, s44, v125
  v_mul_f32 v126, s44, v126
  v_mul_f32 v127, s44, v127
  v_cvt_pk_bf16_f32 v20, v120, v121
  v_cvt_pk_bf16_f32 v21, v122, v123
  v_cvt_pk_bf16_f32 v22, v124, v125
  v_cvt_pk_bf16_f32 v23, v126, v127
  v_accvgpr_write_b32 a40, v16
  v_accvgpr_write_b32 a41, v17
  v_accvgpr_write_b32 a42, v18
  v_accvgpr_write_b32 a43, v19
  v_permlane16_swap_b32 v20, v22
  v_permlane16_swap_b32 v21, v23
  v_accvgpr_write_b32 a44, v20
  v_accvgpr_write_b32 a45, v21
  v_accvgpr_write_b32 a46, v22
  v_accvgpr_write_b32 a47, v23
  v_mfma_f32_16x16x32_bf16 v[160:163], a[64:67], a[0:3], 0
  s_add_u32 m0, s40, 98304
  ds_read_b64_tr_b16 a[128:129], v228 offset:0
  v_mfma_f32_16x16x32_bf16 v[160:163], a[68:71], a[4:7], v[160:163]
  ds_read_b64_tr_b16 a[130:131], v228 offset:4096
  buffer_load_dwordx4 v240, s[20:23], s33 offen nt lds
  v_mfma_f32_16x16x32_bf16 v[160:163], a[72:75], a[8:11], v[160:163]
  ds_read_b64_tr_b16 a[132:133], v229 offset:0
  v_mfma_f32_16x16x32_bf16 v[160:163], a[76:79], a[12:15], v[160:163]
  ds_read_b64_tr_b16 a[134:135], v229 offset:4096
  v_mfma_f32_16x16x32_bf16 v[164:167], a[80:83], a[0:3], 0
  ds_read_b64_tr_b16 a[136:137], v230 offset:0
  v_permlane16_swap_b32 v16, v18
  v_permlane16_swap_b32 v17, v19
  v_mfma_f32_16x16x32_bf16 v[164:167], a[84:87], a[4:7], v[164:167]
  ds_read_b64_tr_b16 a[138:139], v230 offset:4096
  v_mfma_f32_16x16x32_bf16 v[164:167], a[88:91], a[8:11], v[164:167]
  ds_read_b64_tr_b16 a[140:141], v231 offset:0
  v_mfma_f32_16x16x32_bf16 v[164:167], a[92:95], a[12:15], v[164:167]
  ds_read_b64_tr_b16 a[142:143], v231 offset:4096
  v_mfma_f32_16x16x32_bf16 v[168:171], a[64:67], a[16:19], 0
  ds_read_b64_tr_b16 a[144:145], v232 offset:0
  v_mfma_f32_16x16x32_bf16 v[168:171], a[68:71], a[20:23], v[168:171]
  ds_read_b64_tr_b16 a[146:147], v232 offset:4096
  buffer_load_dwordx4 v241, s[20:23], s33 offen offset:1024 nt lds
  v_mfma_f32_16x16x32_bf16 v[168:171], a[72:75], a[24:27], v[168:171]
  ds_read_b64_tr_b16 a[148:149], v233 offset:0
  v_permlane16_swap_b32 v20, v22
  v_permlane16_swap_b32 v21, v23
  v_mfma_f32_16x16x32_bf16 v[168:171], a[76:79], a[28:31], v[168:171]
  ds_read_b64_tr_b16 a[150:151], v233 offset:4096
  v_mfma_f32_16x16x32_bf16 v[172:175], a[80:83], a[16:19], 0
  ds_read_b64_tr_b16 a[152:153], v234 offset:0
  v_mfma_f32_16x16x32_bf16 v[172:175], a[84:87], a[20:23], v[172:175]
  ds_read_b64_tr_b16 a[154:155], v234 offset:4096
  v_mfma_f32_16x16x32_bf16 v[172:175], a[88:91], a[24:27], v[172:175]
  ds_read_b64_tr_b16 a[156:157], v235 offset:0
  v_mfma_f32_16x16x32_bf16 v[172:175], a[92:95], a[28:31], v[172:175]
  ds_read_b64_tr_b16 a[158:159], v235 offset:4096
  v_mfma_f32_16x16x32_bf16 v[176:179], a[64:67], a[32:35], 0
  ds_read_b128 a[96:99], v224 offset:8192
  v_permlane16_swap_b32 v16, v18
  v_permlane16_swap_b32 v17, v19
  v_mfma_f32_16x16x32_bf16 v[176:179], a[68:71], a[36:39], v[176:179]
  ds_read_b128 a[100:103], v225 offset:8192
  buffer_load_dwordx4 v240, s[20:23], s33 offen offset:2048 nt lds
  v_mfma_f32_16x16x32_bf16 v[176:179], a[72:75], a[40:43], v[176:179]
  ds_read_b128 a[104:107], v226 offset:8192
  v_mfma_f32_16x16x32_bf16 v[176:179], a[76:79], a[44:47], v[176:179]
  ds_read_b128 a[108:111], v227 offset:8192
  v_mfma_f32_16x16x32_bf16 v[180:183], a[80:83], a[32:35], 0
  ds_read_b128 a[112:115], v224 offset:12288
  v_mfma_f32_16x16x32_bf16 v[180:183], a[84:87], a[36:39], v[180:183]
  ds_read_b128 a[116:119], v225 offset:12288
  v_mfma_f32_16x16x32_bf16 v[180:183], a[88:91], a[40:43], v[180:183]
  ds_read_b128 a[120:123], v226 offset:12288
  v_permlane16_swap_b32 v20, v22
  v_permlane16_swap_b32 v21, v23
  v_mfma_f32_16x16x32_bf16 v[180:183], a[92:95], a[44:47], v[180:183]
  ds_read_b128 a[124:127], v227 offset:12288
  v_max3_f32 v208, v160, v161, v162
  v_max3_f32 v212, v168, v169, v170
  v_mov_b32 v27, 0x3f803f80
  v_max3_f32 v209, v163, v164, v165
  v_max3_f32 v213, v171, v172, v173
  v_max3_f32 v208, v208, v166, v167
  v_max3_f32 v212, v212, v174, v175
  v_accvgpr_write_b32 a208, v27
  v_max3_f32 v208, v208, v209, v242
  v_max3_f32 v212, v212, v213, v243
  v_mov_b32 v209, v208
  v_mov_b32 v213, v212
  v_accvgpr_write_b32 a209, v27
  v_permlane32_swap_b32 v208, v209
  v_permlane32_swap_b32 v212, v213
  v_max_f32 v208, v208, v209
  v_max_f32 v212, v212, v213
  v_accvgpr_write_b32 a210, v27
  v_mov_b32 v209, v208
  v_mov_b32 v213, v212
  s_nop 0
  v_permlane16_swap_b32 v208, v209
  v_permlane16_swap_b32 v212, v213
  v_accvgpr_write_b32 a211, v27
  v_max_f32 v208, v208, v209
  v_max_f32 v212, v212, v213
  buffer_load_dwordx4 v241, s[20:23], s33 offen offset:3072 nt lds
  v_sub_f32 v160, v160, v208
  v_max3_f32 v216, v176, v177, v178
  v_sub_f32 v161, v161, v208
  v_sub_f32 v162, v162, v208
  v_sub_f32 v163, v163, v208
  v_max3_f32 v217, v179, v180, v181
  v_sub_f32 v164, v164, v208
  v_sub_f32 v165, v165, v208
  v_max3_f32 v216, v216, v182, v183
  v_sub_f32 v166, v166, v208
  v_sub_f32 v167, v167, v208
  v_max3_f32 v216, v216, v217, v244
  v_exp_f32 v160, v160
  v_exp_f32 v161, v161
  v_exp_f32 v162, v162
  v_mov_b32 v217, v216
  v_exp_f32 v163, v163
  v_exp_f32 v164, v164
  v_permlane32_swap_b32 v216, v217
  s_add_u32 s33, s33, 16384
  v_exp_f32 v165, v165
  v_exp_f32 v166, v166
  v_exp_f32 v167, v167
  s_add_u32 m0, s40, 49152
  v_max_f32 v216, v216, v217
  v_sub_f32 v209, 0, v208
  v_sub_f32 v210, 0, v208
  v_mov_b32 v217, v216
  v_sub_f32 v211, 0, v208
  v_sub_f32 v208, 0, v208
  buffer_load_dwordx4 v236, s[16:19], s33 offen nt lds
  v_permlane16_swap_b32 v216, v217
  v_cvt_pk_bf16_f32 v192, v160, v161
  v_cvt_pk_bf16_f32 v193, v162, v163
  v_cvt_pk_bf16_f32 v194, v164, v165
  v_max_f32 v216, v216, v217
  v_cvt_pk_bf16_f32 v195, v166, v167
  s_waitcnt lgkmcnt(0)
  s_nop 0
  v_mfma_f32_16x16x32_bf16 v[32:35], a[128:131], v[192:195], 0
  v_sub_f32 v168, v168, v212
  v_sub_f32 v169, v169, v212
  v_sub_f32 v170, v170, v212
  v_sub_f32 v171, v171, v212
  v_mfma_f32_16x16x32_bf16 v[36:39], a[132:135], v[192:195], 0
  v_sub_f32 v172, v172, v212
  v_sub_f32 v173, v173, v212
  v_sub_f32 v174, v174, v212
  v_mfma_f32_16x16x32_bf16 v[40:43], a[136:139], v[192:195], 0
  v_sub_f32 v175, v175, v212
  v_exp_f32 v168, v168
  v_mfma_f32_16x16x32_bf16 v[44:47], a[140:143], v[192:195], 0
  v_exp_f32 v169, v169
  v_exp_f32 v170, v170
  v_mfma_f32_16x16x32_bf16 v[48:51], a[144:147], v[192:195], 0
  v_exp_f32 v171, v171
  v_exp_f32 v172, v172
  v_mfma_f32_16x16x32_bf16 v[52:55], a[148:151], v[192:195], 0
  buffer_load_dwordx4 v237, s[16:19], s33 offen offset:1024 nt lds
  v_exp_f32 v173, v173
  v_exp_f32 v174, v174
  v_mfma_f32_16x16x32_bf16 v[56:59], a[152:155], v[192:195], 0
  v_exp_f32 v175, v175
  v_sub_f32 v213, 0, v212
  v_sub_f32 v214, 0, v212
  v_mfma_f32_16x16x32_bf16 v[60:63], a[156:159], v[192:195], 0
  v_sub_f32 v215, 0, v212
  v_sub_f32 v212, 0, v212
  v_cvt_pk_bf16_f32 v196, v168, v169
  v_mfma_f32_16x16x32_bf16 a[192:195], a[208:211], v[192:195], 0
  v_cvt_pk_bf16_f32 v197, v170, v171
  v_cvt_pk_bf16_f32 v198, v172, v173
  v_cvt_pk_bf16_f32 v199, v174, v175
  s_nop 1
  v_mfma_f32_16x16x32_bf16 v[64:67], a[128:131], v[196:199], 0
  v_sub_f32 v176, v176, v216
  v_sub_f32 v177, v177, v216
  v_sub_f32 v178, v178, v216
  v_sub_f32 v179, v179, v216
  v_mfma_f32_16x16x32_bf16 v[68:71], a[132:135], v[196:199], 0
  v_sub_f32 v180, v180, v216
  v_sub_f32 v181, v181, v216
  v_sub_f32 v182, v182, v216
  v_sub_f32 v183, v183, v216
  v_mfma_f32_16x16x32_bf16 v[72:75], a[136:139], v[196:199], 0
  v_exp_f32 v176, v176
  v_exp_f32 v177, v177
  v_mfma_f32_16x16x32_bf16 v[76:79], a[140:143], v[196:199], 0
  buffer_load_dwordx4 v238, s[16:19], s33 offen offset:2048 nt lds
  v_exp_f32 v178, v178
  v_exp_f32 v179, v179
  v_mfma_f32_16x16x32_bf16 v[80:83], a[144:147], v[196:199], 0
  v_exp_f32 v180, v180
  v_exp_f32 v181, v181
  v_mfma_f32_16x16x32_bf16 v[84:87], a[148:151], v[196:199], 0
  v_exp_f32 v182, v182
  v_mfma_f32_16x16x32_bf16 v[88:91], a[152:155], v[196:199], 0
  v_exp_f32 v183, v183
  v_sub_f32 v217, 0, v216
  v_sub_f32 v218, 0, v216
  v_sub_f32 v219, 0, v216
  v_mfma_f32_16x16x32_bf16 v[92:95], a[156:159], v[196:199], 0
  v_sub_f32 v216, 0, v216
  v_cvt_pk_bf16_f32 v200, v176, v177
  v_cvt_pk_bf16_f32 v201, v178, v179
  v_cvt_pk_bf16_f32 v202, v180, v181
  v_mfma_f32_16x16x32_bf16 a[196:199], a[208:211], v[196:199], 0
  v_cvt_pk_bf16_f32 v203, v182, v183
  v_mfma_f32_16x16x32_bf16 v[160:163], a[96:99], a[0:3], v[208:211]
  v_mfma_f32_16x16x32_bf16 v[160:163], a[100:103], a[4:7], v[160:163]
  ds_read_b64_tr_b16 a[160:161], v228 offset:8192
  buffer_load_dwordx4 v239, s[16:19], s33 offen offset:3072 nt lds
  v_mfma_f32_16x16x32_bf16 v[160:163], a[104:107], a[8:11], v[160:163]
  v_mfma_f32_16x16x32_bf16 v[160:163], a[108:111], a[12:15], v[160:163]
  ds_read_b64_tr_b16 a[162:163], v228 offset:12288
  v_mfma_f32_16x16x32_bf16 v[164:167], a[112:115], a[0:3], v[208:211]
  v_mfma_f32_16x16x32_bf16 v[164:167], a[116:119], a[4:7], v[164:167]
  ds_read_b64_tr_b16 a[164:165], v229 offset:8192
  ds_read_b64_tr_b16 a[166:167], v229 offset:12288
  v_mfma_f32_16x16x32_bf16 v[164:167], a[120:123], a[8:11], v[164:167]
  v_mfma_f32_16x16x32_bf16 v[164:167], a[124:127], a[12:15], v[164:167]
  ds_read_b64_tr_b16 a[168:169], v230 offset:8192
  v_mfma_f32_16x16x32_bf16 v[96:99], a[128:131], v[200:203], 0
  v_exp_f32 v160, v160
  v_mfma_f32_16x16x32_bf16 v[100:103], a[132:135], v[200:203], 0
  ds_read_b64_tr_b16 a[170:171], v230 offset:12288
  ds_read_b64_tr_b16 a[172:173], v231 offset:8192
  v_mfma_f32_16x16x32_bf16 v[104:107], a[136:139], v[200:203], 0
  v_exp_f32 v161, v161
  v_mfma_f32_16x16x32_bf16 v[108:111], a[140:143], v[200:203], 0
  ds_read_b64_tr_b16 a[174:175], v231 offset:12288
  v_cvt_pk_bf16_f32 v192, v160, v161
  v_mfma_f32_16x16x32_bf16 v[112:115], a[144:147], v[200:203], 0
  v_exp_f32 v162, v162
  v_mfma_f32_16x16x32_bf16 v[116:119], a[148:151], v[200:203], 0
  ds_read_b64_tr_b16 a[176:177], v232 offset:8192
  ds_read_b64_tr_b16 a[178:179], v232 offset:12288
  v_mfma_f32_16x16x32_bf16 v[120:123], a[152:155], v[200:203], 0
  v_exp_f32 v163, v163
  v_mfma_f32_16x16x32_bf16 v[124:127], a[156:159], v[200:203], 0
  v_cvt_pk_bf16_f32 v193, v162, v163
  ds_read_b64_tr_b16 a[180:181], v233 offset:8192
  v_mfma_f32_16x16x32_bf16 a[200:203], a[208:211], v[200:203], 0
  ds_read_b64_tr_b16 a[182:183], v233 offset:12288
  v_mfma_f32_16x16x32_bf16 v[168:171], a[96:99], a[16:19], v[212:215]
  v_exp_f32 v164, v164
  v_mfma_f32_16x16x32_bf16 v[168:171], a[100:103], a[20:23], v[168:171]
  ds_read_b64_tr_b16 a[184:185], v234 offset:8192
  v_mfma_f32_16x16x32_bf16 v[168:171], a[104:107], a[24:27], v[168:171]
  v_exp_f32 v165, v165
  v_mfma_f32_16x16x32_bf16 v[168:171], a[108:111], a[28:31], v[168:171]
  ds_read_b64_tr_b16 a[186:187], v234 offset:12288
  v_cvt_pk_bf16_f32 v194, v164, v165
  v_mfma_f32_16x16x32_bf16 v[172:175], a[112:115], a[16:19], v[212:215]
  v_exp_f32 v166, v166
  v_mfma_f32_16x16x32_bf16 v[172:175], a[116:119], a[20:23], v[172:175]
  ds_read_b64_tr_b16 a[188:189], v235 offset:8192
  ds_read_b64_tr_b16 a[190:191], v235 offset:12288
  v_mfma_f32_16x16x32_bf16 v[172:175], a[120:123], a[24:27], v[172:175]
  v_exp_f32 v167, v167
  v_mfma_f32_16x16x32_bf16 v[172:175], a[124:127], a[28:31], v[172:175]
  v_cvt_pk_bf16_f32 v195, v166, v167
  v_exp_f32 v168, v168
  v_exp_f32 v169, v169
  s_nop 0
  v_cvt_pk_bf16_f32 v196, v168, v169
  v_exp_f32 v170, v170
  v_exp_f32 v171, v171
  s_nop 0
  v_cvt_pk_bf16_f32 v197, v170, v171
  s_waitcnt vmcnt(12) lgkmcnt(0)
  s_barrier
  v_mfma_f32_16x16x32_bf16 v[176:179], a[96:99], a[32:35], v[216:219]
  s_add_u32 m0, s40, 114688
  v_exp_f32 v172, v172
  v_mfma_f32_16x16x32_bf16 v[176:179], a[100:103], a[36:39], v[176:179]
  ds_read_b128 a[64:67], v224 offset:16384
  buffer_load_dwordx4 v240, s[20:23], s33 offen nt lds
  v_mfma_f32_16x16x32_bf16 v[176:179], a[104:107], a[40:43], v[176:179]
  v_exp_f32 v173, v173
  v_mfma_f32_16x16x32_bf16 v[176:179], a[108:111], a[44:47], v[176:179]
  v_cvt_pk_bf16_f32 v198, v172, v173
  ds_read_b128 a[68:71], v225 offset:16384
  v_mfma_f32_16x16x32_bf16 v[180:183], a[112:115], a[32:35], v[216:219]
  v_exp_f32 v174, v174
  v_mfma_f32_16x16x32_bf16 v[180:183], a[116:119], a[36:39], v[180:183]
  ds_read_b128 a[72:75], v226 offset:16384
  v_mfma_f32_16x16x32_bf16 v[180:183], a[120:123], a[40:43], v[180:183]
  v_exp_f32 v175, v175
  v_mfma_f32_16x16x32_bf16 v[180:183], a[124:127], a[44:47], v[180:183]
  ds_read_b128 a[76:79], v227 offset:16384
  v_cvt_pk_bf16_f32 v199, v174, v175
  v_mfma_f32_16x16x32_bf16 v[32:35], a[160:163], v[192:195], v[32:35]
  v_exp_f32 v176, v176
  v_mfma_f32_16x16x32_bf16 v[36:39], a[164:167], v[192:195], v[36:39]
  ds_read_b128 a[80:83], v224 offset:20480
  v_mfma_f32_16x16x32_bf16 v[40:43], a[168:171], v[192:195], v[40:43]
  v_exp_f32 v177, v177
  v_mfma_f32_16x16x32_bf16 v[44:47], a[172:175], v[192:195], v[44:47]
  v_cvt_pk_bf16_f32 v200, v176, v177
  ds_read_b128 a[84:87], v225 offset:20480
  v_mfma_f32_16x16x32_bf16 v[48:51], a[176:179], v[192:195], v[48:51]
  v_exp_f32 v178, v178
  v_mfma_f32_16x16x32_bf16 v[52:55], a[180:183], v[192:195], v[52:55]
  ds_read_b128 a[88:91], v226 offset:20480
  v_mfma_f32_16x16x32_bf16 v[56:59], a[184:187], v[192:195], v[56:59]
  v_exp_f32 v179, v179
  v_mfma_f32_16x16x32_bf16 v[60:63], a[188:191], v[192:195], v[60:63]
  ds_read_b128 a[92:95], v227 offset:20480
  v_cvt_pk_bf16_f32 v201, v178, v179
  v_mfma_f32_16x16x32_bf16 a[192:195], a[208:211], v[192:195], a[192:195]
  v_exp_f32 v180, v180
  buffer_load_dwordx4 v241, s[20:23], s33 offen offset:1024 nt lds
  v_exp_f32 v181, v181
  s_nop 0
  v_cvt_pk_bf16_f32 v202, v180, v181
  v_exp_f32 v182, v182
  v_exp_f32 v183, v183
  s_nop 0
  v_cvt_pk_bf16_f32 v203, v182, v183
  v_mfma_f32_16x16x32_bf16 v[64:67], a[160:163], v[196:199], v[64:67]
  v_mfma_f32_16x16x32_bf16 v[68:71], a[164:167], v[196:199], v[68:71]
  v_mfma_f32_16x16x32_bf16 v[72:75], a[168:171], v[196:199], v[72:75]
  v_mfma_f32_16x16x32_bf16 v[76:79], a[172:175], v[196:199], v[76:79]
  v_mfma_f32_16x16x32_bf16 v[80:83], a[176:179], v[196:199], v[80:83]
  v_mfma_f32_16x16x32_bf16 v[84:87], a[180:183], v[196:199], v[84:87]
  v_mfma_f32_16x16x32_bf16 v[88:91], a[184:187], v[196:199], v[88:91]
  v_mfma_f32_16x16x32_bf16 v[92:95], a[188:191], v[196:199], v[92:95]
  s_waitcnt lgkmcnt(0)
  v_mfma_f32_16x16x32_bf16 a[196:199], a[208:211], v[196:199], a[196:199]
  s_mov_b32 s34, 3
  v_mov_b32 v128, 0
  v_mov_b32 v129, 0
  v_mov_b32 v130, 0
  v_mov_b32 v131, 0
  v_mov_b32 v132, 0
  v_mov_b32 v133, 0
  v_mov_b32 v134, 0
  v_mov_b32 v135, 0
  v_mov_b32 v136, 0
  v_mov_b32 v137, 0
  v_mov_b32 v138, 0
  v_mov_b32 v139, 0
  v_mov_b32 v140, 0
  v_mov_b32 v141, 0
  v_mov_b32 v142, 0
  v_mov_b32 v143, 0
  v_mov_b32 v144, 0
  v_mov_b32 v145, 0
  v_mov_b32 v146, 0
  v_mov_b32 v147, 0
  v_mov_b32 v148, 0
  v_mov_b32 v149, 0
  v_mov_b32 v150, 0
  v_mov_b32 v151, 0
  v_mov_b32 v152, 0
  v_mov_b32 v153, 0
  v_mov_b32 v154, 0
  v_mov_b32 v155, 0
  v_mov_b32 v156, 0
  v_mov_b32 v157, 0
  v_mov_b32 v158, 0
  v_mov_b32 v159, 0
  v_mov_b32 v184, 0
  v_mov_b32 v185, 0
  v_mov_b32 v186, 0
  v_mov_b32 v187, 0
  v_mov_b32 v188, 0
  v_mov_b32 v189, 0
  v_mov_b32 v190, 0
  v_mov_b32 v191, 0
  v_mov_b32 v204, 0
  v_mov_b32 v205, 0
  v_mov_b32 v206, 0
  v_mov_b32 v207, 0
  v_mov_b32 v220, 0
  v_mov_b32 v221, 0
  v_mov_b32 v222, 0
  v_mov_b32 v223, 0
  v_accvgpr_write_b32 a48, 0
  v_accvgpr_write_b32 a49, 0
  v_accvgpr_write_b32 a50, 0
  v_accvgpr_write_b32 a51, 0
  v_accvgpr_write_b32 a52, 0
  v_accvgpr_write_b32 a53, 0
  v_accvgpr_write_b32 a54, 0
  v_accvgpr_write_b32 a55, 0
  v_accvgpr_write_b32 a56, 0
  v_accvgpr_write_b32 a57, 0
  v_accvgpr_write_b32 a58, 0
  v_accvgpr_write_b32 a59, 0
  v_accvgpr_write_b32 a60, 0
  v_accvgpr_write_b32 a61, 0
  v_accvgpr_write_b32 a62, 0
  v_accvgpr_write_b32 a63, 0
  v_accvgpr_write_b32 a204, 0
  v_accvgpr_write_b32 a205, 0
  v_accvgpr_write_b32 a206, 0
  v_accvgpr_write_b32 a207, 0
.p2align 6
L_loop3:
  v_mfma_f32_16x16x32_bf16 v[160:163], a[64:67], a[0:3], v[208:211]
  v_mfma_f32_16x16x32_bf16 v[160:163], a[68:71], a[4:7], v[160:163]
  ds_read_b64_tr_b16 a[128:129], v228 offset:16384
  buffer_load_dwordx4 v240, s[20:23], s33 offen offset:2048 nt lds
  v_mfma_f32_16x16x32_bf16 v[160:163], a[72:75], a[8:11], v[160:163]
  v_mfma_f32_16x16x32_bf16 v[160:163], a[76:79], a[12:15], v[160:163]
  ds_read_b64_tr_b16 a[130:131], v228 offset:20480
  v_mfma_f32_16x16x32_bf16 v[164:167], a[80:83], a[0:3], v[208:211]
  v_mfma_f32_16x16x32_bf16 v[164:167], a[84:87], a[4:7], v[164:167]
  ds_read_b64_tr_b16 a[132:133], v229 offset:16384
  ds_read_b64_tr_b16 a[134:135], v229 offset:20480
  v_mfma_f32_16x16x32_bf16 v[164:167], a[88:91], a[8:11], v[164:167]
  v_mfma_f32_16x16x32_bf16 v[164:167], a[92:95], a[12:15], v[164:167]
  ds_read_b64_tr_b16 a[136:137], v230 offset:16384
  v_mfma_f32_16x16x32_bf16 v[96:99], a[160:163], v[200:203], v[96:99]
  v_exp_f32 v160, v160
  v_mfma_f32_16x16x32_bf16 v[100:103], a[164:167], v[200:203], v[100:103]
  ds_read_b64_tr_b16 a[138:139], v230 offset:20480
  ds_read_b64_tr_b16 a[140:141], v231 offset:16384
  v_mfma_f32_16x16x32_bf16 v[104:107], a[168:171], v[200:203], v[104:107]
  v_exp_f32 v161, v161
  v_mfma_f32_16x16x32_bf16 v[108:111], a[172:175], v[200:203], v[108:111]
  ds_read_b64_tr_b16 a[142:143], v231 offset:20480
  v_cvt_pk_bf16_f32 v192, v160, v161
  v_mfma_f32_16x16x32_bf16 v[112:115], a[176:179], v[200:203], v[112:115]
  v_exp_f32 v162, v162
  v_mfma_f32_16x16x32_bf16 v[116:119], a[180:183], v[200:203], v[116:119]
  ds_read_b64_tr_b16 a[144:145], v232 offset:16384
  ds_read_b64_tr_b16 a[146:147], v232 offset:20480
  v_mfma_f32_16x16x32_bf16 v[120:123], a[184:187], v[200:203], v[120:123]
  v_exp_f32 v163, v163
  v_mfma_f32_16x16x32_bf16 v[124:127], a[188:191], v[200:203], v[124:127]
  v_cvt_pk_bf16_f32 v193, v162, v163
  ds_read_b64_tr_b16 a[148:149], v233 offset:16384
  v_mfma_f32_16x16x32_bf16 a[200:203], a[208:211], v[200:203], a[200:203]
  ds_read_b64_tr_b16 a[150:151], v233 offset:20480
  v_mfma_f32_16x16x32_bf16 v[168:171], a[64:67], a[16:19], v[212:215]
  v_exp_f32 v164, v164
  v_mfma_f32_16x16x32_bf16 v[168:171], a[68:71], a[20:23], v[168:171]
  ds_read_b64_tr_b16 a[152:153], v234 offset:16384
  buffer_load_dwordx4 v241, s[20:23], s33 offen offset:3072 nt lds
  v_mfma_f32_16x16x32_bf16 v[168:171], a[72:75], a[24:27], v[168:171]
  s_add_u32 s33, s33, 16384
  v_exp_f32 v165, v165
  v_mfma_f32_16x16x32_bf16 v[168:171], a[76:79], a[28:31], v[168:171]
  ds_read_b64_tr_b16 a[154:155], v234 offset:20480
  v_cvt_pk_bf16_f32 v194, v164, v165
  v_mfma_f32_16x16x32_bf16 v[172:175], a[80:83], a[16:19], v[212:215]
  v_exp_f32 v166, v166
  v_mfma_f32_16x16x32_bf16 v[172:175], a[84:87], a[20:23], v[172:175]
  ds_read_b64_tr_b16 a[156:157], v235 offset:16384
  ds_read_b64_tr_b16 a[158:159], v235 offset:20480
  v_mfma_f32_16x16x32_bf16 v[172:175], a[88:91], a[24:27], v[172:175]
  v_exp_f32 v167, v167
  v_mfma_f32_16x16x32_bf16 v[172:175], a[92:95], a[28:31], v[172:175]
  v_cvt_pk_bf16_f32 v195, v166, v167
  v_exp_f32 v168, v168
  v_exp_f32 v169, v169
  s_nop 0
  v_cvt_pk_bf16_f32 v196, v168, v169
  v_exp_f32 v170, v170
  v_exp_f32 v171, v171
  s_nop 0
  v_cvt_pk_bf16_f32 v197, v170, v171
  s_waitcnt lgkmcnt(0)
  v_mfma_f32_16x16x32_bf16 v[176:179], a[64:67], a[32:35], v[216:219]
  s_add_u32 m0, s40, 0
  v_exp_f32 v172, v172
  v_mfma_f32_16x16x32_bf16 v[176:179], a[68:71], a[36:39], v[176:179]
  ds_read_b128 a[96:99], v224 offset:24576
  buffer_load_dwordx4 v236, s[16:19], s33 offen nt lds
  v_mfma_f32_16x16x32_bf16 v[176:179], a[72:75], a[40:43], v[176:179]
  v_exp_f32 v173, v173
  v_mfma_f32_16x16x32_bf16 v[176:179], a[76:79], a[44:47], v[176:179]
  v_cvt_pk_bf16_f32 v198, v172, v173
  ds_read_b128 a[100:103], v225 offset:24576
  v_mfma_f32_16x16x32_bf16 v[180:183], a[80:83], a[32:35], v[216:219]
  v_exp_f32 v174, v174
  v_mfma_f32_16x16x32_bf16 v[180:183], a[84:87], a[36:39], v[180:183]
  ds_read_b128 a[104:107], v226 offset:24576
  v_mfma_f32_16x16x32_bf16 v[180:183], a[88:91], a[40:43], v[180:183]
  v_exp_f32 v175, v175
  v_mfma_f32_16x16x32_bf16 v[180:183], a[92:95], a[44:47], v[180:183]
  ds_read_b128 a[108:111], v227 offset:24576
  v_cvt_pk_bf16_f32 v199, v174, v175
  v_mfma_f32_16x16x32_bf16 v[32:35], a[128:131], v[192:195], v[32:35]
  v_exp_f32 v176, v176
  v_mfma_f32_16x16x32_bf16 v[36:39], a[132:135], v[192:195], v[36:39]
  ds_read_b128 a[112:115], v224 offset:28672
  v_mfma_f32_16x16x32_bf16 v[40:43], a[136:139], v[192:195], v[40:43]
  v_exp_f32 v177, v177
  v_mfma_f32_16x16x32_bf16 v[44:47], a[140:143], v[192:195], v[44:47]
  v_cvt_pk_bf16_f32 v200, v176, v177
  ds_read_b128 a[116:119], v225 offset:28672
  v_mfma_f32_16x16x32_bf16 v[48:51], a[144:147], v[192:195], v[48:51]
  v_exp_f32 v178, v178
  v_mfma_f32_16x16x32_bf16 v[52:55], a[148:151], v[192:195], v[52:55]
  ds_read_b128 a[120:123], v226 offset:28672
  v_mfma_f32_16x16x32_bf16 v[56:59], a[152:155], v[192:195], v[56:59]
  v_exp_f32 v179, v179
  v_mfma_f32_16x16x32_bf16 v[60:63], a[156:159], v[192:195], v[60:63]
  ds_read_b128 a[124:127], v227 offset:28672
  v_cvt_pk_bf16_f32 v201, v178, v179
  v_mfma_f32_16x16x32_bf16 a[192:195], a[208:211], v[192:195], a[192:195]
  v_exp_f32 v180, v180
  buffer_load_dwordx4 v237, s[16:19], s33 offen offset:1024 nt lds
  v_exp_f32 v181, v181
  s_nop 0
  v_cvt_pk_bf16_f32 v202, v180, v181
  v_exp_f32 v182, v182
  v_exp_f32 v183, v183
  s_nop 0
  v_cvt_pk_bf16_f32 v203, v182, v183
  v_mfma_f32_16x16x32_bf16 v[64:67], a[128:131], v[196:199], v[64:67]
  v_mfma_f32_16x16x32_bf16 v[68:71], a[132:135], v[196:199], v[68:71]
  v_mfma_f32_16x16x32_bf16 v[72:75], a[136:139], v[196:199], v[72:75]
  v_mfma_f32_16x16x32_bf16 v[76:79], a[140:143], v[196:199], v[76:79]
  v_mfma_f32_16x16x32_bf16 v[80:83], a[144:147], v[196:199], v[80:83]
  v_mfma_f32_16x16x32_bf16 v[84:87], a[148:151], v[196:199], v[84:87]
  v_mfma_f32_16x16x32_bf16 v[88:91], a[152:155], v[196:199], v[88:91]
  v_mfma_f32_16x16x32_bf16 v[92:95], a[156:159], v[196:199], v[92:95]
  s_waitcnt lgkmcnt(0)
  v_mfma_f32_16x16x32_bf16 a[196:199], a[208:211], v[196:199], a[196:199]
  v_mfma_f32_16x16x32_bf16 v[160:163], a[96:99], a[0:3], v[208:211]
  v_mfma_f32_16x16x32_bf16 v[160:163], a[100:103], a[4:7], v[160:163]
  ds_read_b64_tr_b16 a[160:161], v228 offset:24576
  buffer_load_dwordx4 v238, s[16:19], s33 offen offset:2048 nt lds
  v_mfma_f32_16x16x32_bf16 v[160:163], a[104:107], a[8:11], v[160:163]
  v_mfma_f32_16x16x32_bf16 v[160:163], a[108:111], a[12:15], v[160:163]
  ds_read_b64_tr_b16 a[162:163], v228 offset:28672
  v_mfma_f32_16x16x32_bf16 v[164:167], a[112:115], a[0:3], v[208:211]
  v_mfma_f32_16x16x32_bf16 v[164:167], a[116:119], a[4:7], v[164:167]
  ds_read_b64_tr_b16 a[164:165], v229 offset:24576
  ds_read_b64_tr_b16 a[166:167], v229 offset:28672
  v_mfma_f32_16x16x32_bf16 v[164:167], a[120:123], a[8:11], v[164:167]
  v_mfma_f32_16x16x32_bf16 v[164:167], a[124:127], a[12:15], v[164:167]
  ds_read_b64_tr_b16 a[168:169], v230 offset:24576
  v_mfma_f32_16x16x32_bf16 v[96:99], a[128:131], v[200:203], v[96:99]
  v_exp_f32 v160, v160
  v_mfma_f32_16x16x32_bf16 v[100:103], a[132:135], v[200:203], v[100:103]
  ds_read_b64_tr_b16 a[170:171], v230 offset:28672
  ds_read_b64_tr_b16 a[172:173], v231 offset:24576
  v_mfma_f32_16x16x32_bf16 v[104:107], a[136:139], v[200:203], v[104:107]
  v_exp_f32 v161, v161
  v_mfma_f32_16x16x32_bf16 v[108:111], a[140:143], v[200:203], v[108:111]
  ds_read_b64_tr_b16 a[174:175], v231 offset:28672
  v_cvt_pk_bf16_f32 v192, v160, v161
  v_mfma_f32_16x16x32_bf16 v[112:115], a[144:147], v[200:203], v[112:115]
  v_exp_f32 v162, v162
  v_mfma_f32_16x16x32_bf16 v[116:119], a[148:151], v[200:203], v[116:119]
  ds_read_b64_tr_b16 a[176:177], v232 offset:24576
  ds_read_b64_tr_b16 a[178:179], v232 offset:28672
  v_mfma_f32_16x16x32_bf16 v[120:123], a[152:155], v[200:203], v[120:123]
  v_exp_f32 v163, v163
  v_mfma_f32_16x16x32_bf16 v[124:127], a[156:159], v[200:203], v[124:127]
  v_cvt_pk_bf16_f32 v193, v162, v163
  ds_read_b64_tr_b16 a[180:181], v233 offset:24576
  v_mfma_f32_16x16x32_bf16 a[200:203], a[208:211], v[200:203], a[200:203]
  ds_read_b64_tr_b16 a[182:183], v233 offset:28672
  v_mfma_f32_16x16x32_bf16 v[168:171], a[96:99], a[16:19], v[212:215]
  v_exp_f32 v164, v164
  v_mfma_f32_16x16x32_bf16 v[168:171], a[100:103], a[20:23], v[168:171]
  ds_read_b64_tr_b16 a[184:185], v234 offset:24576
  buffer_load_dwordx4 v239, s[16:19], s33 offen offset:3072 nt lds
  v_mfma_f32_16x16x32_bf16 v[168:171], a[104:107], a[24:27], v[168:171]
  v_exp_f32 v165, v165
  v_mfma_f32_16x16x32_bf16 v[168:171], a[108:111], a[28:31], v[168:171]
  ds_read_b64_tr_b16 a[186:187], v234 offset:28672
  v_cvt_pk_bf16_f32 v194, v164, v165
  v_mfma_f32_16x16x32_bf16 v[172:175], a[112:115], a[16:19], v[212:215]
  v_exp_f32 v166, v166
  v_mfma_f32_16x16x32_bf16 v[172:175], a[116:119], a[20:23], v[172:175]
  ds_read_b64_tr_b16 a[188:189], v235 offset:24576
  ds_read_b64_tr_b16 a[190:191], v235 offset:28672
  v_mfma_f32_16x16x32_bf16 v[172:175], a[120:123], a[24:27], v[172:175]
  v_exp_f32 v167, v167
  v_mfma_f32_16x16x32_bf16 v[172:175], a[124:127], a[28:31], v[172:175]
  v_cvt_pk_bf16_f32 v195, v166, v167
  v_exp_f32 v168, v168
  v_exp_f32 v169, v169
  s_nop 0
  v_cvt_pk_bf16_f32 v196, v168, v169
  v_exp_f32 v170, v170
  v_exp_f32 v171, v171
  s_nop 0
  v_cvt_pk_bf16_f32 v197, v170, v171
  s_waitcnt vmcnt(12) lgkmcnt(0)
  s_barrier
  v_mfma_f32_16x16x32_bf16 v[176:179], a[96:99], a[32:35], v[216:219]
  s_add_u32 m0, s40, 65536
  v_exp_f32 v172, v172
  v_mfma_f32_16x16x32_bf16 v[176:179], a[100:103], a[36:39], v[176:179]
  ds_read_b128 a[64:67], v224 offset:32768
  buffer_load_dwordx4 v240, s[20:23], s33 offen nt lds
  v_mfma_f32_16x16x32_bf16 v[176:179], a[104:107], a[40:43], v[176:179]
  v_exp_f32 v173, v173
  v_mfma_f32_16x16x32_bf16 v[176:179], a[108:111], a[44:47], v[176:179]
  v_cvt_pk_bf16_f32 v198, v172, v173
  ds_read_b128 a[68:71], v225 offset:32768
  v_mfma_f32_16x16x32_bf16 v[180:183], a[112:115], a[32:35], v[216:219]
  v_exp_f32 v174, v174
  v_mfma_f32_16x16x32_bf16 v[180:183], a[116:119], a[36:39], v[180:183]
  ds_read_b128 a[72:75], v226 offset:32768
  v_mfma_f32_16x16x32_bf16 v[180:183], a[120:123], a[40:43], v[180:183]
  v_exp_f32 v175, v175
  v_mfma_f32_16x16x32_bf16 v[180:183], a[124:127], a[44:47], v[180:183]
  ds_read_b128 a[76:79], v227 offset:32768
  v_cvt_pk_bf16_f32 v199, v174, v175
  v_mfma_f32_16x16x32_bf16 v[32:35], a[160:163], v[192:195], v[32:35]
  v_exp_f32 v176, v176
  v_mfma_f32_16x16x32_bf16 v[36:39], a[164:167], v[192:195], v[36:39]
  ds_read_b128 a[80:83], v224 offset:36864
  v_mfma_f32_16x16x32_bf16 v[40:43], a[168:171], v[192:195], v[40:43]
  v_exp_f32 v177, v177
  v_mfma_f32_16x16x32_bf16 v[44:47], a[172:175], v[192:195], v[44:47]
  v_cvt_pk_bf16_f32 v200, v176, v177
  ds_read_b128 a[84:87], v225 offset:36864
  v_mfma_f32_16x16x32_bf16 v[48:51], a[176:179], v[192:195], v[48:51]
  v_exp_f32 v178, v178
  v_mfma_f32_16x16x32_bf16 v[52:55], a[180:183], v[192:195], v[52:55]
  ds_read_b128 a[88:91], v226 offset:36864
  v_mfma_f32_16x16x32_bf16 v[56:59], a[184:187], v[192:195], v[56:59]
  v_exp_f32 v179, v179
  v_mfma_f32_16x16x32_bf16 v[60:63], a[188:191], v[192:195], v[60:63]
  ds_read_b128 a[92:95], v227 offset:36864
  v_cvt_pk_bf16_f32 v201, v178, v179
  v_mfma_f32_16x16x32_bf16 a[192:195], a[208:211], v[192:195], a[192:195]
  v_exp_f32 v180, v180
  buffer_load_dwordx4 v241, s[20:23], s33 offen offset:1024 nt lds
  v_exp_f32 v181, v181
  s_nop 0
  v_cvt_pk_bf16_f32 v202, v180, v181
  v_exp_f32 v182, v182
  v_exp_f32 v183, v183
  s_nop 0
  v_cvt_pk_bf16_f32 v203, v182, v183
  v_mfma_f32_16x16x32_bf16 v[64:67], a[160:163], v[196:199], v[64:67]
  v_mfma_f32_16x16x32_bf16 v[68:71], a[164:167], v[196:199], v[68:71]
  v_mfma_f32_16x16x32_bf16 v[72:75], a[168:171], v[196:199], v[72:75]
  v_mfma_f32_16x16x32_bf16 v[76:79], a[172:175], v[196:199], v[76:79]
  v_mfma_f32_16x16x32_bf16 v[80:83], a[176:179], v[196:199], v[80:83]
  v_mfma_f32_16x16x32_bf16 v[84:87], a[180:183], v[196:199], v[84:87]
  v_mfma_f32_16x16x32_bf16 v[88:91], a[184:187], v[196:199], v[88:91]
  v_mfma_f32_16x16x32_bf16 v[92:95], a[188:191], v[196:199], v[92:95]
  s_waitcnt lgkmcnt(0)
  v_mfma_f32_16x16x32_bf16 a[196:199], a[208:211], v[196:199], a[196:199]
  v_mfma_f32_16x16x32_bf16 v[160:163], a[64:67], a[0:3], v[208:211]
  v_mfma_f32_16x16x32_bf16 v[160:163], a[68:71], a[4:7], v[160:163]
  ds_read_b64_tr_b16 a[128:129], v228 offset:32768
  buffer_load_dwordx4 v240, s[20:23], s33 offen offset:2048 nt lds
  v_mfma_f32_16x16x32_bf16 v[160:163], a[72:75], a[8:11], v[160:163]
  v_mfma_f32_16x16x32_bf16 v[160:163], a[76:79], a[12:15], v[160:163]
  ds_read_b64_tr_b16 a[130:131], v228 offset:36864
  v_mfma_f32_16x16x32_bf16 v[164:167], a[80:83], a[0:3], v[208:211]
  v_mfma_f32_16x16x32_bf16 v[164:167], a[84:87], a[4:7], v[164:167]
  ds_read_b64_tr_b16 a[132:133], v229 offset:32768
  ds_read_b64_tr_b16 a[134:135], v229 offset:36864
  v_mfma_f32_16x16x32_bf16 v[164:167], a[88:91], a[8:11], v[164:167]
  v_mfma_f32_16x16x32_bf16 v[164:167], a[92:95], a[12:15], v[164:167]
  ds_read_b64_tr_b16 a[136:137], v230 offset:32768
  v_mfma_f32_16x16x32_bf16 v[96:99], a[160:163], v[200:203], v[96:99]
  v_exp_f32 v160, v160
  v_mfma_f32_16x16x32_bf16 v[100:103], a[164:167], v[200:203], v[100:103]
  ds_read_b64_tr_b16 a[138:139], v230 offset:36864
  ds_read_b64_tr_b16 a[140:141], v231 offset:32768
  v_mfma_f32_16x16x32_bf16 v[104:107], a[168:171], v[200:203], v[104:107]
  v_exp_f32 v161, v161
  v_mfma_f32_16x16x32_bf16 v[108:111], a[172:175], v[200:203], v[108:111]
  ds_read_b64_tr_b16 a[142:143], v231 offset:36864
  v_cvt_pk_bf16_f32 v192, v160, v161
  v_mfma_f32_16x16x32_bf16 v[112:115], a[176:179], v[200:203], v[112:115]
  v_exp_f32 v162, v162
  v_mfma_f32_16x16x32_bf16 v[116:119], a[180:183], v[200:203], v[116:119]
  ds_read_b64_tr_b16 a[144:145], v232 offset:32768
  ds_read_b64_tr_b16 a[146:147], v232 offset:36864
  v_mfma_f32_16x16x32_bf16 v[120:123], a[184:187], v[200:203], v[120:123]
  v_exp_f32 v163, v163
  v_mfma_f32_16x16x32_bf16 v[124:127], a[188:191], v[200:203], v[124:127]
  v_cvt_pk_bf16_f32 v193, v162, v163
  ds_read_b64_tr_b16 a[148:149], v233 offset:32768
  v_mfma_f32_16x16x32_bf16 a[200:203], a[208:211], v[200:203], a[200:203]
  ds_read_b64_tr_b16 a[150:151], v233 offset:36864
  v_mfma_f32_16x16x32_bf16 v[168:171], a[64:67], a[16:19], v[212:215]
  v_exp_f32 v164, v164
  v_mfma_f32_16x16x32_bf16 v[168:171], a[68:71], a[20:23], v[168:171]
  ds_read_b64_tr_b16 a[152:153], v234 offset:32768
  buffer_load_dwordx4 v241, s[20:23], s33 offen offset:3072 nt lds
  v_mfma_f32_16x16x32_bf16 v[168:171], a[72:75], a[24:27], v[168:171]
  s_add_u32 s33, s33, 16384
  v_exp_f32 v165, v165
  v_mfma_f32_16x16x32_bf16 v[168:171], a[76:79], a[28:31], v[168:171]
  ds_read_b64_tr_b16 a[154:155], v234 offset:36864
  v_cvt_pk_bf16_f32 v194, v164, v165
  v_mfma_f32_16x16x32_bf16 v[172:175], a[80:83], a[16:19], v[212:215]
  v_exp_f32 v166, v166
  v_mfma_f32_16x16x32_bf16 v[172:175], a[84:87], a[20:23], v[172:175]
  ds_read_b64_tr_b16 a[156:157], v235 offset:32768
  ds_read_b64_tr_b16 a[158:159], v235 offset:36864
  v_mfma_f32_16x16x32_bf16 v[172:175], a[88:91], a[24:27], v[172:175]
  v_exp_f32 v167, v167
  v_mfma_f32_16x16x32_bf16 v[172:175], a[92:95], a[28:31], v[172:175]
  v_cvt_pk_bf16_f32 v195, v166, v167
  v_exp_f32 v168, v168
  v_exp_f32 v169, v169
  s_nop 0
  v_cvt_pk_bf16_f32 v196, v168, v169
  v_exp_f32 v170, v170
  v_exp_f32 v171, v171
  s_nop 0
  v_cvt_pk_bf16_f32 v197, v170, v171
  s_waitcnt lgkmcnt(0)
  v_mfma_f32_16x16x32_bf16 v[176:179], a[64:67], a[32:35], v[216:219]
  s_add_u32 m0, s40, 16384
  v_exp_f32 v172, v172
  v_mfma_f32_16x16x32_bf16 v[176:179], a[68:71], a[36:39], v[176:179]
  ds_read_b128 a[96:99], v224 offset:40960
  buffer_load_dwordx4 v236, s[16:19], s33 offen nt lds
  v_mfma_f32_16x16x32_bf16 v[176:179], a[72:75], a[40:43], v[176:179]
  v_exp_f32 v173, v173
  v_mfma_f32_16x16x32_bf16 v[176:179], a[76:79], a[44:47], v[176:179]
  v_cvt_pk_bf16_f32 v198, v172, v173
  ds_read_b128 a[100:103], v225 offset:40960
  v_mfma_f32_16x16x32_bf16 v[180:183], a[80:83], a[32:35], v[216:219]
  v_exp_f32 v174, v174
  v_mfma_f32_16x16x32_bf16 v[180:183], a[84:87], a[36:39], v[180:183]
  ds_read_b128 a[104:107], v226 offset:40960
  v_mfma_f32_16x16x32_bf16 v[180:183], a[88:91], a[40:43], v[180:183]
  v_exp_f32 v175, v175
  v_mfma_f32_16x16x32_bf16 v[180:183], a[92:95], a[44:47], v[180:183]
  ds_read_b128 a[108:111], v227 offset:40960
  v_cvt_pk_bf16_f32 v199, v174, v175
  v_mfma_f32_16x16x32_bf16 v[32:35], a[128:131], v[192:195], v[32:35]
  v_exp_f32 v176, v176
  v_mfma_f32_16x16x32_bf16 v[36:39], a[132:135], v[192:195], v[36:39]
  ds_read_b128 a[112:115], v224 offset:45056
  v_mfma_f32_16x16x32_bf16 v[40:43], a[136:139], v[192:195], v[40:43]
  v_exp_f32 v177, v177
  v_mfma_f32_16x16x32_bf16 v[44:47], a[140:143], v[192:195], v[44:47]
  v_cvt_pk_bf16_f32 v200, v176, v177
  ds_read_b128 a[116:119], v225 offset:45056
  v_mfma_f32_16x16x32_bf16 v[48:51], a[144:147], v[192:195], v[48:51]
  v_exp_f32 v178, v178
  v_mfma_f32_16x16x32_bf16 v[52:55], a[148:151], v[192:195], v[52:55]
  ds_read_b128 a[120:123], v226 offset:45056
  v_mfma_f32_16x16x32_bf16 v[56:59], a[152:155], v[192:195], v[56:59]
  v_exp_f32 v179, v179
  v_mfma_f32_16x16x32_bf16 v[60:63], a[156:159], v[192:195], v[60:63]
  ds_read_b128 a[124:127], v227 offset:45056
  v_cvt_pk_bf16_f32 v201, v178, v179
  v_mfma_f32_16x16x32_bf16 a[192:195], a[208:211], v[192:195], a[192:195]
  v_exp_f32 v180, v180
  buffer_load_dwordx4 v237, s[16:19], s33 offen offset:1024 nt lds
  v_exp_f32 v181, v181
  s_nop 0
  v_cvt_pk_bf16_f32 v202, v180, v181
  v_exp_f32 v182, v182
  v_exp_f32 v183, v183
  s_nop 0
  v_cvt_pk_bf16_f32 v203, v182, v183
  v_mfma_f32_16x16x32_bf16 v[64:67], a[128:131], v[196:199], v[64:67]
  v_mfma_f32_16x16x32_bf16 v[68:71], a[132:135], v[196:199], v[68:71]
  v_mfma_f32_16x16x32_bf16 v[72:75], a[136:139], v[196:199], v[72:75]
  v_mfma_f32_16x16x32_bf16 v[76:79], a[140:143], v[196:199], v[76:79]
  v_mfma_f32_16x16x32_bf16 v[80:83], a[144:147], v[196:199], v[80:83]
  v_mfma_f32_16x16x32_bf16 v[84:87], a[148:151], v[196:199], v[84:87]
  v_mfma_f32_16x16x32_bf16 v[88:91], a[152:155], v[196:199], v[88:91]
  v_mfma_f32_16x16x32_bf16 v[92:95], a[156:159], v[196:199], v[92:95]
  s_waitcnt lgkmcnt(0)
  v_mfma_f32_16x16x32_bf16 a[196:199], a[208:211], v[196:199], a[196:199]
  v_mfma_f32_16x16x32_bf16 v[160:163], a[96:99], a[0:3], v[208:211]
  v_mfma_f32_16x16x32_bf16 v[160:163], a[100:103], a[4:7], v[160:163]
  ds_read_b64_tr_b16 a[160:161], v228 offset:40960
  buffer_load_dwordx4 v238, s[16:19], s33 offen offset:2048 nt lds
  v_mfma_f32_16x16x32_bf16 v[160:163], a[104:107], a[8:11], v[160:163]
  v_mfma_f32_16x16x32_bf16 v[160:163], a[108:111], a[12:15], v[160:163]
  ds_read_b64_tr_b16 a[162:163], v228 offset:45056
  v_mfma_f32_16x16x32_bf16 v[164:167], a[112:115], a[0:3], v[208:211]
  v_mfma_f32_16x16x32_bf16 v[164:167], a[116:119], a[4:7], v[164:167]
  ds_read_b64_tr_b16 a[164:165], v229 offset:40960
  ds_read_b64_tr_b16 a[166:167], v229 offset:45056
  v_mfma_f32_16x16x32_bf16 v[164:167], a[120:123], a[8:11], v[164:167]
  v_mfma_f32_16x16x32_bf16 v[164:167], a[124:127], a[12:15], v[164:167]
  ds_read_b64_tr_b16 a[168:169], v230 offset:40960
  v_mfma_f32_16x16x32_bf16 v[96:99], a[128:131], v[200:203], v[96:99]
  v_exp_f32 v160, v160
  v_mfma_f32_16x16x32_bf16 v[100:103], a[132:135], v[200:203], v[100:103]
  ds_read_b64_tr_b16 a[170:171], v230 offset:45056
  ds_read_b64_tr_b16 a[172:173], v231 offset:40960
  v_mfma_f32_16x16x32_bf16 v[104:107], a[136:139], v[200:203], v[104:107]
  v_exp_f32 v161, v161
  v_mfma_f32_16x16x32_bf16 v[108:111], a[140:143], v[200:203], v[108:111]
  ds_read_b64_tr_b16 a[174:175], v231 offset:45056
  v_cvt_pk_bf16_f32 v192, v160, v161
  v_mfma_f32_16x16x32_bf16 v[112:115], a[144:147], v[200:203], v[112:115]
  v_exp_f32 v162, v162
  v_mfma_f32_16x16x32_bf16 v[116:119], a[148:151], v[200:203], v[116:119]
  ds_read_b64_tr_b16 a[176:177], v232 offset:40960
  ds_read_b64_tr_b16 a[178:179], v232 offset:45056
  v_mfma_f32_16x16x32_bf16 v[120:123], a[152:155], v[200:203], v[120:123]
  v_exp_f32 v163, v163
  v_mfma_f32_16x16x32_bf16 v[124:127], a[156:159], v[200:203], v[124:127]
  v_cvt_pk_bf16_f32 v193, v162, v163
  ds_read_b64_tr_b16 a[180:181], v233 offset:40960
  v_mfma_f32_16x16x32_bf16 a[200:203], a[208:211], v[200:203], a[200:203]
  ds_read_b64_tr_b16 a[182:183], v233 offset:45056
  v_mfma_f32_16x16x32_bf16 v[168:171], a[96:99], a[16:19], v[212:215]
  v_exp_f32 v164, v164
  v_mfma_f32_16x16x32_bf16 v[168:171], a[100:103], a[20:23], v[168:171]
  ds_read_b64_tr_b16 a[184:185], v234 offset:40960
  buffer_load_dwordx4 v239, s[16:19], s33 offen offset:3072 nt lds
  v_mfma_f32_16x16x32_bf16 v[168:171], a[104:107], a[24:27], v[168:171]
  v_exp_f32 v165, v165
  v_mfma_f32_16x16x32_bf16 v[168:171], a[108:111], a[28:31], v[168:171]
  ds_read_b64_tr_b16 a[186:187], v234 offset:45056
  v_cvt_pk_bf16_f32 v194, v164, v165
  v_mfma_f32_16x16x32_bf16 v[172:175], a[112:115], a[16:19], v[212:215]
  v_exp_f32 v166, v166
  v_mfma_f32_16x16x32_bf16 v[172:175], a[116:119], a[20:23], v[172:175]
  ds_read_b64_tr_b16 a[188:189], v235 offset:40960
  ds_read_b64_tr_b16 a[190:191], v235 offset:45056
  v_mfma_f32_16x16x32_bf16 v[172:175], a[120:123], a[24:27], v[172:175]
  v_exp_f32 v167, v167
  v_mfma_f32_16x16x32_bf16 v[172:175], a[124:127], a[28:31], v[172:175]
  v_cvt_pk_bf16_f32 v195, v166, v167
  v_exp_f32 v168, v168
  v_exp_f32 v169, v169
  s_nop 0
  v_cvt_pk_bf16_f32 v196, v168, v169
  v_exp_f32 v170, v170
  v_exp_f32 v171, v171
  s_nop 0
  v_cvt_pk_bf16_f32 v197, v170, v171
  s_waitcnt vmcnt(12) lgkmcnt(0)
  s_barrier
  v_mfma_f32_16x16x32_bf16 v[176:179], a[96:99], a[32:35], v[216:219]
  s_add_u32 m0, s40, 81920
  v_exp_f32 v172, v172
  v_mfma_f32_16x16x32_bf16 v[176:179], a[100:103], a[36:39], v[176:179]
  ds_read_b128 a[64:67], v224 offset:49152
  buffer_load_dwordx4 v240, s[20:23], s33 offen nt lds
  v_mfma_f32_16x16x32_bf16 v[176:179], a[104:107], a[40:43], v[176:179]
  v_exp_f32 v173, v173
  v_mfma_f32_16x16x32_bf16 v[176:179], a[108:111], a[44:47], v[176:179]
  v_cvt_pk_bf16_f32 v198, v172, v173
  ds_read_b128 a[68:71], v225 offset:49152
  v_mfma_f32_16x16x32_bf16 v[180:183], a[112:115], a[32:35], v[216:219]
  v_exp_f32 v174, v174
  v_mfma_f32_16x16x32_bf16 v[180:183], a[116:119], a[36:39], v[180:183]
  ds_read_b128 a[72:75], v226 offset:49152
  v_mfma_f32_16x16x32_bf16 v[180:183], a[120:123], a[40:43], v[180:183]
  v_exp_f32 v175, v175
  v_mfma_f32_16x16x32_bf16 v[180:183], a[124:127], a[44:47], v[180:183]
  ds_read_b128 a[76:79], v227 offset:49152
  v_cvt_pk_bf16_f32 v199, v174, v175
  v_mfma_f32_16x16x32_bf16 v[32:35], a[160:163], v[192:195], v[32:35]
  v_exp_f32 v176, v176
  v_mfma_f32_16x16x32_bf16 v[36:39], a[164:167], v[192:195], v[36:39]
  ds_read_b128 a[80:83], v224 offset:53248
  v_mfma_f32_16x16x32_bf16 v[40:43], a[168:171], v[192:195], v[40:43]
  v_exp_f32 v177, v177
  v_mfma_f32_16x16x32_bf16 v[44:47], a[172:175], v[192:195], v[44:47]
  v_cvt_pk_bf16_f32 v200, v176, v177
  ds_read_b128 a[84:87], v225 offset:53248
  v_mfma_f32_16x16x32_bf16 v[48:51], a[176:179], v[192:195], v[48:51]
  v_exp_f32 v178, v178
  v_mfma_f32_16x16x32_bf16 v[52:55], a[180:183], v[192:195], v[52:55]
  ds_read_b128 a[88:91], v226 offset:53248
  v_mfma_f32_16x16x32_bf16 v[56:59], a[184:187], v[192:195], v[56:59]
  v_exp_f32 v179, v179
  v_mfma_f32_16x16x32_bf16 v[60:63], a[188:191], v[192:195], v[60:63]
  ds_read_b128 a[92:95], v227 offset:53248
  v_cvt_pk_bf16_f32 v201, v178, v179
  v_mfma_f32_16x16x32_bf16 a[192:195], a[208:211], v[192:195], a[192:195]
  v_exp_f32 v180, v180
  buffer_load_dwordx4 v241, s[20:23], s33 offen offset:1024 nt lds
  v_exp_f32 v181, v181
  s_nop 0
  v_cvt_pk_bf16_f32 v202, v180, v181
  v_exp_f32 v182, v182
  v_exp_f32 v183, v183
  s_nop 0
  v_cvt_pk_bf16_f32 v203, v182, v183
  v_mfma_f32_16x16x32_bf16 v[64:67], a[160:163], v[196:199], v[64:67]
  v_mfma_f32_16x16x32_bf16 v[68:71], a[164:167], v[196:199], v[68:71]
  v_mfma_f32_16x16x32_bf16 v[72:75], a[168:171], v[196:199], v[72:75]
  v_mfma_f32_16x16x32_bf16 v[76:79], a[172:175], v[196:199], v[76:79]
  v_mfma_f32_16x16x32_bf16 v[80:83], a[176:179], v[196:199], v[80:83]
  v_mfma_f32_16x16x32_bf16 v[84:87], a[180:183], v[196:199], v[84:87]
  v_mfma_f32_16x16x32_bf16 v[88:91], a[184:187], v[196:199], v[88:91]
  v_mfma_f32_16x16x32_bf16 v[92:95], a[188:191], v[196:199], v[92:95]
  s_waitcnt lgkmcnt(0)
  v_mfma_f32_16x16x32_bf16 a[196:199], a[208:211], v[196:199], a[196:199]
  v_mfma_f32_16x16x32_bf16 v[160:163], a[64:67], a[0:3], v[208:211]
  v_mfma_f32_16x16x32_bf16 v[160:163], a[68:71], a[4:7], v[160:163]
  ds_read_b64_tr_b16 a[128:129], v228 offset:49152
  buffer_load_dwordx4 v240, s[20:23], s33 offen offset:2048 nt lds
  v_mfma_f32_16x16x32_bf16 v[160:163], a[72:75], a[8:11], v[160:163]
  v_mfma_f32_16x16x32_bf16 v[160:163], a[76:79], a[12:15], v[160:163]
  ds_read_b64_tr_b16 a[130:131], v228 offset:53248
  v_mfma_f32_16x16x32_bf16 v[164:167], a[80:83], a[0:3], v[208:211]
  v_mfma_f32_16x16x32_bf16 v[164:167], a[84:87], a[4:7], v[164:167]
  ds_read_b64_tr_b16 a[132:133], v229 offset:49152
  ds_read_b64_tr_b16 a[134:135], v229 offset:53248
  v_mfma_f32_16x16x32_bf16 v[164:167], a[88:91], a[8:11], v[164:167]
  v_mfma_f32_16x16x32_bf16 v[164:167], a[92:95], a[12:15], v[164:167]
  ds_read_b64_tr_b16 a[136:137], v230 offset:49152
  v_mfma_f32_16x16x32_bf16 v[96:99], a[160:163], v[200:203], v[96:99]
  v_exp_f32 v160, v160
  v_mfma_f32_16x16x32_bf16 v[100:103], a[164:167], v[200:203], v[100:103]
  ds_read_b64_tr_b16 a[138:139], v230 offset:53248
  ds_read_b64_tr_b16 a[140:141], v231 offset:49152
  v_mfma_f32_16x16x32_bf16 v[104:107], a[168:171], v[200:203], v[104:107]
  v_exp_f32 v161, v161
  v_mfma_f32_16x16x32_bf16 v[108:111], a[172:175], v[200:203], v[108:111]
  ds_read_b64_tr_b16 a[142:143], v231 offset:53248
  v_cvt_pk_bf16_f32 v192, v160, v161
  v_mfma_f32_16x16x32_bf16 v[112:115], a[176:179], v[200:203], v[112:115]
  v_exp_f32 v162, v162
  v_mfma_f32_16x16x32_bf16 v[116:119], a[180:183], v[200:203], v[116:119]
  ds_read_b64_tr_b16 a[144:145], v232 offset:49152
  ds_read_b64_tr_b16 a[146:147], v232 offset:53248
  v_mfma_f32_16x16x32_bf16 v[120:123], a[184:187], v[200:203], v[120:123]
  v_exp_f32 v163, v163
  v_mfma_f32_16x16x32_bf16 v[124:127], a[188:191], v[200:203], v[124:127]
  v_cvt_pk_bf16_f32 v193, v162, v163
  ds_read_b64_tr_b16 a[148:149], v233 offset:49152
  v_mfma_f32_16x16x32_bf16 a[200:203], a[208:211], v[200:203], a[200:203]
  ds_read_b64_tr_b16 a[150:151], v233 offset:53248
  v_mfma_f32_16x16x32_bf16 v[168:171], a[64:67], a[16:19], v[212:215]
  v_exp_f32 v164, v164
  v_mfma_f32_16x16x32_bf16 v[168:171], a[68:71], a[20:23], v[168:171]
  ds_read_b64_tr_b16 a[152:153], v234 offset:49152
  buffer_load_dwordx4 v241, s[20:23], s33 offen offset:3072 nt lds
  v_mfma_f32_16x16x32_bf16 v[168:171], a[72:75], a[24:27], v[168:171]
  s_add_u32 s33, s33, 16384
  v_exp_f32 v165, v165
  v_mfma_f32_16x16x32_bf16 v[168:171], a[76:79], a[28:31], v[168:171]
  ds_read_b64_tr_b16 a[154:155], v234 offset:53248
  v_cvt_pk_bf16_f32 v194, v164, v165
  v_mfma_f32_16x16x32_bf16 v[172:175], a[80:83], a[16:19], v[212:215]
  v_exp_f32 v166, v166
  v_mfma_f32_16x16x32_bf16 v[172:175], a[84:87], a[20:23], v[172:175]
  ds_read_b64_tr_b16 a[156:157], v235 offset:49152
  ds_read_b64_tr_b16 a[158:159], v235 offset:53248
  v_mfma_f32_16x16x32_bf16 v[172:175], a[88:91], a[24:27], v[172:175]
  v_exp_f32 v167, v167
  v_mfma_f32_16x16x32_bf16 v[172:175], a[92:95], a[28:31], v[172:175]
  v_cvt_pk_bf16_f32 v195, v166, v167
  v_exp_f32 v168, v168
  v_exp_f32 v169, v169
  s_nop 0
  v_cvt_pk_bf16_f32 v196, v168, v169
  v_exp_f32 v170, v170
  v_exp_f32 v171, v171
  s_nop 0
  v_cvt_pk_bf16_f32 v197, v170, v171
  s_waitcnt lgkmcnt(0)
  v_mfma_f32_16x16x32_bf16 v[176:179], a[64:67], a[32:35], v[216:219]
  s_add_u32 m0, s40, 32768
  v_exp_f32 v172, v172
  v_mfma_f32_16x16x32_bf16 v[176:179], a[68:71], a[36:39], v[176:179]
  ds_read_b128 a[96:99], v224 offset:57344
  buffer_load_dwordx4 v236, s[16:19], s33 offen nt lds
  v_mfma_f32_16x16x32_bf16 v[176:179], a[72:75], a[40:43], v[176:179]
  v_exp_f32 v173, v173
  v_mfma_f32_16x16x32_bf16 v[176:179], a[76:79], a[44:47], v[176:179]
  v_cvt_pk_bf16_f32 v198, v172, v173
  ds_read_b128 a[100:103], v225 offset:57344
  v_mfma_f32_16x16x32_bf16 v[180:183], a[80:83], a[32:35], v[216:219]
  v_exp_f32 v174, v174
  v_mfma_f32_16x16x32_bf16 v[180:183], a[84:87], a[36:39], v[180:183]
  ds_read_b128 a[104:107], v226 offset:57344
  v_mfma_f32_16x16x32_bf16 v[180:183], a[88:91], a[40:43], v[180:183]
  v_exp_f32 v175, v175
  v_mfma_f32_16x16x32_bf16 v[180:183], a[92:95], a[44:47], v[180:183]
  ds_read_b128 a[108:111], v227 offset:57344
  v_cvt_pk_bf16_f32 v199, v174, v175
  v_mfma_f32_16x16x32_bf16 v[32:35], a[128:131], v[192:195], v[32:35]
  v_exp_f32 v176, v176
  v_mfma_f32_16x16x32_bf16 v[36:39], a[132:135], v[192:195], v[36:39]
  ds_read_b128 a[112:115], v224 offset:61440
  v_mfma_f32_16x16x32_bf16 v[40:43], a[136:139], v[192:195], v[40:43]
  v_exp_f32 v177, v177
  v_mfma_f32_16x16x32_bf16 v[44:47], a[140:143], v[192:195], v[44:47]
  v_cvt_pk_bf16_f32 v200, v176, v177
  ds_read_b128 a[116:119], v225 offset:61440
  v_mfma_f32_16x16x32_bf16 v[48:51], a[144:147], v[192:195], v[48:51]
  v_exp_f32 v178, v178
  v_mfma_f32_16x16x32_bf16 v[52:55], a[148:151], v[192:195], v[52:55]
  ds_read_b128 a[120:123], v226 offset:61440
  v_mfma_f32_16x16x32_bf16 v[56:59], a[152:155], v[192:195], v[56:59]
  v_exp_f32 v179, v179
  v_mfma_f32_16x16x32_bf16 v[60:63], a[156:159], v[192:195], v[60:63]
  ds_read_b128 a[124:127], v227 offset:61440
  v_cvt_pk_bf16_f32 v201, v178, v179
  v_mfma_f32_16x16x32_bf16 a[192:195], a[208:211], v[192:195], a[192:195]
  v_exp_f32 v180, v180
  buffer_load_dwordx4 v237, s[16:19], s33 offen offset:1024 nt lds
  v_exp_f32 v181, v181
  s_nop 0
  v_cvt_pk_bf16_f32 v202, v180, v181
  v_exp_f32 v182, v182
  v_exp_f32 v183, v183
  s_nop 0
  v_cvt_pk_bf16_f32 v203, v182, v183
  v_mfma_f32_16x16x32_bf16 v[64:67], a[128:131], v[196:199], v[64:67]
  v_mfma_f32_16x16x32_bf16 v[68:71], a[132:135], v[196:199], v[68:71]
  v_mfma_f32_16x16x32_bf16 v[72:75], a[136:139], v[196:199], v[72:75]
  v_mfma_f32_16x16x32_bf16 v[76:79], a[140:143], v[196:199], v[76:79]
  v_mfma_f32_16x16x32_bf16 v[80:83], a[144:147], v[196:199], v[80:83]
  v_mfma_f32_16x16x32_bf16 v[84:87], a[148:151], v[196:199], v[84:87]
  v_mfma_f32_16x16x32_bf16 v[88:91], a[152:155], v[196:199], v[88:91]
  v_mfma_f32_16x16x32_bf16 v[92:95], a[156:159], v[196:199], v[92:95]
  s_waitcnt lgkmcnt(0)
  v_mfma_f32_16x16x32_bf16 a[196:199], a[208:211], v[196:199], a[196:199]
  v_mfma_f32_16x16x32_bf16 v[160:163], a[96:99], a[0:3], v[208:211]
  v_mfma_f32_16x16x32_bf16 v[160:163], a[100:103], a[4:7], v[160:163]
  ds_read_b64_tr_b16 a[160:161], v228 offset:57344
  buffer_load_dwordx4 v238, s[16:19], s33 offen offset:2048 nt lds
  v_mfma_f32_16x16x32_bf16 v[160:163], a[104:107], a[8:11], v[160:163]
  v_mfma_f32_16x16x32_bf16 v[160:163], a[108:111], a[12:15], v[160:163]
  ds_read_b64_tr_b16 a[162:163], v228 offset:61440
  v_mfma_f32_16x16x32_bf16 v[164:167], a[112:115], a[0:3], v[208:211]
  v_mfma_f32_16x16x32_bf16 v[164:167], a[116:119], a[4:7], v[164:167]
  ds_read_b64_tr_b16 a[164:165], v229 offset:57344
  ds_read_b64_tr_b16 a[166:167], v229 offset:61440
  v_mfma_f32_16x16x32_bf16 v[164:167], a[120:123], a[8:11], v[164:167]
  v_mfma_f32_16x16x32_bf16 v[164:167], a[124:127], a[12:15], v[164:167]
  ds_read_b64_tr_b16 a[168:169], v230 offset:57344
  v_mfma_f32_16x16x32_bf16 v[96:99], a[128:131], v[200:203], v[96:99]
  v_exp_f32 v160, v160
  v_mfma_f32_16x16x32_bf16 v[100:103], a[132:135], v[200:203], v[100:103]
  ds_read_b64_tr_b16 a[170:171], v230 offset:61440
  ds_read_b64_tr_b16 a[172:173], v231 offset:57344
  v_mfma_f32_16x16x32_bf16 v[104:107], a[136:139], v[200:203], v[104:107]
  v_exp_f32 v161, v161
  v_mfma_f32_16x16x32_bf16 v[108:111], a[140:143], v[200:203], v[108:111]
  ds_read_b64_tr_b16 a[174:175], v231 offset:61440
  v_cvt_pk_bf16_f32 v192, v160, v161
  v_mfma_f32_16x16x32_bf16 v[112:115], a[144:147], v[200:203], v[112:115]
  v_exp_f32 v162, v162
  v_mfma_f32_16x16x32_bf16 v[116:119], a[148:151], v[200:203], v[116:119]
  ds_read_b64_tr_b16 a[176:177], v232 offset:57344
  ds_read_b64_tr_b16 a[178:179], v232 offset:61440
  v_mfma_f32_16x16x32_bf16 v[120:123], a[152:155], v[200:203], v[120:123]
  v_exp_f32 v163, v163
  v_mfma_f32_16x16x32_bf16 v[124:127], a[156:159], v[200:203], v[124:127]
  v_cvt_pk_bf16_f32 v193, v162, v163
  ds_read_b64_tr_b16 a[180:181], v233 offset:57344
  v_mfma_f32_16x16x32_bf16 a[200:203], a[208:211], v[200:203], a[200:203]
  ds_read_b64_tr_b16 a[182:183], v233 offset:61440
  v_mfma_f32_16x16x32_bf16 v[168:171], a[96:99], a[16:19], v[212:215]
  v_exp_f32 v164, v164
  v_mfma_f32_16x16x32_bf16 v[168:171], a[100:103], a[20:23], v[168:171]
  ds_read_b64_tr_b16 a[184:185], v234 offset:57344
  buffer_load_dwordx4 v239, s[16:19], s33 offen offset:3072 nt lds
  v_mfma_f32_16x16x32_bf16 v[168:171], a[104:107], a[24:27], v[168:171]
  v_exp_f32 v165, v165
  v_mfma_f32_16x16x32_bf16 v[168:171], a[108:111], a[28:31], v[168:171]
  ds_read_b64_tr_b16 a[186:187], v234 offset:61440
  v_cvt_pk_bf16_f32 v194, v164, v165
  v_mfma_f32_16x16x32_bf16 v[172:175], a[112:115], a[16:19], v[212:215]
  v_exp_f32 v166, v166
  v_mfma_f32_16x16x32_bf16 v[172:175], a[116:119], a[20:23], v[172:175]
  ds_read_b64_tr_b16 a[188:189], v235 offset:57344
  ds_read_b64_tr_b16 a[190:191], v235 offset:61440
  v_mfma_f32_16x16x32_bf16 v[172:175], a[120:123], a[24:27], v[172:175]
  v_exp_f32 v167, v167
  v_mfma_f32_16x16x32_bf16 v[172:175], a[124:127], a[28:31], v[172:175]
  v_cvt_pk_bf16_f32 v195, v166, v167
  v_exp_f32 v168, v168
  v_exp_f32 v169, v169
  s_nop 0
  v_cvt_pk_bf16_f32 v196, v168, v169
  v_exp_f32 v170, v170
  v_exp_f32 v171, v171
  s_nop 0
  v_cvt_pk_bf16_f32 v197, v170, v171
  s_waitcnt vmcnt(12) lgkmcnt(0)
  s_barrier
  v_mfma_f32_16x16x32_bf16 v[176:179], a[96:99], a[32:35], v[216:219]
  s_add_u32 m0, s40, 98304
  v_exp_f32 v172, v172
  v_mfma_f32_16x16x32_bf16 v[176:179], a[100:103], a[36:39], v[176:179]
  ds_read_b128 a[64:67], v224 offset:0
  buffer_load_dwordx4 v240, s[20:23], s33 offen nt lds
  v_mfma_f32_16x16x32_bf16 v[176:179], a[104:107], a[40:43], v[176:179]
  v_exp_f32 v173, v173
  v_mfma_f32_16x16x32_bf16 v[176:179], a[108:111], a[44:47], v[176:179]
  v_cvt_pk_bf16_f32 v198, v172, v173
  ds_read_b128 a[68:71], v225 offset:0
  v_mfma_f32_16x16x32_bf16 v[180:183], a[112:115], a[32:35], v[216:219]
  v_exp_f32 v174, v174
  v_mfma_f32_16x16x32_bf16 v[180:183], a[116:119], a[36:39], v[180:183]
  ds_read_b128 a[72:75], v226 offset:0
  v_mfma_f32_16x16x32_bf16 v[180:183], a[120:123], a[40:43], v[180:183]
  v_exp_f32 v175, v175
  v_mfma_f32_16x16x32_bf16 v[180:183], a[124:127], a[44:47], v[180:183]
  ds_read_b128 a[76:79], v227 offset:0
  v_cvt_pk_bf16_f32 v199, v174, v175
  v_mfma_f32_16x16x32_bf16 v[32:35], a[160:163], v[192:195], v[32:35]
  v_exp_f32 v176, v176
  v_mfma_f32_16x16x32_bf16 v[36:39], a[164:167], v[192:195], v[36:39]
  ds_read_b128 a[80:83], v224 offset:4096
  v_mfma_f32_16x16x32_bf16 v[40:43], a[168:171], v[192:195], v[40:43]
  v_exp_f32 v177, v177
  v_mfma_f32_16x16x32_bf16 v[44:47], a[172:175], v[192:195], v[44:47]
  v_cvt_pk_bf16_f32 v200, v176, v177
  ds_read_b128 a[84:87], v225 offset:4096
  v_mfma_f32_16x16x32_bf16 v[48:51], a[176:179], v[192:195], v[48:51]
  v_exp_f32 v178, v178
  v_mfma_f32_16x16x32_bf16 v[52:55], a[180:183], v[192:195], v[52:55]
  ds_read_b128 a[88:91], v226 offset:4096
  v_mfma_f32_16x16x32_bf16 v[56:59], a[184:187], v[192:195], v[56:59]
  v_exp_f32 v179, v179
  v_mfma_f32_16x16x32_bf16 v[60:63], a[188:191], v[192:195], v[60:63]
  ds_read_b128 a[92:95], v227 offset:4096
  v_cvt_pk_bf16_f32 v201, v178, v179
  v_mfma_f32_16x16x32_bf16 a[192:195], a[208:211], v[192:195], a[192:195]
  v_exp_f32 v180, v180
  buffer_load_dwordx4 v241, s[20:23], s33 offen offset:1024 nt lds
  v_exp_f32 v181, v181
  s_nop 0
  v_cvt_pk_bf16_f32 v202, v180, v181
  v_exp_f32 v182, v182
  v_exp_f32 v183, v183
  s_nop 0
  v_cvt_pk_bf16_f32 v203, v182, v183
  v_mfma_f32_16x16x32_bf16 v[64:67], a[160:163], v[196:199], v[64:67]
  v_mfma_f32_16x16x32_bf16 v[68:71], a[164:167], v[196:199], v[68:71]
  v_mfma_f32_16x16x32_bf16 v[72:75], a[168:171], v[196:199], v[72:75]
  v_mfma_f32_16x16x32_bf16 v[76:79], a[172:175], v[196:199], v[76:79]
  v_mfma_f32_16x16x32_bf16 v[80:83], a[176:179], v[196:199], v[80:83]
  v_mfma_f32_16x16x32_bf16 v[84:87], a[180:183], v[196:199], v[84:87]
  v_mfma_f32_16x16x32_bf16 v[88:91], a[184:187], v[196:199], v[88:91]
  v_mfma_f32_16x16x32_bf16 v[92:95], a[188:191], v[196:199], v[92:95]
  s_waitcnt lgkmcnt(0)
  v_mfma_f32_16x16x32_bf16 a[196:199], a[208:211], v[196:199], a[196:199]
  v_mfma_f32_16x16x32_bf16 v[160:163], a[64:67], a[0:3], v[208:211]
  v_mfma_f32_16x16x32_bf16 v[160:163], a[68:71], a[4:7], v[160:163]
  ds_read_b64_tr_b16 a[128:129], v228 offset:0
  buffer_load_dwordx4 v240, s[20:23], s33 offen offset:2048 nt lds
  v_mfma_f32_16x16x32_bf16 v[160:163], a[72:75], a[8:11], v[160:163]
  v_mfma_f32_16x16x32_bf16 v[160:163], a[76:79], a[12:15], v[160:163]
  ds_read_b64_tr_b16 a[130:131], v228 offset:4096
  v_mfma_f32_16x16x32_bf16 v[164:167], a[80:83], a[0:3], v[208:211]
  v_mfma_f32_16x16x32_bf16 v[164:167], a[84:87], a[4:7], v[164:167]
  ds_read_b64_tr_b16 a[132:133], v229 offset:0
  ds_read_b64_tr_b16 a[134:135], v229 offset:4096
  v_mfma_f32_16x16x32_bf16 v[164:167], a[88:91], a[8:11], v[164:167]
  v_mfma_f32_16x16x32_bf16 v[164:167], a[92:95], a[12:15], v[164:167]
  ds_read_b64_tr_b16 a[136:137], v230 offset:0
  v_mfma_f32_16x16x32_bf16 v[96:99], a[160:163], v[200:203], v[96:99]
  v_exp_f32 v160, v160
  v_mfma_f32_16x16x32_bf16 v[100:103], a[164:167], v[200:203], v[100:103]
  ds_read_b64_tr_b16 a[138:139], v230 offset:4096
  ds_read_b64_tr_b16 a[140:141], v231 offset:0
  v_mfma_f32_16x16x32_bf16 v[104:107], a[168:171], v[200:203], v[104:107]
  v_exp_f32 v161, v161
  v_mfma_f32_16x16x32_bf16 v[108:111], a[172:175], v[200:203], v[108:111]
  ds_read_b64_tr_b16 a[142:143], v231 offset:4096
  v_cvt_pk_bf16_f32 v192, v160, v161
  v_mfma_f32_16x16x32_bf16 v[112:115], a[176:179], v[200:203], v[112:115]
  v_exp_f32 v162, v162
  v_mfma_f32_16x16x32_bf16 v[116:119], a[180:183], v[200:203], v[116:119]
  ds_read_b64_tr_b16 a[144:145], v232 offset:0
  ds_read_b64_tr_b16 a[146:147], v232 offset:4096
  v_mfma_f32_16x16x32_bf16 v[120:123], a[184:187], v[200:203], v[120:123]
  v_exp_f32 v163, v163
  v_mfma_f32_16x16x32_bf16 v[124:127], a[188:191], v[200:203], v[124:127]
  v_cvt_pk_bf16_f32 v193, v162, v163
  ds_read_b64_tr_b16 a[148:149], v233 offset:0
  v_mfma_f32_16x16x32_bf16 a[200:203], a[208:211], v[200:203], a[200:203]
  ds_read_b64_tr_b16 a[150:151], v233 offset:4096
  v_mfma_f32_16x16x32_bf16 v[168:171], a[64:67], a[16:19], v[212:215]
  v_exp_f32 v164, v164
  v_mfma_f32_16x16x32_bf16 v[168:171], a[68:71], a[20:23], v[168:171]
  ds_read_b64_tr_b16 a[152:153], v234 offset:0
  buffer_load_dwordx4 v241, s[20:23], s33 offen offset:3072 nt lds
  v_mfma_f32_16x16x32_bf16 v[168:171], a[72:75], a[24:27], v[168:171]
  s_add_u32 s33, s33, 16384
  v_exp_f32 v165, v165
  v_mfma_f32_16x16x32_bf16 v[168:171], a[76:79], a[28:31], v[168:171]
  ds_read_b64_tr_b16 a[154:155], v234 offset:4096
  v_cvt_pk_bf16_f32 v194, v164, v165
  v_mfma_f32_16x16x32_bf16 v[172:175], a[80:83], a[16:19], v[212:215]
  v_exp_f32 v166, v166
  v_mfma_f32_16x16x32_bf16 v[172:175], a[84:87], a[20:23], v[172:175]
  ds_read_b64_tr_b16 a[156:157], v235 offset:0
  ds_read_b64_tr_b16 a[158:159], v235 offset:4096
  v_mfma_f32_16x16x32_bf16 v[172:175], a[88:91], a[24:27], v[172:175]
  v_exp_f32 v167, v167
  v_mfma_f32_16x16x32_bf16 v[172:175], a[92:95], a[28:31], v[172:175]
  v_cvt_pk_bf16_f32 v195, v166, v167
  v_exp_f32 v168, v168
  v_exp_f32 v169, v169
  s_nop 0
  v_cvt_pk_bf16_f32 v196, v168, v169
  v_exp_f32 v170, v170
  v_exp_f32 v171, v171
  s_nop 0
  v_cvt_pk_bf16_f32 v197, v170, v171
  s_waitcnt lgkmcnt(0)
  v_mfma_f32_16x16x32_bf16 v[176:179], a[64:67], a[32:35], v[216:219]
  s_add_u32 m0, s40, 49152
  v_exp_f32 v172, v172
  v_mfma_f32_16x16x32_bf16 v[176:179], a[68:71], a[36:39], v[176:179]
  ds_read_b128 a[96:99], v224 offset:8192
  buffer_load_dwordx4 v236, s[16:19], s33 offen nt lds
  v_mfma_f32_16x16x32_bf16 v[176:179], a[72:75], a[40:43], v[176:179]
  v_exp_f32 v173, v173
  v_mfma_f32_16x16x32_bf16 v[176:179], a[76:79], a[44:47], v[176:179]
  v_cvt_pk_bf16_f32 v198, v172, v173
  ds_read_b128 a[100:103], v225 offset:8192
  v_mfma_f32_16x16x32_bf16 v[180:183], a[80:83], a[32:35], v[216:219]
  v_exp_f32 v174, v174
  v_mfma_f32_16x16x32_bf16 v[180:183], a[84:87], a[36:39], v[180:183]
  ds_read_b128 a[104:107], v226 offset:8192
  v_mfma_f32_16x16x32_bf16 v[180:183], a[88:91], a[40:43], v[180:183]
  v_exp_f32 v175, v175
  v_mfma_f32_16x16x32_bf16 v[180:183], a[92:95], a[44:47], v[180:183]
  ds_read_b128 a[108:111], v227 offset:8192
  v_cvt_pk_bf16_f32 v199, v174, v175
  v_mfma_f32_16x16x32_bf16 v[32:35], a[128:131], v[192:195], v[32:35]
  v_exp_f32 v176, v176
  v_mfma_f32_16x16x32_bf16 v[36:39], a[132:135], v[192:195], v[36:39]
  ds_read_b128 a[112:115], v224 offset:12288
  v_mfma_f32_16x16x32_bf16 v[40:43], a[136:139], v[192:195], v[40:43]
  v_exp_f32 v177, v177
  v_mfma_f32_16x16x32_bf16 v[44:47], a[140:143], v[192:195], v[44:47]
  v_cvt_pk_bf16_f32 v200, v176, v177
  ds_read_b128 a[116:119], v225 offset:12288
  v_mfma_f32_16x16x32_bf16 v[48:51], a[144:147], v[192:195], v[48:51]
  v_exp_f32 v178, v178
  v_mfma_f32_16x16x32_bf16 v[52:55], a[148:151], v[192:195], v[52:55]
  ds_read_b128 a[120:123], v226 offset:12288
  v_mfma_f32_16x16x32_bf16 v[56:59], a[152:155], v[192:195], v[56:59]
  v_exp_f32 v179, v179
  v_mfma_f32_16x16x32_bf16 v[60:63], a[156:159], v[192:195], v[60:63]
  ds_read_b128 a[124:127], v227 offset:12288
  v_cvt_pk_bf16_f32 v201, v178, v179
  v_mfma_f32_16x16x32_bf16 a[192:195], a[208:211], v[192:195], a[192:195]
  v_exp_f32 v180, v180
  buffer_load_dwordx4 v237, s[16:19], s33 offen offset:1024 nt lds
  v_exp_f32 v181, v181
  s_nop 0
  v_cvt_pk_bf16_f32 v202, v180, v181
  v_exp_f32 v182, v182
  v_exp_f32 v183, v183
  s_nop 0
  v_cvt_pk_bf16_f32 v203, v182, v183
  v_mfma_f32_16x16x32_bf16 v[64:67], a[128:131], v[196:199], v[64:67]
  v_mfma_f32_16x16x32_bf16 v[68:71], a[132:135], v[196:199], v[68:71]
  v_mfma_f32_16x16x32_bf16 v[72:75], a[136:139], v[196:199], v[72:75]
  v_mfma_f32_16x16x32_bf16 v[76:79], a[140:143], v[196:199], v[76:79]
  v_mfma_f32_16x16x32_bf16 v[80:83], a[144:147], v[196:199], v[80:83]
  v_mfma_f32_16x16x32_bf16 v[84:87], a[148:151], v[196:199], v[84:87]
  v_mfma_f32_16x16x32_bf16 v[88:91], a[152:155], v[196:199], v[88:91]
  v_mfma_f32_16x16x32_bf16 v[92:95], a[156:159], v[196:199], v[92:95]
  s_waitcnt lgkmcnt(0)
  v_mfma_f32_16x16x32_bf16 a[196:199], a[208:211], v[196:199], a[196:199]
  v_mfma_f32_16x16x32_bf16 v[160:163], a[96:99], a[0:3], v[208:211]
  v_mfma_f32_16x16x32_bf16 v[160:163], a[100:103], a[4:7], v[160:163]
  ds_read_b64_tr_b16 a[160:161], v228 offset:8192
  buffer_load_dwordx4 v238, s[16:19], s33 offen offset:2048 nt lds
  v_mfma_f32_16x16x32_bf16 v[160:163], a[104:107], a[8:11], v[160:163]
  v_mfma_f32_16x16x32_bf16 v[160:163], a[108:111], a[12:15], v[160:163]
  ds_read_b64_tr_b16 a[162:163], v228 offset:12288
  v_mfma_f32_16x16x32_bf16 v[164:167], a[112:115], a[0:3], v[208:211]
  v_mfma_f32_16x16x32_bf16 v[164:167], a[116:119], a[4:7], v[164:167]
  ds_read_b64_tr_b16 a[164:165], v229 offset:8192
  ds_read_b64_tr_b16 a[166:167], v229 offset:12288
  v_mfma_f32_16x16x32_bf16 v[164:167], a[120:123], a[8:11], v[164:167]
  v_mfma_f32_16x16x32_bf16 v[164:167], a[124:127], a[12:15], v[164:167]
  ds_read_b64_tr_b16 a[168:169], v230 offset:8192
  v_mfma_f32_16x16x32_bf16 v[96:99], a[128:131], v[200:203], v[96:99]
  v_exp_f32 v160, v160
  v_mfma_f32_16x16x32_bf16 v[100:103], a[132:135], v[200:203], v[100:103]
  ds_read_b64_tr_b16 a[170:171], v230 offset:12288
  ds_read_b64_tr_b16 a[172:173], v231 offset:8192
  v_mfma_f32_16x16x32_bf16 v[104:107], a[136:139], v[200:203], v[104:107]
  v_exp_f32 v161, v161
  v_mfma_f32_16x16x32_bf16 v[108:111], a[140:143], v[200:203], v[108:111]
  ds_read_b64_tr_b16 a[174:175], v231 offset:12288
  v_cvt_pk_bf16_f32 v192, v160, v161
  v_mfma_f32_16x16x32_bf16 v[112:115], a[144:147], v[200:203], v[112:115]
  v_exp_f32 v162, v162
  v_mfma_f32_16x16x32_bf16 v[116:119], a[148:151], v[200:203], v[116:119]
  ds_read_b64_tr_b16 a[176:177], v232 offset:8192
  ds_read_b64_tr_b16 a[178:179], v232 offset:12288
  v_mfma_f32_16x16x32_bf16 v[120:123], a[152:155], v[200:203], v[120:123]
  v_exp_f32 v163, v163
  v_mfma_f32_16x16x32_bf16 v[124:127], a[156:159], v[200:203], v[124:127]
  v_cvt_pk_bf16_f32 v193, v162, v163
  ds_read_b64_tr_b16 a[180:181], v233 offset:8192
  v_mfma_f32_16x16x32_bf16 a[200:203], a[208:211], v[200:203], a[200:203]
  ds_read_b64_tr_b16 a[182:183], v233 offset:12288
  v_mfma_f32_16x16x32_bf16 v[168:171], a[96:99], a[16:19], v[212:215]
  v_exp_f32 v164, v164
  v_mfma_f32_16x16x32_bf16 v[168:171], a[100:103], a[20:23], v[168:171]
  ds_read_b64_tr_b16 a[184:185], v234 offset:8192
  buffer_load_dwordx4 v239, s[16:19], s33 offen offset:3072 nt lds
  v_mfma_f32_16x16x32_bf16 v[168:171], a[104:107], a[24:27], v[168:171]
  v_exp_f32 v165, v165
  v_mfma_f32_16x16x32_bf16 v[168:171], a[108:111], a[28:31], v[168:171]
  ds_read_b64_tr_b16 a[186:187], v234 offset:12288
  v_cvt_pk_bf16_f32 v194, v164, v165
  v_mfma_f32_16x16x32_bf16 v[172:175], a[112:115], a[16:19], v[212:215]
  v_exp_f32 v166, v166
  v_mfma_f32_16x16x32_bf16 v[172:175], a[116:119], a[20:23], v[172:175]
  ds_read_b64_tr_b16 a[188:189], v235 offset:8192
  ds_read_b64_tr_b16 a[190:191], v235 offset:12288
  v_mfma_f32_16x16x32_bf16 v[172:175], a[120:123], a[24:27], v[172:175]
  v_exp_f32 v167, v167
  v_mfma_f32_16x16x32_bf16 v[172:175], a[124:127], a[28:31], v[172:175]
  v_cvt_pk_bf16_f32 v195, v166, v167
  v_exp_f32 v168, v168
  v_exp_f32 v169, v169
  s_nop 0
  v_cvt_pk_bf16_f32 v196, v168, v169
  v_exp_f32 v170, v170
  v_exp_f32 v171, v171
  s_nop 0
  v_cvt_pk_bf16_f32 v197, v170, v171
  s_waitcnt vmcnt(12) lgkmcnt(0)
  s_barrier
  v_mfma_f32_16x16x32_bf16 v[176:179], a[96:99], a[32:35], v[216:219]
  s_add_u32 m0, s40, 114688
  v_exp_f32 v172, v172
  v_mfma_f32_16x16x32_bf16 v[176:179], a[100:103], a[36:39], v[176:179]
  ds_read_b128 a[64:67], v224 offset:16384
  buffer_load_dwordx4 v240, s[20:23], s33 offen nt lds
  v_mfma_f32_16x16x32_bf16 v[176:179], a[104:107], a[40:43], v[176:179]
  v_exp_f32 v173, v173
  v_mfma_f32_16x16x32_bf16 v[176:179], a[108:111], a[44:47], v[176:179]
  v_cvt_pk_bf16_f32 v198, v172, v173
  ds_read_b128 a[68:71], v225 offset:16384
  v_mfma_f32_16x16x32_bf16 v[180:183], a[112:115], a[32:35], v[216:219]
  v_exp_f32 v174, v174
  v_mfma_f32_16x16x32_bf16 v[180:183], a[116:119], a[36:39], v[180:183]
  ds_read_b128 a[72:75], v226 offset:16384
  v_mfma_f32_16x16x32_bf16 v[180:183], a[120:123], a[40:43], v[180:183]
  v_exp_f32 v175, v175
  v_mfma_f32_16x16x32_bf16 v[180:183], a[124:127], a[44:47], v[180:183]
  ds_read_b128 a[76:79], v227 offset:16384
  v_cvt_pk_bf16_f32 v199, v174, v175
  v_mfma_f32_16x16x32_bf16 v[32:35], a[160:163], v[192:195], v[32:35]
  v_exp_f32 v176, v176
  v_mfma_f32_16x16x32_bf16 v[36:39], a[164:167], v[192:195], v[36:39]
  ds_read_b128 a[80:83], v224 offset:20480
  v_mfma_f32_16x16x32_bf16 v[40:43], a[168:171], v[192:195], v[40:43]
  v_exp_f32 v177, v177
  v_mfma_f32_16x16x32_bf16 v[44:47], a[172:175], v[192:195], v[44:47]
  v_cvt_pk_bf16_f32 v200, v176, v177
  ds_read_b128 a[84:87], v225 offset:20480
  v_mfma_f32_16x16x32_bf16 v[48:51], a[176:179], v[192:195], v[48:51]
  v_exp_f32 v178, v178
  v_mfma_f32_16x16x32_bf16 v[52:55], a[180:183], v[192:195], v[52:55]
  ds_read_b128 a[88:91], v226 offset:20480
  v_mfma_f32_16x16x32_bf16 v[56:59], a[184:187], v[192:195], v[56:59]
  v_exp_f32 v179, v179
  v_mfma_f32_16x16x32_bf16 v[60:63], a[188:191], v[192:195], v[60:63]
  ds_read_b128 a[92:95], v227 offset:20480
  v_cvt_pk_bf16_f32 v201, v178, v179
  v_mfma_f32_16x16x32_bf16 a[192:195], a[208:211], v[192:195], a[192:195]
  v_exp_f32 v180, v180
  buffer_load_dwordx4 v241, s[20:23], s33 offen offset:1024 nt lds
  v_exp_f32 v181, v181
  s_nop 0
  v_cvt_pk_bf16_f32 v202, v180, v181
  v_exp_f32 v182, v182
  v_exp_f32 v183, v183
  s_nop 0
  v_cvt_pk_bf16_f32 v203, v182, v183
  v_mfma_f32_16x16x32_bf16 v[64:67], a[160:163], v[196:199], v[64:67]
  v_mfma_f32_16x16x32_bf16 v[68:71], a[164:167], v[196:199], v[68:71]
  v_mfma_f32_16x16x32_bf16 v[72:75], a[168:171], v[196:199], v[72:75]
  v_mfma_f32_16x16x32_bf16 v[76:79], a[172:175], v[196:199], v[76:79]
  v_mfma_f32_16x16x32_bf16 v[80:83], a[176:179], v[196:199], v[80:83]
  v_mfma_f32_16x16x32_bf16 v[84:87], a[180:183], v[196:199], v[84:87]
  v_mfma_f32_16x16x32_bf16 v[88:91], a[184:187], v[196:199], v[88:91]
  s_sub_u32 s34, s34, 1
  v_mfma_f32_16x16x32_bf16 v[92:95], a[188:191], v[196:199], v[92:95]
  s_waitcnt lgkmcnt(0)
  v_mfma_f32_16x16x32_bf16 a[196:199], a[208:211], v[196:199], a[196:199]
  s_cmp_lg_u32 s34, 0
  s_cbranch_scc1 L_loop3
  v_mfma_f32_16x16x32_bf16 v[160:163], a[64:67], a[0:3], v[208:211]
  s_add_u32 m0, s40, 114688
  v_mfma_f32_16x16x32_bf16 v[160:163], a[68:71], a[4:7], v[160:163]
  ds_read_b64_tr_b16 a[128:129], v228 offset:16384
  buffer_load_dwordx4 v240, s[20:23], s33 offen offset:2048 nt lds
  v_mfma_f32_16x16x32_bf16 v[160:163], a[72:75], a[8:11], v[160:163]
  v_mfma_f32_16x16x32_bf16 v[160:163], a[76:79], a[12:15], v[160:163]
  ds_read_b64_tr_b16 a[130:131], v228 offset:20480
  v_mfma_f32_16x16x32_bf16 v[164:167], a[80:83], a[0:3], v[208:211]
  s_add_u32 m0, s40, 114688
  v_mfma_f32_16x16x32_bf16 v[164:167], a[84:87], a[4:7], v[164:167]
  ds_read_b64_tr_b16 a[132:133], v229 offset:16384
  ds_read_b64_tr_b16 a[134:135], v229 offset:20480
  buffer_load_dwordx4 v241, s[20:23], s33 offen offset:3072 nt lds
  v_mfma_f32_16x16x32_bf16 v[164:167], a[88:91], a[8:11], v[164:167]
  s_add_u32 s33, s33, 16384
  v_mfma_f32_16x16x32_bf16 v[164:167], a[92:95], a[12:15], v[164:167]
  ds_read_b64_tr_b16 a[136:137], v230 offset:16384
  v_mfma_f32_16x16x32_bf16 v[96:99], a[160:163], v[200:203], v[96:99]
  v_exp_f32 v160, v160
  v_mfma_f32_16x16x32_bf16 v[100:103], a[164:167], v[200:203], v[100:103]
  ds_read_b64_tr_b16 a[138:139], v230 offset:20480
  ds_read_b64_tr_b16 a[140:141], v231 offset:16384
  v_mfma_f32_16x16x32_bf16 v[104:107], a[168:171], v[200:203], v[104:107]
  v_exp_f32 v161, v161
  v_mfma_f32_16x16x32_bf16 v[108:111], a[172:175], v[200:203], v[108:111]
  ds_read_b64_tr_b16 a[142:143], v231 offset:20480
  v_cvt_pk_bf16_f32 v192, v160, v161
  v_mfma_f32_16x16x32_bf16 v[112:115], a[176:179], v[200:203], v[112:115]
  v_exp_f32 v162, v162
  v_mfma_f32_16x16x32_bf16 v[116:119], a[180:183], v[200:203], v[116:119]
  ds_read_b64_tr_b16 a[144:145], v232 offset:16384
  ds_read_b64_tr_b16 a[146:147], v232 offset:20480
  v_mfma_f32_16x16x32_bf16 v[120:123], a[184:187], v[200:203], v[120:123]
  v_exp_f32 v163, v163
  v_mfma_f32_16x16x32_bf16 v[124:127], a[188:191], v[200:203], v[124:127]
  v_cvt_pk_bf16_f32 v193, v162, v163
  ds_read_b64_tr_b16 a[148:149], v233 offset:16384
  v_mfma_f32_16x16x32_bf16 a[200:203], a[208:211], v[200:203], a[200:203]
  ds_read_b64_tr_b16 a[150:151], v233 offset:20480
  v_mfma_f32_16x16x32_bf16 v[168:171], a[64:67], a[16:19], v[212:215]
  v_exp_f32 v164, v164
  v_mfma_f32_16x16x32_bf16 v[168:171], a[68:71], a[20:23], v[168:171]
  ds_read_b64_tr_b16 a[152:153], v234 offset:16384
  v_mfma_f32_16x16x32_bf16 v[168:171], a[72:75], a[24:27], v[168:171]
  v_exp_f32 v165, v165
  v_mfma_f32_16x16x32_bf16 v[168:171], a[76:79], a[28:31], v[168:171]
  s_add_u32 s42, s41, 0
  ds_read_b64_tr_b16 a[154:155], v234 offset:20480
  v_cvt_pk_bf16_f32 v194, v164, v165
  v_mfma_f32_16x16x32_bf16 v[172:175], a[80:83], a[16:19], v[212:215]
  s_and_b32 s42, s42, 31
  v_exp_f32 v166, v166
  v_mfma_f32_16x16x32_bf16 v[172:175], a[84:87], a[20:23], v[172:175]
  s_mul_i32 s42, s42, 40960
  ds_read_b64_tr_b16 a[156:157], v235 offset:16384
  ds_read_b64_tr_b16 a[158:159], v235 offset:20480
  v_mfma_f32_16x16x32_bf16 v[172:175], a[88:91], a[24:27], v[172:175]
  s_add_u32 m0, s40, 0
  v_exp_f32 v167, v167
  v_mfma_f32_16x16x32_bf16 v[172:175], a[92:95], a[28:31], v[172:175]
  buffer_load_dwordx4 v246, s[8:11], s42 offen lds
  v_cvt_pk_bf16_f32 v195, v166, v167
  v_exp_f32 v168, v168
  global_load_dword v255, v0, s[46:47] sc1
  v_exp_f32 v169, v169
  s_nop 0
  v_cvt_pk_bf16_f32 v196, v168, v169
  v_exp_f32 v170, v170
  v_exp_f32 v171, v171
  s_nop 0
  v_cvt_pk_bf16_f32 v197, v170, v171
  s_waitcnt lgkmcnt(0)
  v_mfma_f32_16x16x32_bf16 v[176:179], a[64:67], a[32:35], v[216:219]
  v_exp_f32 v172, v172
  v_mfma_f32_16x16x32_bf16 v[176:179], a[68:71], a[36:39], v[176:179]
  ds_read_b128 a[96:99], v224 offset:24576
  buffer_load_dwordx4 v247, s[8:11], s42 offen offset:1024 lds
  v_mfma_f32_16x16x32_bf16 v[176:179], a[72:75], a[40:43], v[176:179]
  v_exp_f32 v173, v173
  v_mfma_f32_16x16x32_bf16 v[176:179], a[76:79], a[44:47], v[176:179]
  v_cvt_pk_bf16_f32 v198, v172, v173
  ds_read_b128 a[100:103], v225 offset:24576
  v_mfma_f32_16x16x32_bf16 v[180:183], a[80:83], a[32:35], v[216:219]
  v_exp_f32 v174, v174
  v_mfma_f32_16x16x32_bf16 v[180:183], a[84:87], a[36:39], v[180:183]
  ds_read_b128 a[104:107], v226 offset:24576
  v_mfma_f32_16x16x32_bf16 v[180:183], a[88:91], a[40:43], v[180:183]
  v_exp_f32 v175, v175
  v_mfma_f32_16x16x32_bf16 v[180:183], a[92:95], a[44:47], v[180:183]
  ds_read_b128 a[108:111], v227 offset:24576
  v_cvt_pk_bf16_f32 v199, v174, v175
  v_mfma_f32_16x16x32_bf16 v[32:35], a[128:131], v[192:195], v[32:35]
  v_exp_f32 v176, v176
  v_mfma_f32_16x16x32_bf16 v[36:39], a[132:135], v[192:195], v[36:39]
  ds_read_b128 a[112:115], v224 offset:28672
  v_mfma_f32_16x16x32_bf16 v[40:43], a[136:139], v[192:195], v[40:43]
  v_exp_f32 v177, v177
  v_mfma_f32_16x16x32_bf16 v[44:47], a[140:143], v[192:195], v[44:47]
  v_cvt_pk_bf16_f32 v200, v176, v177
  ds_read_b128 a[116:119], v225 offset:28672
  v_mfma_f32_16x16x32_bf16 v[48:51], a[144:147], v[192:195], v[48:51]
  v_exp_f32 v178, v178
  v_mfma_f32_16x16x32_bf16 v[52:55], a[148:151], v[192:195], v[52:55]
  ds_read_b128 a[120:123], v226 offset:28672
  v_mfma_f32_16x16x32_bf16 v[56:59], a[152:155], v[192:195], v[56:59]
  v_exp_f32 v179, v179
  v_mfma_f32_16x16x32_bf16 v[60:63], a[156:159], v[192:195], v[60:63]
  ds_read_b128 a[124:127], v227 offset:28672
  v_cvt_pk_bf16_f32 v201, v178, v179
  v_mfma_f32_16x16x32_bf16 a[192:195], a[208:211], v[192:195], a[192:195]
  buffer_load_dwordx4 v248, s[8:11], s42 offen offset:2048 lds
  v_exp_f32 v180, v180
  v_exp_f32 v181, v181
  s_nop 0
  v_cvt_pk_bf16_f32 v202, v180, v181
  v_exp_f32 v182, v182
  v_exp_f32 v183, v183
  s_nop 0
  v_cvt_pk_bf16_f32 v203, v182, v183
  v_mfma_f32_16x16x32_bf16 v[64:67], a[128:131], v[196:199], v[64:67]
  v_mfma_f32_16x16x32_bf16 v[68:71], a[132:135], v[196:199], v[68:71]
  buffer_load_dwordx4 v249, s[8:11], s42 offen offset:3072 lds
  v_mfma_f32_16x16x32_bf16 v[72:75], a[136:139], v[196:199], v[72:75]
  v_mfma_f32_16x16x32_bf16 v[76:79], a[140:143], v[196:199], v[76:79]
  v_mfma_f32_16x16x32_bf16 v[80:83], a[144:147], v[196:199], v[80:83]
  v_mfma_f32_16x16x32_bf16 v[84:87], a[148:151], v[196:199], v[84:87]
  v_mfma_f32_16x16x32_bf16 v[88:91], a[152:155], v[196:199], v[88:91]
  v_mfma_f32_16x16x32_bf16 v[92:95], a[156:159], v[196:199], v[92:95]
  s_waitcnt lgkmcnt(0)
  v_mfma_f32_16x16x32_bf16 a[196:199], a[208:211], v[196:199], a[196:199]
  v_mfma_f32_16x16x32_bf16 v[160:163], a[96:99], a[0:3], v[208:211]
  v_mfma_f32_16x16x32_bf16 v[160:163], a[100:103], a[4:7], v[160:163]
  s_add_u32 s42, s41, 1
  ds_read_b64_tr_b16 a[160:161], v228 offset:24576
  v_mfma_f32_16x16x32_bf16 v[160:163], a[104:107], a[8:11], v[160:163]
  s_and_b32 s42, s42, 31
  v_mfma_f32_16x16x32_bf16 v[160:163], a[108:111], a[12:15], v[160:163]
  s_mul_i32 s42, s42, 40960
  ds_read_b64_tr_b16 a[162:163], v228 offset:28672
  v_mfma_f32_16x16x32_bf16 v[164:167], a[112:115], a[0:3], v[208:211]
  s_add_u32 m0, s40, 65536
  v_mfma_f32_16x16x32_bf16 v[164:167], a[116:119], a[4:7], v[164:167]
  ds_read_b64_tr_b16 a[164:165], v229 offset:24576
  ds_read_b64_tr_b16 a[166:167], v229 offset:28672
  buffer_load_dwordx4 v246, s[8:11], s42 offen lds
  v_mfma_f32_16x16x32_bf16 v[164:167], a[120:123], a[8:11], v[164:167]
  v_mfma_f32_16x16x32_bf16 v[164:167], a[124:127], a[12:15], v[164:167]
  ds_read_b64_tr_b16 a[168:169], v230 offset:24576
  v_mfma_f32_16x16x32_bf16 v[96:99], a[128:131], v[200:203], v[96:99]
  v_exp_f32 v160, v160
  v_mfma_f32_16x16x32_bf16 v[100:103], a[132:135], v[200:203], v[100:103]
  ds_read_b64_tr_b16 a[170:171], v230 offset:28672
  ds_read_b64_tr_b16 a[172:173], v231 offset:24576
  v_mfma_f32_16x16x32_bf16 v[104:107], a[136:139], v[200:203], v[104:107]
  v_exp_f32 v161, v161
  v_mfma_f32_16x16x32_bf16 v[108:111], a[140:143], v[200:203], v[108:111]
  ds_read_b64_tr_b16 a[174:175], v231 offset:28672
  v_cvt_pk_bf16_f32 v192, v160, v161
  v_mfma_f32_16x16x32_bf16 v[112:115], a[144:147], v[200:203], v[112:115]
  v_exp_f32 v162, v162
  v_mfma_f32_16x16x32_bf16 v[116:119], a[148:151], v[200:203], v[116:119]
  ds_read_b64_tr_b16 a[176:177], v232 offset:24576
  ds_read_b64_tr_b16 a[178:179], v232 offset:28672
  v_mfma_f32_16x16x32_bf16 v[120:123], a[152:155], v[200:203], v[120:123]
  v_exp_f32 v163, v163
  v_mfma_f32_16x16x32_bf16 v[124:127], a[156:159], v[200:203], v[124:127]
  v_cvt_pk_bf16_f32 v193, v162, v163
  ds_read_b64_tr_b16 a[180:181], v233 offset:24576
  v_mfma_f32_16x16x32_bf16 a[200:203], a[208:211], v[200:203], a[200:203]
  ds_read_b64_tr_b16 a[182:183], v233 offset:28672
  buffer_load_dwordx4 v247, s[8:11], s42 offen offset:1024 lds
  v_mfma_f32_16x16x32_bf16 v[168:171], a[96:99], a[16:19], v[212:215]
  v_exp_f32 v164, v164
  v_mfma_f32_16x16x32_bf16 v[168:171], a[100:103], a[20:23], v[168:171]
  ds_read_b64_tr_b16 a[184:185], v234 offset:24576
  v_mfma_f32_16x16x32_bf16 v[168:171], a[104:107], a[24:27], v[168:171]
  v_exp_f32 v165, v165
  v_mfma_f32_16x16x32_bf16 v[168:171], a[108:111], a[28:31], v[168:171]
  ds_read_b64_tr_b16 a[186:187], v234 offset:28672
  v_cvt_pk_bf16_f32 v194, v164, v165
  v_mfma_f32_16x16x32_bf16 v[172:175], a[112:115], a[16:19], v[212:215]
  v_exp_f32 v166, v166
  v_mfma_f32_16x16x32_bf16 v[172:175], a[116:119], a[20:23], v[172:175]
  ds_read_b64_tr_b16 a[188:189], v235 offset:24576
  ds_read_b64_tr_b16 a[190:191], v235 offset:28672
  v_mfma_f32_16x16x32_bf16 v[172:175], a[120:123], a[24:27], v[172:175]
  v_exp_f32 v167, v167
  v_mfma_f32_16x16x32_bf16 v[172:175], a[124:127], a[28:31], v[172:175]
  buffer_load_dwordx4 v248, s[8:11], s42 offen offset:2048 lds
  v_cvt_pk_bf16_f32 v195, v166, v167
  v_exp_f32 v168, v168
  v_exp_f32 v169, v169
  s_nop 0
  v_cvt_pk_bf16_f32 v196, v168, v169
  v_exp_f32 v170, v170
  buffer_load_dwordx4 v249, s[8:11], s42 offen offset:3072 lds
  v_exp_f32 v171, v171
  s_nop 0
  v_cvt_pk_bf16_f32 v197, v170, v171
  s_waitcnt vmcnt(17) lgkmcnt(0)
  s_barrier
  v_mfma_f32_16x16x32_bf16 v[176:179], a[96:99], a[32:35], v[216:219]
  v_exp_f32 v172, v172
  v_mfma_f32_16x16x32_bf16 v[176:179], a[100:103], a[36:39], v[176:179]
  ds_read_b128 a[64:67], v224 offset:32768
  v_mfma_f32_16x16x32_bf16 v[176:179], a[104:107], a[40:43], v[176:179]
  v_exp_f32 v173, v173
  v_mfma_f32_16x16x32_bf16 v[176:179], a[108:111], a[44:47], v[176:179]
  v_cvt_pk_bf16_f32 v198, v172, v173
  ds_read_b128 a[68:71], v225 offset:32768
  v_mfma_f32_16x16x32_bf16 v[180:183], a[112:115], a[32:35], v[216:219]
  v_exp_f32 v174, v174
  v_mfma_f32_16x16x32_bf16 v[180:183], a[116:119], a[36:39], v[180:183]
  ds_read_b128 a[72:75], v226 offset:32768
  v_mfma_f32_16x16x32_bf16 v[180:183], a[120:123], a[40:43], v[180:183]
  v_exp_f32 v175, v175
  v_mfma_f32_16x16x32_bf16 v[180:183], a[124:127], a[44:47], v[180:183]
  ds_read_b128 a[76:79], v227 offset:32768
  v_cvt_pk_bf16_f32 v199, v174, v175
  v_mfma_f32_16x16x32_bf16 v[32:35], a[160:163], v[192:195], v[32:35]
  v_exp_f32 v176, v176
  v_mfma_f32_16x16x32_bf16 v[36:39], a[164:167], v[192:195], v[36:39]
  ds_read_b128 a[80:83], v224 offset:36864
  v_mfma_f32_16x16x32_bf16 v[40:43], a[168:171], v[192:195], v[40:43]
  v_exp_f32 v177, v177
  v_mfma_f32_16x16x32_bf16 v[44:47], a[172:175], v[192:195], v[44:47]
  v_cvt_pk_bf16_f32 v200, v176, v177
  ds_read_b128 a[84:87], v225 offset:36864
  v_mfma_f32_16x16x32_bf16 v[48:51], a[176:179], v[192:195], v[48:51]
  s_add_u32 s42, s41, 5
  v_exp_f32 v178, v178
  v_mfma_f32_16x16x32_bf16 v[52:55], a[180:183], v[192:195], v[52:55]
  s_and_b32 s42, s42, 31
  ds_read_b128 a[88:91], v226 offset:36864
  v_mfma_f32_16x16x32_bf16 v[56:59], a[184:187], v[192:195], v[56:59]
  s_mul_i32 s42, s42, 40960
  v_exp_f32 v179, v179
  v_mfma_f32_16x16x32_bf16 v[60:63], a[188:191], v[192:195], v[60:63]
  s_add_u32 m0, s40, 131072
  ds_read_b128 a[92:95], v227 offset:36864
  v_cvt_pk_bf16_f32 v201, v178, v179
  v_mfma_f32_16x16x32_bf16 a[192:195], a[208:211], v[192:195], a[192:195]
  buffer_load_dwordx4 v246, s[8:11], s42 offen lds
  v_exp_f32 v180, v180
  buffer_load_dwordx4 v247, s[8:11], s42 offen offset:1024 lds
  v_exp_f32 v181, v181
  s_nop 0
  v_cvt_pk_bf16_f32 v202, v180, v181
  v_exp_f32 v182, v182
  buffer_load_dwordx4 v248, s[8:11], s42 offen offset:2048 lds
  v_exp_f32 v183, v183
  s_nop 0
  v_cvt_pk_bf16_f32 v203, v182, v183
  v_mfma_f32_16x16x32_bf16 v[64:67], a[160:163], v[196:199], v[64:67]
  v_mfma_f32_16x16x32_bf16 v[68:71], a[164:167], v[196:199], v[68:71]
  v_mfma_f32_16x16x32_bf16 v[72:75], a[168:171], v[196:199], v[72:75]
  v_mfma_f32_16x16x32_bf16 v[76:79], a[172:175], v[196:199], v[76:79]
  v_mfma_f32_16x16x32_bf16 v[80:83], a[176:179], v[196:199], v[80:83]
  v_mfma_f32_16x16x32_bf16 v[84:87], a[180:183], v[196:199], v[84:87]
  buffer_load_dwordx4 v249, s[8:11], s42 offen offset:3072 lds
  v_mfma_f32_16x16x32_bf16 v[88:91], a[184:187], v[196:199], v[88:91]
  v_mfma_f32_16x16x32_bf16 v[92:95], a[188:191], v[196:199], v[92:95]
  s_waitcnt lgkmcnt(0)
  v_mfma_f32_16x16x32_bf16 a[196:199], a[208:211], v[196:199], a[196:199]
  v_mfma_f32_16x16x32_bf16 v[160:163], a[64:67], a[0:3], v[208:211]
  v_mfma_f32_16x16x32_bf16 v[160:163], a[68:71], a[4:7], v[160:163]
  s_add_u32 s42, s41, 2
  ds_read_b64_tr_b16 a[128:129], v228 offset:32768
  v_mfma_f32_16x16x32_bf16 v[160:163], a[72:75], a[8:11], v[160:163]
  s_and_b32 s42, s42, 31
  v_mfma_f32_16x16x32_bf16 v[160:163], a[76:79], a[12:15], v[160:163]
  s_mul_i32 s42, s42, 40960
  ds_read_b64_tr_b16 a[130:131], v228 offset:36864
  v_mfma_f32_16x16x32_bf16 v[164:167], a[80:83], a[0:3], v[208:211]
  s_add_u32 m0, s40, 147456
  v_mfma_f32_16x16x32_bf16 v[164:167], a[84:87], a[4:7], v[164:167]
  ds_read_b64_tr_b16 a[132:133], v229 offset:32768
  ds_read_b64_tr_b16 a[134:135], v229 offset:36864
  buffer_load_dwordx4 v246, s[8:11], s42 offen lds
  v_mfma_f32_16x16x32_bf16 v[164:167], a[88:91], a[8:11], v[164:167]
  v_mfma_f32_16x16x32_bf16 v[164:167], a[92:95], a[12:15], v[164:167]
  ds_read_b64_tr_b16 a[136:137], v230 offset:32768
  v_mfma_f32_16x16x32_bf16 v[96:99], a[160:163], v[200:203], v[96:99]
  v_exp_f32 v160, v160
  v_mfma_f32_16x16x32_bf16 v[100:103], a[164:167], v[200:203], v[100:103]
  ds_read_b64_tr_b16 a[138:139], v230 offset:36864
  ds_read_b64_tr_b16 a[140:141], v231 offset:32768
  v_mfma_f32_16x16x32_bf16 v[104:107], a[168:171], v[200:203], v[104:107]
  v_exp_f32 v161, v161
  v_mfma_f32_16x16x32_bf16 v[108:111], a[172:175], v[200:203], v[108:111]
  ds_read_b64_tr_b16 a[142:143], v231 offset:36864
  v_cvt_pk_bf16_f32 v192, v160, v161
  v_mfma_f32_16x16x32_bf16 v[112:115], a[176:179], v[200:203], v[112:115]
  v_exp_f32 v162, v162
  v_mfma_f32_16x16x32_bf16 v[116:119], a[180:183], v[200:203], v[116:119]
  ds_read_b64_tr_b16 a[144:145], v232 offset:32768
  ds_read_b64_tr_b16 a[146:147], v232 offset:36864
  v_mfma_f32_16x16x32_bf16 v[120:123], a[184:187], v[200:203], v[120:123]
  v_exp_f32 v163, v163
  v_mfma_f32_16x16x32_bf16 v[124:127], a[188:191], v[200:203], v[124:127]
  v_cvt_pk_bf16_f32 v193, v162, v163
  ds_read_b64_tr_b16 a[148:149], v233 offset:32768
  v_mfma_f32_16x16x32_bf16 a[200:203], a[208:211], v[200:203], a[200:203]
  ds_read_b64_tr_b16 a[150:151], v233 offset:36864
  buffer_load_dwordx4 v247, s[8:11], s42 offen offset:1024 lds
  v_mfma_f32_16x16x32_bf16 v[168:171], a[64:67], a[16:19], v[212:215]
  v_exp_f32 v164, v164
  v_mfma_f32_16x16x32_bf16 v[168:171], a[68:71], a[20:23], v[168:171]
  ds_read_b64_tr_b16 a[152:153], v234 offset:32768
  v_mfma_f32_16x16x32_bf16 v[168:171], a[72:75], a[24:27], v[168:171]
  v_exp_f32 v165, v165
  v_mfma_f32_16x16x32_bf16 v[168:171], a[76:79], a[28:31], v[168:171]
  ds_read_b64_tr_b16 a[154:155], v234 offset:36864
  v_cvt_pk_bf16_f32 v194, v164, v165
  v_mfma_f32_16x16x32_bf16 v[172:175], a[80:83], a[16:19], v[212:215]
  v_exp_f32 v166, v166
  v_mfma_f32_16x16x32_bf16 v[172:175], a[84:87], a[20:23], v[172:175]
  ds_read_b64_tr_b16 a[156:157], v235 offset:32768
  ds_read_b64_tr_b16 a[158:159], v235 offset:36864
  v_mfma_f32_16x16x32_bf16 v[172:175], a[88:91], a[24:27], v[172:175]
  v_exp_f32 v167, v167
  v_mfma_f32_16x16x32_bf16 v[172:175], a[92:95], a[28:31], v[172:175]
  buffer_load_dwordx4 v248, s[8:11], s42 offen offset:2048 lds
  v_cvt_pk_bf16_f32 v195, v166, v167
  v_exp_f32 v168, v168
  v_exp_f32 v169, v169
  s_nop 0
  v_cvt_pk_bf16_f32 v196, v168, v169
  v_exp_f32 v170, v170
  buffer_load_dwordx4 v249, s[8:11], s42 offen offset:3072 lds
  v_exp_f32 v171, v171
  s_nop 0
  v_cvt_pk_bf16_f32 v197, v170, v171
  s_waitcnt lgkmcnt(0)
  v_mfma_f32_16x16x32_bf16 v[176:179], a[64:67], a[32:35], v[216:219]
  v_exp_f32 v172, v172
  v_mfma_f32_16x16x32_bf16 v[176:179], a[68:71], a[36:39], v[176:179]
  ds_read_b128 a[96:99], v224 offset:40960
  v_mfma_f32_16x16x32_bf16 v[176:179], a[72:75], a[40:43], v[176:179]
  v_exp_f32 v173, v173
  v_mfma_f32_16x16x32_bf16 v[176:179], a[76:79], a[44:47], v[176:179]
  v_cvt_pk_bf16_f32 v198, v172, v173
  ds_read_b128 a[100:103], v225 offset:40960
  v_mfma_f32_16x16x32_bf16 v[180:183], a[80:83], a[32:35], v[216:219]
  v_exp_f32 v174, v174
  v_mfma_f32_16x16x32_bf16 v[180:183], a[84:87], a[36:39], v[180:183]
  ds_read_b128 a[104:107], v226 offset:40960
  v_mfma_f32_16x16x32_bf16 v[180:183], a[88:91], a[40:43], v[180:183]
  v_exp_f32 v175, v175
  v_mfma_f32_16x16x32_bf16 v[180:183], a[92:95], a[44:47], v[180:183]
  ds_read_b128 a[108:111], v227 offset:40960
  v_cvt_pk_bf16_f32 v199, v174, v175
  v_mfma_f32_16x16x32_bf16 v[32:35], a[128:131], v[192:195], v[32:35]
  v_exp_f32 v176, v176
  v_mfma_f32_16x16x32_bf16 v[36:39], a[132:135], v[192:195], v[36:39]
  ds_read_b128 a[112:115], v224 offset:45056
  v_mfma_f32_16x16x32_bf16 v[40:43], a[136:139], v[192:195], v[40:43]
  v_exp_f32 v177, v177
  v_mfma_f32_16x16x32_bf16 v[44:47], a[140:143], v[192:195], v[44:47]
  v_cvt_pk_bf16_f32 v200, v176, v177
  ds_read_b128 a[116:119], v225 offset:45056
  v_mfma_f32_16x16x32_bf16 v[48:51], a[144:147], v[192:195], v[48:51]
  s_add_u32 s42, s41, 3
  v_exp_f32 v178, v178
  v_mfma_f32_16x16x32_bf16 v[52:55], a[148:151], v[192:195], v[52:55]
  s_and_b32 s42, s42, 31
  ds_read_b128 a[120:123], v226 offset:45056
  v_mfma_f32_16x16x32_bf16 v[56:59], a[152:155], v[192:195], v[56:59]
  s_mul_i32 s42, s42, 40960
  v_exp_f32 v179, v179
  v_mfma_f32_16x16x32_bf16 v[60:63], a[156:159], v[192:195], v[60:63]
  s_add_u32 m0, s40, 16384
  ds_read_b128 a[124:127], v227 offset:45056
  v_cvt_pk_bf16_f32 v201, v178, v179
  v_mfma_f32_16x16x32_bf16 a[192:195], a[208:211], v[192:195], a[192:195]
  s_waitcnt vmcnt(12)
  buffer_load_dwordx4 v246, s[8:11], s42 offen lds
  ds_read_b64_tr_b16 a[224:225], v28 offset:0
  v_exp_f32 v180, v180
  buffer_load_dwordx4 v247, s[8:11], s42 offen offset:1024 lds
  ds_read_b64_tr_b16 a[226:227], v28 offset:2048
  v_exp_f32 v181, v181
  ds_read_b64_tr_b16 a[228:229], v29 offset:0
  v_cvt_pk_bf16_f32 v202, v180, v181
  v_exp_f32 v182, v182
  buffer_load_dwordx4 v248, s[8:11], s42 offen offset:2048 lds
  ds_read_b64_tr_b16 a[230:231], v29 offset:2048
  v_exp_f32 v183, v183
  ds_read_b64_tr_b16 a[232:233], v30 offset:0
  v_cvt_pk_bf16_f32 v203, v182, v183
  v_mfma_f32_16x16x32_bf16 v[64:67], a[128:131], v[196:199], v[64:67]
  v_mfma_f32_16x16x32_bf16 v[68:71], a[132:135], v[196:199], v[68:71]
  ds_read_b64_tr_b16 a[234:235], v30 offset:2048
  ds_read_b64_tr_b16 a[236:237], v31 offset:0
  v_mfma_f32_16x16x32_bf16 v[72:75], a[136:139], v[196:199], v[72:75]
  v_mfma_f32_16x16x32_bf16 v[76:79], a[140:143], v[196:199], v[76:79]
  ds_read_b64_tr_b16 a[238:239], v31 offset:2048
  v_mfma_f32_16x16x32_bf16 v[80:83], a[144:147], v[196:199], v[80:83]
  v_mfma_f32_16x16x32_bf16 v[84:87], a[148:151], v[196:199], v[84:87]
  buffer_load_dwordx4 v249, s[8:11], s42 offen offset:3072 lds
  v_mfma_f32_16x16x32_bf16 v[88:91], a[152:155], v[196:199], v[88:91]
  v_mfma_f32_16x16x32_bf16 v[92:95], a[156:159], v[196:199], v[92:95]
  s_waitcnt lgkmcnt(8)
  v_mfma_f32_16x16x32_bf16 a[196:199], a[208:211], v[196:199], a[196:199]
  v_mfma_f32_16x16x32_bf16 v[160:163], a[96:99], a[0:3], v[208:211]
  v_mfma_f32_16x16x32_bf16 v[160:163], a[100:103], a[4:7], v[160:163]
  s_add_u32 s42, s41, 6
  ds_read_b64_tr_b16 a[160:161], v228 offset:40960
  v_mfma_f32_16x16x32_bf16 v[160:163], a[104:107], a[8:11], v[160:163]
  s_and_b32 s42, s42, 31
  v_mfma_f32_16x16x32_bf16 v[160:163], a[108:111], a[12:15], v[160:163]
  s_mul_i32 s42, s42, 40960
  ds_read_b64_tr_b16 a[162:163], v228 offset:45056
  v_mfma_f32_16x16x32_bf16 v[164:167], a[112:115], a[0:3], v[208:211]
  s_add_u32 m0, s40, 81920
  v_mfma_f32_16x16x32_bf16 v[164:167], a[116:119], a[4:7], v[164:167]
  ds_read_b64_tr_b16 a[164:165], v229 offset:40960
  ds_read_b64_tr_b16 a[166:167], v229 offset:45056
  buffer_load_dwordx4 v246, s[8:11], s42 offen lds
  v_mfma_f32_16x16x32_bf16 v[164:167], a[120:123], a[8:11], v[164:167]
  v_mfma_f32_16x16x32_bf16 v[164:167], a[124:127], a[12:15], v[164:167]
  ds_read_b64_tr_b16 a[168:169], v230 offset:40960
  v_mfma_f32_16x16x32_bf16 v[96:99], a[128:131], v[200:203], v[96:99]
  v_exp_f32 v160, v160
  v_mfma_f32_16x16x32_bf16 v[100:103], a[132:135], v[200:203], v[100:103]
  ds_read_b64_tr_b16 a[170:171], v230 offset:45056
  ds_read_b64_tr_b16 a[172:173], v231 offset:40960
  v_mfma_f32_16x16x32_bf16 v[104:107], a[136:139], v[200:203], v[104:107]
  v_exp_f32 v161, v161
  v_mfma_f32_16x16x32_bf16 v[108:111], a[140:143], v[200:203], v[108:111]
  ds_read_b64_tr_b16 a[174:175], v231 offset:45056
  v_cvt_pk_bf16_f32 v192, v160, v161
  v_mfma_f32_16x16x32_bf16 v[112:115], a[144:147], v[200:203], v[112:115]
  v_exp_f32 v162, v162
  v_mfma_f32_16x16x32_bf16 v[116:119], a[148:151], v[200:203], v[116:119]
  ds_read_b64_tr_b16 a[176:177], v232 offset:40960
  ds_read_b64_tr_b16 a[178:179], v232 offset:45056
  v_mfma_f32_16x16x32_bf16 v[120:123], a[152:155], v[200:203], v[120:123]
  v_exp_f32 v163, v163
  v_mfma_f32_16x16x32_bf16 v[124:127], a[156:159], v[200:203], v[124:127]
  s_waitcnt lgkmcnt(10)
  v_cvt_pk_bf16_f32 v193, v162, v163
  ds_read_b64_tr_b16 a[180:181], v233 offset:40960
  v_mfma_f32_16x16x32_bf16 a[200:203], a[208:211], v[200:203], a[200:203]
  ds_read_b64_tr_b16 a[182:183], v233 offset:45056
  buffer_load_dwordx4 v247, s[8:11], s42 offen offset:1024 lds
  v_mfma_f32_16x16x32_bf16 v[168:171], a[96:99], a[16:19], v[212:215]
  v_exp_f32 v164, v164
  v_mfma_f32_16x16x32_bf16 v[168:171], a[100:103], a[20:23], v[168:171]
  ds_read_b64_tr_b16 a[184:185], v234 offset:40960
  v_mfma_f32_16x16x32_bf16 v[168:171], a[104:107], a[24:27], v[168:171]
  v_exp_f32 v165, v165
  v_mfma_f32_16x16x32_bf16 v[168:171], a[108:111], a[28:31], v[168:171]
  ds_read_b64_tr_b16 a[186:187], v234 offset:45056
  v_cvt_pk_bf16_f32 v194, v164, v165
  v_mfma_f32_16x16x32_bf16 v[172:175], a[112:115], a[16:19], v[212:215]
  v_exp_f32 v166, v166
  v_mfma_f32_16x16x32_bf16 v[172:175], a[116:119], a[20:23], v[172:175]
  ds_read_b64_tr_b16 a[188:189], v235 offset:40960
  ds_read_b64_tr_b16 a[190:191], v235 offset:45056
  v_mfma_f32_16x16x32_bf16 v[172:175], a[120:123], a[24:27], v[172:175]
  v_exp_f32 v167, v167
  v_mfma_f32_16x16x32_bf16 v[172:175], a[124:127], a[28:31], v[172:175]
  buffer_load_dwordx4 v248, s[8:11], s42 offen offset:2048 lds
  v_cvt_pk_bf16_f32 v195, v166, v167
  v_exp_f32 v168, v168
  v_exp_f32 v169, v169
  s_nop 0
  v_cvt_pk_bf16_f32 v196, v168, v169
  v_exp_f32 v170, v170
  buffer_load_dwordx4 v249, s[8:11], s42 offen offset:3072 lds
  v_exp_f32 v171, v171
  s_nop 0
  v_cvt_pk_bf16_f32 v197, v170, v171
  s_waitcnt vmcnt(29) lgkmcnt(0)
  s_barrier
  v_mfma_f32_16x16x32_bf16 v[176:179], a[96:99], a[32:35], v[216:219]
  s_waitcnt vmcnt(16)
  v_exp_f32 v172, v172
  v_mfma_f32_16x16x32_bf16 v[176:179], a[100:103], a[36:39], v[176:179]
  s_add_u32 s42, s41, 4
  ds_read_b128 a[64:67], v224 offset:49152
  ds_read_b64_tr_b16 a[240:241], v250 offset:0
  v_mfma_f32_16x16x32_bf16 v[176:179], a[104:107], a[40:43], v[176:179]
  s_and_b32 s42, s42, 31
  v_exp_f32 v173, v173
  v_mfma_f32_16x16x32_bf16 v[176:179], a[108:111], a[44:47], v[176:179]
  s_mul_i32 s42, s42, 40960
  v_cvt_pk_bf16_f32 v198, v172, v173
  ds_read_b128 a[68:71], v225 offset:49152
  v_mfma_f32_16x16x32_bf16 v[180:183], a[112:115], a[32:35], v[216:219]
  s_add_u32 m0, s40, 32768
  v_exp_f32 v174, v174
  v_mfma_f32_16x16x32_bf16 v[180:183], a[116:119], a[36:39], v[180:183]
  ds_read_b128 a[72:75], v226 offset:49152
  buffer_load_dwordx4 v246, s[8:11], s42 offen lds
  ds_read_b64_tr_b16 a[242:243], v250 offset:2048
  v_mfma_f32_16x16x32_bf16 v[180:183], a[120:123], a[40:43], v[180:183]
  v_exp_f32 v175, v175
  v_mfma_f32_16x16x32_bf16 v[180:183], a[124:127], a[44:47], v[180:183]
  ds_read_b128 a[76:79], v227 offset:49152
  buffer_load_dwordx4 v247, s[8:11], s42 offen offset:1024 lds
  v_cvt_pk_bf16_f32 v199, v174, v175
  v_mfma_f32_16x16x32_bf16 v[32:35], a[160:163], v[192:195], v[32:35]
  v_exp_f32 v176, v176
  v_mfma_f32_16x16x32_bf16 v[36:39], a[164:167], v[192:195], v[36:39]
  ds_read_b128 a[80:83], v224 offset:53248
  ds_read_b64_tr_b16 a[244:245], v251 offset:0
  v_mfma_f32_16x16x32_bf16 v[40:43], a[168:171], v[192:195], v[40:43]
  v_exp_f32 v177, v177
  v_mfma_f32_16x16x32_bf16 v[44:47], a[172:175], v[192:195], v[44:47]
  buffer_load_dwordx4 v248, s[8:11], s42 offen offset:2048 lds
  v_cvt_pk_bf16_f32 v200, v176, v177
  ds_read_b128 a[84:87], v225 offset:53248
  v_mfma_f32_16x16x32_bf16 v[48:51], a[176:179], v[192:195], v[48:51]
  v_exp_f32 v178, v178
  v_mfma_f32_16x16x32_bf16 v[52:55], a[180:183], v[192:195], v[52:55]
  ds_read_b128 a[88:91], v226 offset:53248
  ds_read_b64_tr_b16 a[246:247], v251 offset:2048
  v_mfma_f32_16x16x32_bf16 v[56:59], a[184:187], v[192:195], v[56:59]
  v_exp_f32 v179, v179
  v_mfma_f32_16x16x32_bf16 v[60:63], a[188:191], v[192:195], v[60:63]
  ds_read_b128 a[92:95], v227 offset:53248
  buffer_load_dwordx4 v249, s[8:11], s42 offen offset:3072 lds
  v_cvt_pk_bf16_f32 v201, v178, v179
  v_mfma_f32_16x16x32_bf16 a[192:195], a[208:211], v[192:195], a[192:195]
  ds_read_b64_tr_b16 a[248:249], v252 offset:0
  v_exp_f32 v180, v180
  s_add_u32 s42, s41, 7
  ds_read_b64_tr_b16 a[250:251], v252 offset:2048
  s_and_b32 s42, s42, 31
  v_exp_f32 v181, v181
  s_mul_i32 s42, s42, 40960
  ds_read_b64_tr_b16 a[252:253], v253 offset:0
  v_cvt_pk_bf16_f32 v202, v180, v181
  s_add_u32 m0, s40, 98304
  v_exp_f32 v182, v182
  buffer_load_dwordx4 v246, s[8:11], s42 offen lds
  ds_read_b64_tr_b16 a[254:255], v253 offset:2048
  v_exp_f32 v183, v183
  buffer_load_dwordx4 v247, s[8:11], s42 offen offset:1024 lds
  v_cvt_pk_bf16_f32 v203, v182, v183
  v_mfma_f32_16x16x32_bf16 v[64:67], a[160:163], v[196:199], v[64:67]
  s_waitcnt lgkmcnt(4)
  v_mfma_f32_16x16x32_bf16 v[68:71], a[164:167], v[196:199], v[68:71]
  ds_read_b128 a[96:99], v224 offset:57344
  ds_read_b128 a[100:103], v225 offset:57344
  v_mfma_f32_16x16x32_bf16 v[72:75], a[168:171], v[196:199], v[72:75]
  v_mfma_f32_16x16x32_bf16 v[76:79], a[172:175], v[196:199], v[76:79]
  buffer_load_dwordx4 v248, s[8:11], s42 offen offset:2048 lds
  ds_read_b128 a[104:107], v226 offset:57344
  v_mfma_f32_16x16x32_bf16 v[80:83], a[176:179], v[196:199], v[80:83]
  v_mfma_f32_16x16x32_bf16 v[84:87], a[180:183], v[196:199], v[84:87]
  buffer_load_dwordx4 v249, s[8:11], s42 offen offset:3072 lds
  ds_read_b128 a[108:111], v227 offset:57344
  v_mfma_f32_16x16x32_bf16 v[88:91], a[184:187], v[196:199], v[88:91]
  v_mfma_f32_16x16x32_bf16 v[92:95], a[188:191], v[196:199], v[92:95]
  ds_read_b128 a[112:115], v224 offset:61440
  v_mfma_f32_16x16x32_bf16 a[196:199], a[208:211], v[196:199], a[196:199]
  ds_read_b128 a[116:119], v225 offset:61440
  ds_read_b128 a[120:123], v226 offset:61440
  s_branch L_sec1
L_exact:
  s_mov_b32 s35, 1
  s_mov_b32 s18, 262144
  s_mov_b32 s22, 262144
  s_mov_b32 s33, s40
  s_waitcnt vmcnt(0) lgkmcnt(0)
L_exact_loop:
  s_barrier
  s_add_u32 m0, s40, 0
  s_nop 0
  buffer_load_dwordx4 v236, s[16:19], s33 offen nt lds
  buffer_load_dwordx4 v237, s[16:19], s33 offen offset:1024 nt lds
  buffer_load_dwordx4 v238, s[16:19], s33 offen offset:2048 nt lds
  buffer_load_dwordx4 v239, s[16:19], s33 offen offset:3072 nt lds
  s_add_u32 s33, s33, 16384
  s_waitcnt vmcnt(0)
  s_barrier
  ds_read_b128 a[64:67], v224 offset:0
  ds_read_b128 a[68:71], v225 offset:0
  ds_read_b128 a[72:75], v226 offset:0
  ds_read_b128 a[76:79], v227 offset:0
  ds_read_b128 a[80:83], v224 offset:4096
  ds_read_b128 a[84:87], v225 offset:4096
  ds_read_b128 a[88:91], v226 offset:4096
  ds_read_b128 a[92:95], v227 offset:4096
  s_waitcnt lgkmcnt(0)
  v_mfma_f32_16x16x32_bf16 v[160:163], a[64:67], a[0:3], 0
  v_mfma_f32_16x16x32_bf16 v[160:163], a[68:71], a[4:7], v[160:163]
  v_mfma_f32_16x16x32_bf16 v[160:163], a[72:75], a[8:11], v[160:163]
  v_mfma_f32_16x16x32_bf16 v[160:163], a[76:79], a[12:15], v[160:163]
  v_mfma_f32_16x16x32_bf16 v[164:167], a[80:83], a[0:3], 0
  v_mfma_f32_16x16x32_bf16 v[164:167], a[84:87], a[4:7], v[164:167]
  v_mfma_f32_16x16x32_bf16 v[164:167], a[88:91], a[8:11], v[164:167]
  v_mfma_f32_16x16x32_bf16 v[164:167], a[92:95], a[12:15], v[164:167]
  v_mfma_f32_16x16x32_bf16 v[168:171], a[64:67], a[16:19], 0
  v_mfma_f32_16x16x32_bf16 v[168:171], a[68:71], a[20:23], v[168:171]
  v_mfma_f32_16x16x32_bf16 v[168:171], a[72:75], a[24:27], v[168:171]
  v_mfma_f32_16x16x32_bf16 v[168:171], a[76:79], a[28:31], v[168:171]
  v_mfma_f32_16x16x32_bf16 v[172:175], a[80:83], a[16:19], 0
  v_mfma_f32_16x16x32_bf16 v[172:175], a[84:87], a[20:23], v[172:175]
  v_mfma_f32_16x16x32_bf16 v[172:175], a[88:91], a[24:27], v[172:175]
  v_mfma_f32_16x16x32_bf16 v[172:175], a[92:95], a[28:31], v[172:175]
  v_mfma_f32_16x16x32_bf16 v[176:179], a[64:67], a[32:35], 0
  v_mfma_f32_16x16x32_bf16 v[176:179], a[68:71], a[36:39], v[176:179]
  v_mfma_f32_16x16x32_bf16 v[176:179], a[72:75], a[40:43], v[176:179]
  v_mfma_f32_16x16x32_bf16 v[176:179], a[76:79], a[44:47], v[176:179]
  v_mfma_f32_16x16x32_bf16 v[180:183], a[80:83], a[32:35], 0
  v_mfma_f32_16x16x32_bf16 v[180:183], a[84:87], a[36:39], v[180:183]
  v_mfma_f32_16x16x32_bf16 v[180:183], a[88:91], a[40:43], v[180:183]
  v_mfma_f32_16x16x32_bf16 v[180:183], a[92:95], a[44:47], v[180:183]
  v_mfma_f32_16x16x32_bf16 v[184:187], a[64:67], a[48:51], 0
  v_mfma_f32_16x16x32_bf16 v[184:187], a[68:71], a[52:55], v[184:187]
  v_mfma_f32_16x16x32_bf16 v[184:187], a[72:75], a[56:59], v[184:187]
  v_mfma_f32_16x16x32_bf16 v[184:187], a[76:79], a[60:63], v[184:187]
  v_mfma_f32_16x16x32_bf16 v[188:191], a[80:83], a[48:51], 0
  v_mfma_f32_16x16x32_bf16 v[188:191], a[84:87], a[52:55], v[188:191]
  v_mfma_f32_16x16x32_bf16 v[188:191], a[88:91], a[56:59], v[188:191]
  v_mfma_f32_16x16x32_bf16 v[188:191], a[92:95], a[60:63], v[188:191]
  s_nop 7
  v_max3_f32 v242, v242, v160, v161
  v_max3_f32 v242, v242, v162, v163
  v_max3_f32 v242, v242, v164, v165
  v_max3_f32 v242, v242, v166, v167
  v_max3_f32 v243, v243, v168, v169
  v_max3_f32 v243, v243, v170, v171
  v_max3_f32 v243, v243, v172, v173
  v_max3_f32 v243, v243, v174, v175
  v_max3_f32 v244, v244, v176, v177
  v_max3_f32 v244, v244, v178, v179
  v_max3_f32 v244, v244, v180, v181
  v_max3_f32 v244, v244, v182, v183
  v_max3_f32 v245, v245, v184, v185
  v_max3_f32 v245, v245, v186, v187
  v_max3_f32 v245, v245, v188, v189
  v_max3_f32 v245, v245, v190, v191
  ds_read_b128 a[64:67], v224 offset:8192
  ds_read_b128 a[68:71], v225 offset:8192
  ds_read_b128 a[72:75], v226 offset:8192
  ds_read_b128 a[76:79], v227 offset:8192
  ds_read_b128 a[80:83], v224 offset:12288
  ds_read_b128 a[84:87], v225 offset:12288
  ds_read_b128 a[88:91], v226 offset:12288
  ds_read_b128 a[92:95], v227 offset:12288
  s_waitcnt lgkmcnt(0)
  v_mfma_f32_16x16x32_bf16 v[160:163], a[64:67], a[0:3], 0
  v_mfma_f32_16x16x32_bf16 v[160:163], a[68:71], a[4:7], v[160:163]
  v_mfma_f32_16x16x32_bf16 v[160:163], a[72:75], a[8:11], v[160:163]
  v_mfma_f32_16x16x32_bf16 v[160:163], a[76:79], a[12:15], v[160:163]
  v_mfma_f32_16x16x32_bf16 v[164:167], a[80:83], a[0:3], 0
  v_mfma_f32_16x16x32_bf16 v[164:167], a[84:87], a[4:7], v[164:167]
  v_mfma_f32_16x16x32_bf16 v[164:167], a[88:91], a[8:11], v[164:167]
  v_mfma_f32_16x16x32_bf16 v[164:167], a[92:95], a[12:15], v[164:167]
  v_mfma_f32_16x16x32_bf16 v[168:171], a[64:67], a[16:19], 0
  v_mfma_f32_16x16x32_bf16 v[168:171], a[68:71], a[20:23], v[168:171]
  v_mfma_f32_16x16x32_bf16 v[168:171], a[72:75], a[24:27], v[168:171]
  v_mfma_f32_16x16x32_bf16 v[168:171], a[76:79], a[28:31], v[168:171]
  v_mfma_f32_16x16x32_bf16 v[172:175], a[80:83], a[16:19], 0
  v_mfma_f32_16x16x32_bf16 v[172:175], a[84:87], a[20:23], v[172:175]
  v_mfma_f32_16x16x32_bf16 v[172:175], a[88:91], a[24:27], v[172:175]
  v_mfma_f32_16x16x32_bf16 v[172:175], a[92:95], a[28:31], v[172:175]
  v_mfma_f32_16x16x32_bf16 v[176:179], a[64:67], a[32:35], 0
  v_mfma_f32_16x16x32_bf16 v[176:179], a[68:71], a[36:39], v[176:179]
  v_mfma_f32_16x16x32_bf16 v[176:179], a[72:75], a[40:43], v[176:179]
  v_mfma_f32_16x16x32_bf16 v[176:179], a[76:79], a[44:47], v[176:179]
  v_mfma_f32_16x16x32_bf16 v[180:183], a[80:83], a[32:35], 0
  v_mfma_f32_16x16x32_bf16 v[180:183], a[84:87], a[36:39], v[180:183]
  v_mfma_f32_16x16x32_bf16 v[180:183], a[88:91], a[40:43], v[180:183]
  v_mfma_f32_16x16x32_bf16 v[180:183], a[92:95], a[44:47], v[180:183]
  v_mfma_f32_16x16x32_bf16 v[184:187], a[64:67], a[48:51], 0
  v_mfma_f32_16x16x32_bf16 v[184:187], a[68:71], a[52:55], v[184:187]
  v_mfma_f32_16x16x32_bf16 v[184:187], a[72:75], a[56:59], v[184:187]
  v_mfma_f32_16x16x32_bf16 v[184:187], a[76:79], a[60:63], v[184:187]
  v_mfma_f32_16x16x32_bf16 v[188:191], a[80:83], a[48:51], 0
  v_mfma_f32_16x16x32_bf16 v[188:191], a[84:87], a[52:55], v[188:191]
  v_mfma_f32_16x16x32_bf16 v[188:191], a[88:91], a[56:59], v[188:191]
  v_mfma_f32_16x16x32_bf16 v[188:191], a[92:95], a[60:63], v[188:191]
  s_nop 7
  v_max3_f32 v242, v242, v160, v161
  v_max3_f32 v242, v242, v162, v163
  v_max3_f32 v242, v242, v164, v165
  v_max3_f32 v242, v242, v166, v167
  v_max3_f32 v243, v243, v168, v169
  v_max3_f32 v243, v243, v170, v171
  v_max3_f32 v243, v243, v172, v173
  v_max3_f32 v243, v243, v174, v175
  v_max3_f32 v244, v244, v176, v177
  v_max3_f32 v244, v244, v178, v179
  v_max3_f32 v244, v244, v180, v181
  v_max3_f32 v244, v244, v182, v183
  v_max3_f32 v245, v245, v184, v185
  v_max3_f32 v245, v245, v186, v187
  v_max3_f32 v245, v245, v188, v189
  v_max3_f32 v245, v245, v190, v191
  s_cmp_lt_u32 s33, 262144
  s_cbranch_scc1 L_exact_loop
  s_barrier
  s_mov_b32 s33, s40
  s_add_u32 m0, s40, 0
  s_nop 0
  buffer_load_dwordx4 v236, s[16:19], s33 offen nt lds
  buffer_load_dwordx4 v237, s[16:19], s33 offen offset:1024 nt lds
  buffer_load_dwordx4 v238, s[16:19], s33 offen offset:2048 nt lds
  buffer_load_dwordx4 v239, s[16:19], s33 offen offset:3072 nt lds
  s_add_u32 m0, s40, 65536
  s_nop 0
  buffer_load_dwordx4 v240, s[20:23], s33 offen nt lds
  buffer_load_dwordx4 v241, s[20:23], s33 offen offset:1024 nt lds
  buffer_load_dwordx4 v240, s[20:23], s33 offen offset:2048 nt lds
  buffer_load_dwordx4 v241, s[20:23], s33 offen offset:3072 nt lds
  s_add_u32 s33, s33, 16384
  s_add_u32 m0, s40, 16384
  s_nop 0
  buffer_load_dwordx4 v236, s[16:19], s33 offen nt lds
  buffer_load_dwordx4 v237, s[16:19], s33 offen offset:1024 nt lds
  buffer_load_dwordx4 v238, s[16:19], s33 offen offset:2048 nt lds
  buffer_load_dwordx4 v239, s[16:19], s33 offen offset:3072 nt lds
  s_add_u32 m0, s40, 81920
  s_nop 0
  buffer_load_dwordx4 v240, s[20:23], s33 offen nt lds
  buffer_load_dwordx4 v241, s[20:23], s33 offen offset:1024 nt lds
  buffer_load_dwordx4 v240, s[20:23], s33 offen offset:2048 nt lds
  buffer_load_dwordx4 v241, s[20:23], s33 offen offset:3072 nt lds
  s_add_u32 s33, s33, 16384
  s_add_u32 m0, s40, 32768
  s_nop 0
  buffer_load_dwordx4 v236, s[16:19], s33 offen nt lds
  buffer_load_dwordx4 v237, s[16:19], s33 offen offset:1024 nt lds
  buffer_load_dwordx4 v238, s[16:19], s33 offen offset:2048 nt lds
  buffer_load_dwordx4 v239, s[16:19], s33 offen offset:3072 nt lds
  s_add_u32 m0, s40, 98304
  s_nop 0
  buffer_load_dwordx4 v240, s[20:23], s33 offen nt lds
  buffer_load_dwordx4 v241, s[20:23], s33 offen offset:1024 nt lds
  buffer_load_dwordx4 v240, s[20:23], s33 offen offset:2048 nt lds
  buffer_load_dwordx4 v241, s[20:23], s33 offen offset:3072 nt lds
  s_add_u32 s33, s33, 16384
  s_add_u32 m0, s40, 49152
  s_nop 0
  buffer_load_dwordx4 v236, s[16:19], s33 offen nt lds
  buffer_load_dwordx4 v237, s[16:19], s33 offen offset:1024 nt lds
  buffer_load_dwordx4 v238, s[16:19], s33 offen offset:2048 nt lds
  buffer_load_dwordx4 v239, s[16:19], s33 offen offset:3072 nt lds
  s_waitcnt vmcnt(0)
  s_barrier
  ds_read_b128 a[64:67], v224 offset:0
  ds_read_b128 a[68:71], v225 offset:0
  ds_read_b128 a[72:75], v226 offset:0
  ds_read_b128 a[76:79], v227 offset:0
  ds_read_b128 a[80:83], v224 offset:4096
  ds_read_b128 a[84:87], v225 offset:4096
  ds_read_b128 a[88:91], v226 offset:4096
  ds_read_b128 a[92:95], v227 offset:4096
  ds_read_b64_tr_b16 a[128:129], v228 offset:0
  ds_read_b64_tr_b16 a[130:131], v228 offset:4096
  ds_read_b64_tr_b16 a[132:133], v229 offset:0
  ds_read_b64_tr_b16 a[134:135], v229 offset:4096
  ds_read_b64_tr_b16 a[136:137], v230 offset:0
  ds_read_b64_tr_b16 a[138:139], v230 offset:4096
  ds_read_b64_tr_b16 a[140:141], v231 offset:0
  ds_read_b64_tr_b16 a[142:143], v231 offset:4096
  ds_read_b64_tr_b16 a[144:145], v232 offset:0
  ds_read_b64_tr_b16 a[146:147], v232 offset:4096
  ds_read_b64_tr_b16 a[148:149], v233 offset:0
  ds_read_b64_tr_b16 a[150:151], v233 offset:4096
  ds_read_b64_tr_b16 a[152:153], v234 offset:0
  ds_read_b64_tr_b16 a[154:155], v234 offset:4096
  ds_read_b64_tr_b16 a[156:157], v235 offset:0
  ds_read_b64_tr_b16 a[158:159], v235 offset:4096
  s_waitcnt lgkmcnt(0)
  ds_read_b128 a[96:99], v224 offset:8192
  ds_read_b128 a[100:103], v225 offset:8192
  ds_read_b128 a[104:107], v226 offset:8192
  ds_read_b128 a[108:111], v227 offset:8192
  ds_read_b128 a[112:115], v224 offset:12288
  ds_read_b128 a[116:119], v225 offset:12288
  ds_read_b128 a[120:123], v226 offset:12288
  ds_read_b128 a[124:127], v227 offset:12288
  v_mfma_f32_16x16x32_bf16 v[160:163], a[64:67], a[0:3], 0
  v_mfma_f32_16x16x32_bf16 v[160:163], a[68:71], a[4:7], v[160:163]
  v_mfma_f32_16x16x32_bf16 v[160:163], a[72:75], a[8:11], v[160:163]
  v_mfma_f32_16x16x32_bf16 v[160:163], a[76:79], a[12:15], v[160:163]
  v_mfma_f32_16x16x32_bf16 v[164:167], a[80:83], a[0:3], 0
  v_mfma_f32_16x16x32_bf16 v[164:167], a[84:87], a[4:7], v[164:167]
  v_mfma_f32_16x16x32_bf16 v[164:167], a[88:91], a[8:11], v[164:167]
  v_mfma_f32_16x16x32_bf16 v[164:167], a[92:95], a[12:15], v[164:167]
  v_mfma_f32_16x16x32_bf16 v[168:171], a[64:67], a[16:19], 0
  v_mfma_f32_16x16x32_bf16 v[168:171], a[68:71], a[20:23], v[168:171]
  v_mfma_f32_16x16x32_bf16 v[168:171], a[72:75], a[24:27], v[168:171]
  v_mfma_f32_16x16x32_bf16 v[168:171], a[76:79], a[28:31], v[168:171]
  v_mfma_f32_16x16x32_bf16 v[172:175], a[80:83], a[16:19], 0
  v_mfma_f32_16x16x32_bf16 v[172:175], a[84:87], a[20:23], v[172:175]
  v_mfma_f32_16x16x32_bf16 v[172:175], a[88:91], a[24:27], v[172:175]
  v_mfma_f32_16x16x32_bf16 v[172:175], a[92:95], a[28:31], v[172:175]
  v_mfma_f32_16x16x32_bf16 v[176:179], a[64:67], a[32:35], 0
  v_mfma_f32_16x16x32_bf16 v[176:179], a[68:71], a[36:39], v[176:179]
  v_mfma_f32_16x16x32_bf16 v[176:179], a[72:75], a[40:43], v[176:179]
  v_mfma_f32_16x16x32_bf16 v[176:179], a[76:79], a[44:47], v[176:179]
  v_mfma_f32_16x16x32_bf16 v[180:183], a[80:83], a[32:35], 0
  v_mfma_f32_16x16x32_bf16 v[180:183], a[84:87], a[36:39], v[180:183]
  v_mfma_f32_16x16x32_bf16 v[180:183], a[88:91], a[40:43], v[180:183]
  v_mfma_f32_16x16x32_bf16 v[180:183], a[92:95], a[44:47], v[180:183]
  v_mfma_f32_16x16x32_bf16 v[184:187], a[64:67], a[48:51], 0
  v_mfma_f32_16x16x32_bf16 v[184:187], a[68:71], a[52:55], v[184:187]
  v_mfma_f32_16x16x32_bf16 v[184:187], a[72:75], a[56:59], v[184:187]
  v_mfma_f32_16x16x32_bf16 v[184:187], a[76:79], a[60:63], v[184:187]
  v_mfma_f32_16x16x32_bf16 v[188:191], a[80:83], a[48:51], 0
  v_mfma_f32_16x16x32_bf16 v[188:191], a[84:87], a[52:55], v[188:191]
  v_mfma_f32_16x16x32_bf16 v[188:191], a[88:91], a[56:59], v[188:191]
  v_mfma_f32_16x16x32_bf16 v[188:191], a[92:95], a[60:63], v[188:191]
  v_mov_b32 v27, 0x3f803f80
  v_accvgpr_write_b32 a208, v27
  v_accvgpr_write_b32 a209, v27
  v_accvgpr_write_b32 a210, v27
  v_accvgpr_write_b32 a211, v27
  s_nop 7
  v_max3_f32 v208, v160, v161, v162
  v_max3_f32 v212, v168, v169, v170
  v_max3_f32 v216, v176, v177, v178
  v_max3_f32 v220, v184, v185, v186
  v_max3_f32 v209, v163, v164, v165
  v_max3_f32 v213, v171, v172, v173
  v_max3_f32 v217, v179, v180, v181
  v_max3_f32 v221, v187, v188, v189
  v_max3_f32 v208, v208, v166, v167
  v_max3_f32 v212, v212, v174, v175
  v_max3_f32 v216, v216, v182, v183
  v_max3_f32 v220, v220, v190, v191
  v_max3_f32 v208, v208, v209, v242
  v_max3_f32 v212, v212, v213, v243
  v_max3_f32 v216, v216, v217, v244
  v_max3_f32 v220, v220, v221, v245
  v_mov_b32 v209, v208
  v_mov_b32 v213, v212
  v_mov_b32 v217, v216
  v_mov_b32 v221, v220
  v_permlane32_swap_b32 v208, v209
  v_permlane32_swap_b32 v212, v213
  v_permlane32_swap_b32 v216, v217
  v_permlane32_swap_b32 v220, v221
  v_max_f32 v208, v208, v209
  v_max_f32 v212, v212, v213
  v_max_f32 v216, v216, v217
  v_max_f32 v220, v220, v221
  v_mov_b32 v209, v208
  v_mov_b32 v213, v212
  v_mov_b32 v217, v216
  v_mov_b32 v221, v220
  v_permlane16_swap_b32 v208, v209
  v_permlane16_swap_b32 v212, v213
  v_permlane16_swap_b32 v216, v217
  v_permlane16_swap_b32 v220, v221
  v_max_f32 v208, v208, v209
  v_max_f32 v212, v212, v213
  v_max_f32 v216, v216, v217
  v_max_f32 v220, v220, v221
  v_sub_f32 v160, v160, v208
  v_sub_f32 v168, v168, v212
  v_sub_f32 v176, v176, v216
  v_sub_f32 v184, v184, v220
  v_sub_f32 v161, v161, v208
  v_sub_f32 v169, v169, v212
  v_sub_f32 v177, v177, v216
  v_sub_f32 v185, v185, v220
  v_sub_f32 v162, v162, v208
  v_sub_f32 v170, v170, v212
  v_sub_f32 v178, v178, v216
  v_sub_f32 v186, v186, v220
  v_sub_f32 v163, v163, v208
  v_sub_f32 v171, v171, v212
  v_sub_f32 v179, v179, v216
  v_sub_f32 v164, v164, v208
  v_sub_f32 v172, v172, v212
  v_sub_f32 v180, v180, v216
  v_sub_f32 v187, v187, v220
  v_sub_f32 v165, v165, v208
  v_sub_f32 v173, v173, v212
  v_sub_f32 v181, v181, v216
  v_sub_f32 v188, v188, v220
  v_sub_f32 v166, v166, v208
  v_sub_f32 v174, v174, v212
  v_sub_f32 v182, v182, v216
  v_sub_f32 v189, v189, v220
  v_sub_f32 v167, v167, v208
  v_sub_f32 v175, v175, v212
  v_sub_f32 v183, v183, v216
  v_exp_f32 v160, v160
  v_exp_f32 v168, v168
  v_exp_f32 v176, v176
  v_sub_f32 v190, v190, v220
  v_exp_f32 v161, v161
  v_exp_f32 v169, v169
  v_exp_f32 v177, v177
  v_sub_f32 v191, v191, v220
  v_exp_f32 v162, v162
  v_exp_f32 v170, v170
  v_exp_f32 v178, v178
  v_exp_f32 v184, v184
  v_exp_f32 v163, v163
  v_exp_f32 v171, v171
  v_exp_f32 v179, v179
  v_exp_f32 v164, v164
  v_exp_f32 v172, v172
  v_exp_f32 v180, v180
  v_exp_f32 v185, v185
  v_exp_f32 v165, v165
  v_exp_f32 v173, v173
  v_exp_f32 v181, v181
  v_exp_f32 v186, v186
  v_exp_f32 v166, v166
  v_exp_f32 v174, v174
  v_exp_f32 v182, v182
  v_exp_f32 v187, v187
  v_exp_f32 v167, v167
  v_exp_f32 v175, v175
  v_exp_f32 v183, v183
  v_sub_f32 v209, 0, v208
  v_sub_f32 v213, 0, v212
  v_sub_f32 v217, 0, v216
  v_sub_f32 v221, 0, v220
  v_sub_f32 v210, 0, v208
  v_sub_f32 v214, 0, v212
  v_sub_f32 v218, 0, v216
  v_sub_f32 v222, 0, v220
  v_sub_f32 v211, 0, v208
  v_sub_f32 v215, 0, v212
  v_sub_f32 v219, 0, v216
  v_sub_f32 v223, 0, v220
  v_sub_f32 v208, 0, v208
  v_sub_f32 v212, 0, v212
  v_sub_f32 v216, 0, v216
  v_cvt_pk_bf16_f32 v192, v160, v161
  v_cvt_pk_bf16_f32 v196, v168, v169
  v_cvt_pk_bf16_f32 v200, v176, v177
  v_sub_f32 v220, 0, v220
  v_cvt_pk_bf16_f32 v193, v162, v163
  v_cvt_pk_bf16_f32 v197, v170, v171
  v_cvt_pk_bf16_f32 v201, v178, v179
  v_cvt_pk_bf16_f32 v204, v184, v185
  v_cvt_pk_bf16_f32 v194, v164, v165
  v_cvt_pk_bf16_f32 v198, v172, v173
  v_cvt_pk_bf16_f32 v202, v180, v181
  v_cvt_pk_bf16_f32 v205, v186, v187
  v_cvt_pk_bf16_f32 v195, v166, v167
  v_cvt_pk_bf16_f32 v199, v174, v175
  v_cvt_pk_bf16_f32 v203, v182, v183
  s_nop 1
  v_mfma_f32_16x16x32_bf16 v[32:35], a[128:131], v[192:195], 0
  v_mfma_f32_16x16x32_bf16 v[36:39], a[132:135], v[192:195], 0
  v_mfma_f32_16x16x32_bf16 v[40:43], a[136:139], v[192:195], 0
  v_mfma_f32_16x16x32_bf16 v[44:47], a[140:143], v[192:195], 0
  v_mfma_f32_16x16x32_bf16 v[48:51], a[144:147], v[192:195], 0
  v_mfma_f32_16x16x32_bf16 v[52:55], a[148:151], v[192:195], 0
  v_mfma_f32_16x16x32_bf16 v[56:59], a[152:155], v[192:195], 0
  v_mfma_f32_16x16x32_bf16 v[60:63], a[156:159], v[192:195], 0
  v_mfma_f32_16x16x32_bf16 a[192:195], a[208:211], v[192:195], 0
  v_mfma_f32_16x16x32_bf16 v[64:67], a[128:131], v[196:199], 0
  v_mfma_f32_16x16x32_bf16 v[68:71], a[132:135], v[196:199], 0
  v_mfma_f32_16x16x32_bf16 v[72:75], a[136:139], v[196:199], 0
  v_mfma_f32_16x16x32_bf16 v[76:79], a[140:143], v[196:199], 0
  v_mfma_f32_16x16x32_bf16 v[80:83], a[144:147], v[196:199], 0
  v_mfma_f32_16x16x32_bf16 v[84:87], a[148:151], v[196:199], 0
  v_mfma_f32_16x16x32_bf16 v[88:91], a[152:155], v[196:199], 0
  v_mfma_f32_16x16x32_bf16 v[92:95], a[156:159], v[196:199], 0
  v_mfma_f32_16x16x32_bf16 a[196:199], a[208:211], v[196:199], 0
  s_waitcnt lgkmcnt(0)
  v_mfma_f32_16x16x32_bf16 v[160:163], a[96:99], a[0:3], v[208:211]
  v_exp_f32 v188, v188
  v_mfma_f32_16x16x32_bf16 v[160:163], a[100:103], a[4:7], v[160:163]
  ds_read_b64_tr_b16 a[160:161], v228 offset:8192
  v_mfma_f32_16x16x32_bf16 v[160:163], a[104:107], a[8:11], v[160:163]
  v_exp_f32 v189, v189
  v_mfma_f32_16x16x32_bf16 v[160:163], a[108:111], a[12:15], v[160:163]
  v_cvt_pk_bf16_f32 v206, v188, v189
  ds_read_b64_tr_b16 a[162:163], v228 offset:12288
  v_mfma_f32_16x16x32_bf16 v[164:167], a[112:115], a[0:3], v[208:211]
  v_exp_f32 v190, v190
  v_mfma_f32_16x16x32_bf16 v[164:167], a[116:119], a[4:7], v[164:167]
  ds_read_b64_tr_b16 a[164:165], v229 offset:8192
  ds_read_b64_tr_b16 a[166:167], v229 offset:12288
  v_mfma_f32_16x16x32_bf16 v[164:167], a[120:123], a[8:11], v[164:167]
  v_exp_f32 v191, v191
  v_mfma_f32_16x16x32_bf16 v[164:167], a[124:127], a[12:15], v[164:167]
  v_cvt_pk_bf16_f32 v207, v190, v191
  ds_read_b64_tr_b16 a[168:169], v230 offset:8192
  v_mfma_f32_16x16x32_bf16 v[96:99], a[128:131], v[200:203], 0
  v_exp_f32 v160, v160
  v_mfma_f32_16x16x32_bf16 v[100:103], a[132:135], v[200:203], 0
  ds_read_b64_tr_b16 a[170:171], v230 offset:12288
  ds_read_b64_tr_b16 a[172:173], v231 offset:8192
  v_mfma_f32_16x16x32_bf16 v[104:107], a[136:139], v[200:203], 0
  v_exp_f32 v161, v161
  v_mfma_f32_16x16x32_bf16 v[108:111], a[140:143], v[200:203], 0
  ds_read_b64_tr_b16 a[174:175], v231 offset:12288
  v_cvt_pk_bf16_f32 v192, v160, v161
  v_mfma_f32_16x16x32_bf16 v[112:115], a[144:147], v[200:203], 0
  v_exp_f32 v162, v162
  v_mfma_f32_16x16x32_bf16 v[116:119], a[148:151], v[200:203], 0
  ds_read_b64_tr_b16 a[176:177], v232 offset:8192
  ds_read_b64_tr_b16 a[178:179], v232 offset:12288
  v_mfma_f32_16x16x32_bf16 v[120:123], a[152:155], v[200:203], 0
  v_exp_f32 v163, v163
  v_mfma_f32_16x16x32_bf16 v[124:127], a[156:159], v[200:203], 0
  v_cvt_pk_bf16_f32 v193, v162, v163
  ds_read_b64_tr_b16 a[180:181], v233 offset:8192
  v_mfma_f32_16x16x32_bf16 a[200:203], a[208:211], v[200:203], 0
  ds_read_b64_tr_b16 a[182:183], v233 offset:12288
  v_mfma_f32_16x16x32_bf16 v[168:171], a[96:99], a[16:19], v[212:215]
  v_exp_f32 v164, v164
  v_mfma_f32_16x16x32_bf16 v[168:171], a[100:103], a[20:23], v[168:171]
  ds_read_b64_tr_b16 a[184:185], v234 offset:8192
  v_mfma_f32_16x16x32_bf16 v[168:171], a[104:107], a[24:27], v[168:171]
  v_exp_f32 v165, v165
  v_mfma_f32_16x16x32_bf16 v[168:171], a[108:111], a[28:31], v[168:171]
  ds_read_b64_tr_b16 a[186:187], v234 offset:12288
  v_cvt_pk_bf16_f32 v194, v164, v165
  v_mfma_f32_16x16x32_bf16 v[172:175], a[112:115], a[16:19], v[212:215]
  v_exp_f32 v166, v166
  v_mfma_f32_16x16x32_bf16 v[172:175], a[116:119], a[20:23], v[172:175]
  ds_read_b64_tr_b16 a[188:189], v235 offset:8192
  ds_read_b64_tr_b16 a[190:191], v235 offset:12288
  v_mfma_f32_16x16x32_bf16 v[172:175], a[120:123], a[24:27], v[172:175]
  v_exp_f32 v167, v167
  v_mfma_f32_16x16x32_bf16 v[172:175], a[124:127], a[28:31], v[172:175]
  v_cvt_pk_bf16_f32 v195, v166, v167
  v_mfma_f32_16x16x32_bf16 v[128:131], a[128:131], v[204:207], 0
  v_exp_f32 v168, v168
  v_mfma_f32_16x16x32_bf16 v[132:135], a[132:135], v[204:207], 0
  v_mfma_f32_16x16x32_bf16 v[136:139], a[136:139], v[204:207], 0
  v_exp_f32 v169, v169
  v_mfma_f32_16x16x32_bf16 v[140:143], a[140:143], v[204:207], 0
  v_cvt_pk_bf16_f32 v196, v168, v169
  v_mfma_f32_16x16x32_bf16 v[144:147], a[144:147], v[204:207], 0
  v_exp_f32 v170, v170
  v_mfma_f32_16x16x32_bf16 v[148:151], a[148:151], v[204:207], 0
  v_mfma_f32_16x16x32_bf16 v[152:155], a[152:155], v[204:207], 0
  v_exp_f32 v171, v171
  v_mfma_f32_16x16x32_bf16 v[156:159], a[156:159], v[204:207], 0
  v_cvt_pk_bf16_f32 v197, v170, v171
  v_mfma_f32_16x16x32_bf16 a[204:207], a[208:211], v[204:207], 0
  s_waitcnt vmcnt(0) lgkmcnt(0)
  s_barrier
  v_mfma_f32_16x16x32_bf16 v[176:179], a[96:99], a[32:35], v[216:219]
  s_add_u32 m0, s40, 114688
  v_exp_f32 v172, v172
  v_mfma_f32_16x16x32_bf16 v[176:179], a[100:103], a[36:39], v[176:179]
  ds_read_b128 a[64:67], v224 offset:16384
  buffer_load_dwordx4 v240, s[20:23], s33 offen nt lds
  v_mfma_f32_16x16x32_bf16 v[176:179], a[104:107], a[40:43], v[176:179]
  v_exp_f32 v173, v173
  v_mfma_f32_16x16x32_bf16 v[176:179], a[108:111], a[44:47], v[176:179]
  v_cvt_pk_bf16_f32 v198, v172, v173
  ds_read_b128 a[68:71], v225 offset:16384
  v_mfma_f32_16x16x32_bf16 v[180:183], a[112:115], a[32:35], v[216:219]
  v_exp_f32 v174, v174
  v_mfma_f32_16x16x32_bf16 v[180:183], a[116:119], a[36:39], v[180:183]
  ds_read_b128 a[72:75], v226 offset:16384
  v_mfma_f32_16x16x32_bf16 v[180:183], a[120:123], a[40:43], v[180:183]
  v_exp_f32 v175, v175
  v_mfma_f32_16x16x32_bf16 v[180:183], a[124:127], a[44:47], v[180:183]
  ds_read_b128 a[76:79], v227 offset:16384
  v_cvt_pk_bf16_f32 v199, v174, v175
  v_mfma_f32_16x16x32_bf16 v[32:35], a[160:163], v[192:195], v[32:35]
  v_exp_f32 v176, v176
  v_mfma_f32_16x16x32_bf16 v[36:39], a[164:167], v[192:195], v[36:39]
  ds_read_b128 a[80:83], v224 offset:20480
  v_mfma_f32_16x16x32_bf16 v[40:43], a[168:171], v[192:195], v[40:43]
  v_exp_f32 v177, v177
  v_mfma_f32_16x16x32_bf16 v[44:47], a[172:175], v[192:195], v[44:47]
  v_cvt_pk_bf16_f32 v200, v176, v177
  ds_read_b128 a[84:87], v225 offset:20480
  v_mfma_f32_16x16x32_bf16 v[48:51], a[176:179], v[192:195], v[48:51]
  v_exp_f32 v178, v178
  v_mfma_f32_16x16x32_bf16 v[52:55], a[180:183], v[192:195], v[52:55]
  ds_read_b128 a[88:91], v226 offset:20480
  v_mfma_f32_16x16x32_bf16 v[56:59], a[184:187], v[192:195], v[56:59]
  v_exp_f32 v179, v179
  v_mfma_f32_16x16x32_bf16 v[60:63], a[188:191], v[192:195], v[60:63]
  ds_read_b128 a[92:95], v227 offset:20480
  v_cvt_pk_bf16_f32 v201, v178, v179
  v_mfma_f32_16x16x32_bf16 a[192:195], a[208:211], v[192:195], a[192:195]
  v_mfma_f32_16x16x32_bf16 v[184:187], a[96:99], a[48:51], v[220:223]
  v_exp_f32 v180, v180
  v_mfma_f32_16x16x32_bf16 v[184:187], a[100:103], a[52:55], v[184:187]
  buffer_load_dwordx4 v241, s[20:23], s33 offen offset:1024 nt lds
  v_mfma_f32_16x16x32_bf16 v[184:187], a[104:107], a[56:59], v[184:187]
  v_exp_f32 v181, v181
  v_mfma_f32_16x16x32_bf16 v[184:187], a[108:111], a[60:63], v[184:187]
  v_cvt_pk_bf16_f32 v202, v180, v181
  v_mfma_f32_16x16x32_bf16 v[188:191], a[112:115], a[48:51], v[220:223]
  v_exp_f32 v182, v182
  v_mfma_f32_16x16x32_bf16 v[188:191], a[116:119], a[52:55], v[188:191]
  v_mfma_f32_16x16x32_bf16 v[188:191], a[120:123], a[56:59], v[188:191]
  v_exp_f32 v183, v183
  v_mfma_f32_16x16x32_bf16 v[188:191], a[124:127], a[60:63], v[188:191]
  v_cvt_pk_bf16_f32 v203, v182, v183
  v_mfma_f32_16x16x32_bf16 v[64:67], a[160:163], v[196:199], v[64:67]
  v_exp_f32 v184, v184
  v_mfma_f32_16x16x32_bf16 v[68:71], a[164:167], v[196:199], v[68:71]
  v_mfma_f32_16x16x32_bf16 v[72:75], a[168:171], v[196:199], v[72:75]
  v_exp_f32 v185, v185
  v_mfma_f32_16x16x32_bf16 v[76:79], a[172:175], v[196:199], v[76:79]
  v_cvt_pk_bf16_f32 v204, v184, v185
  v_mfma_f32_16x16x32_bf16 v[80:83], a[176:179], v[196:199], v[80:83]
  v_exp_f32 v186, v186
  v_mfma_f32_16x16x32_bf16 v[84:87], a[180:183], v[196:199], v[84:87]
  v_mfma_f32_16x16x32_bf16 v[88:91], a[184:187], v[196:199], v[88:91]
  v_exp_f32 v187, v187
  v_mfma_f32_16x16x32_bf16 v[92:95], a[188:191], v[196:199], v[92:95]
  s_waitcnt lgkmcnt(0)
  v_cvt_pk_bf16_f32 v205, v186, v187
  v_mfma_f32_16x16x32_bf16 a[196:199], a[208:211], v[196:199], a[196:199]
  s_mov_b32 s34, 3
  s_branch L_loop

.section .rodata,"a"
.p2align 6
.amdhsa_kernel standalone__mha_block_cached__near_ridge_kernel
  .amdhsa_next_free_vgpr 512
  .amdhsa_next_free_sgpr 102
  .amdhsa_accum_offset 256
  .amdhsa_group_segment_fixed_size 0
  .amdhsa_kernarg_size 64
  .amdhsa_user_sgpr_count 2
  .amdhsa_user_sgpr_kernarg_segment_ptr 1
  .amdhsa_system_sgpr_workgroup_id_x 1
.end_amdhsa_kernel
```
